```python
import torch

def _softmax(x, axis=-1):
    return torch.softmax(x, dim=axis)
def _gelu(x):
    return torch.nn.functional.gelu(x, approximate="tanh")
def _silu(x):
    return torch.nn.functional.silu(x)
def _sigmoid(x):
    return torch.sigmoid(x)
def _layernorm(x, axis=-1, eps=1e-5):
    m = x.mean(dim=axis, keepdim=True)
    v = x.var(dim=axis, keepdim=True, unbiased=False)
    return (x - m) / torch.sqrt(v + eps)
def _scatter_add(tgt, idx, src, axis=0):
    return tgt.clone().index_add_(axis, idx, src)
def _segment_sum(src, seg, n):
    out = torch.zeros((n,) + src.shape[1:], dtype=src.dtype)
    return out.index_add_(0, seg, src)
def _pad(x, pw):
    flat = tuple(v for pair in reversed(pw) for v in pair)
    return torch.nn.functional.pad(x, flat)

kernel_name = 'concat_heads__gqa_block_cached__gqa_block_cached__near_ridge'

def setup_inputs():

    _w = (lambda a: (lambda t: t.to(torch.bfloat16) if t.is_floating_point() else t)(torch.as_tensor(a)))
    def _A_setup():
        B, Sq, D = 16, 96, 512
        Hq, Hkv, Sk, Dh = 32, 32, 512, 128
        assert Hq % Hkv == 0, (Hq, Hkv)
        return {
            "x": _w((lambda *s: torch.randn(*s, dtype=torch.bfloat16) * 0.8)(B, Sq, D)),
            "k_cache": _w((lambda *s: torch.randn(*s, dtype=torch.bfloat16) * 0.8)(B, Hkv, Sk, Dh)),
            "v_cache": _w((lambda *s: torch.randn(*s, dtype=torch.bfloat16) * 0.05)(B, Hkv, Sk, Dh)),
            "wq": _w((lambda *s: torch.randn(*s, dtype=torch.bfloat16) * 0.8)(D, Hq * Dh) * (D ** -0.5)),
            "wo": _w((lambda *s: torch.randn(*s, dtype=torch.bfloat16) * 0.05)(Hq * Dh, D) * ((Hq * Dh) ** -0.5)),
        }
    _A_in = _A_setup()

    def _B_setup():
        B, Sq, D = 16, 96, 512
        Hq, Hkv, Sk, Dh = 32, 32, 512, 128
        assert Hq % Hkv == 0, (Hq, Hkv)
        return {
            "x": _w((lambda *s: torch.randn(*s, dtype=torch.bfloat16) * 0.8)(B, Sq, D)),
            "k_cache": _w((lambda *s: torch.randn(*s, dtype=torch.bfloat16) * 0.8)(B, Hkv, Sk, Dh)),
            "v_cache": _w((lambda *s: torch.randn(*s, dtype=torch.bfloat16) * 0.05)(B, Hkv, Sk, Dh)),
            "wq": _w((lambda *s: torch.randn(*s, dtype=torch.bfloat16) * 0.8)(D, Hq * Dh) * (D ** -0.5)),
            "wo": _w((lambda *s: torch.randn(*s, dtype=torch.bfloat16) * 0.05)(Hq * Dh, D) * ((Hq * Dh) ** -0.5)),
        }
    _B_in = _B_setup()

    return {
        "A_x": _A_in["x"],
        "A_k_cache": _A_in["k_cache"],
        "A_v_cache": _A_in["v_cache"],
        "A_wq": _A_in["wq"],
        "A_wo": _A_in["wo"],
        "B_x": _B_in["x"],
        "B_k_cache": _B_in["k_cache"],
        "B_v_cache": _B_in["v_cache"],
        "B_wq": _B_in["wq"],
        "B_wo": _B_in["wo"],
    }

def reference(A_x, A_k_cache, A_v_cache, A_wq, A_wo, B_x, B_k_cache, B_v_cache, B_wq, B_wo):
    def _A_ref(x, k_cache, v_cache, wq, wo):
        B, Sq, D = x.shape
        Hq, Dh = 32, 128
        Hkv = k_cache.shape[1]
        rep = Hq // Hkv
        q = (lambda x, *d: x.permute(*d))((x @ wq).reshape(B, Sq, Hq, Dh), 0, 2, 1, 3)
        k = (lambda x, n, axis: torch.repeat_interleave(x, n, dim=axis))(k_cache, rep, axis=1)
        v = (lambda x, n, axis: torch.repeat_interleave(x, n, dim=axis))(v_cache, rep, axis=1)
        scores = torch.einsum("bhqd,bhkd->bhqk", q, k) * (Dh ** -0.5)
        p = _softmax(scores, axis=-1)
        o = torch.einsum("bhqk,bhkd->bhqd", p, v)
        return (lambda x, *d: x.permute(*d))(o, 0, 2, 1, 3).reshape(B, Sq, Hq * Dh) @ wo

    def _B_ref(x, k_cache, v_cache, wq, wo):
        B, Sq, D = x.shape
        Hq, Dh = 32, 128
        Hkv = k_cache.shape[1]
        rep = Hq // Hkv
        q = (lambda x, *d: x.permute(*d))((x @ wq).reshape(B, Sq, Hq, Dh), 0, 2, 1, 3)
        k = (lambda x, n, axis: torch.repeat_interleave(x, n, dim=axis))(k_cache, rep, axis=1)
        v = (lambda x, n, axis: torch.repeat_interleave(x, n, dim=axis))(v_cache, rep, axis=1)
        scores = torch.einsum("bhqd,bhkd->bhqk", q, k) * (Dh ** -0.5)
        p = _softmax(scores, axis=-1)
        o = torch.einsum("bhqk,bhkd->bhqd", p, v)
        return (lambda x, *d: x.permute(*d))(o, 0, 2, 1, 3).reshape(B, Sq, Hq * Dh) @ wo

    a = _A_ref(A_x, A_k_cache, A_v_cache, A_wq, A_wo)
    b = _B_ref(B_x, B_k_cache, B_v_cache, B_wq, B_wo)
    return torch.concatenate([a, b], axis=-1)
```

```asm
; @launch grid=(256,1,1) block=(256,1,1) lds=157760
.amdgcn_target "amdgcn-amd-amdhsa--gfx950"
.text
.globl concat_heads__gqa_block_cached__gqa_block_cached__near_ridge_kernel
.p2align 8
.type concat_heads__gqa_block_cached__gqa_block_cached__near_ridge_kernel,@function
concat_heads__gqa_block_cached__gqa_block_cached__near_ridge_kernel:
  s_cmp_ge_u32 s2, 256
  s_cbranch_scc1 L_done
  s_load_dwordx16 s[36:51], s[0:1], 0
  s_load_dwordx8 s[52:59], s[0:1], 64
  s_load_dwordx2 s[28:29], s[0:1], 96
  s_getpc_b64 s[8:9]
L_pc:
  s_bfe_u32 s3, s2, 0x50003
  s_lshl_b32 s3, s3, 12
  s_mov_b32 s10, (L_code_end - L_pc) & 0xffffffc0
  s_mov_b32 s11, 0x20000
  v_lshlrev_b32 v2, 4, v0
  buffer_load_dwordx4 v[176:179], v2, s[8:11], s3 offen
  s_bfe_u32 s62, s2, 0x10002
  s_bfe_u32 s61, s2, 262148
  s_and_b32 s60, s2, 3
  s_lshl_b32 s60, s60, 1
  s_bfe_u32 s67, s2, 65539
  s_add_u32 s60, s60, s67
  s_lshl_b32 s3, s62, 4
  s_add_u32 s3, s3, s61
  v_lshrrev_b32 v1, 6, v0
  v_and_b32 v100, 63, v0
  v_readfirstlane_b32 s63, v1
  s_mov_b32 s65, 0x3e0293ee
  s_lshl_b32 s93, s60, 19
  s_mov_b32 s64, 0
  s_mov_b32 s30, 0x1802000
  s_mov_b32 s31, 0x20000
  s_cmp_eq_u32 s62, 0
  s_waitcnt lgkmcnt(0)
  s_cselect_b32 s8, s38, s48
  s_cselect_b32 s9, s39, s49
  s_mov_b32 s10, 0x4000000
  s_mov_b32 s11, 0x20000
  s_cselect_b32 s12, s40, s50
  s_cselect_b32 s13, s41, s51
  s_mov_b32 s14, 0x4000000
  s_mov_b32 s15, 0x20000
  s_cselect_b32 s16, s42, s52
  s_cselect_b32 s17, s43, s53
  s_mov_b32 s18, 0x400000
  s_mov_b32 s19, 0x20000
  s_cselect_b32 s24, s36, s46
  s_cselect_b32 s25, s37, s47
  s_mov_b32 s26, 0x180000
  s_mov_b32 s27, 0x20000
  s_cselect_b32 s20, s44, s54
  s_cselect_b32 s21, s45, s55
  s_mov_b32 s22, 0x400000
  s_mov_b32 s23, 0x20000
  s_mov_b32 s32, s56
  s_mov_b32 s33, s57
  s_mov_b32 s34, 0x300000
  s_mov_b32 s35, 0x20000
  s_mov_b32 s4, s58
  s_mov_b32 s5, s59
  s_mov_b32 s6, 256
  s_mov_b32 s7, 0x20000
  s_and_b32 s67, s61, 3
  s_bfe_u32 s52, s61, 131074
  s_lshl_b32 s48, s67, 17
  s_lshl_b32 s50, s67, 8
  s_lshl_b32 s68, s52, 20
  s_or_b32 s50, s50, s68
  s_lshl_b32 s51, s52, 8
  s_and_b32 s52, s52, 2
  s_lshl_b32 s68, s52, 15
  s_or_b32 s49, s48, s68
  s_cmp_eq_u32 s63, 3
  s_cbranch_scc1 L_loader
  v_bfe_u32 v224, v100, 4, 1
  v_lshlrev_b32 v224, 1, v224
  v_and_b32 v225, 7, v100
  v_xor_b32 v224, v224, v225
  v_lshlrev_b32 v224, 4, v224
  v_lshrrev_b32 v225, 3, v100
  v_lshl_add_u32 v76, v225, 13, v224
  v_xor_b32 v77, 64, v76
  v_lshrrev_b32 v224, 4, v100
  v_and_b32 v225, 7, v100
  v_xor_b32 v224, v224, v225
  v_lshlrev_b32 v224, 4, v224
  v_lshrrev_b32 v225, 3, v100
  v_lshl_add_u32 v78, v225, 10, v224
  v_xor_b32 v79, 64, v78
  s_mul_i32 s90, s61, 96
  s_lshl_b32 s67, s63, 5
  s_add_u32 s90, s90, s67
  s_lshl_b32 s90, s90, 10
  s_or_b32 s90, s90, s51
  s_mul_i32 s69, s63, 6
  s_lshl_b32 s91, s60, 10
  s_or_b32 s91, s91, s50
  s_add_u32 s67, s69, 0
  s_min_u32 s67, s67, 14
  s_lshl_b32 s74, s67, 10
  s_and_b32 s68, s67, 7
  s_lshl_b32 s68, s68, 16
  s_lshr_b32 s67, s67, 3
  s_lshl_b32 s67, s67, 7
  s_or_b32 s68, s68, s67
  s_or_b32 s80, s68, s91
  s_add_u32 s67, s69, 1
  s_min_u32 s67, s67, 15
  s_lshl_b32 s75, s67, 10
  s_and_b32 s68, s67, 7
  s_lshl_b32 s68, s68, 16
  s_lshr_b32 s67, s67, 3
  s_lshl_b32 s67, s67, 7
  s_or_b32 s68, s68, s67
  s_or_b32 s81, s68, s91
  s_add_u32 s67, s69, 2
  s_min_u32 s67, s67, 14
  s_lshl_b32 s76, s67, 10
  s_and_b32 s68, s67, 7
  s_lshl_b32 s68, s68, 16
  s_lshr_b32 s67, s67, 3
  s_lshl_b32 s67, s67, 7
  s_or_b32 s68, s68, s67
  s_or_b32 s82, s68, s91
  s_add_u32 s67, s69, 3
  s_min_u32 s67, s67, 15
  s_lshl_b32 s77, s67, 10
  s_and_b32 s68, s67, 7
  s_lshl_b32 s68, s68, 16
  s_lshr_b32 s67, s67, 3
  s_lshl_b32 s67, s67, 7
  s_or_b32 s68, s68, s67
  s_or_b32 s83, s68, s91
  s_add_u32 s67, s69, 4
  s_min_u32 s67, s67, 14
  s_lshl_b32 s78, s67, 10
  s_and_b32 s68, s67, 7
  s_lshl_b32 s68, s68, 16
  s_lshr_b32 s67, s67, 3
  s_lshl_b32 s67, s67, 7
  s_or_b32 s68, s68, s67
  s_or_b32 s84, s68, s91
  s_add_u32 s67, s69, 5
  s_min_u32 s67, s67, 15
  s_lshl_b32 s79, s67, 10
  s_and_b32 s68, s67, 7
  s_lshl_b32 s68, s68, 16
  s_lshr_b32 s67, s67, 3
  s_lshl_b32 s67, s67, 7
  s_or_b32 s68, s68, s67
  s_or_b32 s85, s68, s91
  s_lshl_b32 s91, s63, 12
  v_lshrrev_b32 v64, 4, v100
  v_lshlrev_b32 v64, 10, v64
  v_bfe_u32 v224, v100, 2, 2
  v_lshl_add_u32 v64, v224, 7, v64
  v_bfe_u32 v224, v100, 3, 2
  v_lshl_add_u32 v64, v224, 5, v64
  v_and_b32 v224, 3, v100
  v_lshl_add_u32 v64, v224, 3, v64
  v_add_u32 v64, 17408, v64
  v_xor_b32 v65, 32, v64
  v_xor_b32 v66, 64, v64
  v_xor_b32 v67, 96, v64
  v_add_u32 v68, 82944, v64
  v_add_u32 v69, 82944, v65
  v_add_u32 v70, 82944, v66
  v_add_u32 v71, 82944, v67
  s_add_u32 s67, s91, 34816
  v_bfe_u32 v224, v100, 1, 3
  v_lshrrev_b32 v225, 4, v100
  v_xor_b32 v224, v224, v225
  v_lshlrev_b32 v224, 4, v224
  v_and_b32 v225, 15, v100
  v_lshl_add_u32 v72, v225, 7, v224
  v_add_u32 v72, s67, v72
  v_xor_b32 v73, 64, v72
  v_add_u32 v74, 98304, v72
  v_add_u32 v75, 98304, v73
  v_bfe_u32 v224, v100, 4, 1
  v_lshrrev_b32 v225, 5, v100
  v_lshl_add_u32 v225, v224, 1, v225
  v_and_b32 v224, 3, v100
  v_xor_b32 v225, v224, v225
  v_lshlrev_b32 v225, 4, v225
  v_lshl_add_u32 v225, v224, 8, v225
  v_bfe_u32 v224, v100, 2, 2
  v_mul_u32_u24 v224, 1088, v224
  v_add_u32 v228, v224, v225
  v_lshrrev_b32 v229, 2, v100
  v_lshlrev_b32 v229, 8, v229
  v_bfe_u32 v224, v100, 2, 3
  v_lshl_add_u32 v229, v224, 5, v229
  v_and_b32 v224, 3, v100
  v_lshl_add_u32 v229, v224, 3, v229
  v_add_u32 v229, 34816, v229
  s_lshl_b32 s67, s52, 6
  v_xor_b32 v229, s67, v229
  v_xor_b32 v230, 32, v229
  v_xor_b32 v231, 64, v229
  v_xor_b32 v232, 96, v229
  v_xor_b32 v233, 128, v229
  v_xor_b32 v234, 160, v229
  v_xor_b32 v235, 192, v229
  v_xor_b32 v236, 224, v229
  s_lshl_b32 s67, s63, 13
  s_add_u32 s67, s67, 0x20800
  v_lshlrev_b32 v237, 4, v100
  v_add_u32 v237, s67, v237
  v_add_u32 v250, 50176, v64
  v_add_u32 v251, 50176, v65
  v_add_u32 v252, 50176, v66
  v_add_u32 v253, 50176, v67
  s_lshl_b32 s92, s3, 3
  s_add_u32 s92, s92, s60
  s_mul_i32 s92, s92, 3
  s_add_u32 s92, s92, s63
  s_lshl_b32 s92, s92, 15
  s_mov_b32 s94, 0x47800000
  s_mov_b32 s66, 0
  s_mov_b32 s40, 0x37800000
  v_accvgpr_write_b32 a128, 0
  v_accvgpr_write_b32 a129, 0
  v_accvgpr_write_b32 a130, 0
  v_accvgpr_write_b32 a131, 0
  v_accvgpr_write_b32 a132, 0
  v_accvgpr_write_b32 a133, 0
  v_accvgpr_write_b32 a134, 0
  v_accvgpr_write_b32 a135, 0
  v_accvgpr_write_b32 a136, 0
  v_accvgpr_write_b32 a137, 0
  v_accvgpr_write_b32 a138, 0
  v_accvgpr_write_b32 a139, 0
  v_accvgpr_write_b32 a140, 0
  v_accvgpr_write_b32 a141, 0
  v_accvgpr_write_b32 a142, 0
  v_accvgpr_write_b32 a143, 0
  v_accvgpr_write_b32 a144, 0
  v_accvgpr_write_b32 a145, 0
  v_accvgpr_write_b32 a146, 0
  v_accvgpr_write_b32 a147, 0
  v_accvgpr_write_b32 a148, 0
  v_accvgpr_write_b32 a149, 0
  v_accvgpr_write_b32 a150, 0
  v_accvgpr_write_b32 a151, 0
  v_accvgpr_write_b32 a152, 0
  v_accvgpr_write_b32 a153, 0
  v_accvgpr_write_b32 a154, 0
  v_accvgpr_write_b32 a155, 0
  v_accvgpr_write_b32 a156, 0
  v_accvgpr_write_b32 a157, 0
  v_accvgpr_write_b32 a158, 0
  v_accvgpr_write_b32 a159, 0
  v_accvgpr_write_b32 a160, 0
  v_accvgpr_write_b32 a161, 0
  v_accvgpr_write_b32 a162, 0
  v_accvgpr_write_b32 a163, 0
  v_accvgpr_write_b32 a164, 0
  v_accvgpr_write_b32 a165, 0
  v_accvgpr_write_b32 a166, 0
  v_accvgpr_write_b32 a167, 0
  v_accvgpr_write_b32 a168, 0
  v_accvgpr_write_b32 a169, 0
  v_accvgpr_write_b32 a170, 0
  v_accvgpr_write_b32 a171, 0
  v_accvgpr_write_b32 a172, 0
  v_accvgpr_write_b32 a173, 0
  v_accvgpr_write_b32 a174, 0
  v_accvgpr_write_b32 a175, 0
  v_accvgpr_write_b32 a176, 0
  v_accvgpr_write_b32 a177, 0
  v_accvgpr_write_b32 a178, 0
  v_accvgpr_write_b32 a179, 0
  v_accvgpr_write_b32 a180, 0
  v_accvgpr_write_b32 a181, 0
  v_accvgpr_write_b32 a182, 0
  v_accvgpr_write_b32 a183, 0
  v_accvgpr_write_b32 a184, 0
  v_accvgpr_write_b32 a185, 0
  v_accvgpr_write_b32 a186, 0
  v_accvgpr_write_b32 a187, 0
  v_accvgpr_write_b32 a188, 0
  v_accvgpr_write_b32 a189, 0
  v_accvgpr_write_b32 a190, 0
  v_accvgpr_write_b32 a191, 0
  v_accvgpr_write_b32 a192, 0
  v_accvgpr_write_b32 a193, 0
  v_accvgpr_write_b32 a194, 0
  v_accvgpr_write_b32 a195, 0
  v_accvgpr_write_b32 a196, 0
  v_accvgpr_write_b32 a197, 0
  v_accvgpr_write_b32 a198, 0
  v_accvgpr_write_b32 a199, 0
  v_accvgpr_write_b32 a200, 0
  v_accvgpr_write_b32 a201, 0
  v_accvgpr_write_b32 a202, 0
  v_accvgpr_write_b32 a203, 0
  v_accvgpr_write_b32 a204, 0
  v_accvgpr_write_b32 a205, 0
  v_accvgpr_write_b32 a206, 0
  v_accvgpr_write_b32 a207, 0
  v_accvgpr_write_b32 a208, 0
  v_accvgpr_write_b32 a209, 0
  v_accvgpr_write_b32 a210, 0
  v_accvgpr_write_b32 a211, 0
  v_accvgpr_write_b32 a212, 0
  v_accvgpr_write_b32 a213, 0
  v_accvgpr_write_b32 a214, 0
  v_accvgpr_write_b32 a215, 0
  v_accvgpr_write_b32 a216, 0
  v_accvgpr_write_b32 a217, 0
  v_accvgpr_write_b32 a218, 0
  v_accvgpr_write_b32 a219, 0
  v_accvgpr_write_b32 a220, 0
  v_accvgpr_write_b32 a221, 0
  v_accvgpr_write_b32 a222, 0
  v_accvgpr_write_b32 a223, 0
  v_accvgpr_write_b32 a224, 0
  v_accvgpr_write_b32 a225, 0
  v_accvgpr_write_b32 a226, 0
  v_accvgpr_write_b32 a227, 0
  v_accvgpr_write_b32 a228, 0
  v_accvgpr_write_b32 a229, 0
  v_accvgpr_write_b32 a230, 0
  v_accvgpr_write_b32 a231, 0
  v_accvgpr_write_b32 a232, 0
  v_accvgpr_write_b32 a233, 0
  v_accvgpr_write_b32 a234, 0
  v_accvgpr_write_b32 a235, 0
  v_accvgpr_write_b32 a236, 0
  v_accvgpr_write_b32 a237, 0
  v_accvgpr_write_b32 a238, 0
  v_accvgpr_write_b32 a239, 0
  v_mov_b32 v168, 0
  v_mov_b32 v169, 0
  v_mov_b32 v170, 0
  v_mov_b32 v171, 0
  v_mov_b32 v172, 0
  v_mov_b32 v173, 0
  v_mov_b32 v174, 0
  v_mov_b32 v175, 0
  s_add_u32 m0, s91, 133120
  s_xor_b32 s67, s90, 256
  buffer_load_dwordx4 v78, s[24:27], s67 offen lds
  s_add_u32 m0, s91, 134144
  s_xor_b32 s67, s90, 8448
  buffer_load_dwordx4 v79, s[24:27], s67 offen lds
  s_add_u32 m0, s91, 135168
  s_xor_b32 s67, s90, 16640
  buffer_load_dwordx4 v78, s[24:27], s67 offen lds
  s_add_u32 m0, s91, 136192
  s_xor_b32 s67, s90, 24832
  buffer_load_dwordx4 v79, s[24:27], s67 offen lds
  s_add_u32 m0, s74, 17408
  s_xor_b32 s67, s80, 1048576
  buffer_load_dwordx4 v76, s[16:19], s67 offen lds
  s_add_u32 m0, s75, 17408
  s_xor_b32 s67, s81, 1048576
  buffer_load_dwordx4 v77, s[16:19], s67 offen lds
  s_add_u32 m0, s76, 17408
  s_xor_b32 s67, s82, 1048576
  buffer_load_dwordx4 v76, s[16:19], s67 offen lds
  s_add_u32 m0, s77, 17408
  s_xor_b32 s67, s83, 1048576
  buffer_load_dwordx4 v77, s[16:19], s67 offen lds
  s_add_u32 m0, s78, 17408
  s_xor_b32 s67, s84, 1048576
  buffer_load_dwordx4 v76, s[16:19], s67 offen lds
  s_add_u32 m0, s79, 17408
  s_xor_b32 s67, s85, 1048576
  buffer_load_dwordx4 v77, s[16:19], s67 offen lds
  s_add_u32 m0, s91, 145408
  s_xor_b32 s67, s90, 384
  buffer_load_dwordx4 v78, s[24:27], s67 offen lds
  s_add_u32 m0, s91, 146432
  s_xor_b32 s67, s90, 8576
  buffer_load_dwordx4 v79, s[24:27], s67 offen lds
  s_add_u32 m0, s91, 147456
  s_xor_b32 s67, s90, 16768
  buffer_load_dwordx4 v78, s[24:27], s67 offen lds
  s_add_u32 m0, s91, 148480
  s_xor_b32 s67, s90, 24960
  buffer_load_dwordx4 v79, s[24:27], s67 offen lds
  s_add_u32 m0, s74, 116736
  s_xor_b32 s67, s80, 1572864
  buffer_load_dwordx4 v76, s[16:19], s67 offen lds
  s_add_u32 m0, s75, 116736
  s_xor_b32 s67, s81, 1572864
  buffer_load_dwordx4 v77, s[16:19], s67 offen lds
  s_add_u32 m0, s76, 116736
  s_xor_b32 s67, s82, 1572864
  buffer_load_dwordx4 v76, s[16:19], s67 offen lds
  s_add_u32 m0, s77, 116736
  s_xor_b32 s67, s83, 1572864
  buffer_load_dwordx4 v77, s[16:19], s67 offen lds
  s_add_u32 m0, s78, 116736
  s_xor_b32 s67, s84, 1572864
  buffer_load_dwordx4 v76, s[16:19], s67 offen lds
  s_add_u32 m0, s79, 116736
  s_xor_b32 s67, s85, 1572864
  buffer_load_dwordx4 v77, s[16:19], s67 offen lds
  s_barrier
  ds_read_b128 a[0:3], v72 offset:0
  ds_read_b128 a[4:7], v72 offset:2048
  ds_read_b64_tr_b16 v[192:193], v64 offset:50176
  ds_read_b64_tr_b16 v[194:195], v64 offset:50688
  ds_read_b64_tr_b16 v[196:197], v65 offset:50176
  ds_read_b64_tr_b16 v[198:199], v65 offset:50688
  ds_read_b64_tr_b16 v[200:201], v66 offset:50176
  ds_read_b64_tr_b16 v[202:203], v66 offset:50688
  ds_read_b64_tr_b16 v[204:205], v67 offset:50176
  ds_read_b64_tr_b16 v[206:207], v67 offset:50688
  ds_read_b64_tr_b16 v[208:209], v64 offset:58368
  ds_read_b64_tr_b16 v[210:211], v64 offset:58880
  ds_read_b64_tr_b16 v[212:213], v65 offset:58368
  ds_read_b64_tr_b16 v[214:215], v65 offset:58880
  ds_read_b64_tr_b16 v[216:217], v66 offset:58368
  s_waitcnt lgkmcnt(14)
  ds_read_b64_tr_b16 v[218:219], v66 offset:58880
  s_waitcnt lgkmcnt(10)
  v_mfma_f32_16x16x32_bf16 v[0:3], v[192:195], a[0:3], 0
  ds_read_b64_tr_b16 v[220:221], v67 offset:58368
  v_mfma_f32_16x16x32_bf16 v[4:7], v[192:195], a[4:7], 0
  ds_read_b64_tr_b16 v[222:223], v67 offset:58880
  v_mfma_f32_16x16x32_bf16 v[8:11], v[196:199], a[0:3], 0
  ds_read_b128 a[8:11], v73 offset:0
  ds_read_b128 a[12:15], v73 offset:2048
  v_mfma_f32_16x16x32_bf16 v[12:15], v[196:199], a[4:7], 0
  ds_read_b64_tr_b16 v[192:193], v64 offset:54272
  s_waitcnt lgkmcnt(14)
  ds_read_b64_tr_b16 v[194:195], v64 offset:54784
  s_waitcnt lgkmcnt(12)
  v_mfma_f32_16x16x32_bf16 v[16:19], v[200:203], a[0:3], 0
  ds_read_b64_tr_b16 v[196:197], v65 offset:54272
  v_mfma_f32_16x16x32_bf16 v[20:23], v[200:203], a[4:7], 0
  ds_read_b64_tr_b16 v[198:199], v65 offset:54784
  v_mfma_f32_16x16x32_bf16 v[24:27], v[204:207], a[0:3], 0
  ds_read_b64_tr_b16 v[200:201], v66 offset:54272
  v_mfma_f32_16x16x32_bf16 v[28:31], v[204:207], a[4:7], 0
  s_waitcnt lgkmcnt(14)
  ds_read_b64_tr_b16 v[202:203], v66 offset:54784
  s_waitcnt lgkmcnt(12)
  v_mfma_f32_16x16x32_bf16 v[32:35], v[208:211], a[0:3], 0
  ds_read_b64_tr_b16 v[204:205], v67 offset:54272
  v_mfma_f32_16x16x32_bf16 v[36:39], v[208:211], a[4:7], 0
  ds_read_b64_tr_b16 v[206:207], v67 offset:54784
  v_mfma_f32_16x16x32_bf16 v[40:43], v[212:215], a[0:3], 0
  ds_read_b64_tr_b16 v[208:209], v64 offset:62464
  v_mfma_f32_16x16x32_bf16 v[44:47], v[212:215], a[4:7], 0
  s_waitcnt lgkmcnt(14)
  ds_read_b64_tr_b16 v[210:211], v64 offset:62976
  s_waitcnt lgkmcnt(12)
  v_mfma_f32_16x16x32_bf16 v[48:51], v[216:219], a[0:3], 0
  ds_read_b64_tr_b16 v[212:213], v65 offset:62464
  v_mfma_f32_16x16x32_bf16 v[52:55], v[216:219], a[4:7], 0
  ds_read_b64_tr_b16 v[214:215], v65 offset:62976
  v_mfma_f32_16x16x32_bf16 v[56:59], v[220:223], a[0:3], 0
  ds_read_b64_tr_b16 v[216:217], v66 offset:62464
  v_mfma_f32_16x16x32_bf16 v[60:63], v[220:223], a[4:7], 0
  s_waitcnt lgkmcnt(14)
  ds_read_b64_tr_b16 v[218:219], v66 offset:62976
  s_waitcnt lgkmcnt(10)
  v_mfma_f32_16x16x32_bf16 v[0:3], v[192:195], a[8:11], v[0:3]
  ds_read_b64_tr_b16 v[220:221], v67 offset:62464
  v_mfma_f32_16x16x32_bf16 v[4:7], v[192:195], a[12:15], v[4:7]
  ds_read_b64_tr_b16 v[222:223], v67 offset:62976
  v_mfma_f32_16x16x32_bf16 v[8:11], v[196:199], a[8:11], v[8:11]
  v_mfma_f32_16x16x32_bf16 v[12:15], v[196:199], a[12:15], v[12:15]
  s_waitcnt lgkmcnt(8)
  v_mfma_f32_16x16x32_bf16 v[16:19], v[200:203], a[8:11], v[16:19]
  v_mfma_f32_16x16x32_bf16 v[20:23], v[200:203], a[12:15], v[20:23]
  v_mfma_f32_16x16x32_bf16 v[24:27], v[204:207], a[8:11], v[24:27]
  v_mfma_f32_16x16x32_bf16 v[28:31], v[204:207], a[12:15], v[28:31]
  s_waitcnt lgkmcnt(0)
  s_barrier
  ds_read_b128 a[16:19], v72 offset:12288
  ds_read_b128 a[20:23], v72 offset:14336
  ds_read_b64_tr_b16 v[192:193], v68 offset:0
  ds_read_b64_tr_b16 v[194:195], v68 offset:512
  ds_read_b64_tr_b16 v[196:197], v69 offset:0
  ds_read_b64_tr_b16 v[198:199], v69 offset:512
  ds_read_b64_tr_b16 v[200:201], v70 offset:0
  ds_read_b64_tr_b16 v[202:203], v70 offset:512
  ds_read_b64_tr_b16 v[204:205], v71 offset:0
  ds_read_b64_tr_b16 v[206:207], v71 offset:512
  v_mfma_f32_16x16x32_bf16 v[32:35], v[208:211], a[8:11], v[32:35]
  v_mfma_f32_16x16x32_bf16 v[36:39], v[208:211], a[12:15], v[36:39]
  ds_read_b64_tr_b16 v[208:209], v68 offset:8192
  ds_read_b64_tr_b16 v[210:211], v68 offset:8704
  v_mfma_f32_16x16x32_bf16 v[40:43], v[212:215], a[8:11], v[40:43]
  v_mfma_f32_16x16x32_bf16 v[44:47], v[212:215], a[12:15], v[44:47]
  ds_read_b64_tr_b16 v[212:213], v69 offset:8192
  ds_read_b64_tr_b16 v[214:215], v69 offset:8704
  v_mfma_f32_16x16x32_bf16 v[48:51], v[216:219], a[8:11], v[48:51]
  v_mfma_f32_16x16x32_bf16 v[52:55], v[216:219], a[12:15], v[52:55]
  ds_read_b64_tr_b16 v[216:217], v70 offset:8192
  s_waitcnt lgkmcnt(14)
  ds_read_b64_tr_b16 v[218:219], v70 offset:8704
  v_mfma_f32_16x16x32_bf16 v[56:59], v[220:223], a[8:11], v[56:59]
  v_mfma_f32_16x16x32_bf16 v[60:63], v[220:223], a[12:15], v[60:63]
  s_waitcnt lgkmcnt(10)
  v_mfma_f32_16x16x32_bf16 v[0:3], v[192:195], a[16:19], v[0:3]
  ds_read_b64_tr_b16 v[220:221], v71 offset:8192
  v_mfma_f32_16x16x32_bf16 v[4:7], v[192:195], a[20:23], v[4:7]
  ds_read_b64_tr_b16 v[222:223], v71 offset:8704
  v_mfma_f32_16x16x32_bf16 v[8:11], v[196:199], a[16:19], v[8:11]
  ds_read_b128 a[24:27], v73 offset:12288
  ds_read_b128 a[28:31], v73 offset:14336
  v_mfma_f32_16x16x32_bf16 v[12:15], v[196:199], a[20:23], v[12:15]
  ds_read_b64_tr_b16 v[192:193], v68 offset:4096
  s_waitcnt lgkmcnt(14)
  ds_read_b64_tr_b16 v[194:195], v68 offset:4608
  s_waitcnt lgkmcnt(12)
  v_mfma_f32_16x16x32_bf16 v[16:19], v[200:203], a[16:19], v[16:19]
  ds_read_b64_tr_b16 v[196:197], v69 offset:4096
  v_mfma_f32_16x16x32_bf16 v[20:23], v[200:203], a[20:23], v[20:23]
  ds_read_b64_tr_b16 v[198:199], v69 offset:4608
  v_mfma_f32_16x16x32_bf16 v[24:27], v[204:207], a[16:19], v[24:27]
  ds_read_b64_tr_b16 v[200:201], v70 offset:4096
  v_mfma_f32_16x16x32_bf16 v[28:31], v[204:207], a[20:23], v[28:31]
  s_waitcnt lgkmcnt(14)
  ds_read_b64_tr_b16 v[202:203], v70 offset:4608
  s_waitcnt lgkmcnt(12)
  v_mfma_f32_16x16x32_bf16 v[32:35], v[208:211], a[16:19], v[32:35]
  ds_read_b64_tr_b16 v[204:205], v71 offset:4096
  v_mfma_f32_16x16x32_bf16 v[36:39], v[208:211], a[20:23], v[36:39]
  ds_read_b64_tr_b16 v[206:207], v71 offset:4608
  v_mfma_f32_16x16x32_bf16 v[40:43], v[212:215], a[16:19], v[40:43]
  ds_read_b64_tr_b16 v[208:209], v68 offset:12288
  v_mfma_f32_16x16x32_bf16 v[44:47], v[212:215], a[20:23], v[44:47]
  s_waitcnt lgkmcnt(14)
  ds_read_b64_tr_b16 v[210:211], v68 offset:12800
  s_waitcnt lgkmcnt(12)
  v_mfma_f32_16x16x32_bf16 v[48:51], v[216:219], a[16:19], v[48:51]
  ds_read_b64_tr_b16 v[212:213], v69 offset:12288
  v_mfma_f32_16x16x32_bf16 v[52:55], v[216:219], a[20:23], v[52:55]
  ds_read_b64_tr_b16 v[214:215], v69 offset:12800
  v_mfma_f32_16x16x32_bf16 v[56:59], v[220:223], a[16:19], v[56:59]
  ds_read_b64_tr_b16 v[216:217], v70 offset:12288
  v_mfma_f32_16x16x32_bf16 v[60:63], v[220:223], a[20:23], v[60:63]
  s_waitcnt lgkmcnt(14)
  ds_read_b64_tr_b16 v[218:219], v70 offset:12800
  s_waitcnt lgkmcnt(10)
  v_mfma_f32_16x16x32_bf16 v[0:3], v[192:195], a[24:27], v[0:3]
  ds_read_b64_tr_b16 v[220:221], v71 offset:12288
  v_mfma_f32_16x16x32_bf16 v[4:7], v[192:195], a[28:31], v[4:7]
  ds_read_b64_tr_b16 v[222:223], v71 offset:12800
  v_mfma_f32_16x16x32_bf16 v[8:11], v[196:199], a[24:27], v[8:11]
  v_mfma_f32_16x16x32_bf16 v[12:15], v[196:199], a[28:31], v[12:15]
  s_waitcnt lgkmcnt(8)
  v_mfma_f32_16x16x32_bf16 v[16:19], v[200:203], a[24:27], v[16:19]
  v_mfma_f32_16x16x32_bf16 v[20:23], v[200:203], a[28:31], v[20:23]
  v_mfma_f32_16x16x32_bf16 v[24:27], v[204:207], a[24:27], v[24:27]
  v_mfma_f32_16x16x32_bf16 v[28:31], v[204:207], a[28:31], v[28:31]
  s_waitcnt vmcnt(10) lgkmcnt(0)
  s_barrier
  ds_read_b128 a[32:35], v74 offset:0
  ds_read_b128 a[36:39], v74 offset:2048
  ds_read_b64_tr_b16 v[192:193], v64 offset:0
  ds_read_b64_tr_b16 v[194:195], v64 offset:512
  ds_read_b64_tr_b16 v[196:197], v65 offset:0
  ds_read_b64_tr_b16 v[198:199], v65 offset:512
  ds_read_b64_tr_b16 v[200:201], v66 offset:0
  ds_read_b64_tr_b16 v[202:203], v66 offset:512
  ds_read_b64_tr_b16 v[204:205], v67 offset:0
  ds_read_b64_tr_b16 v[206:207], v67 offset:512
  v_mfma_f32_16x16x32_bf16 v[32:35], v[208:211], a[24:27], v[32:35]
  v_mfma_f32_16x16x32_bf16 v[36:39], v[208:211], a[28:31], v[36:39]
  ds_read_b64_tr_b16 v[208:209], v64 offset:8192
  ds_read_b64_tr_b16 v[210:211], v64 offset:8704
  v_mfma_f32_16x16x32_bf16 v[40:43], v[212:215], a[24:27], v[40:43]
  v_mfma_f32_16x16x32_bf16 v[44:47], v[212:215], a[28:31], v[44:47]
  ds_read_b64_tr_b16 v[212:213], v65 offset:8192
  ds_read_b64_tr_b16 v[214:215], v65 offset:8704
  v_mfma_f32_16x16x32_bf16 v[48:51], v[216:219], a[24:27], v[48:51]
  v_mfma_f32_16x16x32_bf16 v[52:55], v[216:219], a[28:31], v[52:55]
  ds_read_b64_tr_b16 v[216:217], v66 offset:8192
  s_waitcnt lgkmcnt(14)
  ds_read_b64_tr_b16 v[218:219], v66 offset:8704
  v_mfma_f32_16x16x32_bf16 v[56:59], v[220:223], a[24:27], v[56:59]
  v_mfma_f32_16x16x32_bf16 v[60:63], v[220:223], a[28:31], v[60:63]
  s_waitcnt lgkmcnt(10)
  v_mfma_f32_16x16x32_bf16 v[0:3], v[192:195], a[32:35], v[0:3]
  ds_read_b64_tr_b16 v[220:221], v67 offset:8192
  v_mfma_f32_16x16x32_bf16 v[4:7], v[192:195], a[36:39], v[4:7]
  ds_read_b64_tr_b16 v[222:223], v67 offset:8704
  v_mfma_f32_16x16x32_bf16 v[8:11], v[196:199], a[32:35], v[8:11]
  ds_read_b128 a[40:43], v75 offset:0
  ds_read_b128 a[44:47], v75 offset:2048
  v_mfma_f32_16x16x32_bf16 v[12:15], v[196:199], a[36:39], v[12:15]
  ds_read_b64_tr_b16 v[192:193], v64 offset:4096
  s_waitcnt lgkmcnt(14)
  ds_read_b64_tr_b16 v[194:195], v64 offset:4608
  s_waitcnt lgkmcnt(12)
  v_mfma_f32_16x16x32_bf16 v[16:19], v[200:203], a[32:35], v[16:19]
  ds_read_b64_tr_b16 v[196:197], v65 offset:4096
  v_mfma_f32_16x16x32_bf16 v[20:23], v[200:203], a[36:39], v[20:23]
  ds_read_b64_tr_b16 v[198:199], v65 offset:4608
  v_mfma_f32_16x16x32_bf16 v[24:27], v[204:207], a[32:35], v[24:27]
  ds_read_b64_tr_b16 v[200:201], v66 offset:4096
  v_mfma_f32_16x16x32_bf16 v[28:31], v[204:207], a[36:39], v[28:31]
  s_waitcnt lgkmcnt(14)
  ds_read_b64_tr_b16 v[202:203], v66 offset:4608
  s_waitcnt lgkmcnt(12)
  v_mfma_f32_16x16x32_bf16 v[32:35], v[208:211], a[32:35], v[32:35]
  ds_read_b64_tr_b16 v[204:205], v67 offset:4096
  v_mfma_f32_16x16x32_bf16 v[36:39], v[208:211], a[36:39], v[36:39]
  ds_read_b64_tr_b16 v[206:207], v67 offset:4608
  v_mfma_f32_16x16x32_bf16 v[40:43], v[212:215], a[32:35], v[40:43]
  ds_read_b64_tr_b16 v[208:209], v64 offset:12288
  v_mfma_f32_16x16x32_bf16 v[44:47], v[212:215], a[36:39], v[44:47]
  s_waitcnt lgkmcnt(14)
  ds_read_b64_tr_b16 v[210:211], v64 offset:12800
  s_waitcnt lgkmcnt(12)
  v_mfma_f32_16x16x32_bf16 v[48:51], v[216:219], a[32:35], v[48:51]
  ds_read_b64_tr_b16 v[212:213], v65 offset:12288
  v_mfma_f32_16x16x32_bf16 v[52:55], v[216:219], a[36:39], v[52:55]
  ds_read_b64_tr_b16 v[214:215], v65 offset:12800
  v_mfma_f32_16x16x32_bf16 v[56:59], v[220:223], a[32:35], v[56:59]
  ds_read_b64_tr_b16 v[216:217], v66 offset:12288
  v_mfma_f32_16x16x32_bf16 v[60:63], v[220:223], a[36:39], v[60:63]
  s_waitcnt lgkmcnt(14)
  ds_read_b64_tr_b16 v[218:219], v66 offset:12800
  s_waitcnt lgkmcnt(10)
  v_mfma_f32_16x16x32_bf16 v[0:3], v[192:195], a[40:43], v[0:3]
  ds_read_b64_tr_b16 v[220:221], v67 offset:12288
  v_mfma_f32_16x16x32_bf16 v[4:7], v[192:195], a[44:47], v[4:7]
  ds_read_b64_tr_b16 v[222:223], v67 offset:12800
  v_mfma_f32_16x16x32_bf16 v[8:11], v[196:199], a[40:43], v[8:11]
  v_mfma_f32_16x16x32_bf16 v[12:15], v[196:199], a[44:47], v[12:15]
  s_waitcnt lgkmcnt(8)
  v_mfma_f32_16x16x32_bf16 v[16:19], v[200:203], a[40:43], v[16:19]
  v_mfma_f32_16x16x32_bf16 v[20:23], v[200:203], a[44:47], v[20:23]
  v_mfma_f32_16x16x32_bf16 v[24:27], v[204:207], a[40:43], v[24:27]
  v_mfma_f32_16x16x32_bf16 v[28:31], v[204:207], a[44:47], v[28:31]
  s_waitcnt vmcnt(0) lgkmcnt(0)
  s_barrier
  ds_read_b128 a[48:51], v74 offset:12288
  ds_read_b128 a[52:55], v74 offset:14336
  ds_read_b64_tr_b16 v[192:193], v68 offset:16384
  ds_read_b64_tr_b16 v[194:195], v68 offset:16896
  ds_read_b64_tr_b16 v[196:197], v69 offset:16384
  ds_read_b64_tr_b16 v[198:199], v69 offset:16896
  ds_read_b64_tr_b16 v[200:201], v70 offset:16384
  ds_read_b64_tr_b16 v[202:203], v70 offset:16896
  ds_read_b64_tr_b16 v[204:205], v71 offset:16384
  ds_read_b64_tr_b16 v[206:207], v71 offset:16896
  v_mfma_f32_16x16x32_bf16 v[32:35], v[208:211], a[40:43], v[32:35]
  v_mfma_f32_16x16x32_bf16 v[36:39], v[208:211], a[44:47], v[36:39]
  ds_read_b64_tr_b16 v[208:209], v68 offset:24576
  ds_read_b64_tr_b16 v[210:211], v68 offset:25088
  v_mfma_f32_16x16x32_bf16 v[40:43], v[212:215], a[40:43], v[40:43]
  v_mfma_f32_16x16x32_bf16 v[44:47], v[212:215], a[44:47], v[44:47]
  ds_read_b64_tr_b16 v[212:213], v69 offset:24576
  ds_read_b64_tr_b16 v[214:215], v69 offset:25088
  v_mfma_f32_16x16x32_bf16 v[48:51], v[216:219], a[40:43], v[48:51]
  v_mfma_f32_16x16x32_bf16 v[52:55], v[216:219], a[44:47], v[52:55]
  ds_read_b64_tr_b16 v[216:217], v70 offset:24576
  s_waitcnt lgkmcnt(14)
  ds_read_b64_tr_b16 v[218:219], v70 offset:25088
  v_mfma_f32_16x16x32_bf16 v[56:59], v[220:223], a[40:43], v[56:59]
  v_mfma_f32_16x16x32_bf16 v[60:63], v[220:223], a[44:47], v[60:63]
  s_waitcnt lgkmcnt(10)
  v_mfma_f32_16x16x32_bf16 v[0:3], v[192:195], a[48:51], v[0:3]
  ds_read_b64_tr_b16 v[220:221], v71 offset:24576
  v_mfma_f32_16x16x32_bf16 v[4:7], v[192:195], a[52:55], v[4:7]
  ds_read_b64_tr_b16 v[222:223], v71 offset:25088
  v_mfma_f32_16x16x32_bf16 v[8:11], v[196:199], a[48:51], v[8:11]
  ds_read_b128 a[56:59], v75 offset:12288
  ds_read_b128 a[60:63], v75 offset:14336
  v_mfma_f32_16x16x32_bf16 v[12:15], v[196:199], a[52:55], v[12:15]
  ds_read_b64_tr_b16 v[192:193], v68 offset:20480
  s_waitcnt lgkmcnt(14)
  ds_read_b64_tr_b16 v[194:195], v68 offset:20992
  s_waitcnt lgkmcnt(12)
  v_mfma_f32_16x16x32_bf16 v[16:19], v[200:203], a[48:51], v[16:19]
  ds_read_b64_tr_b16 v[196:197], v69 offset:20480
  v_mfma_f32_16x16x32_bf16 v[20:23], v[200:203], a[52:55], v[20:23]
  ds_read_b64_tr_b16 v[198:199], v69 offset:20992
  v_mfma_f32_16x16x32_bf16 v[24:27], v[204:207], a[48:51], v[24:27]
  ds_read_b64_tr_b16 v[200:201], v70 offset:20480
  v_mfma_f32_16x16x32_bf16 v[28:31], v[204:207], a[52:55], v[28:31]
  s_waitcnt lgkmcnt(14)
  ds_read_b64_tr_b16 v[202:203], v70 offset:20992
  s_waitcnt lgkmcnt(12)
  v_mfma_f32_16x16x32_bf16 v[32:35], v[208:211], a[48:51], v[32:35]
  ds_read_b64_tr_b16 v[204:205], v71 offset:20480
  v_mfma_f32_16x16x32_bf16 v[36:39], v[208:211], a[52:55], v[36:39]
  ds_read_b64_tr_b16 v[206:207], v71 offset:20992
  v_mfma_f32_16x16x32_bf16 v[40:43], v[212:215], a[48:51], v[40:43]
  ds_read_b64_tr_b16 v[208:209], v68 offset:28672
  v_mfma_f32_16x16x32_bf16 v[44:47], v[212:215], a[52:55], v[44:47]
  s_waitcnt lgkmcnt(14)
  ds_read_b64_tr_b16 v[210:211], v68 offset:29184
  s_waitcnt lgkmcnt(12)
  v_mfma_f32_16x16x32_bf16 v[48:51], v[216:219], a[48:51], v[48:51]
  ds_read_b64_tr_b16 v[212:213], v69 offset:28672
  v_mfma_f32_16x16x32_bf16 v[52:55], v[216:219], a[52:55], v[52:55]
  ds_read_b64_tr_b16 v[214:215], v69 offset:29184
  v_mfma_f32_16x16x32_bf16 v[56:59], v[220:223], a[48:51], v[56:59]
  ds_read_b64_tr_b16 v[216:217], v70 offset:28672
  v_mfma_f32_16x16x32_bf16 v[60:63], v[220:223], a[52:55], v[60:63]
  s_waitcnt lgkmcnt(14)
  ds_read_b64_tr_b16 v[218:219], v70 offset:29184
  s_waitcnt lgkmcnt(10)
  v_mfma_f32_16x16x32_bf16 v[0:3], v[192:195], a[56:59], v[0:3]
  ds_read_b64_tr_b16 v[220:221], v71 offset:28672
  v_mfma_f32_16x16x32_bf16 v[4:7], v[192:195], a[60:63], v[4:7]
  ds_read_b64_tr_b16 v[222:223], v71 offset:29184
  v_mfma_f32_16x16x32_bf16 v[8:11], v[196:199], a[56:59], v[8:11]
  v_mfma_f32_16x16x32_bf16 v[12:15], v[196:199], a[60:63], v[12:15]
  s_waitcnt lgkmcnt(8)
  v_mfma_f32_16x16x32_bf16 v[16:19], v[200:203], a[56:59], v[16:19]
  v_mfma_f32_16x16x32_bf16 v[20:23], v[200:203], a[60:63], v[20:23]
  v_mfma_f32_16x16x32_bf16 v[24:27], v[204:207], a[56:59], v[24:27]
  v_mfma_f32_16x16x32_bf16 v[28:31], v[204:207], a[60:63], v[28:31]
  s_waitcnt lgkmcnt(0)
  s_barrier
  ds_read_b128 a[64:67], v72 offset:0
  ds_read_b128 a[68:71], v72 offset:2048
  ds_read_b64_tr_b16 v[192:193], v64 offset:50176
  ds_read_b64_tr_b16 v[194:195], v64 offset:50688
  ds_read_b64_tr_b16 v[196:197], v65 offset:50176
  ds_read_b64_tr_b16 v[198:199], v65 offset:50688
  ds_read_b64_tr_b16 v[200:201], v66 offset:50176
  ds_read_b64_tr_b16 v[202:203], v66 offset:50688
  ds_read_b64_tr_b16 v[204:205], v67 offset:50176
  ds_read_b64_tr_b16 v[206:207], v67 offset:50688
  v_mfma_f32_16x16x32_bf16 v[32:35], v[208:211], a[56:59], v[32:35]
  v_mfma_f32_16x16x32_bf16 v[36:39], v[208:211], a[60:63], v[36:39]
  ds_read_b64_tr_b16 v[208:209], v64 offset:58368
  ds_read_b64_tr_b16 v[210:211], v64 offset:58880
  v_mfma_f32_16x16x32_bf16 v[40:43], v[212:215], a[56:59], v[40:43]
  v_mfma_f32_16x16x32_bf16 v[44:47], v[212:215], a[60:63], v[44:47]
  ds_read_b64_tr_b16 v[212:213], v65 offset:58368
  ds_read_b64_tr_b16 v[214:215], v65 offset:58880
  v_mfma_f32_16x16x32_bf16 v[48:51], v[216:219], a[56:59], v[48:51]
  v_mfma_f32_16x16x32_bf16 v[52:55], v[216:219], a[60:63], v[52:55]
  ds_read_b64_tr_b16 v[216:217], v66 offset:58368
  s_waitcnt lgkmcnt(14)
  ds_read_b64_tr_b16 v[218:219], v66 offset:58880
  v_mfma_f32_16x16x32_bf16 v[56:59], v[220:223], a[56:59], v[56:59]
  v_mfma_f32_16x16x32_bf16 v[60:63], v[220:223], a[60:63], v[60:63]
  s_waitcnt lgkmcnt(10)
  v_mfma_f32_16x16x32_bf16 v[0:3], v[192:195], a[64:67], v[0:3]
  ds_read_b64_tr_b16 v[220:221], v67 offset:58368
  v_mfma_f32_16x16x32_bf16 v[4:7], v[192:195], a[68:71], v[4:7]
  ds_read_b64_tr_b16 v[222:223], v67 offset:58880
  v_mfma_f32_16x16x32_bf16 v[8:11], v[196:199], a[64:67], v[8:11]
  ds_read_b128 a[72:75], v73 offset:0
  ds_read_b128 a[76:79], v73 offset:2048
  v_mfma_f32_16x16x32_bf16 v[12:15], v[196:199], a[68:71], v[12:15]
  ds_read_b64_tr_b16 v[192:193], v64 offset:54272
  s_waitcnt lgkmcnt(14)
  ds_read_b64_tr_b16 v[194:195], v64 offset:54784
  s_waitcnt lgkmcnt(12)
  v_mfma_f32_16x16x32_bf16 v[16:19], v[200:203], a[64:67], v[16:19]
  ds_read_b64_tr_b16 v[196:197], v65 offset:54272
  v_mfma_f32_16x16x32_bf16 v[20:23], v[200:203], a[68:71], v[20:23]
  ds_read_b64_tr_b16 v[198:199], v65 offset:54784
  v_mfma_f32_16x16x32_bf16 v[24:27], v[204:207], a[64:67], v[24:27]
  ds_read_b64_tr_b16 v[200:201], v66 offset:54272
  v_mfma_f32_16x16x32_bf16 v[28:31], v[204:207], a[68:71], v[28:31]
  s_waitcnt lgkmcnt(14)
  ds_read_b64_tr_b16 v[202:203], v66 offset:54784
  s_waitcnt lgkmcnt(12)
  v_mfma_f32_16x16x32_bf16 v[32:35], v[208:211], a[64:67], v[32:35]
  ds_read_b64_tr_b16 v[204:205], v67 offset:54272
  v_mfma_f32_16x16x32_bf16 v[36:39], v[208:211], a[68:71], v[36:39]
  ds_read_b64_tr_b16 v[206:207], v67 offset:54784
  v_mfma_f32_16x16x32_bf16 v[40:43], v[212:215], a[64:67], v[40:43]
  ds_read_b64_tr_b16 v[208:209], v64 offset:62464
  v_mfma_f32_16x16x32_bf16 v[44:47], v[212:215], a[68:71], v[44:47]
  s_waitcnt lgkmcnt(14)
  ds_read_b64_tr_b16 v[210:211], v64 offset:62976
  s_waitcnt lgkmcnt(12)
  v_mfma_f32_16x16x32_bf16 v[48:51], v[216:219], a[64:67], v[48:51]
  ds_read_b64_tr_b16 v[212:213], v65 offset:62464
  v_mfma_f32_16x16x32_bf16 v[52:55], v[216:219], a[68:71], v[52:55]
  ds_read_b64_tr_b16 v[214:215], v65 offset:62976
  v_mfma_f32_16x16x32_bf16 v[56:59], v[220:223], a[64:67], v[56:59]
  ds_read_b64_tr_b16 v[216:217], v66 offset:62464
  v_mfma_f32_16x16x32_bf16 v[60:63], v[220:223], a[68:71], v[60:63]
  s_waitcnt lgkmcnt(14)
  ds_read_b64_tr_b16 v[218:219], v66 offset:62976
  s_waitcnt lgkmcnt(10)
  v_mfma_f32_16x16x32_bf16 v[0:3], v[192:195], a[72:75], v[0:3]
  ds_read_b64_tr_b16 v[220:221], v67 offset:62464
  v_mfma_f32_16x16x32_bf16 v[4:7], v[192:195], a[76:79], v[4:7]
  ds_read_b64_tr_b16 v[222:223], v67 offset:62976
  v_mfma_f32_16x16x32_bf16 v[8:11], v[196:199], a[72:75], v[8:11]
  v_mfma_f32_16x16x32_bf16 v[12:15], v[196:199], a[76:79], v[12:15]
  s_waitcnt lgkmcnt(8)
  v_mfma_f32_16x16x32_bf16 v[16:19], v[200:203], a[72:75], v[16:19]
  v_mfma_f32_16x16x32_bf16 v[20:23], v[200:203], a[76:79], v[20:23]
  v_mfma_f32_16x16x32_bf16 v[24:27], v[204:207], a[72:75], v[24:27]
  v_mfma_f32_16x16x32_bf16 v[28:31], v[204:207], a[76:79], v[28:31]
  s_waitcnt lgkmcnt(0)
  s_barrier
  ds_read_b128 a[80:83], v72 offset:12288
  ds_read_b128 a[84:87], v72 offset:14336
  ds_read_b64_tr_b16 v[192:193], v68 offset:0
  ds_read_b64_tr_b16 v[194:195], v68 offset:512
  ds_read_b64_tr_b16 v[196:197], v69 offset:0
  ds_read_b64_tr_b16 v[198:199], v69 offset:512
  ds_read_b64_tr_b16 v[200:201], v70 offset:0
  ds_read_b64_tr_b16 v[202:203], v70 offset:512
  ds_read_b64_tr_b16 v[204:205], v71 offset:0
  ds_read_b64_tr_b16 v[206:207], v71 offset:512
  v_mfma_f32_16x16x32_bf16 v[32:35], v[208:211], a[72:75], v[32:35]
  v_mfma_f32_16x16x32_bf16 v[36:39], v[208:211], a[76:79], v[36:39]
  ds_read_b64_tr_b16 v[208:209], v68 offset:8192
  ds_read_b64_tr_b16 v[210:211], v68 offset:8704
  v_mfma_f32_16x16x32_bf16 v[40:43], v[212:215], a[72:75], v[40:43]
  v_mfma_f32_16x16x32_bf16 v[44:47], v[212:215], a[76:79], v[44:47]
  ds_read_b64_tr_b16 v[212:213], v69 offset:8192
  ds_read_b64_tr_b16 v[214:215], v69 offset:8704
  v_mfma_f32_16x16x32_bf16 v[48:51], v[216:219], a[72:75], v[48:51]
  v_mfma_f32_16x16x32_bf16 v[52:55], v[216:219], a[76:79], v[52:55]
  ds_read_b64_tr_b16 v[216:217], v70 offset:8192
  s_waitcnt lgkmcnt(14)
  ds_read_b64_tr_b16 v[218:219], v70 offset:8704
  v_mfma_f32_16x16x32_bf16 v[56:59], v[220:223], a[72:75], v[56:59]
  v_mfma_f32_16x16x32_bf16 v[60:63], v[220:223], a[76:79], v[60:63]
  s_waitcnt lgkmcnt(10)
  v_mfma_f32_16x16x32_bf16 v[0:3], v[192:195], a[80:83], v[0:3]
  ds_read_b64_tr_b16 v[220:221], v71 offset:8192
  v_mfma_f32_16x16x32_bf16 v[4:7], v[192:195], a[84:87], v[4:7]
  ds_read_b64_tr_b16 v[222:223], v71 offset:8704
  v_mfma_f32_16x16x32_bf16 v[8:11], v[196:199], a[80:83], v[8:11]
  ds_read_b128 a[88:91], v73 offset:12288
  ds_read_b128 a[92:95], v73 offset:14336
  v_mfma_f32_16x16x32_bf16 v[12:15], v[196:199], a[84:87], v[12:15]
  ds_read_b64_tr_b16 v[192:193], v68 offset:4096
  s_waitcnt lgkmcnt(14)
  ds_read_b64_tr_b16 v[194:195], v68 offset:4608
  s_waitcnt lgkmcnt(12)
  v_mfma_f32_16x16x32_bf16 v[16:19], v[200:203], a[80:83], v[16:19]
  ds_read_b64_tr_b16 v[196:197], v69 offset:4096
  v_mfma_f32_16x16x32_bf16 v[20:23], v[200:203], a[84:87], v[20:23]
  ds_read_b64_tr_b16 v[198:199], v69 offset:4608
  v_mfma_f32_16x16x32_bf16 v[24:27], v[204:207], a[80:83], v[24:27]
  ds_read_b64_tr_b16 v[200:201], v70 offset:4096
  v_mfma_f32_16x16x32_bf16 v[28:31], v[204:207], a[84:87], v[28:31]
  s_waitcnt lgkmcnt(14)
  ds_read_b64_tr_b16 v[202:203], v70 offset:4608
  s_waitcnt lgkmcnt(12)
  v_mfma_f32_16x16x32_bf16 v[32:35], v[208:211], a[80:83], v[32:35]
  ds_read_b64_tr_b16 v[204:205], v71 offset:4096
  v_mfma_f32_16x16x32_bf16 v[36:39], v[208:211], a[84:87], v[36:39]
  ds_read_b64_tr_b16 v[206:207], v71 offset:4608
  v_mfma_f32_16x16x32_bf16 v[40:43], v[212:215], a[80:83], v[40:43]
  ds_read_b64_tr_b16 v[208:209], v68 offset:12288
  v_mfma_f32_16x16x32_bf16 v[44:47], v[212:215], a[84:87], v[44:47]
  s_waitcnt lgkmcnt(14)
  ds_read_b64_tr_b16 v[210:211], v68 offset:12800
  s_waitcnt lgkmcnt(12)
  v_mfma_f32_16x16x32_bf16 v[48:51], v[216:219], a[80:83], v[48:51]
  ds_read_b64_tr_b16 v[212:213], v69 offset:12288
  v_mfma_f32_16x16x32_bf16 v[52:55], v[216:219], a[84:87], v[52:55]
  ds_read_b64_tr_b16 v[214:215], v69 offset:12800
  v_mfma_f32_16x16x32_bf16 v[56:59], v[220:223], a[80:83], v[56:59]
  ds_read_b64_tr_b16 v[216:217], v70 offset:12288
  v_mfma_f32_16x16x32_bf16 v[60:63], v[220:223], a[84:87], v[60:63]
  s_waitcnt lgkmcnt(14)
  ds_read_b64_tr_b16 v[218:219], v70 offset:12800
  s_waitcnt lgkmcnt(10)
  v_mfma_f32_16x16x32_bf16 v[0:3], v[192:195], a[88:91], v[0:3]
  ds_read_b64_tr_b16 v[220:221], v71 offset:12288
  v_mfma_f32_16x16x32_bf16 v[4:7], v[192:195], a[92:95], v[4:7]
  ds_read_b64_tr_b16 v[222:223], v71 offset:12800
  v_mfma_f32_16x16x32_bf16 v[8:11], v[196:199], a[88:91], v[8:11]
  v_mfma_f32_16x16x32_bf16 v[12:15], v[196:199], a[92:95], v[12:15]
  s_waitcnt lgkmcnt(8)
  v_mfma_f32_16x16x32_bf16 v[16:19], v[200:203], a[88:91], v[16:19]
  v_mfma_f32_16x16x32_bf16 v[20:23], v[200:203], a[92:95], v[20:23]
  v_mfma_f32_16x16x32_bf16 v[24:27], v[204:207], a[88:91], v[24:27]
  v_mfma_f32_16x16x32_bf16 v[28:31], v[204:207], a[92:95], v[28:31]
  s_waitcnt lgkmcnt(0)
  s_barrier
  ds_read_b128 a[96:99], v74 offset:0
  ds_read_b128 a[100:103], v74 offset:2048
  ds_read_b64_tr_b16 v[192:193], v64 offset:0
  ds_read_b64_tr_b16 v[194:195], v64 offset:512
  ds_read_b64_tr_b16 v[196:197], v65 offset:0
  ds_read_b64_tr_b16 v[198:199], v65 offset:512
  ds_read_b64_tr_b16 v[200:201], v66 offset:0
  ds_read_b64_tr_b16 v[202:203], v66 offset:512
  ds_read_b64_tr_b16 v[204:205], v67 offset:0
  ds_read_b64_tr_b16 v[206:207], v67 offset:512
  v_mfma_f32_16x16x32_bf16 v[32:35], v[208:211], a[88:91], v[32:35]
  v_mfma_f32_16x16x32_bf16 v[36:39], v[208:211], a[92:95], v[36:39]
  ds_read_b64_tr_b16 v[208:209], v64 offset:8192
  ds_read_b64_tr_b16 v[210:211], v64 offset:8704
  v_mfma_f32_16x16x32_bf16 v[40:43], v[212:215], a[88:91], v[40:43]
  v_mfma_f32_16x16x32_bf16 v[44:47], v[212:215], a[92:95], v[44:47]
  ds_read_b64_tr_b16 v[212:213], v65 offset:8192
  ds_read_b64_tr_b16 v[214:215], v65 offset:8704
  v_mfma_f32_16x16x32_bf16 v[48:51], v[216:219], a[88:91], v[48:51]
  v_mfma_f32_16x16x32_bf16 v[52:55], v[216:219], a[92:95], v[52:55]
  ds_read_b64_tr_b16 v[216:217], v66 offset:8192
  s_waitcnt lgkmcnt(14)
  ds_read_b64_tr_b16 v[218:219], v66 offset:8704
  v_mfma_f32_16x16x32_bf16 v[56:59], v[220:223], a[88:91], v[56:59]
  v_mfma_f32_16x16x32_bf16 v[60:63], v[220:223], a[92:95], v[60:63]
  s_waitcnt lgkmcnt(10)
  v_mfma_f32_16x16x32_bf16 v[0:3], v[192:195], a[96:99], v[0:3]
  ds_read_b64_tr_b16 v[220:221], v67 offset:8192
  v_mfma_f32_16x16x32_bf16 v[4:7], v[192:195], a[100:103], v[4:7]
  ds_read_b64_tr_b16 v[222:223], v67 offset:8704
  v_mfma_f32_16x16x32_bf16 v[8:11], v[196:199], a[96:99], v[8:11]
  ds_read_b128 a[104:107], v75 offset:0
  ds_read_b128 a[108:111], v75 offset:2048
  v_mfma_f32_16x16x32_bf16 v[12:15], v[196:199], a[100:103], v[12:15]
  ds_read_b64_tr_b16 v[192:193], v64 offset:4096
  s_waitcnt lgkmcnt(14)
  ds_read_b64_tr_b16 v[194:195], v64 offset:4608
  s_waitcnt lgkmcnt(12)
  v_mfma_f32_16x16x32_bf16 v[16:19], v[200:203], a[96:99], v[16:19]
  ds_read_b64_tr_b16 v[196:197], v65 offset:4096
  v_mfma_f32_16x16x32_bf16 v[20:23], v[200:203], a[100:103], v[20:23]
  ds_read_b64_tr_b16 v[198:199], v65 offset:4608
  v_mfma_f32_16x16x32_bf16 v[24:27], v[204:207], a[96:99], v[24:27]
  ds_read_b64_tr_b16 v[200:201], v66 offset:4096
  v_mfma_f32_16x16x32_bf16 v[28:31], v[204:207], a[100:103], v[28:31]
  s_waitcnt lgkmcnt(14)
  ds_read_b64_tr_b16 v[202:203], v66 offset:4608
  s_waitcnt lgkmcnt(12)
  v_mfma_f32_16x16x32_bf16 v[32:35], v[208:211], a[96:99], v[32:35]
  ds_read_b64_tr_b16 v[204:205], v67 offset:4096
  v_mfma_f32_16x16x32_bf16 v[36:39], v[208:211], a[100:103], v[36:39]
  ds_read_b64_tr_b16 v[206:207], v67 offset:4608
  v_mfma_f32_16x16x32_bf16 v[40:43], v[212:215], a[96:99], v[40:43]
  ds_read_b64_tr_b16 v[208:209], v64 offset:12288
  v_mfma_f32_16x16x32_bf16 v[44:47], v[212:215], a[100:103], v[44:47]
  s_waitcnt lgkmcnt(14)
  ds_read_b64_tr_b16 v[210:211], v64 offset:12800
  s_waitcnt lgkmcnt(12)
  v_mfma_f32_16x16x32_bf16 v[48:51], v[216:219], a[96:99], v[48:51]
  ds_read_b64_tr_b16 v[212:213], v65 offset:12288
  v_mfma_f32_16x16x32_bf16 v[52:55], v[216:219], a[100:103], v[52:55]
  ds_read_b64_tr_b16 v[214:215], v65 offset:12800
  v_mfma_f32_16x16x32_bf16 v[56:59], v[220:223], a[96:99], v[56:59]
  ds_read_b64_tr_b16 v[216:217], v66 offset:12288
  v_mfma_f32_16x16x32_bf16 v[60:63], v[220:223], a[100:103], v[60:63]
  s_waitcnt lgkmcnt(14)
  ds_read_b64_tr_b16 v[218:219], v66 offset:12800
  s_waitcnt lgkmcnt(10)
  v_mfma_f32_16x16x32_bf16 v[0:3], v[192:195], a[104:107], v[0:3]
  ds_read_b64_tr_b16 v[220:221], v67 offset:12288
  v_mfma_f32_16x16x32_bf16 v[4:7], v[192:195], a[108:111], v[4:7]
  ds_read_b64_tr_b16 v[222:223], v67 offset:12800
  v_mfma_f32_16x16x32_bf16 v[8:11], v[196:199], a[104:107], v[8:11]
  v_mfma_f32_16x16x32_bf16 v[12:15], v[196:199], a[108:111], v[12:15]
  s_waitcnt lgkmcnt(8)
  v_mfma_f32_16x16x32_bf16 v[16:19], v[200:203], a[104:107], v[16:19]
  v_mfma_f32_16x16x32_bf16 v[20:23], v[200:203], a[108:111], v[20:23]
  v_mfma_f32_16x16x32_bf16 v[24:27], v[204:207], a[104:107], v[24:27]
  v_mfma_f32_16x16x32_bf16 v[28:31], v[204:207], a[108:111], v[28:31]
  s_waitcnt lgkmcnt(0)
  s_barrier
  ds_read_b128 a[112:115], v74 offset:12288
  ds_read_b128 a[116:119], v74 offset:14336
  ds_read_b64_tr_b16 v[192:193], v68 offset:16384
  ds_read_b64_tr_b16 v[194:195], v68 offset:16896
  ds_read_b64_tr_b16 v[196:197], v69 offset:16384
  ds_read_b64_tr_b16 v[198:199], v69 offset:16896
  ds_read_b64_tr_b16 v[200:201], v70 offset:16384
  ds_read_b64_tr_b16 v[202:203], v70 offset:16896
  ds_read_b64_tr_b16 v[204:205], v71 offset:16384
  ds_read_b64_tr_b16 v[206:207], v71 offset:16896
  v_mfma_f32_16x16x32_bf16 v[32:35], v[208:211], a[104:107], v[32:35]
  v_mfma_f32_16x16x32_bf16 v[36:39], v[208:211], a[108:111], v[36:39]
  ds_read_b64_tr_b16 v[208:209], v68 offset:24576
  ds_read_b64_tr_b16 v[210:211], v68 offset:25088
  v_mfma_f32_16x16x32_bf16 v[40:43], v[212:215], a[104:107], v[40:43]
  v_mfma_f32_16x16x32_bf16 v[44:47], v[212:215], a[108:111], v[44:47]
  ds_read_b64_tr_b16 v[212:213], v69 offset:24576
  ds_read_b64_tr_b16 v[214:215], v69 offset:25088
  v_mfma_f32_16x16x32_bf16 v[48:51], v[216:219], a[104:107], v[48:51]
  v_mfma_f32_16x16x32_bf16 v[52:55], v[216:219], a[108:111], v[52:55]
  ds_read_b64_tr_b16 v[216:217], v70 offset:24576
  s_waitcnt lgkmcnt(14)
  ds_read_b64_tr_b16 v[218:219], v70 offset:25088
  v_mfma_f32_16x16x32_bf16 v[56:59], v[220:223], a[104:107], v[56:59]
  v_mfma_f32_16x16x32_bf16 v[60:63], v[220:223], a[108:111], v[60:63]
  s_waitcnt lgkmcnt(10)
  v_mfma_f32_16x16x32_bf16 v[0:3], v[192:195], a[112:115], v[0:3]
  ds_read_b64_tr_b16 v[220:221], v71 offset:24576
  v_mfma_f32_16x16x32_bf16 v[4:7], v[192:195], a[116:119], v[4:7]
  ds_read_b64_tr_b16 v[222:223], v71 offset:25088
  v_mfma_f32_16x16x32_bf16 v[8:11], v[196:199], a[112:115], v[8:11]
  ds_read_b128 a[120:123], v75 offset:12288
  ds_read_b128 a[124:127], v75 offset:14336
  v_mfma_f32_16x16x32_bf16 v[12:15], v[196:199], a[116:119], v[12:15]
  ds_read_b64_tr_b16 v[192:193], v68 offset:20480
  s_waitcnt lgkmcnt(14)
  ds_read_b64_tr_b16 v[194:195], v68 offset:20992
  s_waitcnt lgkmcnt(12)
  v_mfma_f32_16x16x32_bf16 v[16:19], v[200:203], a[112:115], v[16:19]
  ds_read_b64_tr_b16 v[196:197], v69 offset:20480
  v_mfma_f32_16x16x32_bf16 v[20:23], v[200:203], a[116:119], v[20:23]
  ds_read_b64_tr_b16 v[198:199], v69 offset:20992
  v_mfma_f32_16x16x32_bf16 v[24:27], v[204:207], a[112:115], v[24:27]
  ds_read_b64_tr_b16 v[200:201], v70 offset:20480
  v_mfma_f32_16x16x32_bf16 v[28:31], v[204:207], a[116:119], v[28:31]
  s_waitcnt lgkmcnt(14)
  ds_read_b64_tr_b16 v[202:203], v70 offset:20992
  s_waitcnt lgkmcnt(12)
  v_mfma_f32_16x16x32_bf16 v[32:35], v[208:211], a[112:115], v[32:35]
  ds_read_b64_tr_b16 v[204:205], v71 offset:20480
  v_mfma_f32_16x16x32_bf16 v[36:39], v[208:211], a[116:119], v[36:39]
  ds_read_b64_tr_b16 v[206:207], v71 offset:20992
  v_mfma_f32_16x16x32_bf16 v[40:43], v[212:215], a[112:115], v[40:43]
  ds_read_b64_tr_b16 v[208:209], v68 offset:28672
  v_mfma_f32_16x16x32_bf16 v[44:47], v[212:215], a[116:119], v[44:47]
  s_waitcnt lgkmcnt(14)
  ds_read_b64_tr_b16 v[210:211], v68 offset:29184
  s_waitcnt lgkmcnt(12)
  v_mfma_f32_16x16x32_bf16 v[48:51], v[216:219], a[112:115], v[48:51]
  ds_read_b64_tr_b16 v[212:213], v69 offset:28672
  v_mfma_f32_16x16x32_bf16 v[52:55], v[216:219], a[116:119], v[52:55]
  ds_read_b64_tr_b16 v[214:215], v69 offset:29184
  v_mfma_f32_16x16x32_bf16 v[56:59], v[220:223], a[112:115], v[56:59]
  ds_read_b64_tr_b16 v[216:217], v70 offset:28672
  v_mfma_f32_16x16x32_bf16 v[60:63], v[220:223], a[116:119], v[60:63]
  s_waitcnt lgkmcnt(14)
  ds_read_b64_tr_b16 v[218:219], v70 offset:29184
  s_waitcnt lgkmcnt(10)
  v_mfma_f32_16x16x32_bf16 v[0:3], v[192:195], a[120:123], v[0:3]
  ds_read_b64_tr_b16 v[220:221], v71 offset:28672
  v_mfma_f32_16x16x32_bf16 v[4:7], v[192:195], a[124:127], v[4:7]
  ds_read_b64_tr_b16 v[222:223], v71 offset:29184
  v_mfma_f32_16x16x32_bf16 v[8:11], v[196:199], a[120:123], v[8:11]
  v_mfma_f32_16x16x32_bf16 v[12:15], v[196:199], a[124:127], v[12:15]
  s_waitcnt lgkmcnt(8)
  v_mfma_f32_16x16x32_bf16 v[16:19], v[200:203], a[120:123], v[16:19]
  v_mfma_f32_16x16x32_bf16 v[20:23], v[200:203], a[124:127], v[20:23]
  v_mfma_f32_16x16x32_bf16 v[24:27], v[204:207], a[120:123], v[24:27]
  v_mfma_f32_16x16x32_bf16 v[28:31], v[204:207], a[124:127], v[28:31]
  s_waitcnt lgkmcnt(0)
  s_barrier
  ds_read_b128 v[192:195], v228 offset:0
  ds_read_b128 v[196:199], v228 offset:64
  ds_read_b128 v[200:203], v228 offset:128
  ds_read_b128 v[204:207], v228 offset:192
  v_mfma_f32_16x16x32_bf16 v[32:35], v[208:211], a[120:123], v[32:35]
  v_mfma_f32_16x16x32_bf16 v[36:39], v[208:211], a[124:127], v[36:39]
  ds_read_b128 v[208:211], v228 offset:4352
  v_mfma_f32_16x16x32_bf16 v[40:43], v[212:215], a[120:123], v[40:43]
  v_mfma_f32_16x16x32_bf16 v[44:47], v[212:215], a[124:127], v[44:47]
  ds_read_b128 v[212:215], v228 offset:4416
  v_mfma_f32_16x16x32_bf16 v[48:51], v[216:219], a[120:123], v[48:51]
  v_mfma_f32_16x16x32_bf16 v[52:55], v[216:219], a[124:127], v[52:55]
  ds_read_b128 v[216:219], v228 offset:4480
  v_mfma_f32_16x16x32_bf16 v[56:59], v[220:223], a[120:123], v[56:59]
  v_mfma_f32_16x16x32_bf16 v[60:63], v[220:223], a[124:127], v[60:63]
  v_mov_b32 v224, s65
  v_pk_mul_f32 v[0:1], v[0:1], v[224:225] op_sel_hi:[1,0]
  v_pk_mul_f32 v[2:3], v[2:3], v[224:225] op_sel_hi:[1,0]
  v_cvt_pk_bf16_f32 v64, v0, v1
  v_cvt_pk_bf16_f32 v65, v2, v3
  v_pk_mul_f32 v[4:5], v[4:5], v[224:225] op_sel_hi:[1,0]
  v_pk_mul_f32 v[6:7], v[6:7], v[224:225] op_sel_hi:[1,0]
  v_cvt_pk_bf16_f32 v80, v4, v5
  v_cvt_pk_bf16_f32 v81, v6, v7
  v_pk_mul_f32 v[8:9], v[8:9], v[224:225] op_sel_hi:[1,0]
  v_pk_mul_f32 v[10:11], v[10:11], v[224:225] op_sel_hi:[1,0]
  v_cvt_pk_bf16_f32 v66, v8, v9
  v_cvt_pk_bf16_f32 v67, v10, v11
  v_pk_mul_f32 v[12:13], v[12:13], v[224:225] op_sel_hi:[1,0]
  v_pk_mul_f32 v[14:15], v[14:15], v[224:225] op_sel_hi:[1,0]
  v_cvt_pk_bf16_f32 v82, v12, v13
  v_cvt_pk_bf16_f32 v83, v14, v15
  v_pk_mul_f32 v[16:17], v[16:17], v[224:225] op_sel_hi:[1,0]
  v_pk_mul_f32 v[18:19], v[18:19], v[224:225] op_sel_hi:[1,0]
  v_cvt_pk_bf16_f32 v68, v16, v17
  v_cvt_pk_bf16_f32 v69, v18, v19
  v_pk_mul_f32 v[20:21], v[20:21], v[224:225] op_sel_hi:[1,0]
  v_pk_mul_f32 v[22:23], v[22:23], v[224:225] op_sel_hi:[1,0]
  v_cvt_pk_bf16_f32 v84, v20, v21
  v_cvt_pk_bf16_f32 v85, v22, v23
  v_pk_mul_f32 v[24:25], v[24:25], v[224:225] op_sel_hi:[1,0]
  v_pk_mul_f32 v[26:27], v[26:27], v[224:225] op_sel_hi:[1,0]
  v_cvt_pk_bf16_f32 v70, v24, v25
  v_cvt_pk_bf16_f32 v71, v26, v27
  v_pk_mul_f32 v[28:29], v[28:29], v[224:225] op_sel_hi:[1,0]
  v_pk_mul_f32 v[30:31], v[30:31], v[224:225] op_sel_hi:[1,0]
  v_cvt_pk_bf16_f32 v86, v28, v29
  v_cvt_pk_bf16_f32 v87, v30, v31
  v_pk_mul_f32 v[32:33], v[32:33], v[224:225] op_sel_hi:[1,0]
  v_pk_mul_f32 v[34:35], v[34:35], v[224:225] op_sel_hi:[1,0]
  v_cvt_pk_bf16_f32 v72, v32, v33
  v_cvt_pk_bf16_f32 v73, v34, v35
  v_pk_mul_f32 v[36:37], v[36:37], v[224:225] op_sel_hi:[1,0]
  v_pk_mul_f32 v[38:39], v[38:39], v[224:225] op_sel_hi:[1,0]
  v_cvt_pk_bf16_f32 v88, v36, v37
  v_cvt_pk_bf16_f32 v89, v38, v39
  v_pk_mul_f32 v[40:41], v[40:41], v[224:225] op_sel_hi:[1,0]
  v_pk_mul_f32 v[42:43], v[42:43], v[224:225] op_sel_hi:[1,0]
  v_cvt_pk_bf16_f32 v74, v40, v41
  v_cvt_pk_bf16_f32 v75, v42, v43
  v_pk_mul_f32 v[44:45], v[44:45], v[224:225] op_sel_hi:[1,0]
  v_pk_mul_f32 v[46:47], v[46:47], v[224:225] op_sel_hi:[1,0]
  v_cvt_pk_bf16_f32 v90, v44, v45
  v_cvt_pk_bf16_f32 v91, v46, v47
  v_pk_mul_f32 v[48:49], v[48:49], v[224:225] op_sel_hi:[1,0]
  v_pk_mul_f32 v[50:51], v[50:51], v[224:225] op_sel_hi:[1,0]
  v_cvt_pk_bf16_f32 v76, v48, v49
  v_cvt_pk_bf16_f32 v77, v50, v51
  v_pk_mul_f32 v[52:53], v[52:53], v[224:225] op_sel_hi:[1,0]
  v_pk_mul_f32 v[54:55], v[54:55], v[224:225] op_sel_hi:[1,0]
  v_cvt_pk_bf16_f32 v92, v52, v53
  v_cvt_pk_bf16_f32 v93, v54, v55
  v_pk_mul_f32 v[56:57], v[56:57], v[224:225] op_sel_hi:[1,0]
  v_pk_mul_f32 v[58:59], v[58:59], v[224:225] op_sel_hi:[1,0]
  v_cvt_pk_bf16_f32 v78, v56, v57
  v_cvt_pk_bf16_f32 v79, v58, v59
  v_pk_mul_f32 v[60:61], v[60:61], v[224:225] op_sel_hi:[1,0]
  v_pk_mul_f32 v[62:63], v[62:63], v[224:225] op_sel_hi:[1,0]
  v_cvt_pk_bf16_f32 v94, v60, v61
  v_cvt_pk_bf16_f32 v95, v62, v63
  v_permlane16_swap_b32 v64, v66
  v_permlane16_swap_b32 v65, v67
  v_permlane16_swap_b32 v68, v70
  v_permlane16_swap_b32 v69, v71
  v_permlane16_swap_b32 v72, v74
  v_permlane16_swap_b32 v73, v75
  v_permlane16_swap_b32 v76, v78
  v_permlane16_swap_b32 v77, v79
  v_permlane16_swap_b32 v80, v82
  v_permlane16_swap_b32 v81, v83
  v_permlane16_swap_b32 v84, v86
  v_permlane16_swap_b32 v85, v87
  v_permlane16_swap_b32 v88, v90
  v_permlane16_swap_b32 v89, v91
  v_permlane16_swap_b32 v92, v94
  v_permlane16_swap_b32 v93, v95
  s_waitcnt lgkmcnt(5)
  v_mfma_f32_16x16x32_bf16 v[136:139], v[192:195], v[64:67], v[168:171]
  ds_read_b128 v[220:223], v228 offset:4544
  v_mfma_f32_16x16x32_bf16 v[140:143], v[192:195], v[80:83], v[172:175]
  v_mfma_f32_16x16x32_bf16 v[136:139], v[196:199], v[68:71], v[136:139]
  ds_read_b64_tr_b16 v[192:193], v250 offset:0
  v_mfma_f32_16x16x32_bf16 v[140:143], v[196:199], v[84:87], v[140:143]
  ds_read_b64_tr_b16 v[194:195], v250 offset:512
  s_waitcnt lgkmcnt(6)
  v_mfma_f32_16x16x32_bf16 v[136:139], v[200:203], v[72:75], v[136:139]
  ds_read_b64_tr_b16 v[196:197], v251 offset:0
  v_mfma_f32_16x16x32_bf16 v[140:143], v[200:203], v[88:91], v[140:143]
  ds_read_b64_tr_b16 v[198:199], v251 offset:512
  v_mfma_f32_16x16x32_bf16 v[136:139], v[204:207], v[76:79], v[136:139]
  ds_read_b64_tr_b16 v[200:201], v252 offset:0
  v_mfma_f32_16x16x32_bf16 v[140:143], v[204:207], v[92:95], v[140:143]
  ds_read_b64_tr_b16 v[202:203], v252 offset:512
  s_waitcnt lgkmcnt(8)
  v_mfma_f32_16x16x32_bf16 v[144:147], v[208:211], v[64:67], v[168:171]
  ds_read_b64_tr_b16 v[204:205], v253 offset:0
  v_mfma_f32_16x16x32_bf16 v[148:151], v[208:211], v[80:83], v[172:175]
  ds_read_b64_tr_b16 v[206:207], v253 offset:512
  v_mfma_f32_16x16x32_bf16 v[144:147], v[212:215], v[68:71], v[144:147]
  ds_read_b64_tr_b16 v[208:209], v250 offset:4096
  v_mfma_f32_16x16x32_bf16 v[148:151], v[212:215], v[84:87], v[148:151]
  ds_read_b64_tr_b16 v[210:211], v250 offset:4608
  s_waitcnt lgkmcnt(10)
  v_mfma_f32_16x16x32_bf16 v[144:147], v[216:219], v[72:75], v[144:147]
  ds_read_b64_tr_b16 v[212:213], v251 offset:4096
  v_mfma_f32_16x16x32_bf16 v[148:151], v[216:219], v[88:91], v[148:151]
  ds_read_b64_tr_b16 v[214:215], v251 offset:4608
  v_mfma_f32_16x16x32_bf16 v[144:147], v[220:223], v[76:79], v[144:147]
  ds_read_b64_tr_b16 v[216:217], v252 offset:4096
  v_mfma_f32_16x16x32_bf16 v[148:151], v[220:223], v[92:95], v[148:151]
  ds_read_b64_tr_b16 v[218:219], v252 offset:4608
  s_waitcnt lgkmcnt(10)
  v_mfma_f32_16x16x32_bf16 v[96:99], v[192:195], a[0:3], 0
  ds_read_b64_tr_b16 v[220:221], v253 offset:4096
  v_mfma_f32_16x16x32_bf16 v[100:103], v[192:195], a[4:7], 0
  ds_read_b64_tr_b16 v[222:223], v253 offset:4608
  v_mfma_f32_16x16x32_bf16 v[104:107], v[196:199], a[0:3], 0
  v_mfma_f32_16x16x32_bf16 v[108:111], v[196:199], a[4:7], 0
  s_waitcnt lgkmcnt(8)
  v_mfma_f32_16x16x32_bf16 v[112:115], v[200:203], a[0:3], 0
  v_mfma_f32_16x16x32_bf16 v[116:119], v[200:203], a[4:7], 0
  v_mfma_f32_16x16x32_bf16 v[120:123], v[204:207], a[0:3], 0
  v_mfma_f32_16x16x32_bf16 v[124:127], v[204:207], a[4:7], 0
  s_waitcnt lgkmcnt(0)
  s_barrier
  ds_read_b128 v[192:195], v228 offset:8704
  ds_read_b128 v[196:199], v228 offset:8768
  ds_read_b128 v[200:203], v228 offset:8832
  ds_read_b128 v[204:207], v228 offset:8896
  v_mfma_f32_16x16x32_bf16 v[96:99], v[208:211], a[8:11], v[96:99]
  v_mfma_f32_16x16x32_bf16 v[100:103], v[208:211], a[12:15], v[100:103]
  ds_read_b128 v[208:211], v228 offset:13056
  v_mfma_f32_16x16x32_bf16 v[104:107], v[212:215], a[8:11], v[104:107]
  v_mfma_f32_16x16x32_bf16 v[108:111], v[212:215], a[12:15], v[108:111]
  ds_read_b128 v[212:215], v228 offset:13120
  v_mfma_f32_16x16x32_bf16 v[112:115], v[216:219], a[8:11], v[112:115]
  v_mfma_f32_16x16x32_bf16 v[116:119], v[216:219], a[12:15], v[116:119]
  ds_read_b128 v[216:219], v228 offset:13184
  v_mfma_f32_16x16x32_bf16 v[120:123], v[220:223], a[8:11], v[120:123]
  v_mfma_f32_16x16x32_bf16 v[124:127], v[220:223], a[12:15], v[124:127]
  s_waitcnt lgkmcnt(5)
  v_mfma_f32_16x16x32_bf16 v[152:155], v[192:195], v[64:67], v[168:171]
  ds_read_b128 v[220:223], v228 offset:13248
  v_exp_f32 v224, v136
  v_mfma_f32_16x16x32_bf16 v[156:159], v[192:195], v[80:83], v[172:175]
  v_exp_f32 v225, v137
  v_mfma_f32_16x16x32_bf16 v[152:155], v[196:199], v[68:71], v[152:155]
  ds_read_b64_tr_b16 v[192:193], v250 offset:8192
  v_exp_f32 v226, v138
  v_add_f32 v243, v224, v225
  v_mfma_f32_16x16x32_bf16 v[156:159], v[196:199], v[84:87], v[156:159]
  ds_read_b64_tr_b16 v[194:195], v250 offset:8704
  v_exp_f32 v227, v139
  s_waitcnt lgkmcnt(6)
  v_mfma_f32_16x16x32_bf16 v[152:155], v[200:203], v[72:75], v[152:155]
  ds_read_b64_tr_b16 v[196:197], v251 offset:8192
  v_cvt_pk_bf16_f32 v176, v224, v225
  v_exp_f32 v224, v144
  v_mfma_f32_16x16x32_bf16 v[156:159], v[200:203], v[88:91], v[156:159]
  ds_read_b64_tr_b16 v[198:199], v251 offset:8704
  v_add_f32 v243, v243, v226
  v_mfma_f32_16x16x32_bf16 v[152:155], v[204:207], v[76:79], v[152:155]
  ds_read_b64_tr_b16 v[200:201], v252 offset:8192
  v_exp_f32 v225, v145
  v_mfma_f32_16x16x32_bf16 v[156:159], v[204:207], v[92:95], v[156:159]
  ds_read_b64_tr_b16 v[202:203], v252 offset:8704
  v_cvt_pk_bf16_f32 v177, v226, v227
  v_add_f32 v243, v243, v227
  s_waitcnt lgkmcnt(8)
  v_mfma_f32_16x16x32_bf16 v[160:163], v[208:211], v[64:67], v[168:171]
  ds_read_b64_tr_b16 v[204:205], v253 offset:8192
  v_exp_f32 v226, v146
  v_mfma_f32_16x16x32_bf16 v[164:167], v[208:211], v[80:83], v[172:175]
  ds_read_b64_tr_b16 v[206:207], v253 offset:8704
  v_add_f32 v243, v243, v224
  v_exp_f32 v227, v147
  v_mfma_f32_16x16x32_bf16 v[160:163], v[212:215], v[68:71], v[160:163]
  ds_read_b64_tr_b16 v[208:209], v250 offset:12288
  v_cvt_pk_bf16_f32 v178, v224, v225
  v_mfma_f32_16x16x32_bf16 v[164:167], v[212:215], v[84:87], v[164:167]
  ds_read_b64_tr_b16 v[210:211], v250 offset:12800
  v_add_f32 v243, v243, v225
  s_waitcnt lgkmcnt(10)
  v_mfma_f32_16x16x32_bf16 v[160:163], v[216:219], v[72:75], v[160:163]
  ds_read_b64_tr_b16 v[212:213], v251 offset:12288
  v_exp_f32 v224, v140
  v_add_f32 v243, v243, v226
  v_mfma_f32_16x16x32_bf16 v[164:167], v[216:219], v[88:91], v[164:167]
  ds_read_b64_tr_b16 v[214:215], v251 offset:12800
  v_exp_f32 v225, v141
  v_mfma_f32_16x16x32_bf16 v[160:163], v[220:223], v[76:79], v[160:163]
  ds_read_b64_tr_b16 v[216:217], v252 offset:12288
  v_cvt_pk_bf16_f32 v179, v226, v227
  v_add_f32 v243, v243, v227
  v_mfma_f32_16x16x32_bf16 v[164:167], v[220:223], v[92:95], v[164:167]
  ds_read_b64_tr_b16 v[218:219], v252 offset:12800
  v_exp_f32 v226, v142
  s_waitcnt lgkmcnt(10)
  v_mfma_f32_16x16x32_bf16 v[96:99], v[192:195], a[16:19], v[96:99]
  ds_read_b64_tr_b16 v[220:221], v253 offset:12288
  v_add_f32 v244, v224, v225
  v_mfma_f32_16x16x32_bf16 v[100:103], v[192:195], a[20:23], v[100:103]
  ds_read_b64_tr_b16 v[222:223], v253 offset:12800
  v_exp_f32 v227, v143
  v_cvt_pk_bf16_f32 v180, v224, v225
  v_mfma_f32_16x16x32_bf16 v[104:107], v[196:199], a[16:19], v[104:107]
  v_exp_f32 v224, v148
  v_mfma_f32_16x16x32_bf16 v[108:111], v[196:199], a[20:23], v[108:111]
  v_add_f32 v244, v244, v226
  v_exp_f32 v225, v149
  s_waitcnt lgkmcnt(8)
  v_mfma_f32_16x16x32_bf16 v[112:115], v[200:203], a[16:19], v[112:115]
  v_cvt_pk_bf16_f32 v181, v226, v227
  v_mfma_f32_16x16x32_bf16 v[116:119], v[200:203], a[20:23], v[116:119]
  v_add_f32 v244, v244, v227
  v_mfma_f32_16x16x32_bf16 v[120:123], v[204:207], a[16:19], v[120:123]
  v_exp_f32 v226, v150
  v_add_f32 v244, v244, v224
  v_mfma_f32_16x16x32_bf16 v[124:127], v[204:207], a[20:23], v[124:127]
  s_waitcnt lgkmcnt(0)
  s_barrier
  ds_read_b128 v[192:195], v228 offset:17408
  ds_read_b128 v[196:199], v228 offset:17472
  ds_read_b128 v[200:203], v228 offset:17536
  ds_read_b128 v[204:207], v228 offset:17600
  v_exp_f32 v227, v151
  v_mfma_f32_16x16x32_bf16 v[96:99], v[208:211], a[24:27], v[96:99]
  v_cvt_pk_bf16_f32 v182, v224, v225
  v_add_f32 v244, v244, v225
  v_mfma_f32_16x16x32_bf16 v[100:103], v[208:211], a[28:31], v[100:103]
  ds_read_b128 v[208:211], v228 offset:21760
  v_add_f32 v244, v244, v226
  v_mfma_f32_16x16x32_bf16 v[104:107], v[212:215], a[24:27], v[104:107]
  v_cvt_pk_bf16_f32 v183, v226, v227
  v_mfma_f32_16x16x32_bf16 v[108:111], v[212:215], a[28:31], v[108:111]
  ds_read_b128 v[212:215], v228 offset:21824
  v_add_f32 v244, v244, v227
  v_add_f32 v245, v243, v244
  v_mfma_f32_16x16x32_bf16 v[112:115], v[216:219], a[24:27], v[112:115]
  v_cmp_nge_f32 vcc, s94, v245
  v_mfma_f32_16x16x32_bf16 v[116:119], v[216:219], a[28:31], v[116:119]
  ds_read_b128 v[216:219], v228 offset:21888
  v_min_f32 v245, v243, v244
  v_cmp_nle_f32 s[38:39], s40, v245
  v_mfma_f32_16x16x32_bf16 v[120:123], v[220:223], a[24:27], v[120:123]
  v_mfma_f32_16x16x32_bf16 v[124:127], v[220:223], a[28:31], v[124:127]
  s_nop 0
  s_or_b64 vcc, s[38:39], vcc
  v_mov_b32 v241, 0
  v_mov_b32 v242, 0
  s_cbranch_vccnz T_h1
  v_add_f32 v241, v241, v243
  v_add_f32 v242, v242, v244
R_h1:
  s_waitcnt lgkmcnt(5)
  v_mfma_f32_16x16x32_bf16 v[136:139], v[192:195], v[64:67], v[168:171]
  ds_read_b128 v[220:223], v228 offset:21952
  v_mfma_f32_16x16x32_bf16 v[140:143], v[192:195], v[80:83], v[172:175]
  v_exp_f32 v224, v152
  v_exp_f32 v225, v153
  v_mfma_f32_16x16x32_bf16 v[136:139], v[196:199], v[68:71], v[136:139]
  ds_read_b64_tr_b16 v[192:193], v229 offset:16384
  v_exp_f32 v226, v154
  v_mfma_f32_16x16x32_bf16 v[140:143], v[196:199], v[84:87], v[140:143]
  ds_read_b64_tr_b16 v[194:195], v229 offset:20480
  v_add_f32 v243, v224, v225
  s_waitcnt lgkmcnt(6)
  v_mfma_f32_16x16x32_bf16 v[136:139], v[200:203], v[72:75], v[136:139]
  ds_read_b64_tr_b16 v[196:197], v230 offset:16384
  v_exp_f32 v227, v155
  v_mfma_f32_16x16x32_bf16 v[140:143], v[200:203], v[88:91], v[140:143]
  ds_read_b64_tr_b16 v[198:199], v230 offset:20480
  v_mfma_f32_16x16x32_bf16 v[136:139], v[204:207], v[76:79], v[136:139]
  ds_read_b64_tr_b16 v[200:201], v231 offset:16384
  v_cvt_pk_bf16_f32 v184, v224, v225
  v_mfma_f32_16x16x32_bf16 v[140:143], v[204:207], v[92:95], v[140:143]
  ds_read_b64_tr_b16 v[202:203], v231 offset:20480
  v_exp_f32 v224, v160
  s_waitcnt lgkmcnt(8)
  v_mfma_f32_16x16x32_bf16 v[144:147], v[208:211], v[64:67], v[168:171]
  ds_read_b64_tr_b16 v[204:205], v232 offset:16384
  v_add_f32 v243, v243, v226
  v_mfma_f32_16x16x32_bf16 v[148:151], v[208:211], v[80:83], v[172:175]
  ds_read_b64_tr_b16 v[206:207], v232 offset:20480
  v_exp_f32 v225, v161
  v_mfma_f32_16x16x32_bf16 v[144:147], v[212:215], v[68:71], v[144:147]
  ds_read_b64_tr_b16 v[208:209], v233 offset:16384
  v_cvt_pk_bf16_f32 v185, v226, v227
  v_mfma_f32_16x16x32_bf16 v[148:151], v[212:215], v[84:87], v[148:151]
  ds_read_b64_tr_b16 v[210:211], v233 offset:20480
  s_waitcnt lgkmcnt(10)
  v_mfma_f32_16x16x32_bf16 v[144:147], v[216:219], v[72:75], v[144:147]
  ds_read_b64_tr_b16 v[212:213], v234 offset:16384
  v_add_f32 v243, v243, v227
  v_mfma_f32_16x16x32_bf16 v[148:151], v[216:219], v[88:91], v[148:151]
  ds_read_b64_tr_b16 v[214:215], v234 offset:20480
  v_exp_f32 v226, v162
  v_mfma_f32_16x16x32_bf16 v[144:147], v[220:223], v[76:79], v[144:147]
  ds_read_b64_tr_b16 v[216:217], v235 offset:16384
  v_add_f32 v243, v243, v224
  v_mfma_f32_16x16x32_bf16 v[148:151], v[220:223], v[92:95], v[148:151]
  ds_read_b64_tr_b16 v[218:219], v235 offset:20480
  v_exp_f32 v227, v163
  s_waitcnt lgkmcnt(10)
  v_mfma_f32_16x16x32_bf16 v[0:3], v[192:195], v[176:179], 0
  ds_read_b64_tr_b16 v[220:221], v236 offset:16384
  v_cvt_pk_bf16_f32 v186, v224, v225
  v_mfma_f32_16x16x32_bf16 v[4:7], v[192:195], v[180:183], 0
  ds_read_b64_tr_b16 v[222:223], v236 offset:20480
  v_mfma_f32_16x16x32_bf16 v[8:11], v[196:199], v[176:179], 0
  ds_read_b64_tr_b16 v[192:193], v250 offset:16384
  v_add_f32 v243, v243, v225
  v_mfma_f32_16x16x32_bf16 v[12:15], v[196:199], v[180:183], 0
  ds_read_b64_tr_b16 v[194:195], v250 offset:16896
  v_exp_f32 v224, v156
  s_waitcnt lgkmcnt(10)
  v_mfma_f32_16x16x32_bf16 v[16:19], v[200:203], v[176:179], 0
  ds_read_b64_tr_b16 v[196:197], v251 offset:16384
  v_add_f32 v243, v243, v226
  v_mfma_f32_16x16x32_bf16 v[20:23], v[200:203], v[180:183], 0
  ds_read_b64_tr_b16 v[198:199], v251 offset:16896
  v_exp_f32 v225, v157
  v_mfma_f32_16x16x32_bf16 v[24:27], v[204:207], v[176:179], 0
  ds_read_b64_tr_b16 v[200:201], v252 offset:16384
  v_cvt_pk_bf16_f32 v187, v226, v227
  v_mfma_f32_16x16x32_bf16 v[28:31], v[204:207], v[180:183], 0
  ds_read_b64_tr_b16 v[202:203], v252 offset:16896
  s_waitcnt lgkmcnt(10)
  v_mfma_f32_16x16x32_bf16 v[32:35], v[208:211], v[176:179], 0
  ds_read_b64_tr_b16 v[204:205], v253 offset:16384
  v_add_f32 v243, v243, v227
  v_mfma_f32_16x16x32_bf16 v[36:39], v[208:211], v[180:183], 0
  ds_read_b64_tr_b16 v[206:207], v253 offset:16896
  v_exp_f32 v226, v158
  v_mfma_f32_16x16x32_bf16 v[40:43], v[212:215], v[176:179], 0
  ds_read_b64_tr_b16 v[208:209], v250 offset:20480
  v_add_f32 v244, v224, v225
  v_mfma_f32_16x16x32_bf16 v[44:47], v[212:215], v[180:183], 0
  ds_read_b64_tr_b16 v[210:211], v250 offset:20992
  v_exp_f32 v227, v159
  s_waitcnt lgkmcnt(10)
  v_mfma_f32_16x16x32_bf16 v[48:51], v[216:219], v[176:179], 0
  ds_read_b64_tr_b16 v[212:213], v251 offset:20480
  v_cvt_pk_bf16_f32 v188, v224, v225
  v_mfma_f32_16x16x32_bf16 v[52:55], v[216:219], v[180:183], 0
  ds_read_b64_tr_b16 v[214:215], v251 offset:20992
  v_mfma_f32_16x16x32_bf16 v[56:59], v[220:223], v[176:179], 0
  ds_read_b64_tr_b16 v[216:217], v252 offset:20480
  v_exp_f32 v224, v164
  v_mfma_f32_16x16x32_bf16 v[60:63], v[220:223], v[180:183], 0
  ds_read_b64_tr_b16 v[218:219], v252 offset:20992
  v_add_f32 v244, v244, v226
  s_waitcnt lgkmcnt(10)
  v_mfma_f32_16x16x32_bf16 v[96:99], v[192:195], a[32:35], v[96:99]
  ds_read_b64_tr_b16 v[220:221], v253 offset:20480
  v_exp_f32 v225, v165
  v_mfma_f32_16x16x32_bf16 v[100:103], v[192:195], a[36:39], v[100:103]
  ds_read_b64_tr_b16 v[222:223], v253 offset:20992
  v_cvt_pk_bf16_f32 v189, v226, v227
  v_mfma_f32_16x16x32_bf16 v[104:107], v[196:199], a[32:35], v[104:107]
  v_add_f32 v244, v244, v227
  v_mfma_f32_16x16x32_bf16 v[108:111], v[196:199], a[36:39], v[108:111]
  v_exp_f32 v226, v166
  s_waitcnt lgkmcnt(8)
  v_mfma_f32_16x16x32_bf16 v[112:115], v[200:203], a[32:35], v[112:115]
  v_add_f32 v244, v244, v224
  v_exp_f32 v227, v167
  v_mfma_f32_16x16x32_bf16 v[116:119], v[200:203], a[36:39], v[116:119]
  v_cvt_pk_bf16_f32 v190, v224, v225
  v_mfma_f32_16x16x32_bf16 v[120:123], v[204:207], a[32:35], v[120:123]
  v_add_f32 v244, v244, v225
  v_mfma_f32_16x16x32_bf16 v[124:127], v[204:207], a[36:39], v[124:127]
  s_waitcnt lgkmcnt(0)
  s_barrier
  ds_read_b128 v[192:195], v228 offset:26112
  ds_read_b128 v[196:199], v228 offset:26176
  ds_read_b128 v[200:203], v228 offset:26240
  ds_read_b128 v[204:207], v228 offset:26304
  v_mfma_f32_16x16x32_bf16 v[96:99], v[208:211], a[40:43], v[96:99]
  v_add_f32 v244, v244, v226
  v_mfma_f32_16x16x32_bf16 v[100:103], v[208:211], a[44:47], v[100:103]
  ds_read_b128 v[208:211], v228 offset:30464
  v_mfma_f32_16x16x32_bf16 v[104:107], v[212:215], a[40:43], v[104:107]
  v_cvt_pk_bf16_f32 v191, v226, v227
  v_mfma_f32_16x16x32_bf16 v[108:111], v[212:215], a[44:47], v[108:111]
  ds_read_b128 v[212:215], v228 offset:30528
  v_mfma_f32_16x16x32_bf16 v[112:115], v[216:219], a[40:43], v[112:115]
  v_add_f32 v244, v244, v227
  v_mfma_f32_16x16x32_bf16 v[116:119], v[216:219], a[44:47], v[116:119]
  ds_read_b128 v[216:219], v228 offset:30592
  v_add_f32 v245, v243, v244
  v_mfma_f32_16x16x32_bf16 v[120:123], v[220:223], a[40:43], v[120:123]
  v_cmp_nge_f32 vcc, s94, v245
  v_mfma_f32_16x16x32_bf16 v[124:127], v[220:223], a[44:47], v[124:127]
  s_cbranch_vccnz T_h2
  v_add_f32 v241, v241, v243
  v_add_f32 v242, v242, v244
R_h2:
  s_waitcnt lgkmcnt(5)
  v_mfma_f32_16x16x32_bf16 v[152:155], v[192:195], v[64:67], v[168:171]
  ds_read_b128 v[220:223], v228 offset:30656
  v_mfma_f32_16x16x32_bf16 v[156:159], v[192:195], v[80:83], v[172:175]
  v_exp_f32 v224, v136
  v_exp_f32 v225, v137
  v_mfma_f32_16x16x32_bf16 v[152:155], v[196:199], v[68:71], v[152:155]
  ds_read_b64_tr_b16 v[192:193], v229 offset:24576
  v_exp_f32 v226, v138
  v_mfma_f32_16x16x32_bf16 v[156:159], v[196:199], v[84:87], v[156:159]
  ds_read_b64_tr_b16 v[194:195], v229 offset:28672
  v_add_f32 v243, v224, v225
  s_waitcnt lgkmcnt(6)
  v_mfma_f32_16x16x32_bf16 v[152:155], v[200:203], v[72:75], v[152:155]
  ds_read_b64_tr_b16 v[196:197], v230 offset:24576
  v_exp_f32 v227, v139
  v_mfma_f32_16x16x32_bf16 v[156:159], v[200:203], v[88:91], v[156:159]
  ds_read_b64_tr_b16 v[198:199], v230 offset:28672
  v_mfma_f32_16x16x32_bf16 v[152:155], v[204:207], v[76:79], v[152:155]
  ds_read_b64_tr_b16 v[200:201], v231 offset:24576
  v_cvt_pk_bf16_f32 v176, v224, v225
  v_mfma_f32_16x16x32_bf16 v[156:159], v[204:207], v[92:95], v[156:159]
  ds_read_b64_tr_b16 v[202:203], v231 offset:28672
  v_exp_f32 v224, v144
  s_waitcnt lgkmcnt(8)
  v_mfma_f32_16x16x32_bf16 v[160:163], v[208:211], v[64:67], v[168:171]
  ds_read_b64_tr_b16 v[204:205], v232 offset:24576
  v_add_f32 v243, v243, v226
  v_mfma_f32_16x16x32_bf16 v[164:167], v[208:211], v[80:83], v[172:175]
  ds_read_b64_tr_b16 v[206:207], v232 offset:28672
  v_exp_f32 v225, v145
  v_mfma_f32_16x16x32_bf16 v[160:163], v[212:215], v[68:71], v[160:163]
  ds_read_b64_tr_b16 v[208:209], v233 offset:24576
  v_cvt_pk_bf16_f32 v177, v226, v227
  v_mfma_f32_16x16x32_bf16 v[164:167], v[212:215], v[84:87], v[164:167]
  ds_read_b64_tr_b16 v[210:211], v233 offset:28672
  s_waitcnt lgkmcnt(10)
  v_mfma_f32_16x16x32_bf16 v[160:163], v[216:219], v[72:75], v[160:163]
  ds_read_b64_tr_b16 v[212:213], v234 offset:24576
  v_add_f32 v243, v243, v227
  v_mfma_f32_16x16x32_bf16 v[164:167], v[216:219], v[88:91], v[164:167]
  ds_read_b64_tr_b16 v[214:215], v234 offset:28672
  v_exp_f32 v226, v146
  v_mfma_f32_16x16x32_bf16 v[160:163], v[220:223], v[76:79], v[160:163]
  ds_read_b64_tr_b16 v[216:217], v235 offset:24576
  v_add_f32 v243, v243, v224
  v_mfma_f32_16x16x32_bf16 v[164:167], v[220:223], v[92:95], v[164:167]
  ds_read_b64_tr_b16 v[218:219], v235 offset:28672
  v_exp_f32 v227, v147
  s_waitcnt lgkmcnt(10)
  v_mfma_f32_16x16x32_bf16 v[0:3], v[192:195], v[184:187], v[0:3]
  ds_read_b64_tr_b16 v[220:221], v236 offset:24576
  v_cvt_pk_bf16_f32 v178, v224, v225
  v_mfma_f32_16x16x32_bf16 v[4:7], v[192:195], v[188:191], v[4:7]
  ds_read_b64_tr_b16 v[222:223], v236 offset:28672
  v_mfma_f32_16x16x32_bf16 v[8:11], v[196:199], v[184:187], v[8:11]
  ds_read_b64_tr_b16 v[192:193], v250 offset:24576
  v_add_f32 v243, v243, v225
  v_mfma_f32_16x16x32_bf16 v[12:15], v[196:199], v[188:191], v[12:15]
  ds_read_b64_tr_b16 v[194:195], v250 offset:25088
  v_exp_f32 v224, v140
  s_waitcnt lgkmcnt(10)
  v_mfma_f32_16x16x32_bf16 v[16:19], v[200:203], v[184:187], v[16:19]
  ds_read_b64_tr_b16 v[196:197], v251 offset:24576
  v_add_f32 v243, v243, v226
  v_mfma_f32_16x16x32_bf16 v[20:23], v[200:203], v[188:191], v[20:23]
  ds_read_b64_tr_b16 v[198:199], v251 offset:25088
  v_exp_f32 v225, v141
  v_mfma_f32_16x16x32_bf16 v[24:27], v[204:207], v[184:187], v[24:27]
  ds_read_b64_tr_b16 v[200:201], v252 offset:24576
  v_cvt_pk_bf16_f32 v179, v226, v227
  v_mfma_f32_16x16x32_bf16 v[28:31], v[204:207], v[188:191], v[28:31]
  ds_read_b64_tr_b16 v[202:203], v252 offset:25088
  s_waitcnt lgkmcnt(10)
  v_mfma_f32_16x16x32_bf16 v[32:35], v[208:211], v[184:187], v[32:35]
  ds_read_b64_tr_b16 v[204:205], v253 offset:24576
  v_add_f32 v243, v243, v227
  v_mfma_f32_16x16x32_bf16 v[36:39], v[208:211], v[188:191], v[36:39]
  ds_read_b64_tr_b16 v[206:207], v253 offset:25088
  v_exp_f32 v226, v142
  v_mfma_f32_16x16x32_bf16 v[40:43], v[212:215], v[184:187], v[40:43]
  ds_read_b64_tr_b16 v[208:209], v250 offset:28672
  v_add_f32 v244, v224, v225
  v_mfma_f32_16x16x32_bf16 v[44:47], v[212:215], v[188:191], v[44:47]
  ds_read_b64_tr_b16 v[210:211], v250 offset:29184
  v_exp_f32 v227, v143
  s_waitcnt lgkmcnt(10)
  v_mfma_f32_16x16x32_bf16 v[48:51], v[216:219], v[184:187], v[48:51]
  ds_read_b64_tr_b16 v[212:213], v251 offset:28672
  v_cvt_pk_bf16_f32 v180, v224, v225
  v_mfma_f32_16x16x32_bf16 v[52:55], v[216:219], v[188:191], v[52:55]
  ds_read_b64_tr_b16 v[214:215], v251 offset:29184
  v_mfma_f32_16x16x32_bf16 v[56:59], v[220:223], v[184:187], v[56:59]
  ds_read_b64_tr_b16 v[216:217], v252 offset:28672
  v_exp_f32 v224, v148
  v_mfma_f32_16x16x32_bf16 v[60:63], v[220:223], v[188:191], v[60:63]
  ds_read_b64_tr_b16 v[218:219], v252 offset:29184
  v_add_f32 v244, v244, v226
  s_waitcnt lgkmcnt(10)
  v_mfma_f32_16x16x32_bf16 v[96:99], v[192:195], a[48:51], v[96:99]
  ds_read_b64_tr_b16 v[220:221], v253 offset:28672
  v_exp_f32 v225, v149
  v_mfma_f32_16x16x32_bf16 v[100:103], v[192:195], a[52:55], v[100:103]
  ds_read_b64_tr_b16 v[222:223], v253 offset:29184
  v_cvt_pk_bf16_f32 v181, v226, v227
  v_mfma_f32_16x16x32_bf16 v[104:107], v[196:199], a[48:51], v[104:107]
  v_add_f32 v244, v244, v227
  v_mfma_f32_16x16x32_bf16 v[108:111], v[196:199], a[52:55], v[108:111]
  v_exp_f32 v226, v150
  s_waitcnt lgkmcnt(8)
  v_mfma_f32_16x16x32_bf16 v[112:115], v[200:203], a[48:51], v[112:115]
  v_add_f32 v244, v244, v224
  v_exp_f32 v227, v151
  v_mfma_f32_16x16x32_bf16 v[116:119], v[200:203], a[52:55], v[116:119]
  v_cvt_pk_bf16_f32 v182, v224, v225
  v_mfma_f32_16x16x32_bf16 v[120:123], v[204:207], a[48:51], v[120:123]
  v_add_f32 v244, v244, v225
  v_mfma_f32_16x16x32_bf16 v[124:127], v[204:207], a[52:55], v[124:127]
  s_waitcnt lgkmcnt(0)
  s_barrier
  ds_read_b128 v[192:195], v228 offset:0
  ds_read_b128 v[196:199], v228 offset:64
  ds_read_b128 v[200:203], v228 offset:128
  ds_read_b128 v[204:207], v228 offset:192
  v_mfma_f32_16x16x32_bf16 v[96:99], v[208:211], a[56:59], v[96:99]
  v_add_f32 v244, v244, v226
  v_mfma_f32_16x16x32_bf16 v[100:103], v[208:211], a[60:63], v[100:103]
  ds_read_b128 v[208:211], v228 offset:4352
  v_mfma_f32_16x16x32_bf16 v[104:107], v[212:215], a[56:59], v[104:107]
  v_cvt_pk_bf16_f32 v183, v226, v227
  v_mfma_f32_16x16x32_bf16 v[108:111], v[212:215], a[60:63], v[108:111]
  ds_read_b128 v[212:215], v228 offset:4416
  v_mfma_f32_16x16x32_bf16 v[112:115], v[216:219], a[56:59], v[112:115]
  v_add_f32 v244, v244, v227
  v_mfma_f32_16x16x32_bf16 v[116:119], v[216:219], a[60:63], v[116:119]
  ds_read_b128 v[216:219], v228 offset:4480
  v_add_f32 v245, v243, v244
  v_mfma_f32_16x16x32_bf16 v[120:123], v[220:223], a[56:59], v[120:123]
  v_cmp_nge_f32 vcc, s94, v245
  v_mfma_f32_16x16x32_bf16 v[124:127], v[220:223], a[60:63], v[124:127]
  s_cbranch_vccnz T_h3
  v_add_f32 v241, v241, v243
  v_add_f32 v242, v242, v244
R_h3:
  s_waitcnt lgkmcnt(5)
  v_mfma_f32_16x16x32_bf16 v[136:139], v[192:195], v[64:67], v[168:171]
  ds_read_b128 v[220:223], v228 offset:4544
  v_mfma_f32_16x16x32_bf16 v[140:143], v[192:195], v[80:83], v[172:175]
  v_exp_f32 v224, v152
  v_exp_f32 v225, v153
  v_mfma_f32_16x16x32_bf16 v[136:139], v[196:199], v[68:71], v[136:139]
  ds_read_b64_tr_b16 v[192:193], v229 offset:0
  v_exp_f32 v226, v154
  v_mfma_f32_16x16x32_bf16 v[140:143], v[196:199], v[84:87], v[140:143]
  ds_read_b64_tr_b16 v[194:195], v229 offset:4096
  v_add_f32 v243, v224, v225
  s_waitcnt lgkmcnt(6)
  v_mfma_f32_16x16x32_bf16 v[136:139], v[200:203], v[72:75], v[136:139]
  ds_read_b64_tr_b16 v[196:197], v230 offset:0
  v_exp_f32 v227, v155
  v_mfma_f32_16x16x32_bf16 v[140:143], v[200:203], v[88:91], v[140:143]
  ds_read_b64_tr_b16 v[198:199], v230 offset:4096
  v_mfma_f32_16x16x32_bf16 v[136:139], v[204:207], v[76:79], v[136:139]
  ds_read_b64_tr_b16 v[200:201], v231 offset:0
  v_cvt_pk_bf16_f32 v184, v224, v225
  v_mfma_f32_16x16x32_bf16 v[140:143], v[204:207], v[92:95], v[140:143]
  ds_read_b64_tr_b16 v[202:203], v231 offset:4096
  v_exp_f32 v224, v160
  s_waitcnt lgkmcnt(8)
  v_mfma_f32_16x16x32_bf16 v[144:147], v[208:211], v[64:67], v[168:171]
  ds_read_b64_tr_b16 v[204:205], v232 offset:0
  v_add_f32 v243, v243, v226
  v_mfma_f32_16x16x32_bf16 v[148:151], v[208:211], v[80:83], v[172:175]
  ds_read_b64_tr_b16 v[206:207], v232 offset:4096
  v_exp_f32 v225, v161
  v_mfma_f32_16x16x32_bf16 v[144:147], v[212:215], v[68:71], v[144:147]
  ds_read_b64_tr_b16 v[208:209], v233 offset:0
  v_cvt_pk_bf16_f32 v185, v226, v227
  v_mfma_f32_16x16x32_bf16 v[148:151], v[212:215], v[84:87], v[148:151]
  ds_read_b64_tr_b16 v[210:211], v233 offset:4096
  s_waitcnt lgkmcnt(10)
  v_mfma_f32_16x16x32_bf16 v[144:147], v[216:219], v[72:75], v[144:147]
  ds_read_b64_tr_b16 v[212:213], v234 offset:0
  v_add_f32 v243, v243, v227
  v_mfma_f32_16x16x32_bf16 v[148:151], v[216:219], v[88:91], v[148:151]
  ds_read_b64_tr_b16 v[214:215], v234 offset:4096
  v_exp_f32 v226, v162
  v_mfma_f32_16x16x32_bf16 v[144:147], v[220:223], v[76:79], v[144:147]
  ds_read_b64_tr_b16 v[216:217], v235 offset:0
  v_add_f32 v243, v243, v224
  v_mfma_f32_16x16x32_bf16 v[148:151], v[220:223], v[92:95], v[148:151]
  ds_read_b64_tr_b16 v[218:219], v235 offset:4096
  v_exp_f32 v227, v163
  s_waitcnt lgkmcnt(10)
  v_mfma_f32_16x16x32_bf16 v[0:3], v[192:195], v[176:179], v[0:3]
  ds_read_b64_tr_b16 v[220:221], v236 offset:0
  v_cvt_pk_bf16_f32 v186, v224, v225
  v_mfma_f32_16x16x32_bf16 v[4:7], v[192:195], v[180:183], v[4:7]
  ds_read_b64_tr_b16 v[222:223], v236 offset:4096
  v_mfma_f32_16x16x32_bf16 v[8:11], v[196:199], v[176:179], v[8:11]
  ds_read_b64_tr_b16 v[192:193], v250 offset:0
  v_add_f32 v243, v243, v225
  v_mfma_f32_16x16x32_bf16 v[12:15], v[196:199], v[180:183], v[12:15]
  ds_read_b64_tr_b16 v[194:195], v250 offset:512
  v_exp_f32 v224, v156
  s_waitcnt lgkmcnt(10)
  v_mfma_f32_16x16x32_bf16 v[16:19], v[200:203], v[176:179], v[16:19]
  ds_read_b64_tr_b16 v[196:197], v251 offset:0
  v_add_f32 v243, v243, v226
  v_mfma_f32_16x16x32_bf16 v[20:23], v[200:203], v[180:183], v[20:23]
  ds_read_b64_tr_b16 v[198:199], v251 offset:512
  v_exp_f32 v225, v157
  v_mfma_f32_16x16x32_bf16 v[24:27], v[204:207], v[176:179], v[24:27]
  ds_read_b64_tr_b16 v[200:201], v252 offset:0
  v_cvt_pk_bf16_f32 v187, v226, v227
  v_mfma_f32_16x16x32_bf16 v[28:31], v[204:207], v[180:183], v[28:31]
  ds_read_b64_tr_b16 v[202:203], v252 offset:512
  s_waitcnt lgkmcnt(10)
  v_mfma_f32_16x16x32_bf16 v[32:35], v[208:211], v[176:179], v[32:35]
  ds_read_b64_tr_b16 v[204:205], v253 offset:0
  v_add_f32 v243, v243, v227
  v_mfma_f32_16x16x32_bf16 v[36:39], v[208:211], v[180:183], v[36:39]
  ds_read_b64_tr_b16 v[206:207], v253 offset:512
  v_exp_f32 v226, v158
  v_mfma_f32_16x16x32_bf16 v[40:43], v[212:215], v[176:179], v[40:43]
  ds_read_b64_tr_b16 v[208:209], v250 offset:4096
  v_add_f32 v244, v224, v225
  v_mfma_f32_16x16x32_bf16 v[44:47], v[212:215], v[180:183], v[44:47]
  ds_read_b64_tr_b16 v[210:211], v250 offset:4608
  v_exp_f32 v227, v159
  s_waitcnt lgkmcnt(10)
  v_mfma_f32_16x16x32_bf16 v[48:51], v[216:219], v[176:179], v[48:51]
  ds_read_b64_tr_b16 v[212:213], v251 offset:4096
  v_cvt_pk_bf16_f32 v188, v224, v225
  v_mfma_f32_16x16x32_bf16 v[52:55], v[216:219], v[180:183], v[52:55]
  ds_read_b64_tr_b16 v[214:215], v251 offset:4608
  v_mfma_f32_16x16x32_bf16 v[56:59], v[220:223], v[176:179], v[56:59]
  ds_read_b64_tr_b16 v[216:217], v252 offset:4096
  v_exp_f32 v224, v164
  v_mfma_f32_16x16x32_bf16 v[60:63], v[220:223], v[180:183], v[60:63]
  ds_read_b64_tr_b16 v[218:219], v252 offset:4608
  v_add_f32 v244, v244, v226
  s_waitcnt lgkmcnt(10)
  v_mfma_f32_16x16x32_bf16 v[96:99], v[192:195], a[64:67], v[96:99]
  ds_read_b64_tr_b16 v[220:221], v253 offset:4096
  v_exp_f32 v225, v165
  v_mfma_f32_16x16x32_bf16 v[100:103], v[192:195], a[68:71], v[100:103]
  ds_read_b64_tr_b16 v[222:223], v253 offset:4608
  v_cvt_pk_bf16_f32 v189, v226, v227
  v_mfma_f32_16x16x32_bf16 v[104:107], v[196:199], a[64:67], v[104:107]
  v_add_f32 v244, v244, v227
  v_mfma_f32_16x16x32_bf16 v[108:111], v[196:199], a[68:71], v[108:111]
  v_exp_f32 v226, v166
  s_waitcnt lgkmcnt(8)
  v_mfma_f32_16x16x32_bf16 v[112:115], v[200:203], a[64:67], v[112:115]
  v_add_f32 v244, v244, v224
  v_exp_f32 v227, v167
  v_mfma_f32_16x16x32_bf16 v[116:119], v[200:203], a[68:71], v[116:119]
  v_cvt_pk_bf16_f32 v190, v224, v225
  v_mfma_f32_16x16x32_bf16 v[120:123], v[204:207], a[64:67], v[120:123]
  v_add_f32 v244, v244, v225
  v_mfma_f32_16x16x32_bf16 v[124:127], v[204:207], a[68:71], v[124:127]
  s_waitcnt lgkmcnt(0)
  s_barrier
  ds_read_b128 v[192:195], v228 offset:8704
  ds_read_b128 v[196:199], v228 offset:8768
  ds_read_b128 v[200:203], v228 offset:8832
  ds_read_b128 v[204:207], v228 offset:8896
  v_mfma_f32_16x16x32_bf16 v[96:99], v[208:211], a[72:75], v[96:99]
  v_add_f32 v244, v244, v226
  v_mfma_f32_16x16x32_bf16 v[100:103], v[208:211], a[76:79], v[100:103]
  ds_read_b128 v[208:211], v228 offset:13056
  v_mfma_f32_16x16x32_bf16 v[104:107], v[212:215], a[72:75], v[104:107]
  v_cvt_pk_bf16_f32 v191, v226, v227
  v_mfma_f32_16x16x32_bf16 v[108:111], v[212:215], a[76:79], v[108:111]
  ds_read_b128 v[212:215], v228 offset:13120
  v_mfma_f32_16x16x32_bf16 v[112:115], v[216:219], a[72:75], v[112:115]
  v_add_f32 v244, v244, v227
  v_mfma_f32_16x16x32_bf16 v[116:119], v[216:219], a[76:79], v[116:119]
  ds_read_b128 v[216:219], v228 offset:13184
  v_add_f32 v245, v243, v244
  v_mfma_f32_16x16x32_bf16 v[120:123], v[220:223], a[72:75], v[120:123]
  v_cmp_nge_f32 vcc, s94, v245
  v_mfma_f32_16x16x32_bf16 v[124:127], v[220:223], a[76:79], v[124:127]
  s_cbranch_vccnz T_h4
  v_add_f32 v241, v241, v243
  v_add_f32 v242, v242, v244
R_h4:
  s_waitcnt lgkmcnt(5)
  v_mfma_f32_16x16x32_bf16 v[152:155], v[192:195], v[64:67], v[168:171]
  ds_read_b128 v[220:223], v228 offset:13248
  v_mfma_f32_16x16x32_bf16 v[156:159], v[192:195], v[80:83], v[172:175]
  v_exp_f32 v224, v136
  v_exp_f32 v225, v137
  v_mfma_f32_16x16x32_bf16 v[152:155], v[196:199], v[68:71], v[152:155]
  ds_read_b64_tr_b16 v[192:193], v229 offset:8192
  v_exp_f32 v226, v138
  v_mfma_f32_16x16x32_bf16 v[156:159], v[196:199], v[84:87], v[156:159]
  ds_read_b64_tr_b16 v[194:195], v229 offset:12288
  v_add_f32 v243, v224, v225
  s_waitcnt lgkmcnt(6)
  v_mfma_f32_16x16x32_bf16 v[152:155], v[200:203], v[72:75], v[152:155]
  ds_read_b64_tr_b16 v[196:197], v230 offset:8192
  v_exp_f32 v227, v139
  v_mfma_f32_16x16x32_bf16 v[156:159], v[200:203], v[88:91], v[156:159]
  ds_read_b64_tr_b16 v[198:199], v230 offset:12288
  v_mfma_f32_16x16x32_bf16 v[152:155], v[204:207], v[76:79], v[152:155]
  ds_read_b64_tr_b16 v[200:201], v231 offset:8192
  v_cvt_pk_bf16_f32 v176, v224, v225
  v_mfma_f32_16x16x32_bf16 v[156:159], v[204:207], v[92:95], v[156:159]
  ds_read_b64_tr_b16 v[202:203], v231 offset:12288
  v_exp_f32 v224, v144
  s_waitcnt lgkmcnt(8)
  v_mfma_f32_16x16x32_bf16 v[160:163], v[208:211], v[64:67], v[168:171]
  ds_read_b64_tr_b16 v[204:205], v232 offset:8192
  v_add_f32 v243, v243, v226
  v_mfma_f32_16x16x32_bf16 v[164:167], v[208:211], v[80:83], v[172:175]
  ds_read_b64_tr_b16 v[206:207], v232 offset:12288
  v_exp_f32 v225, v145
  v_mfma_f32_16x16x32_bf16 v[160:163], v[212:215], v[68:71], v[160:163]
  ds_read_b64_tr_b16 v[208:209], v233 offset:8192
  v_cvt_pk_bf16_f32 v177, v226, v227
  v_mfma_f32_16x16x32_bf16 v[164:167], v[212:215], v[84:87], v[164:167]
  ds_read_b64_tr_b16 v[210:211], v233 offset:12288
  s_waitcnt lgkmcnt(10)
  v_mfma_f32_16x16x32_bf16 v[160:163], v[216:219], v[72:75], v[160:163]
  ds_read_b64_tr_b16 v[212:213], v234 offset:8192
  v_add_f32 v243, v243, v227
  v_mfma_f32_16x16x32_bf16 v[164:167], v[216:219], v[88:91], v[164:167]
  ds_read_b64_tr_b16 v[214:215], v234 offset:12288
  v_exp_f32 v226, v146
  v_mfma_f32_16x16x32_bf16 v[160:163], v[220:223], v[76:79], v[160:163]
  ds_read_b64_tr_b16 v[216:217], v235 offset:8192
  v_add_f32 v243, v243, v224
  v_mfma_f32_16x16x32_bf16 v[164:167], v[220:223], v[92:95], v[164:167]
  ds_read_b64_tr_b16 v[218:219], v235 offset:12288
  v_exp_f32 v227, v147
  s_waitcnt lgkmcnt(10)
  v_mfma_f32_16x16x32_bf16 v[0:3], v[192:195], v[184:187], v[0:3]
  ds_read_b64_tr_b16 v[220:221], v236 offset:8192
  v_cvt_pk_bf16_f32 v178, v224, v225
  v_mfma_f32_16x16x32_bf16 v[4:7], v[192:195], v[188:191], v[4:7]
  ds_read_b64_tr_b16 v[222:223], v236 offset:12288
  v_mfma_f32_16x16x32_bf16 v[8:11], v[196:199], v[184:187], v[8:11]
  ds_read_b64_tr_b16 v[192:193], v250 offset:8192
  v_add_f32 v243, v243, v225
  v_mfma_f32_16x16x32_bf16 v[12:15], v[196:199], v[188:191], v[12:15]
  ds_read_b64_tr_b16 v[194:195], v250 offset:8704
  v_exp_f32 v224, v140
  s_waitcnt lgkmcnt(10)
  v_mfma_f32_16x16x32_bf16 v[16:19], v[200:203], v[184:187], v[16:19]
  ds_read_b64_tr_b16 v[196:197], v251 offset:8192
  v_add_f32 v243, v243, v226
  v_mfma_f32_16x16x32_bf16 v[20:23], v[200:203], v[188:191], v[20:23]
  ds_read_b64_tr_b16 v[198:199], v251 offset:8704
  v_exp_f32 v225, v141
  v_mfma_f32_16x16x32_bf16 v[24:27], v[204:207], v[184:187], v[24:27]
  ds_read_b64_tr_b16 v[200:201], v252 offset:8192
  v_cvt_pk_bf16_f32 v179, v226, v227
  v_mfma_f32_16x16x32_bf16 v[28:31], v[204:207], v[188:191], v[28:31]
  ds_read_b64_tr_b16 v[202:203], v252 offset:8704
  s_waitcnt lgkmcnt(10)
  v_mfma_f32_16x16x32_bf16 v[32:35], v[208:211], v[184:187], v[32:35]
  ds_read_b64_tr_b16 v[204:205], v253 offset:8192
  v_add_f32 v243, v243, v227
  v_mfma_f32_16x16x32_bf16 v[36:39], v[208:211], v[188:191], v[36:39]
  ds_read_b64_tr_b16 v[206:207], v253 offset:8704
  v_exp_f32 v226, v142
  v_mfma_f32_16x16x32_bf16 v[40:43], v[212:215], v[184:187], v[40:43]
  ds_read_b64_tr_b16 v[208:209], v250 offset:12288
  v_add_f32 v244, v224, v225
  v_mfma_f32_16x16x32_bf16 v[44:47], v[212:215], v[188:191], v[44:47]
  ds_read_b64_tr_b16 v[210:211], v250 offset:12800
  v_exp_f32 v227, v143
  s_waitcnt lgkmcnt(10)
  v_mfma_f32_16x16x32_bf16 v[48:51], v[216:219], v[184:187], v[48:51]
  ds_read_b64_tr_b16 v[212:213], v251 offset:12288
  v_cvt_pk_bf16_f32 v180, v224, v225
  v_mfma_f32_16x16x32_bf16 v[52:55], v[216:219], v[188:191], v[52:55]
  ds_read_b64_tr_b16 v[214:215], v251 offset:12800
  v_mfma_f32_16x16x32_bf16 v[56:59], v[220:223], v[184:187], v[56:59]
  ds_read_b64_tr_b16 v[216:217], v252 offset:12288
  v_exp_f32 v224, v148
  v_mfma_f32_16x16x32_bf16 v[60:63], v[220:223], v[188:191], v[60:63]
  ds_read_b64_tr_b16 v[218:219], v252 offset:12800
  v_add_f32 v244, v244, v226
  s_waitcnt lgkmcnt(10)
  v_mfma_f32_16x16x32_bf16 v[96:99], v[192:195], a[80:83], v[96:99]
  ds_read_b64_tr_b16 v[220:221], v253 offset:12288
  v_exp_f32 v225, v149
  v_mfma_f32_16x16x32_bf16 v[100:103], v[192:195], a[84:87], v[100:103]
  ds_read_b64_tr_b16 v[222:223], v253 offset:12800
  v_cvt_pk_bf16_f32 v181, v226, v227
  v_mfma_f32_16x16x32_bf16 v[104:107], v[196:199], a[80:83], v[104:107]
  v_add_f32 v244, v244, v227
  v_mfma_f32_16x16x32_bf16 v[108:111], v[196:199], a[84:87], v[108:111]
  v_exp_f32 v226, v150
  s_waitcnt lgkmcnt(8)
  v_mfma_f32_16x16x32_bf16 v[112:115], v[200:203], a[80:83], v[112:115]
  v_add_f32 v244, v244, v224
  v_exp_f32 v227, v151
  v_mfma_f32_16x16x32_bf16 v[116:119], v[200:203], a[84:87], v[116:119]
  v_cvt_pk_bf16_f32 v182, v224, v225
  v_mfma_f32_16x16x32_bf16 v[120:123], v[204:207], a[80:83], v[120:123]
  v_add_f32 v244, v244, v225
  v_mfma_f32_16x16x32_bf16 v[124:127], v[204:207], a[84:87], v[124:127]
  s_waitcnt lgkmcnt(0)
  s_barrier
  ds_read_b128 v[192:195], v228 offset:17408
  ds_read_b128 v[196:199], v228 offset:17472
  ds_read_b128 v[200:203], v228 offset:17536
  ds_read_b128 v[204:207], v228 offset:17600
  v_mfma_f32_16x16x32_bf16 v[96:99], v[208:211], a[88:91], v[96:99]
  v_add_f32 v244, v244, v226
  v_mfma_f32_16x16x32_bf16 v[100:103], v[208:211], a[92:95], v[100:103]
  ds_read_b128 v[208:211], v228 offset:21760
  v_mfma_f32_16x16x32_bf16 v[104:107], v[212:215], a[88:91], v[104:107]
  v_cvt_pk_bf16_f32 v183, v226, v227
  v_mfma_f32_16x16x32_bf16 v[108:111], v[212:215], a[92:95], v[108:111]
  ds_read_b128 v[212:215], v228 offset:21824
  v_mfma_f32_16x16x32_bf16 v[112:115], v[216:219], a[88:91], v[112:115]
  v_add_f32 v244, v244, v227
  v_mfma_f32_16x16x32_bf16 v[116:119], v[216:219], a[92:95], v[116:119]
  ds_read_b128 v[216:219], v228 offset:21888
  v_add_f32 v245, v243, v244
  v_mfma_f32_16x16x32_bf16 v[120:123], v[220:223], a[88:91], v[120:123]
  v_cmp_nge_f32 vcc, s94, v245
  v_mfma_f32_16x16x32_bf16 v[124:127], v[220:223], a[92:95], v[124:127]
  s_cbranch_vccnz T_h5
  v_add_f32 v241, v241, v243
  v_add_f32 v242, v242, v244
R_h5:
  s_waitcnt lgkmcnt(5)
  v_mfma_f32_16x16x32_bf16 v[136:139], v[192:195], v[64:67], v[168:171]
  ds_read_b128 v[220:223], v228 offset:21952
  v_mfma_f32_16x16x32_bf16 v[140:143], v[192:195], v[80:83], v[172:175]
  v_exp_f32 v224, v152
  v_exp_f32 v225, v153
  v_mfma_f32_16x16x32_bf16 v[136:139], v[196:199], v[68:71], v[136:139]
  ds_read_b64_tr_b16 v[192:193], v229 offset:16384
  v_exp_f32 v226, v154
  v_mfma_f32_16x16x32_bf16 v[140:143], v[196:199], v[84:87], v[140:143]
  ds_read_b64_tr_b16 v[194:195], v229 offset:20480
  v_add_f32 v243, v224, v225
  s_waitcnt lgkmcnt(6)
  v_mfma_f32_16x16x32_bf16 v[136:139], v[200:203], v[72:75], v[136:139]
  ds_read_b64_tr_b16 v[196:197], v230 offset:16384
  v_exp_f32 v227, v155
  v_mfma_f32_16x16x32_bf16 v[140:143], v[200:203], v[88:91], v[140:143]
  ds_read_b64_tr_b16 v[198:199], v230 offset:20480
  v_mfma_f32_16x16x32_bf16 v[136:139], v[204:207], v[76:79], v[136:139]
  ds_read_b64_tr_b16 v[200:201], v231 offset:16384
  v_cvt_pk_bf16_f32 v184, v224, v225
  v_mfma_f32_16x16x32_bf16 v[140:143], v[204:207], v[92:95], v[140:143]
  ds_read_b64_tr_b16 v[202:203], v231 offset:20480
  v_exp_f32 v224, v160
  s_waitcnt lgkmcnt(8)
  v_mfma_f32_16x16x32_bf16 v[144:147], v[208:211], v[64:67], v[168:171]
  ds_read_b64_tr_b16 v[204:205], v232 offset:16384
  v_add_f32 v243, v243, v226
  v_mfma_f32_16x16x32_bf16 v[148:151], v[208:211], v[80:83], v[172:175]
  ds_read_b64_tr_b16 v[206:207], v232 offset:20480
  v_exp_f32 v225, v161
  v_mfma_f32_16x16x32_bf16 v[144:147], v[212:215], v[68:71], v[144:147]
  ds_read_b64_tr_b16 v[208:209], v233 offset:16384
  v_cvt_pk_bf16_f32 v185, v226, v227
  v_mfma_f32_16x16x32_bf16 v[148:151], v[212:215], v[84:87], v[148:151]
  ds_read_b64_tr_b16 v[210:211], v233 offset:20480
  s_waitcnt lgkmcnt(10)
  v_mfma_f32_16x16x32_bf16 v[144:147], v[216:219], v[72:75], v[144:147]
  ds_read_b64_tr_b16 v[212:213], v234 offset:16384
  v_add_f32 v243, v243, v227
  v_mfma_f32_16x16x32_bf16 v[148:151], v[216:219], v[88:91], v[148:151]
  ds_read_b64_tr_b16 v[214:215], v234 offset:20480
  v_exp_f32 v226, v162
  v_mfma_f32_16x16x32_bf16 v[144:147], v[220:223], v[76:79], v[144:147]
  ds_read_b64_tr_b16 v[216:217], v235 offset:16384
  v_add_f32 v243, v243, v224
  v_mfma_f32_16x16x32_bf16 v[148:151], v[220:223], v[92:95], v[148:151]
  ds_read_b64_tr_b16 v[218:219], v235 offset:20480
  v_exp_f32 v227, v163
  s_waitcnt lgkmcnt(10)
  v_mfma_f32_16x16x32_bf16 v[0:3], v[192:195], v[176:179], v[0:3]
  ds_read_b64_tr_b16 v[220:221], v236 offset:16384
  v_cvt_pk_bf16_f32 v186, v224, v225
  v_mfma_f32_16x16x32_bf16 v[4:7], v[192:195], v[180:183], v[4:7]
  ds_read_b64_tr_b16 v[222:223], v236 offset:20480
  v_mfma_f32_16x16x32_bf16 v[8:11], v[196:199], v[176:179], v[8:11]
  ds_read_b64_tr_b16 v[192:193], v250 offset:16384
  v_add_f32 v243, v243, v225
  v_mfma_f32_16x16x32_bf16 v[12:15], v[196:199], v[180:183], v[12:15]
  ds_read_b64_tr_b16 v[194:195], v250 offset:16896
  v_exp_f32 v224, v156
  s_waitcnt lgkmcnt(10)
  v_mfma_f32_16x16x32_bf16 v[16:19], v[200:203], v[176:179], v[16:19]
  ds_read_b64_tr_b16 v[196:197], v251 offset:16384
  v_add_f32 v243, v243, v226
  v_mfma_f32_16x16x32_bf16 v[20:23], v[200:203], v[180:183], v[20:23]
  ds_read_b64_tr_b16 v[198:199], v251 offset:16896
  v_exp_f32 v225, v157
  v_mfma_f32_16x16x32_bf16 v[24:27], v[204:207], v[176:179], v[24:27]
  ds_read_b64_tr_b16 v[200:201], v252 offset:16384
  v_cvt_pk_bf16_f32 v187, v226, v227
  v_mfma_f32_16x16x32_bf16 v[28:31], v[204:207], v[180:183], v[28:31]
  ds_read_b64_tr_b16 v[202:203], v252 offset:16896
  s_waitcnt lgkmcnt(10)
  v_mfma_f32_16x16x32_bf16 v[32:35], v[208:211], v[176:179], v[32:35]
  ds_read_b64_tr_b16 v[204:205], v253 offset:16384
  v_add_f32 v243, v243, v227
  v_mfma_f32_16x16x32_bf16 v[36:39], v[208:211], v[180:183], v[36:39]
  ds_read_b64_tr_b16 v[206:207], v253 offset:16896
  v_exp_f32 v226, v158
  v_mfma_f32_16x16x32_bf16 v[40:43], v[212:215], v[176:179], v[40:43]
  ds_read_b64_tr_b16 v[208:209], v250 offset:20480
  v_add_f32 v244, v224, v225
  v_mfma_f32_16x16x32_bf16 v[44:47], v[212:215], v[180:183], v[44:47]
  ds_read_b64_tr_b16 v[210:211], v250 offset:20992
  v_exp_f32 v227, v159
  s_waitcnt lgkmcnt(10)
  v_mfma_f32_16x16x32_bf16 v[48:51], v[216:219], v[176:179], v[48:51]
  ds_read_b64_tr_b16 v[212:213], v251 offset:20480
  v_cvt_pk_bf16_f32 v188, v224, v225
  v_mfma_f32_16x16x32_bf16 v[52:55], v[216:219], v[180:183], v[52:55]
  ds_read_b64_tr_b16 v[214:215], v251 offset:20992
  v_mfma_f32_16x16x32_bf16 v[56:59], v[220:223], v[176:179], v[56:59]
  ds_read_b64_tr_b16 v[216:217], v252 offset:20480
  v_exp_f32 v224, v164
  v_mfma_f32_16x16x32_bf16 v[60:63], v[220:223], v[180:183], v[60:63]
  ds_read_b64_tr_b16 v[218:219], v252 offset:20992
  v_add_f32 v244, v244, v226
  s_waitcnt lgkmcnt(10)
  v_mfma_f32_16x16x32_bf16 v[96:99], v[192:195], a[96:99], v[96:99]
  ds_read_b64_tr_b16 v[220:221], v253 offset:20480
  v_exp_f32 v225, v165
  v_mfma_f32_16x16x32_bf16 v[100:103], v[192:195], a[100:103], v[100:103]
  ds_read_b64_tr_b16 v[222:223], v253 offset:20992
  v_cvt_pk_bf16_f32 v189, v226, v227
  v_mfma_f32_16x16x32_bf16 v[104:107], v[196:199], a[96:99], v[104:107]
  v_add_f32 v244, v244, v227
  v_mfma_f32_16x16x32_bf16 v[108:111], v[196:199], a[100:103], v[108:111]
  v_exp_f32 v226, v166
  s_waitcnt lgkmcnt(8)
  v_mfma_f32_16x16x32_bf16 v[112:115], v[200:203], a[96:99], v[112:115]
  v_add_f32 v244, v244, v224
  v_exp_f32 v227, v167
  v_mfma_f32_16x16x32_bf16 v[116:119], v[200:203], a[100:103], v[116:119]
  v_cvt_pk_bf16_f32 v190, v224, v225
  v_mfma_f32_16x16x32_bf16 v[120:123], v[204:207], a[96:99], v[120:123]
  v_add_f32 v244, v244, v225
  v_mfma_f32_16x16x32_bf16 v[124:127], v[204:207], a[100:103], v[124:127]
  s_waitcnt lgkmcnt(0)
  s_barrier
  ds_read_b128 v[192:195], v228 offset:26112
  ds_read_b128 v[196:199], v228 offset:26176
  ds_read_b128 v[200:203], v228 offset:26240
  ds_read_b128 v[204:207], v228 offset:26304
  v_mfma_f32_16x16x32_bf16 v[96:99], v[208:211], a[104:107], v[96:99]
  v_add_f32 v244, v244, v226
  v_mfma_f32_16x16x32_bf16 v[100:103], v[208:211], a[108:111], v[100:103]
  ds_read_b128 v[208:211], v228 offset:30464
  v_mfma_f32_16x16x32_bf16 v[104:107], v[212:215], a[104:107], v[104:107]
  v_cvt_pk_bf16_f32 v191, v226, v227
  v_mfma_f32_16x16x32_bf16 v[108:111], v[212:215], a[108:111], v[108:111]
  ds_read_b128 v[212:215], v228 offset:30528
  v_mfma_f32_16x16x32_bf16 v[112:115], v[216:219], a[104:107], v[112:115]
  v_add_f32 v244, v244, v227
  v_mfma_f32_16x16x32_bf16 v[116:119], v[216:219], a[108:111], v[116:119]
  ds_read_b128 v[216:219], v228 offset:30592
  v_add_f32 v245, v243, v244
  v_mfma_f32_16x16x32_bf16 v[120:123], v[220:223], a[104:107], v[120:123]
  v_cmp_nge_f32 vcc, s94, v245
  v_mfma_f32_16x16x32_bf16 v[124:127], v[220:223], a[108:111], v[124:127]
  s_cbranch_vccnz T_h6
  v_add_f32 v241, v241, v243
  v_add_f32 v242, v242, v244
R_h6:
  s_waitcnt lgkmcnt(5)
  v_mfma_f32_16x16x32_bf16 v[152:155], v[192:195], v[64:67], v[168:171]
  ds_read_b128 v[220:223], v228 offset:30656
  v_mfma_f32_16x16x32_bf16 v[156:159], v[192:195], v[80:83], v[172:175]
  v_exp_f32 v224, v136
  v_exp_f32 v225, v137
  v_mfma_f32_16x16x32_bf16 v[152:155], v[196:199], v[68:71], v[152:155]
  ds_read_b64_tr_b16 v[192:193], v229 offset:24576
  v_exp_f32 v226, v138
  v_mfma_f32_16x16x32_bf16 v[156:159], v[196:199], v[84:87], v[156:159]
  ds_read_b64_tr_b16 v[194:195], v229 offset:28672
  v_add_f32 v243, v224, v225
  s_waitcnt lgkmcnt(6)
  v_mfma_f32_16x16x32_bf16 v[152:155], v[200:203], v[72:75], v[152:155]
  ds_read_b64_tr_b16 v[196:197], v230 offset:24576
  v_exp_f32 v227, v139
  v_mfma_f32_16x16x32_bf16 v[156:159], v[200:203], v[88:91], v[156:159]
  ds_read_b64_tr_b16 v[198:199], v230 offset:28672
  v_mfma_f32_16x16x32_bf16 v[152:155], v[204:207], v[76:79], v[152:155]
  ds_read_b64_tr_b16 v[200:201], v231 offset:24576
  v_cvt_pk_bf16_f32 v176, v224, v225
  v_mfma_f32_16x16x32_bf16 v[156:159], v[204:207], v[92:95], v[156:159]
  ds_read_b64_tr_b16 v[202:203], v231 offset:28672
  v_exp_f32 v224, v144
  s_waitcnt lgkmcnt(8)
  v_mfma_f32_16x16x32_bf16 v[160:163], v[208:211], v[64:67], v[168:171]
  ds_read_b64_tr_b16 v[204:205], v232 offset:24576
  v_add_f32 v243, v243, v226
  v_mfma_f32_16x16x32_bf16 v[164:167], v[208:211], v[80:83], v[172:175]
  ds_read_b64_tr_b16 v[206:207], v232 offset:28672
  v_exp_f32 v225, v145
  v_mfma_f32_16x16x32_bf16 v[160:163], v[212:215], v[68:71], v[160:163]
  ds_read_b64_tr_b16 v[208:209], v233 offset:24576
  v_cvt_pk_bf16_f32 v177, v226, v227
  v_mfma_f32_16x16x32_bf16 v[164:167], v[212:215], v[84:87], v[164:167]
  ds_read_b64_tr_b16 v[210:211], v233 offset:28672
  s_waitcnt lgkmcnt(10)
  v_mfma_f32_16x16x32_bf16 v[160:163], v[216:219], v[72:75], v[160:163]
  ds_read_b64_tr_b16 v[212:213], v234 offset:24576
  v_add_f32 v243, v243, v227
  v_mfma_f32_16x16x32_bf16 v[164:167], v[216:219], v[88:91], v[164:167]
  ds_read_b64_tr_b16 v[214:215], v234 offset:28672
  v_exp_f32 v226, v146
  v_mfma_f32_16x16x32_bf16 v[160:163], v[220:223], v[76:79], v[160:163]
  ds_read_b64_tr_b16 v[216:217], v235 offset:24576
  v_add_f32 v243, v243, v224
  v_mfma_f32_16x16x32_bf16 v[164:167], v[220:223], v[92:95], v[164:167]
  ds_read_b64_tr_b16 v[218:219], v235 offset:28672
  v_exp_f32 v227, v147
  s_waitcnt lgkmcnt(10)
  v_mfma_f32_16x16x32_bf16 v[0:3], v[192:195], v[184:187], v[0:3]
  ds_read_b64_tr_b16 v[220:221], v236 offset:24576
  v_cvt_pk_bf16_f32 v178, v224, v225
  v_mfma_f32_16x16x32_bf16 v[4:7], v[192:195], v[188:191], v[4:7]
  ds_read_b64_tr_b16 v[222:223], v236 offset:28672
  v_mfma_f32_16x16x32_bf16 v[8:11], v[196:199], v[184:187], v[8:11]
  ds_read_b64_tr_b16 v[192:193], v250 offset:24576
  v_add_f32 v243, v243, v225
  v_mfma_f32_16x16x32_bf16 v[12:15], v[196:199], v[188:191], v[12:15]
  ds_read_b64_tr_b16 v[194:195], v250 offset:25088
  v_exp_f32 v224, v140
  s_waitcnt lgkmcnt(10)
  v_mfma_f32_16x16x32_bf16 v[16:19], v[200:203], v[184:187], v[16:19]
  ds_read_b64_tr_b16 v[196:197], v251 offset:24576
  v_add_f32 v243, v243, v226
  v_mfma_f32_16x16x32_bf16 v[20:23], v[200:203], v[188:191], v[20:23]
  ds_read_b64_tr_b16 v[198:199], v251 offset:25088
  v_exp_f32 v225, v141
  v_mfma_f32_16x16x32_bf16 v[24:27], v[204:207], v[184:187], v[24:27]
  ds_read_b64_tr_b16 v[200:201], v252 offset:24576
  v_cvt_pk_bf16_f32 v179, v226, v227
  v_mfma_f32_16x16x32_bf16 v[28:31], v[204:207], v[188:191], v[28:31]
  ds_read_b64_tr_b16 v[202:203], v252 offset:25088
  s_waitcnt lgkmcnt(10)
  v_mfma_f32_16x16x32_bf16 v[32:35], v[208:211], v[184:187], v[32:35]
  ds_read_b64_tr_b16 v[204:205], v253 offset:24576
  v_add_f32 v243, v243, v227
  v_mfma_f32_16x16x32_bf16 v[36:39], v[208:211], v[188:191], v[36:39]
  ds_read_b64_tr_b16 v[206:207], v253 offset:25088
  v_exp_f32 v226, v142
  v_mfma_f32_16x16x32_bf16 v[40:43], v[212:215], v[184:187], v[40:43]
  ds_read_b64_tr_b16 v[208:209], v250 offset:28672
  v_add_f32 v244, v224, v225
  v_mfma_f32_16x16x32_bf16 v[44:47], v[212:215], v[188:191], v[44:47]
  ds_read_b64_tr_b16 v[210:211], v250 offset:29184
  v_exp_f32 v227, v143
  s_waitcnt lgkmcnt(10)
  v_mfma_f32_16x16x32_bf16 v[48:51], v[216:219], v[184:187], v[48:51]
  ds_read_b64_tr_b16 v[212:213], v251 offset:28672
  v_cvt_pk_bf16_f32 v180, v224, v225
  v_mfma_f32_16x16x32_bf16 v[52:55], v[216:219], v[188:191], v[52:55]
  ds_read_b64_tr_b16 v[214:215], v251 offset:29184
  v_mfma_f32_16x16x32_bf16 v[56:59], v[220:223], v[184:187], v[56:59]
  ds_read_b64_tr_b16 v[216:217], v252 offset:28672
  v_exp_f32 v224, v148
  v_mfma_f32_16x16x32_bf16 v[60:63], v[220:223], v[188:191], v[60:63]
  ds_read_b64_tr_b16 v[218:219], v252 offset:29184
  v_add_f32 v244, v244, v226
  s_waitcnt lgkmcnt(10)
  v_mfma_f32_16x16x32_bf16 v[96:99], v[192:195], a[112:115], v[96:99]
  ds_read_b64_tr_b16 v[220:221], v253 offset:28672
  v_exp_f32 v225, v149
  v_mfma_f32_16x16x32_bf16 v[100:103], v[192:195], a[116:119], v[100:103]
  ds_read_b64_tr_b16 v[222:223], v253 offset:29184
  v_cvt_pk_bf16_f32 v181, v226, v227
  v_mfma_f32_16x16x32_bf16 v[104:107], v[196:199], a[112:115], v[104:107]
  v_add_f32 v244, v244, v227
  v_mfma_f32_16x16x32_bf16 v[108:111], v[196:199], a[116:119], v[108:111]
  v_exp_f32 v226, v150
  s_waitcnt lgkmcnt(8)
  v_mfma_f32_16x16x32_bf16 v[112:115], v[200:203], a[112:115], v[112:115]
  v_add_f32 v244, v244, v224
  v_exp_f32 v227, v151
  v_mfma_f32_16x16x32_bf16 v[116:119], v[200:203], a[116:119], v[116:119]
  v_cvt_pk_bf16_f32 v182, v224, v225
  v_mfma_f32_16x16x32_bf16 v[120:123], v[204:207], a[112:115], v[120:123]
  v_add_f32 v244, v244, v225
  v_mfma_f32_16x16x32_bf16 v[124:127], v[204:207], a[116:119], v[124:127]
  s_waitcnt lgkmcnt(0)
  s_barrier
  ds_read_b128 v[192:195], v228 offset:0
  ds_read_b128 v[196:199], v228 offset:64
  ds_read_b128 v[200:203], v228 offset:128
  ds_read_b128 v[204:207], v228 offset:192
  v_mfma_f32_16x16x32_bf16 v[96:99], v[208:211], a[120:123], v[96:99]
  v_add_f32 v244, v244, v226
  v_mfma_f32_16x16x32_bf16 v[100:103], v[208:211], a[124:127], v[100:103]
  ds_read_b128 v[208:211], v228 offset:4352
  v_mfma_f32_16x16x32_bf16 v[104:107], v[212:215], a[120:123], v[104:107]
  v_cvt_pk_bf16_f32 v183, v226, v227
  v_mfma_f32_16x16x32_bf16 v[108:111], v[212:215], a[124:127], v[108:111]
  ds_read_b128 v[212:215], v228 offset:4416
  v_mfma_f32_16x16x32_bf16 v[112:115], v[216:219], a[120:123], v[112:115]
  v_add_f32 v244, v244, v227
  v_mfma_f32_16x16x32_bf16 v[116:119], v[216:219], a[124:127], v[116:119]
  ds_read_b128 v[216:219], v228 offset:4480
  v_add_f32 v245, v243, v244
  v_mfma_f32_16x16x32_bf16 v[120:123], v[220:223], a[120:123], v[120:123]
  v_cmp_nge_f32 vcc, s94, v245
  v_mfma_f32_16x16x32_bf16 v[124:127], v[220:223], a[124:127], v[124:127]
  s_cbranch_vccnz T_h7
  v_add_f32 v241, v241, v243
  v_add_f32 v242, v242, v244
R_h7:
  s_waitcnt lgkmcnt(5)
  v_mfma_f32_16x16x32_bf16 v[136:139], v[192:195], v[64:67], v[168:171]
  ds_read_b128 v[220:223], v228 offset:4544
  v_mfma_f32_16x16x32_bf16 v[140:143], v[192:195], v[80:83], v[172:175]
  v_mfma_f32_16x16x32_bf16 v[136:139], v[196:199], v[68:71], v[136:139]
  ds_read_b64_tr_b16 v[192:193], v229 offset:0
  v_mfma_f32_16x16x32_bf16 v[140:143], v[196:199], v[84:87], v[140:143]
  ds_read_b64_tr_b16 v[194:195], v229 offset:4096
  v_mul_f32 v96, s65, v96
  v_mul_f32 v97, s65, v97
  s_waitcnt lgkmcnt(6)
  v_mfma_f32_16x16x32_bf16 v[136:139], v[200:203], v[72:75], v[136:139]
  ds_read_b64_tr_b16 v[196:197], v230 offset:0
  v_mul_f32 v98, s65, v98
  v_mul_f32 v99, s65, v99
  v_mul_f32 v100, s65, v100
  v_mfma_f32_16x16x32_bf16 v[140:143], v[200:203], v[88:91], v[140:143]
  ds_read_b64_tr_b16 v[198:199], v230 offset:4096
  v_mul_f32 v101, s65, v101
  v_mul_f32 v102, s65, v102
  v_mfma_f32_16x16x32_bf16 v[136:139], v[204:207], v[76:79], v[136:139]
  ds_read_b64_tr_b16 v[200:201], v231 offset:0
  v_mul_f32 v103, s65, v103
  v_mul_f32 v104, s65, v104
  v_mul_f32 v105, s65, v105
  v_mfma_f32_16x16x32_bf16 v[140:143], v[204:207], v[92:95], v[140:143]
  ds_read_b64_tr_b16 v[202:203], v231 offset:4096
  v_mul_f32 v106, s65, v106
  v_mul_f32 v107, s65, v107
  s_waitcnt lgkmcnt(8)
  v_mfma_f32_16x16x32_bf16 v[144:147], v[208:211], v[64:67], v[168:171]
  ds_read_b64_tr_b16 v[204:205], v232 offset:0
  v_mul_f32 v108, s65, v108
  v_mul_f32 v109, s65, v109
  v_mul_f32 v110, s65, v110
  v_mfma_f32_16x16x32_bf16 v[148:151], v[208:211], v[80:83], v[172:175]
  ds_read_b64_tr_b16 v[206:207], v232 offset:4096
  v_mul_f32 v111, s65, v111
  v_mul_f32 v112, s65, v112
  v_mul_f32 v113, s65, v113
  v_mfma_f32_16x16x32_bf16 v[144:147], v[212:215], v[68:71], v[144:147]
  ds_read_b64_tr_b16 v[208:209], v233 offset:0
  v_mul_f32 v114, s65, v114
  v_mul_f32 v115, s65, v115
  v_mfma_f32_16x16x32_bf16 v[148:151], v[212:215], v[84:87], v[148:151]
  ds_read_b64_tr_b16 v[210:211], v233 offset:4096
  v_mul_f32 v116, s65, v116
  v_mul_f32 v117, s65, v117
  v_mul_f32 v118, s65, v118
  s_waitcnt lgkmcnt(10)
  v_mfma_f32_16x16x32_bf16 v[144:147], v[216:219], v[72:75], v[144:147]
  ds_read_b64_tr_b16 v[212:213], v234 offset:0
  v_mul_f32 v119, s65, v119
  v_mul_f32 v120, s65, v120
  v_mfma_f32_16x16x32_bf16 v[148:151], v[216:219], v[88:91], v[148:151]
  ds_read_b64_tr_b16 v[214:215], v234 offset:4096
  v_mul_f32 v121, s65, v121
  v_mul_f32 v122, s65, v122
  v_mul_f32 v123, s65, v123
  v_mfma_f32_16x16x32_bf16 v[144:147], v[220:223], v[76:79], v[144:147]
  ds_read_b64_tr_b16 v[216:217], v235 offset:0
  v_mul_f32 v124, s65, v124
  v_mul_f32 v125, s65, v125
  v_mfma_f32_16x16x32_bf16 v[148:151], v[220:223], v[92:95], v[148:151]
  ds_read_b64_tr_b16 v[218:219], v235 offset:4096
  v_mul_f32 v126, s65, v126
  v_mul_f32 v127, s65, v127
  v_cvt_pk_bf16_f32 v96, v96, v97
  s_waitcnt lgkmcnt(10)
  v_mfma_f32_16x16x32_bf16 v[0:3], v[192:195], v[176:179], v[0:3]
  ds_read_b64_tr_b16 v[220:221], v236 offset:0
  v_cvt_pk_bf16_f32 v97, v98, v99
  v_cvt_pk_bf16_f32 v98, v104, v105
  v_cvt_pk_bf16_f32 v99, v106, v107
  v_exp_f32 v224, v152
  v_mfma_f32_16x16x32_bf16 v[4:7], v[192:195], v[180:183], v[4:7]
  ds_read_b64_tr_b16 v[222:223], v236 offset:4096
  v_cvt_pk_bf16_f32 v100, v100, v101
  v_cvt_pk_bf16_f32 v101, v102, v103
  v_exp_f32 v225, v153
  v_mfma_f32_16x16x32_bf16 v[8:11], v[196:199], v[176:179], v[8:11]
  ds_read_b64_tr_b16 v[192:193], v250 offset:0
  v_cvt_pk_bf16_f32 v102, v108, v109
  v_cvt_pk_bf16_f32 v103, v110, v111
  v_cvt_pk_bf16_f32 v112, v112, v113
  v_exp_f32 v226, v154
  v_add_f32 v243, v224, v225
  v_mfma_f32_16x16x32_bf16 v[12:15], v[196:199], v[180:183], v[12:15]
  ds_read_b64_tr_b16 v[194:195], v250 offset:512
  v_cvt_pk_bf16_f32 v113, v114, v115
  v_cvt_pk_bf16_f32 v114, v120, v121
  v_exp_f32 v227, v155
  s_waitcnt lgkmcnt(10)
  v_mfma_f32_16x16x32_bf16 v[16:19], v[200:203], v[176:179], v[16:19]
  ds_read_b64_tr_b16 v[196:197], v251 offset:0
  v_cvt_pk_bf16_f32 v115, v122, v123
  v_cvt_pk_bf16_f32 v116, v116, v117
  v_cvt_pk_bf16_f32 v117, v118, v119
  v_cvt_pk_bf16_f32 v184, v224, v225
  v_mfma_f32_16x16x32_bf16 v[20:23], v[200:203], v[180:183], v[20:23]
  ds_read_b64_tr_b16 v[198:199], v251 offset:512
  v_cvt_pk_bf16_f32 v118, v124, v125
  v_cvt_pk_bf16_f32 v119, v126, v127
  v_exp_f32 v224, v160
  v_add_f32 v243, v243, v226
  v_mfma_f32_16x16x32_bf16 v[24:27], v[204:207], v[176:179], v[24:27]
  ds_read_b64_tr_b16 v[200:201], v252 offset:0
  v_permlane16_swap_b32 v96, v98
  v_permlane16_swap_b32 v97, v99
  v_permlane16_swap_b32 v100, v102
  v_exp_f32 v225, v161
  v_mfma_f32_16x16x32_bf16 v[28:31], v[204:207], v[180:183], v[28:31]
  ds_read_b64_tr_b16 v[202:203], v252 offset:512
  v_permlane16_swap_b32 v101, v103
  v_permlane16_swap_b32 v112, v114
  v_permlane16_swap_b32 v113, v115
  v_cvt_pk_bf16_f32 v185, v226, v227
  s_waitcnt lgkmcnt(10)
  v_mfma_f32_16x16x32_bf16 v[32:35], v[208:211], v[176:179], v[32:35]
  ds_read_b64_tr_b16 v[204:205], v253 offset:0
  v_permlane16_swap_b32 v116, v118
  v_permlane16_swap_b32 v117, v119
  v_add_f32 v243, v243, v227
  v_exp_f32 v226, v162
  v_mfma_f32_16x16x32_bf16 v[36:39], v[208:211], v[180:183], v[36:39]
  ds_read_b64_tr_b16 v[206:207], v253 offset:512
  v_accvgpr_write_b32 a240, v96
  v_accvgpr_write_b32 a241, v97
  v_accvgpr_write_b32 a242, v98
  v_add_f32 v243, v243, v224
  v_mfma_f32_16x16x32_bf16 v[40:43], v[212:215], v[176:179], v[40:43]
  ds_read_b64_tr_b16 v[208:209], v250 offset:4096
  v_accvgpr_write_b32 a243, v99
  v_accvgpr_write_b32 a248, v100
  v_exp_f32 v227, v163
  v_mfma_f32_16x16x32_bf16 v[44:47], v[212:215], v[180:183], v[44:47]
  ds_read_b64_tr_b16 v[210:211], v250 offset:4608
  v_accvgpr_write_b32 a249, v101
  v_accvgpr_write_b32 a250, v102
  v_accvgpr_write_b32 a251, v103
  v_cvt_pk_bf16_f32 v186, v224, v225
  v_add_f32 v243, v243, v225
  s_waitcnt lgkmcnt(10)
  v_mfma_f32_16x16x32_bf16 v[48:51], v[216:219], v[176:179], v[48:51]
  ds_read_b64_tr_b16 v[212:213], v251 offset:4096
  v_accvgpr_write_b32 a244, v112
  v_accvgpr_write_b32 a245, v113
  v_exp_f32 v224, v156
  v_mfma_f32_16x16x32_bf16 v[52:55], v[216:219], v[180:183], v[52:55]
  ds_read_b64_tr_b16 v[214:215], v251 offset:4608
  v_accvgpr_write_b32 a246, v114
  v_accvgpr_write_b32 a247, v115
  v_accvgpr_write_b32 a252, v116
  v_add_f32 v243, v243, v226
  v_mfma_f32_16x16x32_bf16 v[56:59], v[220:223], v[176:179], v[56:59]
  ds_read_b64_tr_b16 v[216:217], v252 offset:4096
  v_accvgpr_write_b32 a253, v117
  v_accvgpr_write_b32 a254, v118
  v_accvgpr_write_b32 a255, v119
  v_exp_f32 v225, v157
  v_cvt_pk_bf16_f32 v187, v226, v227
  v_mfma_f32_16x16x32_bf16 v[60:63], v[220:223], v[180:183], v[60:63]
  ds_read_b64_tr_b16 v[218:219], v252 offset:4608
  v_add_f32 v243, v243, v227
  s_waitcnt lgkmcnt(10)
  v_mfma_f32_16x16x32_bf16 v[96:99], v[192:195], a[0:3], 0
  ds_read_b64_tr_b16 v[220:221], v253 offset:4096
  v_exp_f32 v226, v158
  v_mfma_f32_16x16x32_bf16 v[100:103], v[192:195], a[4:7], 0
  ds_read_b64_tr_b16 v[222:223], v253 offset:4608
  v_add_f32 v244, v224, v225
  v_exp_f32 v227, v159
  v_mfma_f32_16x16x32_bf16 v[104:107], v[196:199], a[0:3], 0
  v_cvt_pk_bf16_f32 v188, v224, v225
  v_mfma_f32_16x16x32_bf16 v[108:111], v[196:199], a[4:7], 0
  v_exp_f32 v224, v164
  s_waitcnt lgkmcnt(8)
  v_mfma_f32_16x16x32_bf16 v[112:115], v[200:203], a[0:3], 0
  v_add_f32 v244, v244, v226
  v_exp_f32 v225, v165
  v_mfma_f32_16x16x32_bf16 v[116:119], v[200:203], a[4:7], 0
  v_cvt_pk_bf16_f32 v189, v226, v227
  v_mfma_f32_16x16x32_bf16 v[120:123], v[204:207], a[0:3], 0
  v_add_f32 v244, v244, v227
  v_mfma_f32_16x16x32_bf16 v[124:127], v[204:207], a[4:7], 0
  s_waitcnt lgkmcnt(0)
  s_barrier
  ds_read_b128 v[192:195], v228 offset:8704
  ds_read_b128 v[196:199], v228 offset:8768
  ds_read_b128 v[200:203], v228 offset:8832
  ds_read_b128 v[204:207], v228 offset:8896
  v_exp_f32 v226, v166
  v_add_f32 v244, v244, v224
  v_mfma_f32_16x16x32_bf16 v[96:99], v[208:211], a[8:11], v[96:99]
  v_exp_f32 v227, v167
  v_mfma_f32_16x16x32_bf16 v[100:103], v[208:211], a[12:15], v[100:103]
  ds_read_b128 v[208:211], v228 offset:13056
  v_cvt_pk_bf16_f32 v190, v224, v225
  v_mfma_f32_16x16x32_bf16 v[104:107], v[212:215], a[8:11], v[104:107]
  v_add_f32 v244, v244, v225
  v_add_f32 v244, v244, v226
  v_mfma_f32_16x16x32_bf16 v[108:111], v[212:215], a[12:15], v[108:111]
  ds_read_b128 v[212:215], v228 offset:13120
  v_cvt_pk_bf16_f32 v191, v226, v227
  v_mfma_f32_16x16x32_bf16 v[112:115], v[216:219], a[8:11], v[112:115]
  v_add_f32 v244, v244, v227
  v_mfma_f32_16x16x32_bf16 v[116:119], v[216:219], a[12:15], v[116:119]
  ds_read_b128 v[216:219], v228 offset:13184
  v_add_f32 v245, v243, v244
  v_cmp_nge_f32 vcc, s94, v245
  v_mfma_f32_16x16x32_bf16 v[120:123], v[220:223], a[8:11], v[120:123]
  v_mfma_f32_16x16x32_bf16 v[124:127], v[220:223], a[12:15], v[124:127]
  s_cbranch_vccnz T_h8
  v_add_f32 v241, v241, v243
  v_add_f32 v242, v242, v244
R_h8:
  s_waitcnt lgkmcnt(5)
  v_mfma_f32_16x16x32_bf16 v[152:155], v[192:195], v[64:67], v[168:171]
  ds_read_b128 v[220:223], v228 offset:13248
  v_mfma_f32_16x16x32_bf16 v[156:159], v[192:195], v[80:83], v[172:175]
  v_exp_f32 v224, v136
  v_exp_f32 v225, v137
  v_mfma_f32_16x16x32_bf16 v[152:155], v[196:199], v[68:71], v[152:155]
  ds_read_b64_tr_b16 v[192:193], v229 offset:8192
  v_exp_f32 v226, v138
  v_accvgpr_write_b32 a0, 0
  v_mfma_f32_16x16x32_bf16 v[156:159], v[196:199], v[84:87], v[156:159]
  ds_read_b64_tr_b16 v[194:195], v229 offset:12288
  v_add_f32 v243, v224, v225
  s_waitcnt lgkmcnt(6)
  v_mfma_f32_16x16x32_bf16 v[152:155], v[200:203], v[72:75], v[152:155]
  ds_read_b64_tr_b16 v[196:197], v230 offset:8192
  v_exp_f32 v227, v139
  v_accvgpr_write_b32 a1, 0
  v_mfma_f32_16x16x32_bf16 v[156:159], v[200:203], v[88:91], v[156:159]
  ds_read_b64_tr_b16 v[198:199], v230 offset:12288
  v_mfma_f32_16x16x32_bf16 v[152:155], v[204:207], v[76:79], v[152:155]
  ds_read_b64_tr_b16 v[200:201], v231 offset:8192
  v_cvt_pk_bf16_f32 v176, v224, v225
  v_accvgpr_write_b32 a2, 0
  v_mfma_f32_16x16x32_bf16 v[156:159], v[204:207], v[92:95], v[156:159]
  ds_read_b64_tr_b16 v[202:203], v231 offset:12288
  v_exp_f32 v224, v144
  s_waitcnt lgkmcnt(8)
  v_mfma_f32_16x16x32_bf16 v[160:163], v[208:211], v[64:67], v[168:171]
  ds_read_b64_tr_b16 v[204:205], v232 offset:8192
  v_add_f32 v243, v243, v226
  v_accvgpr_write_b32 a3, 0
  v_mfma_f32_16x16x32_bf16 v[164:167], v[208:211], v[80:83], v[172:175]
  ds_read_b64_tr_b16 v[206:207], v232 offset:12288
  v_exp_f32 v225, v145
  v_mfma_f32_16x16x32_bf16 v[160:163], v[212:215], v[68:71], v[160:163]
  ds_read_b64_tr_b16 v[208:209], v233 offset:8192
  v_cvt_pk_bf16_f32 v177, v226, v227
  v_accvgpr_write_b32 a4, 0
  v_mfma_f32_16x16x32_bf16 v[164:167], v[212:215], v[84:87], v[164:167]
  ds_read_b64_tr_b16 v[210:211], v233 offset:12288
  s_waitcnt lgkmcnt(10)
  v_mfma_f32_16x16x32_bf16 v[160:163], v[216:219], v[72:75], v[160:163]
  ds_read_b64_tr_b16 v[212:213], v234 offset:8192
  v_add_f32 v243, v243, v227
  v_accvgpr_write_b32 a5, 0
  v_mfma_f32_16x16x32_bf16 v[164:167], v[216:219], v[88:91], v[164:167]
  ds_read_b64_tr_b16 v[214:215], v234 offset:12288
  v_exp_f32 v226, v146
  v_mfma_f32_16x16x32_bf16 v[160:163], v[220:223], v[76:79], v[160:163]
  ds_read_b64_tr_b16 v[216:217], v235 offset:8192
  v_add_f32 v243, v243, v224
  v_accvgpr_write_b32 a6, 0
  v_mfma_f32_16x16x32_bf16 v[164:167], v[220:223], v[92:95], v[164:167]
  ds_read_b64_tr_b16 v[218:219], v235 offset:12288
  v_exp_f32 v227, v147
  s_waitcnt lgkmcnt(10)
  v_mfma_f32_16x16x32_bf16 v[0:3], v[192:195], v[184:187], v[0:3]
  ds_read_b64_tr_b16 v[220:221], v236 offset:8192
  v_cvt_pk_bf16_f32 v178, v224, v225
  v_accvgpr_write_b32 a7, 0
  v_mfma_f32_16x16x32_bf16 v[4:7], v[192:195], v[188:191], v[4:7]
  ds_read_b64_tr_b16 v[222:223], v236 offset:12288
  v_mfma_f32_16x16x32_bf16 v[8:11], v[196:199], v[184:187], v[8:11]
  ds_read_b64_tr_b16 v[192:193], v250 offset:8192
  v_add_f32 v243, v243, v225
  v_mfma_f32_16x16x32_bf16 v[12:15], v[196:199], v[188:191], v[12:15]
  ds_read_b64_tr_b16 v[194:195], v250 offset:8704
  v_exp_f32 v224, v140
  v_accvgpr_write_b32 a8, 0
  s_waitcnt lgkmcnt(10)
  v_mfma_f32_16x16x32_bf16 v[16:19], v[200:203], v[184:187], v[16:19]
  ds_read_b64_tr_b16 v[196:197], v251 offset:8192
  v_add_f32 v243, v243, v226
  v_mfma_f32_16x16x32_bf16 v[20:23], v[200:203], v[188:191], v[20:23]
  ds_read_b64_tr_b16 v[198:199], v251 offset:8704
  v_exp_f32 v225, v141
  v_accvgpr_write_b32 a9, 0
  v_mfma_f32_16x16x32_bf16 v[24:27], v[204:207], v[184:187], v[24:27]
  ds_read_b64_tr_b16 v[200:201], v252 offset:8192
  v_cvt_pk_bf16_f32 v179, v226, v227
  v_mfma_f32_16x16x32_bf16 v[28:31], v[204:207], v[188:191], v[28:31]
  ds_read_b64_tr_b16 v[202:203], v252 offset:8704
  v_accvgpr_write_b32 a10, 0
  s_waitcnt lgkmcnt(10)
  v_mfma_f32_16x16x32_bf16 v[32:35], v[208:211], v[184:187], v[32:35]
  ds_read_b64_tr_b16 v[204:205], v253 offset:8192
  v_add_f32 v243, v243, v227
  v_mfma_f32_16x16x32_bf16 v[36:39], v[208:211], v[188:191], v[36:39]
  ds_read_b64_tr_b16 v[206:207], v253 offset:8704
  v_exp_f32 v226, v142
  v_accvgpr_write_b32 a11, 0
  v_mfma_f32_16x16x32_bf16 v[40:43], v[212:215], v[184:187], v[40:43]
  ds_read_b64_tr_b16 v[208:209], v250 offset:12288
  v_add_f32 v244, v224, v225
  v_mfma_f32_16x16x32_bf16 v[44:47], v[212:215], v[188:191], v[44:47]
  ds_read_b64_tr_b16 v[210:211], v250 offset:12800
  v_exp_f32 v227, v143
  v_accvgpr_write_b32 a12, 0
  s_waitcnt lgkmcnt(10)
  v_mfma_f32_16x16x32_bf16 v[48:51], v[216:219], v[184:187], v[48:51]
  ds_read_b64_tr_b16 v[212:213], v251 offset:12288
  v_cvt_pk_bf16_f32 v180, v224, v225
  v_mfma_f32_16x16x32_bf16 v[52:55], v[216:219], v[188:191], v[52:55]
  ds_read_b64_tr_b16 v[214:215], v251 offset:12800
  v_accvgpr_write_b32 a13, 0
  v_mfma_f32_16x16x32_bf16 v[56:59], v[220:223], v[184:187], v[56:59]
  ds_read_b64_tr_b16 v[216:217], v252 offset:12288
  v_exp_f32 v224, v148
  v_mfma_f32_16x16x32_bf16 v[60:63], v[220:223], v[188:191], v[60:63]
  ds_read_b64_tr_b16 v[218:219], v252 offset:12800
  v_add_f32 v244, v244, v226
  v_accvgpr_write_b32 a14, 0
  s_waitcnt lgkmcnt(10)
  v_mfma_f32_16x16x32_bf16 v[96:99], v[192:195], a[16:19], v[96:99]
  ds_read_b64_tr_b16 v[220:221], v253 offset:12288
  v_exp_f32 v225, v149
  v_mfma_f32_16x16x32_bf16 v[100:103], v[192:195], a[20:23], v[100:103]
  ds_read_b64_tr_b16 v[222:223], v253 offset:12800
  v_cvt_pk_bf16_f32 v181, v226, v227
  v_accvgpr_write_b32 a15, 0
  v_mfma_f32_16x16x32_bf16 v[104:107], v[196:199], a[16:19], v[104:107]
  v_add_f32 v244, v244, v227
  v_mfma_f32_16x16x32_bf16 v[108:111], v[196:199], a[20:23], v[108:111]
  v_exp_f32 v226, v150
  s_waitcnt lgkmcnt(8)
  v_mfma_f32_16x16x32_bf16 v[112:115], v[200:203], a[16:19], v[112:115]
  v_add_f32 v244, v244, v224
  v_exp_f32 v227, v151
  v_mfma_f32_16x16x32_bf16 v[116:119], v[200:203], a[20:23], v[116:119]
  v_cvt_pk_bf16_f32 v182, v224, v225
  v_mfma_f32_16x16x32_bf16 v[120:123], v[204:207], a[16:19], v[120:123]
  v_add_f32 v244, v244, v225
  v_mfma_f32_16x16x32_bf16 v[124:127], v[204:207], a[20:23], v[124:127]
  s_waitcnt lgkmcnt(0)
  s_barrier
  ds_read_b128 v[192:195], v228 offset:17408
  ds_read_b128 v[196:199], v228 offset:17472
  ds_read_b128 v[200:203], v228 offset:17536
  ds_read_b128 v[204:207], v228 offset:17600
  v_mfma_f32_16x16x32_bf16 v[96:99], v[208:211], a[24:27], v[96:99]
  v_add_f32 v244, v244, v226
  v_mfma_f32_16x16x32_bf16 v[100:103], v[208:211], a[28:31], v[100:103]
  ds_read_b128 v[208:211], v228 offset:21760
  v_mfma_f32_16x16x32_bf16 v[104:107], v[212:215], a[24:27], v[104:107]
  v_cvt_pk_bf16_f32 v183, v226, v227
  v_mfma_f32_16x16x32_bf16 v[108:111], v[212:215], a[28:31], v[108:111]
  ds_read_b128 v[212:215], v228 offset:21824
  v_mfma_f32_16x16x32_bf16 v[112:115], v[216:219], a[24:27], v[112:115]
  v_add_f32 v244, v244, v227
  v_mfma_f32_16x16x32_bf16 v[116:119], v[216:219], a[28:31], v[116:119]
  ds_read_b128 v[216:219], v228 offset:21888
  v_add_f32 v245, v243, v244
  v_mfma_f32_16x16x32_bf16 v[120:123], v[220:223], a[24:27], v[120:123]
  v_cmp_nge_f32 vcc, s94, v245
  v_mfma_f32_16x16x32_bf16 v[124:127], v[220:223], a[28:31], v[124:127]
  s_cbranch_vccnz T_h9
  v_add_f32 v241, v241, v243
  v_add_f32 v242, v242, v244
R_h9:
  s_waitcnt lgkmcnt(5)
  v_mfma_f32_16x16x32_bf16 v[136:139], v[192:195], v[64:67], v[168:171]
  ds_read_b128 v[220:223], v228 offset:21952
  v_mfma_f32_16x16x32_bf16 v[140:143], v[192:195], v[80:83], v[172:175]
  v_exp_f32 v224, v152
  v_exp_f32 v225, v153
  v_mfma_f32_16x16x32_bf16 v[136:139], v[196:199], v[68:71], v[136:139]
  ds_read_b64_tr_b16 v[192:193], v229 offset:16384
  v_exp_f32 v226, v154
  v_accvgpr_write_b32 a16, 0
  v_mfma_f32_16x16x32_bf16 v[140:143], v[196:199], v[84:87], v[140:143]
  ds_read_b64_tr_b16 v[194:195], v229 offset:20480
  v_add_f32 v243, v224, v225
  s_waitcnt lgkmcnt(6)
  v_mfma_f32_16x16x32_bf16 v[136:139], v[200:203], v[72:75], v[136:139]
  ds_read_b64_tr_b16 v[196:197], v230 offset:16384
  v_exp_f32 v227, v155
  v_accvgpr_write_b32 a17, 0
  v_mfma_f32_16x16x32_bf16 v[140:143], v[200:203], v[88:91], v[140:143]
  ds_read_b64_tr_b16 v[198:199], v230 offset:20480
  v_mfma_f32_16x16x32_bf16 v[136:139], v[204:207], v[76:79], v[136:139]
  ds_read_b64_tr_b16 v[200:201], v231 offset:16384
  v_cvt_pk_bf16_f32 v184, v224, v225
  v_accvgpr_write_b32 a18, 0
  v_mfma_f32_16x16x32_bf16 v[140:143], v[204:207], v[92:95], v[140:143]
  ds_read_b64_tr_b16 v[202:203], v231 offset:20480
  v_exp_f32 v224, v160
  s_waitcnt lgkmcnt(8)
  v_mfma_f32_16x16x32_bf16 v[144:147], v[208:211], v[64:67], v[168:171]
  ds_read_b64_tr_b16 v[204:205], v232 offset:16384
  v_add_f32 v243, v243, v226
  v_accvgpr_write_b32 a19, 0
  v_mfma_f32_16x16x32_bf16 v[148:151], v[208:211], v[80:83], v[172:175]
  ds_read_b64_tr_b16 v[206:207], v232 offset:20480
  v_exp_f32 v225, v161
  v_mfma_f32_16x16x32_bf16 v[144:147], v[212:215], v[68:71], v[144:147]
  ds_read_b64_tr_b16 v[208:209], v233 offset:16384
  v_cvt_pk_bf16_f32 v185, v226, v227
  v_accvgpr_write_b32 a20, 0
  v_mfma_f32_16x16x32_bf16 v[148:151], v[212:215], v[84:87], v[148:151]
  ds_read_b64_tr_b16 v[210:211], v233 offset:20480
  s_waitcnt lgkmcnt(10)
  v_mfma_f32_16x16x32_bf16 v[144:147], v[216:219], v[72:75], v[144:147]
  ds_read_b64_tr_b16 v[212:213], v234 offset:16384
  v_add_f32 v243, v243, v227
  v_accvgpr_write_b32 a21, 0
  v_mfma_f32_16x16x32_bf16 v[148:151], v[216:219], v[88:91], v[148:151]
  ds_read_b64_tr_b16 v[214:215], v234 offset:20480
  v_exp_f32 v226, v162
  v_mfma_f32_16x16x32_bf16 v[144:147], v[220:223], v[76:79], v[144:147]
  ds_read_b64_tr_b16 v[216:217], v235 offset:16384
  v_add_f32 v243, v243, v224
  v_accvgpr_write_b32 a22, 0
  v_mfma_f32_16x16x32_bf16 v[148:151], v[220:223], v[92:95], v[148:151]
  ds_read_b64_tr_b16 v[218:219], v235 offset:20480
  v_exp_f32 v227, v163
  s_waitcnt lgkmcnt(10)
  v_mfma_f32_16x16x32_bf16 v[0:3], v[192:195], v[176:179], v[0:3]
  ds_read_b64_tr_b16 v[220:221], v236 offset:16384
  v_cvt_pk_bf16_f32 v186, v224, v225
  v_accvgpr_write_b32 a23, 0
  v_mfma_f32_16x16x32_bf16 v[4:7], v[192:195], v[180:183], v[4:7]
  ds_read_b64_tr_b16 v[222:223], v236 offset:20480
  v_mfma_f32_16x16x32_bf16 v[8:11], v[196:199], v[176:179], v[8:11]
  ds_read_b64_tr_b16 v[192:193], v250 offset:16384
  v_add_f32 v243, v243, v225
  v_mfma_f32_16x16x32_bf16 v[12:15], v[196:199], v[180:183], v[12:15]
  ds_read_b64_tr_b16 v[194:195], v250 offset:16896
  v_exp_f32 v224, v156
  v_accvgpr_write_b32 a24, 0
  s_waitcnt lgkmcnt(10)
  v_mfma_f32_16x16x32_bf16 v[16:19], v[200:203], v[176:179], v[16:19]
  ds_read_b64_tr_b16 v[196:197], v251 offset:16384
  v_add_f32 v243, v243, v226
  v_mfma_f32_16x16x32_bf16 v[20:23], v[200:203], v[180:183], v[20:23]
  ds_read_b64_tr_b16 v[198:199], v251 offset:16896
  v_exp_f32 v225, v157
  v_accvgpr_write_b32 a25, 0
  v_mfma_f32_16x16x32_bf16 v[24:27], v[204:207], v[176:179], v[24:27]
  ds_read_b64_tr_b16 v[200:201], v252 offset:16384
  v_cvt_pk_bf16_f32 v187, v226, v227
  v_mfma_f32_16x16x32_bf16 v[28:31], v[204:207], v[180:183], v[28:31]
  ds_read_b64_tr_b16 v[202:203], v252 offset:16896
  v_accvgpr_write_b32 a26, 0
  s_waitcnt lgkmcnt(10)
  v_mfma_f32_16x16x32_bf16 v[32:35], v[208:211], v[176:179], v[32:35]
  ds_read_b64_tr_b16 v[204:205], v253 offset:16384
  v_add_f32 v243, v243, v227
  v_mfma_f32_16x16x32_bf16 v[36:39], v[208:211], v[180:183], v[36:39]
  ds_read_b64_tr_b16 v[206:207], v253 offset:16896
  v_exp_f32 v226, v158
  v_accvgpr_write_b32 a27, 0
  v_mfma_f32_16x16x32_bf16 v[40:43], v[212:215], v[176:179], v[40:43]
  ds_read_b64_tr_b16 v[208:209], v250 offset:20480
  v_add_f32 v244, v224, v225
  v_mfma_f32_16x16x32_bf16 v[44:47], v[212:215], v[180:183], v[44:47]
  ds_read_b64_tr_b16 v[210:211], v250 offset:20992
  v_exp_f32 v227, v159
  v_accvgpr_write_b32 a28, 0
  s_waitcnt lgkmcnt(10)
  v_mfma_f32_16x16x32_bf16 v[48:51], v[216:219], v[176:179], v[48:51]
  ds_read_b64_tr_b16 v[212:213], v251 offset:20480
  v_cvt_pk_bf16_f32 v188, v224, v225
  v_mfma_f32_16x16x32_bf16 v[52:55], v[216:219], v[180:183], v[52:55]
  ds_read_b64_tr_b16 v[214:215], v251 offset:20992
  v_accvgpr_write_b32 a29, 0
  v_mfma_f32_16x16x32_bf16 v[56:59], v[220:223], v[176:179], v[56:59]
  ds_read_b64_tr_b16 v[216:217], v252 offset:20480
  v_exp_f32 v224, v164
  v_mfma_f32_16x16x32_bf16 v[60:63], v[220:223], v[180:183], v[60:63]
  ds_read_b64_tr_b16 v[218:219], v252 offset:20992
  v_add_f32 v244, v244, v226
  v_accvgpr_write_b32 a30, 0
  s_waitcnt lgkmcnt(10)
  v_mfma_f32_16x16x32_bf16 v[96:99], v[192:195], a[32:35], v[96:99]
  ds_read_b64_tr_b16 v[220:221], v253 offset:20480
  v_exp_f32 v225, v165
  v_mfma_f32_16x16x32_bf16 v[100:103], v[192:195], a[36:39], v[100:103]
  ds_read_b64_tr_b16 v[222:223], v253 offset:20992
  v_cvt_pk_bf16_f32 v189, v226, v227
  v_accvgpr_write_b32 a31, 0
  v_mfma_f32_16x16x32_bf16 v[104:107], v[196:199], a[32:35], v[104:107]
  v_add_f32 v244, v244, v227
  v_mfma_f32_16x16x32_bf16 v[108:111], v[196:199], a[36:39], v[108:111]
  v_exp_f32 v226, v166
  s_waitcnt lgkmcnt(8)
  v_mfma_f32_16x16x32_bf16 v[112:115], v[200:203], a[32:35], v[112:115]
  v_add_f32 v244, v244, v224
  v_exp_f32 v227, v167
  v_mfma_f32_16x16x32_bf16 v[116:119], v[200:203], a[36:39], v[116:119]
  v_cvt_pk_bf16_f32 v190, v224, v225
  v_mfma_f32_16x16x32_bf16 v[120:123], v[204:207], a[32:35], v[120:123]
  v_add_f32 v244, v244, v225
  v_mfma_f32_16x16x32_bf16 v[124:127], v[204:207], a[36:39], v[124:127]
  s_waitcnt lgkmcnt(0)
  s_barrier
  ds_read_b128 v[192:195], v228 offset:26112
  ds_read_b128 v[196:199], v228 offset:26176
  ds_read_b128 v[200:203], v228 offset:26240
  ds_read_b128 v[204:207], v228 offset:26304
  v_mfma_f32_16x16x32_bf16 v[96:99], v[208:211], a[40:43], v[96:99]
  v_add_f32 v244, v244, v226
  v_mfma_f32_16x16x32_bf16 v[100:103], v[208:211], a[44:47], v[100:103]
  ds_read_b128 v[208:211], v228 offset:30464
  v_mfma_f32_16x16x32_bf16 v[104:107], v[212:215], a[40:43], v[104:107]
  v_cvt_pk_bf16_f32 v191, v226, v227
  v_mfma_f32_16x16x32_bf16 v[108:111], v[212:215], a[44:47], v[108:111]
  ds_read_b128 v[212:215], v228 offset:30528
  v_mfma_f32_16x16x32_bf16 v[112:115], v[216:219], a[40:43], v[112:115]
  v_add_f32 v244, v244, v227
  v_mfma_f32_16x16x32_bf16 v[116:119], v[216:219], a[44:47], v[116:119]
  ds_read_b128 v[216:219], v228 offset:30592
  v_add_f32 v245, v243, v244
  v_mfma_f32_16x16x32_bf16 v[120:123], v[220:223], a[40:43], v[120:123]
  v_cmp_nge_f32 vcc, s94, v245
  v_mfma_f32_16x16x32_bf16 v[124:127], v[220:223], a[44:47], v[124:127]
  s_cbranch_vccnz T_h10
  v_add_f32 v241, v241, v243
  v_add_f32 v242, v242, v244
R_h10:
  s_waitcnt lgkmcnt(5)
  v_mfma_f32_16x16x32_bf16 v[152:155], v[192:195], v[64:67], v[168:171]
  ds_read_b128 v[220:223], v228 offset:30656
  v_mfma_f32_16x16x32_bf16 v[156:159], v[192:195], v[80:83], v[172:175]
  v_exp_f32 v224, v136
  v_exp_f32 v225, v137
  v_mfma_f32_16x16x32_bf16 v[152:155], v[196:199], v[68:71], v[152:155]
  ds_read_b64_tr_b16 v[192:193], v229 offset:24576
  v_exp_f32 v226, v138
  v_accvgpr_write_b32 a32, 0
  v_mfma_f32_16x16x32_bf16 v[156:159], v[196:199], v[84:87], v[156:159]
  ds_read_b64_tr_b16 v[194:195], v229 offset:28672
  v_add_f32 v243, v224, v225
  s_waitcnt lgkmcnt(6)
  v_mfma_f32_16x16x32_bf16 v[152:155], v[200:203], v[72:75], v[152:155]
  ds_read_b64_tr_b16 v[196:197], v230 offset:24576
  v_exp_f32 v227, v139
  v_accvgpr_write_b32 a33, 0
  v_mfma_f32_16x16x32_bf16 v[156:159], v[200:203], v[88:91], v[156:159]
  ds_read_b64_tr_b16 v[198:199], v230 offset:28672
  v_mfma_f32_16x16x32_bf16 v[152:155], v[204:207], v[76:79], v[152:155]
  ds_read_b64_tr_b16 v[200:201], v231 offset:24576
  v_cvt_pk_bf16_f32 v176, v224, v225
  v_accvgpr_write_b32 a34, 0
  v_mfma_f32_16x16x32_bf16 v[156:159], v[204:207], v[92:95], v[156:159]
  ds_read_b64_tr_b16 v[202:203], v231 offset:28672
  v_exp_f32 v224, v144
  s_waitcnt lgkmcnt(8)
  v_mfma_f32_16x16x32_bf16 v[160:163], v[208:211], v[64:67], v[168:171]
  ds_read_b64_tr_b16 v[204:205], v232 offset:24576
  v_add_f32 v243, v243, v226
  v_accvgpr_write_b32 a35, 0
  v_mfma_f32_16x16x32_bf16 v[164:167], v[208:211], v[80:83], v[172:175]
  ds_read_b64_tr_b16 v[206:207], v232 offset:28672
  v_exp_f32 v225, v145
  v_mfma_f32_16x16x32_bf16 v[160:163], v[212:215], v[68:71], v[160:163]
  ds_read_b64_tr_b16 v[208:209], v233 offset:24576
  v_cvt_pk_bf16_f32 v177, v226, v227
  v_accvgpr_write_b32 a36, 0
  v_mfma_f32_16x16x32_bf16 v[164:167], v[212:215], v[84:87], v[164:167]
  ds_read_b64_tr_b16 v[210:211], v233 offset:28672
  s_waitcnt lgkmcnt(10)
  v_mfma_f32_16x16x32_bf16 v[160:163], v[216:219], v[72:75], v[160:163]
  ds_read_b64_tr_b16 v[212:213], v234 offset:24576
  v_add_f32 v243, v243, v227
  v_accvgpr_write_b32 a37, 0
  v_mfma_f32_16x16x32_bf16 v[164:167], v[216:219], v[88:91], v[164:167]
  ds_read_b64_tr_b16 v[214:215], v234 offset:28672
  v_exp_f32 v226, v146
  v_mfma_f32_16x16x32_bf16 v[160:163], v[220:223], v[76:79], v[160:163]
  ds_read_b64_tr_b16 v[216:217], v235 offset:24576
  v_add_f32 v243, v243, v224
  v_accvgpr_write_b32 a38, 0
  v_mfma_f32_16x16x32_bf16 v[164:167], v[220:223], v[92:95], v[164:167]
  ds_read_b64_tr_b16 v[218:219], v235 offset:28672
  v_exp_f32 v227, v147
  s_waitcnt lgkmcnt(10)
  v_mfma_f32_16x16x32_bf16 v[0:3], v[192:195], v[184:187], v[0:3]
  ds_read_b64_tr_b16 v[220:221], v236 offset:24576
  v_cvt_pk_bf16_f32 v178, v224, v225
  v_accvgpr_write_b32 a39, 0
  v_mfma_f32_16x16x32_bf16 v[4:7], v[192:195], v[188:191], v[4:7]
  ds_read_b64_tr_b16 v[222:223], v236 offset:28672
  v_mfma_f32_16x16x32_bf16 v[8:11], v[196:199], v[184:187], v[8:11]
  ds_read_b64_tr_b16 v[192:193], v250 offset:24576
  v_add_f32 v243, v243, v225
  v_mfma_f32_16x16x32_bf16 v[12:15], v[196:199], v[188:191], v[12:15]
  ds_read_b64_tr_b16 v[194:195], v250 offset:25088
  v_exp_f32 v224, v140
  v_accvgpr_write_b32 a40, 0
  s_waitcnt lgkmcnt(10)
  v_mfma_f32_16x16x32_bf16 v[16:19], v[200:203], v[184:187], v[16:19]
  ds_read_b64_tr_b16 v[196:197], v251 offset:24576
  v_add_f32 v243, v243, v226
  v_mfma_f32_16x16x32_bf16 v[20:23], v[200:203], v[188:191], v[20:23]
  ds_read_b64_tr_b16 v[198:199], v251 offset:25088
  v_exp_f32 v225, v141
  v_accvgpr_write_b32 a41, 0
  v_mfma_f32_16x16x32_bf16 v[24:27], v[204:207], v[184:187], v[24:27]
  ds_read_b64_tr_b16 v[200:201], v252 offset:24576
  v_cvt_pk_bf16_f32 v179, v226, v227
  v_mfma_f32_16x16x32_bf16 v[28:31], v[204:207], v[188:191], v[28:31]
  ds_read_b64_tr_b16 v[202:203], v252 offset:25088
  v_accvgpr_write_b32 a42, 0
  s_waitcnt lgkmcnt(10)
  v_mfma_f32_16x16x32_bf16 v[32:35], v[208:211], v[184:187], v[32:35]
  ds_read_b64_tr_b16 v[204:205], v253 offset:24576
  v_add_f32 v243, v243, v227
  v_mfma_f32_16x16x32_bf16 v[36:39], v[208:211], v[188:191], v[36:39]
  ds_read_b64_tr_b16 v[206:207], v253 offset:25088
  v_exp_f32 v226, v142
  v_accvgpr_write_b32 a43, 0
  v_mfma_f32_16x16x32_bf16 v[40:43], v[212:215], v[184:187], v[40:43]
  ds_read_b64_tr_b16 v[208:209], v250 offset:28672
  v_add_f32 v244, v224, v225
  v_mfma_f32_16x16x32_bf16 v[44:47], v[212:215], v[188:191], v[44:47]
  ds_read_b64_tr_b16 v[210:211], v250 offset:29184
  v_exp_f32 v227, v143
  v_accvgpr_write_b32 a44, 0
  s_waitcnt lgkmcnt(10)
  v_mfma_f32_16x16x32_bf16 v[48:51], v[216:219], v[184:187], v[48:51]
  ds_read_b64_tr_b16 v[212:213], v251 offset:28672
  v_cvt_pk_bf16_f32 v180, v224, v225
  v_mfma_f32_16x16x32_bf16 v[52:55], v[216:219], v[188:191], v[52:55]
  ds_read_b64_tr_b16 v[214:215], v251 offset:29184
  v_accvgpr_write_b32 a45, 0
  v_mfma_f32_16x16x32_bf16 v[56:59], v[220:223], v[184:187], v[56:59]
  ds_read_b64_tr_b16 v[216:217], v252 offset:28672
  v_exp_f32 v224, v148
  v_mfma_f32_16x16x32_bf16 v[60:63], v[220:223], v[188:191], v[60:63]
  ds_read_b64_tr_b16 v[218:219], v252 offset:29184
  v_add_f32 v244, v244, v226
  v_accvgpr_write_b32 a46, 0
  s_waitcnt lgkmcnt(10)
  v_mfma_f32_16x16x32_bf16 v[96:99], v[192:195], a[48:51], v[96:99]
  ds_read_b64_tr_b16 v[220:221], v253 offset:28672
  v_exp_f32 v225, v149
  v_mfma_f32_16x16x32_bf16 v[100:103], v[192:195], a[52:55], v[100:103]
  ds_read_b64_tr_b16 v[222:223], v253 offset:29184
  v_cvt_pk_bf16_f32 v181, v226, v227
  v_accvgpr_write_b32 a47, 0
  v_mfma_f32_16x16x32_bf16 v[104:107], v[196:199], a[48:51], v[104:107]
  v_add_f32 v244, v244, v227
  v_mfma_f32_16x16x32_bf16 v[108:111], v[196:199], a[52:55], v[108:111]
  v_exp_f32 v226, v150
  s_waitcnt lgkmcnt(8)
  v_mfma_f32_16x16x32_bf16 v[112:115], v[200:203], a[48:51], v[112:115]
  v_add_f32 v244, v244, v224
  v_exp_f32 v227, v151
  v_mfma_f32_16x16x32_bf16 v[116:119], v[200:203], a[52:55], v[116:119]
  v_cvt_pk_bf16_f32 v182, v224, v225
  v_mfma_f32_16x16x32_bf16 v[120:123], v[204:207], a[48:51], v[120:123]
  v_add_f32 v244, v244, v225
  v_mfma_f32_16x16x32_bf16 v[124:127], v[204:207], a[52:55], v[124:127]
  s_waitcnt lgkmcnt(0)
  s_barrier
  ds_read_b128 v[192:195], v228 offset:0
  ds_read_b128 v[196:199], v228 offset:64
  ds_read_b128 v[200:203], v228 offset:128
  ds_read_b128 v[204:207], v228 offset:192
  v_mfma_f32_16x16x32_bf16 v[96:99], v[208:211], a[56:59], v[96:99]
  v_add_f32 v244, v244, v226
  v_mfma_f32_16x16x32_bf16 v[100:103], v[208:211], a[60:63], v[100:103]
  ds_read_b128 v[208:211], v228 offset:4352
  v_mfma_f32_16x16x32_bf16 v[104:107], v[212:215], a[56:59], v[104:107]
  v_cvt_pk_bf16_f32 v183, v226, v227
  v_mfma_f32_16x16x32_bf16 v[108:111], v[212:215], a[60:63], v[108:111]
  ds_read_b128 v[212:215], v228 offset:4416
  v_mfma_f32_16x16x32_bf16 v[112:115], v[216:219], a[56:59], v[112:115]
  v_add_f32 v244, v244, v227
  v_mfma_f32_16x16x32_bf16 v[116:119], v[216:219], a[60:63], v[116:119]
  ds_read_b128 v[216:219], v228 offset:4480
  v_add_f32 v245, v243, v244
  v_mfma_f32_16x16x32_bf16 v[120:123], v[220:223], a[56:59], v[120:123]
  v_cmp_nge_f32 vcc, s94, v245
  v_mfma_f32_16x16x32_bf16 v[124:127], v[220:223], a[60:63], v[124:127]
  s_cbranch_vccnz T_h11
  v_add_f32 v241, v241, v243
  v_add_f32 v242, v242, v244
R_h11:
  s_waitcnt lgkmcnt(5)
  v_mfma_f32_16x16x32_bf16 v[136:139], v[192:195], v[64:67], v[168:171]
  ds_read_b128 v[220:223], v228 offset:4544
  v_mfma_f32_16x16x32_bf16 v[140:143], v[192:195], v[80:83], v[172:175]
  v_exp_f32 v224, v152
  v_exp_f32 v225, v153
  v_mfma_f32_16x16x32_bf16 v[136:139], v[196:199], v[68:71], v[136:139]
  ds_read_b64_tr_b16 v[192:193], v229 offset:0
  v_exp_f32 v226, v154
  v_accvgpr_write_b32 a48, 0
  v_mfma_f32_16x16x32_bf16 v[140:143], v[196:199], v[84:87], v[140:143]
  ds_read_b64_tr_b16 v[194:195], v229 offset:4096
  v_add_f32 v243, v224, v225
  s_waitcnt lgkmcnt(6)
  v_mfma_f32_16x16x32_bf16 v[136:139], v[200:203], v[72:75], v[136:139]
  ds_read_b64_tr_b16 v[196:197], v230 offset:0
  v_exp_f32 v227, v155
  v_accvgpr_write_b32 a49, 0
  v_mfma_f32_16x16x32_bf16 v[140:143], v[200:203], v[88:91], v[140:143]
  ds_read_b64_tr_b16 v[198:199], v230 offset:4096
  v_mfma_f32_16x16x32_bf16 v[136:139], v[204:207], v[76:79], v[136:139]
  ds_read_b64_tr_b16 v[200:201], v231 offset:0
  v_cvt_pk_bf16_f32 v184, v224, v225
  v_accvgpr_write_b32 a50, 0
  v_mfma_f32_16x16x32_bf16 v[140:143], v[204:207], v[92:95], v[140:143]
  ds_read_b64_tr_b16 v[202:203], v231 offset:4096
  v_exp_f32 v224, v160
  s_waitcnt lgkmcnt(8)
  v_mfma_f32_16x16x32_bf16 v[144:147], v[208:211], v[64:67], v[168:171]
  ds_read_b64_tr_b16 v[204:205], v232 offset:0
  v_add_f32 v243, v243, v226
  v_accvgpr_write_b32 a51, 0
  v_mfma_f32_16x16x32_bf16 v[148:151], v[208:211], v[80:83], v[172:175]
  ds_read_b64_tr_b16 v[206:207], v232 offset:4096
  v_exp_f32 v225, v161
  v_mfma_f32_16x16x32_bf16 v[144:147], v[212:215], v[68:71], v[144:147]
  ds_read_b64_tr_b16 v[208:209], v233 offset:0
  v_cvt_pk_bf16_f32 v185, v226, v227
  v_accvgpr_write_b32 a52, 0
  v_mfma_f32_16x16x32_bf16 v[148:151], v[212:215], v[84:87], v[148:151]
  ds_read_b64_tr_b16 v[210:211], v233 offset:4096
  s_waitcnt lgkmcnt(10)
  v_mfma_f32_16x16x32_bf16 v[144:147], v[216:219], v[72:75], v[144:147]
  ds_read_b64_tr_b16 v[212:213], v234 offset:0
  v_add_f32 v243, v243, v227
  v_accvgpr_write_b32 a53, 0
  v_mfma_f32_16x16x32_bf16 v[148:151], v[216:219], v[88:91], v[148:151]
  ds_read_b64_tr_b16 v[214:215], v234 offset:4096
  v_exp_f32 v226, v162
  v_mfma_f32_16x16x32_bf16 v[144:147], v[220:223], v[76:79], v[144:147]
  ds_read_b64_tr_b16 v[216:217], v235 offset:0
  v_add_f32 v243, v243, v224
  v_accvgpr_write_b32 a54, 0
  v_mfma_f32_16x16x32_bf16 v[148:151], v[220:223], v[92:95], v[148:151]
  ds_read_b64_tr_b16 v[218:219], v235 offset:4096
  v_exp_f32 v227, v163
  s_waitcnt lgkmcnt(10)
  v_mfma_f32_16x16x32_bf16 v[0:3], v[192:195], v[176:179], v[0:3]
  ds_read_b64_tr_b16 v[220:221], v236 offset:0
  v_cvt_pk_bf16_f32 v186, v224, v225
  v_accvgpr_write_b32 a55, 0
  v_mfma_f32_16x16x32_bf16 v[4:7], v[192:195], v[180:183], v[4:7]
  ds_read_b64_tr_b16 v[222:223], v236 offset:4096
  v_mfma_f32_16x16x32_bf16 v[8:11], v[196:199], v[176:179], v[8:11]
  ds_read_b64_tr_b16 v[192:193], v250 offset:0
  v_add_f32 v243, v243, v225
  v_mfma_f32_16x16x32_bf16 v[12:15], v[196:199], v[180:183], v[12:15]
  ds_read_b64_tr_b16 v[194:195], v250 offset:512
  v_exp_f32 v224, v156
  v_accvgpr_write_b32 a56, 0
  s_waitcnt lgkmcnt(10)
  v_mfma_f32_16x16x32_bf16 v[16:19], v[200:203], v[176:179], v[16:19]
  ds_read_b64_tr_b16 v[196:197], v251 offset:0
  v_add_f32 v243, v243, v226
  v_mfma_f32_16x16x32_bf16 v[20:23], v[200:203], v[180:183], v[20:23]
  ds_read_b64_tr_b16 v[198:199], v251 offset:512
  v_exp_f32 v225, v157
  v_accvgpr_write_b32 a57, 0
  v_mfma_f32_16x16x32_bf16 v[24:27], v[204:207], v[176:179], v[24:27]
  ds_read_b64_tr_b16 v[200:201], v252 offset:0
  v_cvt_pk_bf16_f32 v187, v226, v227
  v_mfma_f32_16x16x32_bf16 v[28:31], v[204:207], v[180:183], v[28:31]
  ds_read_b64_tr_b16 v[202:203], v252 offset:512
  v_accvgpr_write_b32 a58, 0
  s_waitcnt lgkmcnt(10)
  v_mfma_f32_16x16x32_bf16 v[32:35], v[208:211], v[176:179], v[32:35]
  ds_read_b64_tr_b16 v[204:205], v253 offset:0
  v_add_f32 v243, v243, v227
  v_mfma_f32_16x16x32_bf16 v[36:39], v[208:211], v[180:183], v[36:39]
  ds_read_b64_tr_b16 v[206:207], v253 offset:512
  v_exp_f32 v226, v158
  v_accvgpr_write_b32 a59, 0
  v_mfma_f32_16x16x32_bf16 v[40:43], v[212:215], v[176:179], v[40:43]
  ds_read_b64_tr_b16 v[208:209], v250 offset:4096
  v_add_f32 v244, v224, v225
  v_mfma_f32_16x16x32_bf16 v[44:47], v[212:215], v[180:183], v[44:47]
  ds_read_b64_tr_b16 v[210:211], v250 offset:4608
  v_exp_f32 v227, v159
  v_accvgpr_write_b32 a60, 0
  s_waitcnt lgkmcnt(10)
  v_mfma_f32_16x16x32_bf16 v[48:51], v[216:219], v[176:179], v[48:51]
  ds_read_b64_tr_b16 v[212:213], v251 offset:4096
  v_cvt_pk_bf16_f32 v188, v224, v225
  v_mfma_f32_16x16x32_bf16 v[52:55], v[216:219], v[180:183], v[52:55]
  ds_read_b64_tr_b16 v[214:215], v251 offset:4608
  v_accvgpr_write_b32 a61, 0
  v_mfma_f32_16x16x32_bf16 v[56:59], v[220:223], v[176:179], v[56:59]
  ds_read_b64_tr_b16 v[216:217], v252 offset:4096
  v_exp_f32 v224, v164
  v_mfma_f32_16x16x32_bf16 v[60:63], v[220:223], v[180:183], v[60:63]
  ds_read_b64_tr_b16 v[218:219], v252 offset:4608
  v_add_f32 v244, v244, v226
  v_accvgpr_write_b32 a62, 0
  s_waitcnt lgkmcnt(10)
  v_mfma_f32_16x16x32_bf16 v[96:99], v[192:195], a[64:67], v[96:99]
  ds_read_b64_tr_b16 v[220:221], v253 offset:4096
  v_exp_f32 v225, v165
  v_mfma_f32_16x16x32_bf16 v[100:103], v[192:195], a[68:71], v[100:103]
  ds_read_b64_tr_b16 v[222:223], v253 offset:4608
  v_cvt_pk_bf16_f32 v189, v226, v227
  v_accvgpr_write_b32 a63, 0
  v_mfma_f32_16x16x32_bf16 v[104:107], v[196:199], a[64:67], v[104:107]
  v_add_f32 v244, v244, v227
  v_mfma_f32_16x16x32_bf16 v[108:111], v[196:199], a[68:71], v[108:111]
  v_exp_f32 v226, v166
  s_waitcnt lgkmcnt(8)
  v_mfma_f32_16x16x32_bf16 v[112:115], v[200:203], a[64:67], v[112:115]
  v_add_f32 v244, v244, v224
  v_exp_f32 v227, v167
  v_mfma_f32_16x16x32_bf16 v[116:119], v[200:203], a[68:71], v[116:119]
  v_cvt_pk_bf16_f32 v190, v224, v225
  v_mfma_f32_16x16x32_bf16 v[120:123], v[204:207], a[64:67], v[120:123]
  v_add_f32 v244, v244, v225
  v_mfma_f32_16x16x32_bf16 v[124:127], v[204:207], a[68:71], v[124:127]
  s_waitcnt lgkmcnt(0)
  s_barrier
  ds_read_b128 v[192:195], v228 offset:8704
  ds_read_b128 v[196:199], v228 offset:8768
  ds_read_b128 v[200:203], v228 offset:8832
  ds_read_b128 v[204:207], v228 offset:8896
  v_mfma_f32_16x16x32_bf16 v[96:99], v[208:211], a[72:75], v[96:99]
  v_add_f32 v244, v244, v226
  v_mfma_f32_16x16x32_bf16 v[100:103], v[208:211], a[76:79], v[100:103]
  ds_read_b128 v[208:211], v228 offset:13056
  v_mfma_f32_16x16x32_bf16 v[104:107], v[212:215], a[72:75], v[104:107]
  v_cvt_pk_bf16_f32 v191, v226, v227
  v_mfma_f32_16x16x32_bf16 v[108:111], v[212:215], a[76:79], v[108:111]
  ds_read_b128 v[212:215], v228 offset:13120
  v_mfma_f32_16x16x32_bf16 v[112:115], v[216:219], a[72:75], v[112:115]
  v_add_f32 v244, v244, v227
  v_mfma_f32_16x16x32_bf16 v[116:119], v[216:219], a[76:79], v[116:119]
  ds_read_b128 v[216:219], v228 offset:13184
  v_add_f32 v245, v243, v244
  v_mfma_f32_16x16x32_bf16 v[120:123], v[220:223], a[72:75], v[120:123]
  v_cmp_nge_f32 vcc, s94, v245
  v_mfma_f32_16x16x32_bf16 v[124:127], v[220:223], a[76:79], v[124:127]
  s_cbranch_vccnz T_h12
  v_add_f32 v241, v241, v243
  v_add_f32 v242, v242, v244
R_h12:
  s_waitcnt lgkmcnt(5)
  v_mfma_f32_16x16x32_bf16 v[152:155], v[192:195], v[64:67], v[168:171]
  ds_read_b128 v[220:223], v228 offset:13248
  v_mfma_f32_16x16x32_bf16 v[156:159], v[192:195], v[80:83], v[172:175]
  v_exp_f32 v224, v136
  v_exp_f32 v225, v137
  v_mfma_f32_16x16x32_bf16 v[152:155], v[196:199], v[68:71], v[152:155]
  ds_read_b64_tr_b16 v[192:193], v229 offset:8192
  v_exp_f32 v226, v138
  v_accvgpr_write_b32 a64, 0
  v_mfma_f32_16x16x32_bf16 v[156:159], v[196:199], v[84:87], v[156:159]
  ds_read_b64_tr_b16 v[194:195], v229 offset:12288
  v_add_f32 v243, v224, v225
  s_waitcnt lgkmcnt(6)
  v_mfma_f32_16x16x32_bf16 v[152:155], v[200:203], v[72:75], v[152:155]
  ds_read_b64_tr_b16 v[196:197], v230 offset:8192
  v_exp_f32 v227, v139
  v_accvgpr_write_b32 a65, 0
  v_mfma_f32_16x16x32_bf16 v[156:159], v[200:203], v[88:91], v[156:159]
  ds_read_b64_tr_b16 v[198:199], v230 offset:12288
  v_mfma_f32_16x16x32_bf16 v[152:155], v[204:207], v[76:79], v[152:155]
  ds_read_b64_tr_b16 v[200:201], v231 offset:8192
  v_cvt_pk_bf16_f32 v176, v224, v225
  v_accvgpr_write_b32 a66, 0
  v_mfma_f32_16x16x32_bf16 v[156:159], v[204:207], v[92:95], v[156:159]
  ds_read_b64_tr_b16 v[202:203], v231 offset:12288
  v_exp_f32 v224, v144
  s_waitcnt lgkmcnt(8)
  v_mfma_f32_16x16x32_bf16 v[160:163], v[208:211], v[64:67], v[168:171]
  ds_read_b64_tr_b16 v[204:205], v232 offset:8192
  v_add_f32 v243, v243, v226
  v_accvgpr_write_b32 a67, 0
  v_mfma_f32_16x16x32_bf16 v[164:167], v[208:211], v[80:83], v[172:175]
  ds_read_b64_tr_b16 v[206:207], v232 offset:12288
  v_exp_f32 v225, v145
  v_mfma_f32_16x16x32_bf16 v[160:163], v[212:215], v[68:71], v[160:163]
  ds_read_b64_tr_b16 v[208:209], v233 offset:8192
  v_cvt_pk_bf16_f32 v177, v226, v227
  v_accvgpr_write_b32 a68, 0
  v_mfma_f32_16x16x32_bf16 v[164:167], v[212:215], v[84:87], v[164:167]
  ds_read_b64_tr_b16 v[210:211], v233 offset:12288
  s_waitcnt lgkmcnt(10)
  v_mfma_f32_16x16x32_bf16 v[160:163], v[216:219], v[72:75], v[160:163]
  ds_read_b64_tr_b16 v[212:213], v234 offset:8192
  v_add_f32 v243, v243, v227
  v_accvgpr_write_b32 a69, 0
  v_mfma_f32_16x16x32_bf16 v[164:167], v[216:219], v[88:91], v[164:167]
  ds_read_b64_tr_b16 v[214:215], v234 offset:12288
  v_exp_f32 v226, v146
  v_mfma_f32_16x16x32_bf16 v[160:163], v[220:223], v[76:79], v[160:163]
  ds_read_b64_tr_b16 v[216:217], v235 offset:8192
  v_add_f32 v243, v243, v224
  v_accvgpr_write_b32 a70, 0
  v_mfma_f32_16x16x32_bf16 v[164:167], v[220:223], v[92:95], v[164:167]
  ds_read_b64_tr_b16 v[218:219], v235 offset:12288
  v_exp_f32 v227, v147
  s_waitcnt lgkmcnt(10)
  v_mfma_f32_16x16x32_bf16 v[0:3], v[192:195], v[184:187], v[0:3]
  ds_read_b64_tr_b16 v[220:221], v236 offset:8192
  v_cvt_pk_bf16_f32 v178, v224, v225
  v_accvgpr_write_b32 a71, 0
  v_mfma_f32_16x16x32_bf16 v[4:7], v[192:195], v[188:191], v[4:7]
  ds_read_b64_tr_b16 v[222:223], v236 offset:12288
  v_mfma_f32_16x16x32_bf16 v[8:11], v[196:199], v[184:187], v[8:11]
  ds_read_b64_tr_b16 v[192:193], v250 offset:8192
  v_add_f32 v243, v243, v225
  v_mfma_f32_16x16x32_bf16 v[12:15], v[196:199], v[188:191], v[12:15]
  ds_read_b64_tr_b16 v[194:195], v250 offset:8704
  v_exp_f32 v224, v140
  v_accvgpr_write_b32 a72, 0
  s_waitcnt lgkmcnt(10)
  v_mfma_f32_16x16x32_bf16 v[16:19], v[200:203], v[184:187], v[16:19]
  ds_read_b64_tr_b16 v[196:197], v251 offset:8192
  v_add_f32 v243, v243, v226
  v_mfma_f32_16x16x32_bf16 v[20:23], v[200:203], v[188:191], v[20:23]
  ds_read_b64_tr_b16 v[198:199], v251 offset:8704
  v_exp_f32 v225, v141
  v_accvgpr_write_b32 a73, 0
  v_mfma_f32_16x16x32_bf16 v[24:27], v[204:207], v[184:187], v[24:27]
  ds_read_b64_tr_b16 v[200:201], v252 offset:8192
  v_cvt_pk_bf16_f32 v179, v226, v227
  v_mfma_f32_16x16x32_bf16 v[28:31], v[204:207], v[188:191], v[28:31]
  ds_read_b64_tr_b16 v[202:203], v252 offset:8704
  v_accvgpr_write_b32 a74, 0
  s_waitcnt lgkmcnt(10)
  v_mfma_f32_16x16x32_bf16 v[32:35], v[208:211], v[184:187], v[32:35]
  ds_read_b64_tr_b16 v[204:205], v253 offset:8192
  v_add_f32 v243, v243, v227
  v_mfma_f32_16x16x32_bf16 v[36:39], v[208:211], v[188:191], v[36:39]
  ds_read_b64_tr_b16 v[206:207], v253 offset:8704
  v_exp_f32 v226, v142
  v_accvgpr_write_b32 a75, 0
  v_mfma_f32_16x16x32_bf16 v[40:43], v[212:215], v[184:187], v[40:43]
  ds_read_b64_tr_b16 v[208:209], v250 offset:12288
  v_add_f32 v244, v224, v225
  v_mfma_f32_16x16x32_bf16 v[44:47], v[212:215], v[188:191], v[44:47]
  ds_read_b64_tr_b16 v[210:211], v250 offset:12800
  v_exp_f32 v227, v143
  v_accvgpr_write_b32 a76, 0
  s_waitcnt lgkmcnt(10)
  v_mfma_f32_16x16x32_bf16 v[48:51], v[216:219], v[184:187], v[48:51]
  ds_read_b64_tr_b16 v[212:213], v251 offset:12288
  v_cvt_pk_bf16_f32 v180, v224, v225
  v_mfma_f32_16x16x32_bf16 v[52:55], v[216:219], v[188:191], v[52:55]
  ds_read_b64_tr_b16 v[214:215], v251 offset:12800
  v_accvgpr_write_b32 a77, 0
  v_mfma_f32_16x16x32_bf16 v[56:59], v[220:223], v[184:187], v[56:59]
  ds_read_b64_tr_b16 v[216:217], v252 offset:12288
  v_exp_f32 v224, v148
  v_mfma_f32_16x16x32_bf16 v[60:63], v[220:223], v[188:191], v[60:63]
  ds_read_b64_tr_b16 v[218:219], v252 offset:12800
  v_add_f32 v244, v244, v226
  v_accvgpr_write_b32 a78, 0
  s_waitcnt lgkmcnt(10)
  v_mfma_f32_16x16x32_bf16 v[96:99], v[192:195], a[80:83], v[96:99]
  ds_read_b64_tr_b16 v[220:221], v253 offset:12288
  v_exp_f32 v225, v149
  v_mfma_f32_16x16x32_bf16 v[100:103], v[192:195], a[84:87], v[100:103]
  ds_read_b64_tr_b16 v[222:223], v253 offset:12800
  v_cvt_pk_bf16_f32 v181, v226, v227
  v_accvgpr_write_b32 a79, 0
  v_mfma_f32_16x16x32_bf16 v[104:107], v[196:199], a[80:83], v[104:107]
  v_add_f32 v244, v244, v227
  v_mfma_f32_16x16x32_bf16 v[108:111], v[196:199], a[84:87], v[108:111]
  v_exp_f32 v226, v150
  s_waitcnt lgkmcnt(8)
  v_mfma_f32_16x16x32_bf16 v[112:115], v[200:203], a[80:83], v[112:115]
  v_add_f32 v244, v244, v224
  v_exp_f32 v227, v151
  v_mfma_f32_16x16x32_bf16 v[116:119], v[200:203], a[84:87], v[116:119]
  v_cvt_pk_bf16_f32 v182, v224, v225
  v_mfma_f32_16x16x32_bf16 v[120:123], v[204:207], a[80:83], v[120:123]
  v_add_f32 v244, v244, v225
  v_mfma_f32_16x16x32_bf16 v[124:127], v[204:207], a[84:87], v[124:127]
  s_waitcnt lgkmcnt(0)
  s_barrier
  ds_read_b128 v[192:195], v228 offset:17408
  ds_read_b128 v[196:199], v228 offset:17472
  ds_read_b128 v[200:203], v228 offset:17536
  ds_read_b128 v[204:207], v228 offset:17600
  v_mfma_f32_16x16x32_bf16 v[96:99], v[208:211], a[88:91], v[96:99]
  v_add_f32 v244, v244, v226
  v_mfma_f32_16x16x32_bf16 v[100:103], v[208:211], a[92:95], v[100:103]
  ds_read_b128 v[208:211], v228 offset:21760
  v_mfma_f32_16x16x32_bf16 v[104:107], v[212:215], a[88:91], v[104:107]
  v_cvt_pk_bf16_f32 v183, v226, v227
  v_mfma_f32_16x16x32_bf16 v[108:111], v[212:215], a[92:95], v[108:111]
  ds_read_b128 v[212:215], v228 offset:21824
  v_mfma_f32_16x16x32_bf16 v[112:115], v[216:219], a[88:91], v[112:115]
  v_add_f32 v244, v244, v227
  v_mfma_f32_16x16x32_bf16 v[116:119], v[216:219], a[92:95], v[116:119]
  ds_read_b128 v[216:219], v228 offset:21888
  v_add_f32 v245, v243, v244
  v_mfma_f32_16x16x32_bf16 v[120:123], v[220:223], a[88:91], v[120:123]
  v_cmp_nge_f32 vcc, s94, v245
  v_mfma_f32_16x16x32_bf16 v[124:127], v[220:223], a[92:95], v[124:127]
  s_cbranch_vccnz T_h13
  v_add_f32 v241, v241, v243
  v_add_f32 v242, v242, v244
R_h13:
  s_waitcnt lgkmcnt(5)
  v_mfma_f32_16x16x32_bf16 v[136:139], v[192:195], v[64:67], v[168:171]
  ds_read_b128 v[220:223], v228 offset:21952
  v_mfma_f32_16x16x32_bf16 v[140:143], v[192:195], v[80:83], v[172:175]
  v_exp_f32 v224, v152
  v_exp_f32 v225, v153
  v_mfma_f32_16x16x32_bf16 v[136:139], v[196:199], v[68:71], v[136:139]
  ds_read_b64_tr_b16 v[192:193], v229 offset:16384
  v_exp_f32 v226, v154
  v_accvgpr_write_b32 a80, 0
  v_mfma_f32_16x16x32_bf16 v[140:143], v[196:199], v[84:87], v[140:143]
  ds_read_b64_tr_b16 v[194:195], v229 offset:20480
  v_add_f32 v243, v224, v225
  s_waitcnt lgkmcnt(6)
  v_mfma_f32_16x16x32_bf16 v[136:139], v[200:203], v[72:75], v[136:139]
  ds_read_b64_tr_b16 v[196:197], v230 offset:16384
  v_exp_f32 v227, v155
  v_accvgpr_write_b32 a81, 0
  v_mfma_f32_16x16x32_bf16 v[140:143], v[200:203], v[88:91], v[140:143]
  ds_read_b64_tr_b16 v[198:199], v230 offset:20480
  v_mfma_f32_16x16x32_bf16 v[136:139], v[204:207], v[76:79], v[136:139]
  ds_read_b64_tr_b16 v[200:201], v231 offset:16384
  v_cvt_pk_bf16_f32 v184, v224, v225
  v_accvgpr_write_b32 a82, 0
  v_mfma_f32_16x16x32_bf16 v[140:143], v[204:207], v[92:95], v[140:143]
  ds_read_b64_tr_b16 v[202:203], v231 offset:20480
  v_exp_f32 v224, v160
  s_waitcnt lgkmcnt(8)
  v_mfma_f32_16x16x32_bf16 v[144:147], v[208:211], v[64:67], v[168:171]
  ds_read_b64_tr_b16 v[204:205], v232 offset:16384
  v_add_f32 v243, v243, v226
  v_accvgpr_write_b32 a83, 0
  v_mfma_f32_16x16x32_bf16 v[148:151], v[208:211], v[80:83], v[172:175]
  ds_read_b64_tr_b16 v[206:207], v232 offset:20480
  v_exp_f32 v225, v161
  v_mfma_f32_16x16x32_bf16 v[144:147], v[212:215], v[68:71], v[144:147]
  ds_read_b64_tr_b16 v[208:209], v233 offset:16384
  v_cvt_pk_bf16_f32 v185, v226, v227
  v_accvgpr_write_b32 a84, 0
  v_mfma_f32_16x16x32_bf16 v[148:151], v[212:215], v[84:87], v[148:151]
  ds_read_b64_tr_b16 v[210:211], v233 offset:20480
  s_waitcnt lgkmcnt(10)
  v_mfma_f32_16x16x32_bf16 v[144:147], v[216:219], v[72:75], v[144:147]
  ds_read_b64_tr_b16 v[212:213], v234 offset:16384
  v_add_f32 v243, v243, v227
  v_accvgpr_write_b32 a85, 0
  v_mfma_f32_16x16x32_bf16 v[148:151], v[216:219], v[88:91], v[148:151]
  ds_read_b64_tr_b16 v[214:215], v234 offset:20480
  v_exp_f32 v226, v162
  v_mfma_f32_16x16x32_bf16 v[144:147], v[220:223], v[76:79], v[144:147]
  ds_read_b64_tr_b16 v[216:217], v235 offset:16384
  v_add_f32 v243, v243, v224
  v_accvgpr_write_b32 a86, 0
  v_mfma_f32_16x16x32_bf16 v[148:151], v[220:223], v[92:95], v[148:151]
  ds_read_b64_tr_b16 v[218:219], v235 offset:20480
  v_exp_f32 v227, v163
  s_waitcnt lgkmcnt(10)
  v_mfma_f32_16x16x32_bf16 v[0:3], v[192:195], v[176:179], v[0:3]
  ds_read_b64_tr_b16 v[220:221], v236 offset:16384
  v_cvt_pk_bf16_f32 v186, v224, v225
  v_accvgpr_write_b32 a87, 0
  v_mfma_f32_16x16x32_bf16 v[4:7], v[192:195], v[180:183], v[4:7]
  ds_read_b64_tr_b16 v[222:223], v236 offset:20480
  v_mfma_f32_16x16x32_bf16 v[8:11], v[196:199], v[176:179], v[8:11]
  ds_read_b64_tr_b16 v[192:193], v250 offset:16384
  v_add_f32 v243, v243, v225
  v_mfma_f32_16x16x32_bf16 v[12:15], v[196:199], v[180:183], v[12:15]
  ds_read_b64_tr_b16 v[194:195], v250 offset:16896
  v_exp_f32 v224, v156
  v_accvgpr_write_b32 a88, 0
  s_waitcnt lgkmcnt(10)
  v_mfma_f32_16x16x32_bf16 v[16:19], v[200:203], v[176:179], v[16:19]
  ds_read_b64_tr_b16 v[196:197], v251 offset:16384
  v_add_f32 v243, v243, v226
  v_mfma_f32_16x16x32_bf16 v[20:23], v[200:203], v[180:183], v[20:23]
  ds_read_b64_tr_b16 v[198:199], v251 offset:16896
  v_exp_f32 v225, v157
  v_accvgpr_write_b32 a89, 0
  v_mfma_f32_16x16x32_bf16 v[24:27], v[204:207], v[176:179], v[24:27]
  ds_read_b64_tr_b16 v[200:201], v252 offset:16384
  v_cvt_pk_bf16_f32 v187, v226, v227
  v_mfma_f32_16x16x32_bf16 v[28:31], v[204:207], v[180:183], v[28:31]
  ds_read_b64_tr_b16 v[202:203], v252 offset:16896
  v_accvgpr_write_b32 a90, 0
  s_waitcnt lgkmcnt(10)
  v_mfma_f32_16x16x32_bf16 v[32:35], v[208:211], v[176:179], v[32:35]
  ds_read_b64_tr_b16 v[204:205], v253 offset:16384
  v_add_f32 v243, v243, v227
  v_mfma_f32_16x16x32_bf16 v[36:39], v[208:211], v[180:183], v[36:39]
  ds_read_b64_tr_b16 v[206:207], v253 offset:16896
  v_exp_f32 v226, v158
  v_accvgpr_write_b32 a91, 0
  v_mfma_f32_16x16x32_bf16 v[40:43], v[212:215], v[176:179], v[40:43]
  ds_read_b64_tr_b16 v[208:209], v250 offset:20480
  v_add_f32 v244, v224, v225
  v_mfma_f32_16x16x32_bf16 v[44:47], v[212:215], v[180:183], v[44:47]
  ds_read_b64_tr_b16 v[210:211], v250 offset:20992
  v_exp_f32 v227, v159
  v_accvgpr_write_b32 a92, 0
  s_waitcnt lgkmcnt(10)
  v_mfma_f32_16x16x32_bf16 v[48:51], v[216:219], v[176:179], v[48:51]
  ds_read_b64_tr_b16 v[212:213], v251 offset:20480
  v_cvt_pk_bf16_f32 v188, v224, v225
  v_mfma_f32_16x16x32_bf16 v[52:55], v[216:219], v[180:183], v[52:55]
  ds_read_b64_tr_b16 v[214:215], v251 offset:20992
  v_accvgpr_write_b32 a93, 0
  v_mfma_f32_16x16x32_bf16 v[56:59], v[220:223], v[176:179], v[56:59]
  ds_read_b64_tr_b16 v[216:217], v252 offset:20480
  v_exp_f32 v224, v164
  v_mfma_f32_16x16x32_bf16 v[60:63], v[220:223], v[180:183], v[60:63]
  ds_read_b64_tr_b16 v[218:219], v252 offset:20992
  v_add_f32 v244, v244, v226
  v_accvgpr_write_b32 a94, 0
  s_waitcnt lgkmcnt(10)
  v_mfma_f32_16x16x32_bf16 v[96:99], v[192:195], a[96:99], v[96:99]
  ds_read_b64_tr_b16 v[220:221], v253 offset:20480
  v_exp_f32 v225, v165
  v_mfma_f32_16x16x32_bf16 v[100:103], v[192:195], a[100:103], v[100:103]
  ds_read_b64_tr_b16 v[222:223], v253 offset:20992
  v_cvt_pk_bf16_f32 v189, v226, v227
  v_accvgpr_write_b32 a95, 0
  v_mfma_f32_16x16x32_bf16 v[104:107], v[196:199], a[96:99], v[104:107]
  v_add_f32 v244, v244, v227
  v_mfma_f32_16x16x32_bf16 v[108:111], v[196:199], a[100:103], v[108:111]
  v_exp_f32 v226, v166
  s_waitcnt lgkmcnt(8)
  v_mfma_f32_16x16x32_bf16 v[112:115], v[200:203], a[96:99], v[112:115]
  v_add_f32 v244, v244, v224
  v_exp_f32 v227, v167
  v_mfma_f32_16x16x32_bf16 v[116:119], v[200:203], a[100:103], v[116:119]
  v_cvt_pk_bf16_f32 v190, v224, v225
  v_mfma_f32_16x16x32_bf16 v[120:123], v[204:207], a[96:99], v[120:123]
  v_add_f32 v244, v244, v225
  v_mfma_f32_16x16x32_bf16 v[124:127], v[204:207], a[100:103], v[124:127]
  s_waitcnt lgkmcnt(0)
  s_barrier
  ds_read_b128 v[192:195], v228 offset:26112
  ds_read_b128 v[196:199], v228 offset:26176
  ds_read_b128 v[200:203], v228 offset:26240
  ds_read_b128 v[204:207], v228 offset:26304
  v_mfma_f32_16x16x32_bf16 v[96:99], v[208:211], a[104:107], v[96:99]
  v_add_f32 v244, v244, v226
  v_mfma_f32_16x16x32_bf16 v[100:103], v[208:211], a[108:111], v[100:103]
  ds_read_b128 v[208:211], v228 offset:30464
  v_mfma_f32_16x16x32_bf16 v[104:107], v[212:215], a[104:107], v[104:107]
  v_cvt_pk_bf16_f32 v191, v226, v227
  v_mfma_f32_16x16x32_bf16 v[108:111], v[212:215], a[108:111], v[108:111]
  ds_read_b128 v[212:215], v228 offset:30528
  v_mfma_f32_16x16x32_bf16 v[112:115], v[216:219], a[104:107], v[112:115]
  v_add_f32 v244, v244, v227
  v_mfma_f32_16x16x32_bf16 v[116:119], v[216:219], a[108:111], v[116:119]
  ds_read_b128 v[216:219], v228 offset:30592
  v_add_f32 v245, v243, v244
  v_mfma_f32_16x16x32_bf16 v[120:123], v[220:223], a[104:107], v[120:123]
  v_cmp_nge_f32 vcc, s94, v245
  v_mfma_f32_16x16x32_bf16 v[124:127], v[220:223], a[108:111], v[124:127]
  s_cbranch_vccnz T_h14
  v_add_f32 v241, v241, v243
  v_add_f32 v242, v242, v244
R_h14:
  s_waitcnt lgkmcnt(5)
  v_mfma_f32_16x16x32_bf16 v[152:155], v[192:195], v[64:67], v[168:171]
  ds_read_b128 v[220:223], v228 offset:30656
  v_mfma_f32_16x16x32_bf16 v[156:159], v[192:195], v[80:83], v[172:175]
  v_exp_f32 v224, v136
  v_exp_f32 v225, v137
  v_mfma_f32_16x16x32_bf16 v[152:155], v[196:199], v[68:71], v[152:155]
  ds_read_b64_tr_b16 v[192:193], v229 offset:24576
  v_exp_f32 v226, v138
  v_accvgpr_write_b32 a96, 0
  v_mfma_f32_16x16x32_bf16 v[156:159], v[196:199], v[84:87], v[156:159]
  ds_read_b64_tr_b16 v[194:195], v229 offset:28672
  v_add_f32 v243, v224, v225
  s_waitcnt lgkmcnt(6)
  v_mfma_f32_16x16x32_bf16 v[152:155], v[200:203], v[72:75], v[152:155]
  ds_read_b64_tr_b16 v[196:197], v230 offset:24576
  v_exp_f32 v227, v139
  v_accvgpr_write_b32 a97, 0
  v_mfma_f32_16x16x32_bf16 v[156:159], v[200:203], v[88:91], v[156:159]
  ds_read_b64_tr_b16 v[198:199], v230 offset:28672
  v_mfma_f32_16x16x32_bf16 v[152:155], v[204:207], v[76:79], v[152:155]
  ds_read_b64_tr_b16 v[200:201], v231 offset:24576
  v_cvt_pk_bf16_f32 v176, v224, v225
  v_accvgpr_write_b32 a98, 0
  v_mfma_f32_16x16x32_bf16 v[156:159], v[204:207], v[92:95], v[156:159]
  ds_read_b64_tr_b16 v[202:203], v231 offset:28672
  v_exp_f32 v224, v144
  s_waitcnt lgkmcnt(8)
  v_mfma_f32_16x16x32_bf16 v[160:163], v[208:211], v[64:67], v[168:171]
  ds_read_b64_tr_b16 v[204:205], v232 offset:24576
  v_add_f32 v243, v243, v226
  v_accvgpr_write_b32 a99, 0
  v_mfma_f32_16x16x32_bf16 v[164:167], v[208:211], v[80:83], v[172:175]
  ds_read_b64_tr_b16 v[206:207], v232 offset:28672
  v_exp_f32 v225, v145
  v_mfma_f32_16x16x32_bf16 v[160:163], v[212:215], v[68:71], v[160:163]
  ds_read_b64_tr_b16 v[208:209], v233 offset:24576
  v_cvt_pk_bf16_f32 v177, v226, v227
  v_accvgpr_write_b32 a100, 0
  v_mfma_f32_16x16x32_bf16 v[164:167], v[212:215], v[84:87], v[164:167]
  ds_read_b64_tr_b16 v[210:211], v233 offset:28672
  s_waitcnt lgkmcnt(10)
  v_mfma_f32_16x16x32_bf16 v[160:163], v[216:219], v[72:75], v[160:163]
  ds_read_b64_tr_b16 v[212:213], v234 offset:24576
  v_add_f32 v243, v243, v227
  v_accvgpr_write_b32 a101, 0
  v_mfma_f32_16x16x32_bf16 v[164:167], v[216:219], v[88:91], v[164:167]
  ds_read_b64_tr_b16 v[214:215], v234 offset:28672
  v_exp_f32 v226, v146
  v_mfma_f32_16x16x32_bf16 v[160:163], v[220:223], v[76:79], v[160:163]
  ds_read_b64_tr_b16 v[216:217], v235 offset:24576
  v_add_f32 v243, v243, v224
  v_accvgpr_write_b32 a102, 0
  v_mfma_f32_16x16x32_bf16 v[164:167], v[220:223], v[92:95], v[164:167]
  ds_read_b64_tr_b16 v[218:219], v235 offset:28672
  v_exp_f32 v227, v147
  s_waitcnt lgkmcnt(10)
  v_mfma_f32_16x16x32_bf16 v[0:3], v[192:195], v[184:187], v[0:3]
  ds_read_b64_tr_b16 v[220:221], v236 offset:24576
  v_cvt_pk_bf16_f32 v178, v224, v225
  v_accvgpr_write_b32 a103, 0
  v_mfma_f32_16x16x32_bf16 v[4:7], v[192:195], v[188:191], v[4:7]
  ds_read_b64_tr_b16 v[222:223], v236 offset:28672
  v_accvgpr_read_b32 v64, a240
  v_mfma_f32_16x16x32_bf16 v[8:11], v[196:199], v[184:187], v[8:11]
  ds_read_b64_tr_b16 v[192:193], v250 offset:24576
  v_add_f32 v243, v243, v225
  v_accvgpr_read_b32 v65, a241
  v_mfma_f32_16x16x32_bf16 v[12:15], v[196:199], v[188:191], v[12:15]
  ds_read_b64_tr_b16 v[194:195], v250 offset:25088
  v_exp_f32 v224, v140
  v_accvgpr_read_b32 v66, a242
  v_accvgpr_write_b32 a104, 0
  s_waitcnt lgkmcnt(10)
  v_mfma_f32_16x16x32_bf16 v[16:19], v[200:203], v[184:187], v[16:19]
  ds_read_b64_tr_b16 v[196:197], v251 offset:24576
  v_add_f32 v243, v243, v226
  v_accvgpr_read_b32 v67, a243
  v_mfma_f32_16x16x32_bf16 v[20:23], v[200:203], v[188:191], v[20:23]
  ds_read_b64_tr_b16 v[198:199], v251 offset:25088
  v_exp_f32 v225, v141
  v_accvgpr_read_b32 v68, a244
  v_accvgpr_write_b32 a105, 0
  v_mfma_f32_16x16x32_bf16 v[24:27], v[204:207], v[184:187], v[24:27]
  ds_read_b64_tr_b16 v[200:201], v252 offset:24576
  v_cvt_pk_bf16_f32 v179, v226, v227
  v_accvgpr_read_b32 v69, a245
  v_mfma_f32_16x16x32_bf16 v[28:31], v[204:207], v[188:191], v[28:31]
  ds_read_b64_tr_b16 v[202:203], v252 offset:25088
  v_accvgpr_read_b32 v70, a246
  v_accvgpr_write_b32 a106, 0
  s_waitcnt lgkmcnt(10)
  v_mfma_f32_16x16x32_bf16 v[32:35], v[208:211], v[184:187], v[32:35]
  ds_read_b64_tr_b16 v[204:205], v253 offset:24576
  v_add_f32 v243, v243, v227
  v_accvgpr_read_b32 v71, a247
  v_mfma_f32_16x16x32_bf16 v[36:39], v[208:211], v[188:191], v[36:39]
  ds_read_b64_tr_b16 v[206:207], v253 offset:25088
  v_exp_f32 v226, v142
  v_accvgpr_read_b32 v80, a248
  v_accvgpr_write_b32 a107, 0
  v_mfma_f32_16x16x32_bf16 v[40:43], v[212:215], v[184:187], v[40:43]
  ds_read_b64_tr_b16 v[208:209], v250 offset:28672
  v_add_f32 v244, v224, v225
  v_accvgpr_read_b32 v81, a249
  v_mfma_f32_16x16x32_bf16 v[44:47], v[212:215], v[188:191], v[44:47]
  ds_read_b64_tr_b16 v[210:211], v250 offset:29184
  v_exp_f32 v227, v143
  v_accvgpr_read_b32 v82, a250
  v_accvgpr_write_b32 a108, 0
  s_waitcnt lgkmcnt(10)
  v_mfma_f32_16x16x32_bf16 v[48:51], v[216:219], v[184:187], v[48:51]
  ds_read_b64_tr_b16 v[212:213], v251 offset:28672
  v_cvt_pk_bf16_f32 v180, v224, v225
  v_accvgpr_read_b32 v83, a251
  v_mfma_f32_16x16x32_bf16 v[52:55], v[216:219], v[188:191], v[52:55]
  ds_read_b64_tr_b16 v[214:215], v251 offset:29184
  v_accvgpr_read_b32 v84, a252
  v_accvgpr_write_b32 a109, 0
  v_mfma_f32_16x16x32_bf16 v[56:59], v[220:223], v[184:187], v[56:59]
  ds_read_b64_tr_b16 v[216:217], v252 offset:28672
  v_exp_f32 v224, v148
  v_accvgpr_read_b32 v85, a253
  v_mfma_f32_16x16x32_bf16 v[60:63], v[220:223], v[188:191], v[60:63]
  ds_read_b64_tr_b16 v[218:219], v252 offset:29184
  v_add_f32 v244, v244, v226
  v_accvgpr_read_b32 v86, a254
  v_accvgpr_read_b32 v87, a255
  v_accvgpr_write_b32 a110, 0
  s_waitcnt lgkmcnt(10)
  v_mfma_f32_16x16x32_bf16 v[96:99], v[192:195], a[112:115], v[96:99]
  ds_read_b64_tr_b16 v[220:221], v253 offset:28672
  v_exp_f32 v225, v149
  v_accvgpr_write_b32 a240, 0
  v_mfma_f32_16x16x32_bf16 v[100:103], v[192:195], a[116:119], v[100:103]
  ds_read_b64_tr_b16 v[222:223], v253 offset:29184
  v_cvt_pk_bf16_f32 v181, v226, v227
  v_accvgpr_write_b32 a241, 0
  v_accvgpr_write_b32 a111, 0
  v_mfma_f32_16x16x32_bf16 v[104:107], v[196:199], a[112:115], v[104:107]
  v_add_f32 v244, v244, v227
  v_accvgpr_write_b32 a242, 0
  v_mfma_f32_16x16x32_bf16 v[108:111], v[196:199], a[116:119], v[108:111]
  v_exp_f32 v226, v150
  v_accvgpr_write_b32 a243, 0
  s_waitcnt lgkmcnt(8)
  v_mfma_f32_16x16x32_bf16 v[112:115], v[200:203], a[112:115], v[112:115]
  v_add_f32 v244, v244, v224
  v_exp_f32 v227, v151
  v_accvgpr_write_b32 a244, 0
  v_mfma_f32_16x16x32_bf16 v[116:119], v[200:203], a[116:119], v[116:119]
  v_cvt_pk_bf16_f32 v182, v224, v225
  v_accvgpr_write_b32 a245, 0
  v_mfma_f32_16x16x32_bf16 v[120:123], v[204:207], a[112:115], v[120:123]
  v_add_f32 v244, v244, v225
  v_accvgpr_write_b32 a246, 0
  v_mfma_f32_16x16x32_bf16 v[124:127], v[204:207], a[116:119], v[124:127]
  s_waitcnt lgkmcnt(0)
  s_barrier
  ds_read_b128 v[192:195], v228 offset:0
  ds_read_b128 v[196:199], v228 offset:64
  ds_read_b128 v[200:203], v228 offset:128
  ds_read_b128 v[204:207], v228 offset:192
  v_accvgpr_write_b32 a247, 0
  v_mfma_f32_16x16x32_bf16 v[96:99], v[208:211], a[120:123], v[96:99]
  v_add_f32 v244, v244, v226
  v_accvgpr_write_b32 a248, 0
  v_mfma_f32_16x16x32_bf16 v[100:103], v[208:211], a[124:127], v[100:103]
  ds_read_b128 v[208:211], v228 offset:4352
  v_accvgpr_write_b32 a249, 0
  v_mfma_f32_16x16x32_bf16 v[104:107], v[212:215], a[120:123], v[104:107]
  v_cvt_pk_bf16_f32 v183, v226, v227
  v_accvgpr_write_b32 a250, 0
  v_mfma_f32_16x16x32_bf16 v[108:111], v[212:215], a[124:127], v[108:111]
  ds_read_b128 v[212:215], v228 offset:4416
  v_accvgpr_write_b32 a251, 0
  v_mfma_f32_16x16x32_bf16 v[112:115], v[216:219], a[120:123], v[112:115]
  v_add_f32 v244, v244, v227
  v_accvgpr_write_b32 a252, 0
  v_mfma_f32_16x16x32_bf16 v[116:119], v[216:219], a[124:127], v[116:119]
  ds_read_b128 v[216:219], v228 offset:4480
  v_add_f32 v245, v243, v244
  v_accvgpr_write_b32 a253, 0
  v_mfma_f32_16x16x32_bf16 v[120:123], v[220:223], a[120:123], v[120:123]
  v_cmp_nge_f32 vcc, s94, v245
  v_accvgpr_write_b32 a254, 0
  v_accvgpr_write_b32 a255, 0
  v_mfma_f32_16x16x32_bf16 v[124:127], v[220:223], a[124:127], v[124:127]
  s_cbranch_vccnz T_h15
  v_add_f32 v241, v241, v243
  v_add_f32 v242, v242, v244
R_h15:
  v_mov_b32 v224, s65
  v_accvgpr_write_b32 a112, 0
  v_accvgpr_write_b32 a113, 0
  v_accvgpr_write_b32 a114, 0
  v_accvgpr_write_b32 a115, 0
  v_accvgpr_write_b32 a116, 0
  v_accvgpr_write_b32 a117, 0
  v_accvgpr_write_b32 a118, 0
  v_accvgpr_write_b32 a119, 0
  v_accvgpr_write_b32 a120, 0
  v_accvgpr_write_b32 a121, 0
  v_accvgpr_write_b32 a122, 0
  v_accvgpr_write_b32 a123, 0
  v_accvgpr_write_b32 a124, 0
  v_accvgpr_write_b32 a125, 0
  v_accvgpr_write_b32 a126, 0
  v_accvgpr_write_b32 a127, 0
  v_mov_b32 v168, 0
  v_mov_b32 v169, 0
  v_mov_b32 v170, 0
  v_mov_b32 v171, 0
  v_mov_b32 v172, 0
  v_mov_b32 v173, 0
  v_mov_b32 v174, 0
  v_mov_b32 v175, 0
  v_pk_mul_f32 v[96:97], v[96:97], v[224:225] op_sel_hi:[1,0]
  v_pk_mul_f32 v[98:99], v[98:99], v[224:225] op_sel_hi:[1,0]
  v_cvt_pk_bf16_f32 v72, v96, v97
  v_cvt_pk_bf16_f32 v73, v98, v99
  v_pk_mul_f32 v[100:101], v[100:101], v[224:225] op_sel_hi:[1,0]
  v_pk_mul_f32 v[102:103], v[102:103], v[224:225] op_sel_hi:[1,0]
  v_cvt_pk_bf16_f32 v88, v100, v101
  v_cvt_pk_bf16_f32 v89, v102, v103
  v_pk_mul_f32 v[104:105], v[104:105], v[224:225] op_sel_hi:[1,0]
  v_pk_mul_f32 v[106:107], v[106:107], v[224:225] op_sel_hi:[1,0]
  v_cvt_pk_bf16_f32 v74, v104, v105
  v_cvt_pk_bf16_f32 v75, v106, v107
  v_pk_mul_f32 v[108:109], v[108:109], v[224:225] op_sel_hi:[1,0]
  v_pk_mul_f32 v[110:111], v[110:111], v[224:225] op_sel_hi:[1,0]
  v_cvt_pk_bf16_f32 v90, v108, v109
  v_cvt_pk_bf16_f32 v91, v110, v111
  v_pk_mul_f32 v[112:113], v[112:113], v[224:225] op_sel_hi:[1,0]
  v_pk_mul_f32 v[114:115], v[114:115], v[224:225] op_sel_hi:[1,0]
  v_cvt_pk_bf16_f32 v76, v112, v113
  v_cvt_pk_bf16_f32 v77, v114, v115
  v_pk_mul_f32 v[116:117], v[116:117], v[224:225] op_sel_hi:[1,0]
  v_pk_mul_f32 v[118:119], v[118:119], v[224:225] op_sel_hi:[1,0]
  v_cvt_pk_bf16_f32 v92, v116, v117
  v_cvt_pk_bf16_f32 v93, v118, v119
  v_pk_mul_f32 v[120:121], v[120:121], v[224:225] op_sel_hi:[1,0]
  v_pk_mul_f32 v[122:123], v[122:123], v[224:225] op_sel_hi:[1,0]
  v_cvt_pk_bf16_f32 v78, v120, v121
  v_cvt_pk_bf16_f32 v79, v122, v123
  v_pk_mul_f32 v[124:125], v[124:125], v[224:225] op_sel_hi:[1,0]
  v_pk_mul_f32 v[126:127], v[126:127], v[224:225] op_sel_hi:[1,0]
  v_cvt_pk_bf16_f32 v94, v124, v125
  v_cvt_pk_bf16_f32 v95, v126, v127
  v_mov_b32 v96, 0
  v_mov_b32 v97, 0
  v_mov_b32 v98, 0
  v_mov_b32 v99, 0
  v_mov_b32 v100, 0
  v_mov_b32 v101, 0
  v_mov_b32 v102, 0
  v_mov_b32 v103, 0
  v_permlane16_swap_b32 v72, v74
  v_permlane16_swap_b32 v73, v75
  v_permlane16_swap_b32 v76, v78
  v_permlane16_swap_b32 v77, v79
  v_permlane16_swap_b32 v88, v90
  v_permlane16_swap_b32 v89, v91
  v_permlane16_swap_b32 v92, v94
  v_permlane16_swap_b32 v93, v95
  s_mov_b32 s64, 16
L_cloop:
  s_waitcnt lgkmcnt(5)
  v_mfma_f32_16x16x32_bf16 v[136:139], v[192:195], v[64:67], v[168:171]
  ds_read_b128 v[220:223], v228 offset:4544
  v_mfma_f32_16x16x32_bf16 v[140:143], v[192:195], v[80:83], v[172:175]
  v_exp_f32 v224, v152
  v_exp_f32 v225, v153
  v_mfma_f32_16x16x32_bf16 v[136:139], v[196:199], v[68:71], v[136:139]
  ds_read_b64_tr_b16 v[192:193], v229 offset:0
  v_exp_f32 v226, v154
  v_mfma_f32_16x16x32_bf16 v[140:143], v[196:199], v[84:87], v[140:143]
  ds_read_b64_tr_b16 v[194:195], v229 offset:4096
  v_add_f32 v243, v224, v225
  s_waitcnt lgkmcnt(6)
  v_mfma_f32_16x16x32_bf16 v[136:139], v[200:203], v[72:75], v[136:139]
  ds_read_b64_tr_b16 v[196:197], v230 offset:0
  v_exp_f32 v227, v155
  v_mfma_f32_16x16x32_bf16 v[140:143], v[200:203], v[88:91], v[140:143]
  ds_read_b64_tr_b16 v[198:199], v230 offset:4096
  v_mfma_f32_16x16x32_bf16 v[136:139], v[204:207], v[76:79], v[136:139]
  ds_read_b64_tr_b16 v[200:201], v231 offset:0
  v_cvt_pk_bf16_f32 v184, v224, v225
  v_mfma_f32_16x16x32_bf16 v[140:143], v[204:207], v[92:95], v[140:143]
  ds_read_b64_tr_b16 v[202:203], v231 offset:4096
  v_exp_f32 v224, v160
  s_waitcnt lgkmcnt(8)
  v_mfma_f32_16x16x32_bf16 v[144:147], v[208:211], v[64:67], v[168:171]
  ds_read_b64_tr_b16 v[204:205], v232 offset:0
  v_add_f32 v243, v243, v226
  v_mfma_f32_16x16x32_bf16 v[148:151], v[208:211], v[80:83], v[172:175]
  ds_read_b64_tr_b16 v[206:207], v232 offset:4096
  v_exp_f32 v225, v161
  v_mfma_f32_16x16x32_bf16 v[144:147], v[212:215], v[68:71], v[144:147]
  ds_read_b64_tr_b16 v[208:209], v233 offset:0
  v_cvt_pk_bf16_f32 v185, v226, v227
  v_mfma_f32_16x16x32_bf16 v[148:151], v[212:215], v[84:87], v[148:151]
  ds_read_b64_tr_b16 v[210:211], v233 offset:4096
  s_waitcnt lgkmcnt(10)
  v_mfma_f32_16x16x32_bf16 v[144:147], v[216:219], v[72:75], v[144:147]
  ds_read_b64_tr_b16 v[212:213], v234 offset:0
  v_add_f32 v243, v243, v227
  v_mfma_f32_16x16x32_bf16 v[148:151], v[216:219], v[88:91], v[148:151]
  ds_read_b64_tr_b16 v[214:215], v234 offset:4096
  v_exp_f32 v226, v162
  v_mfma_f32_16x16x32_bf16 v[144:147], v[220:223], v[76:79], v[144:147]
  ds_read_b64_tr_b16 v[216:217], v235 offset:0
  v_add_f32 v243, v243, v224
  v_mfma_f32_16x16x32_bf16 v[148:151], v[220:223], v[92:95], v[148:151]
  ds_read_b64_tr_b16 v[218:219], v235 offset:4096
  v_exp_f32 v227, v163
  s_waitcnt lgkmcnt(10)
  v_mfma_f32_16x16x32_bf16 v[0:3], v[192:195], v[176:179], v[0:3]
  ds_read_b64_tr_b16 v[220:221], v236 offset:0
  v_cvt_pk_bf16_f32 v186, v224, v225
  v_mfma_f32_16x16x32_bf16 v[4:7], v[192:195], v[180:183], v[4:7]
  ds_read_b64_tr_b16 v[222:223], v236 offset:4096
  v_mfma_f32_16x16x32_bf16 v[8:11], v[196:199], v[176:179], v[8:11]
  ds_read_b64_tr_b16 v[192:193], v229 offset:32768
  v_add_f32 v243, v243, v225
  v_mfma_f32_16x16x32_bf16 v[12:15], v[196:199], v[180:183], v[12:15]
  ds_read_b64_tr_b16 v[194:195], v229 offset:36864
  v_exp_f32 v224, v156
  s_waitcnt lgkmcnt(10)
  v_mfma_f32_16x16x32_bf16 v[16:19], v[200:203], v[176:179], v[16:19]
  ds_read_b64_tr_b16 v[196:197], v230 offset:32768
  v_add_f32 v243, v243, v226
  v_mfma_f32_16x16x32_bf16 v[20:23], v[200:203], v[180:183], v[20:23]
  ds_read_b64_tr_b16 v[198:199], v230 offset:36864
  v_exp_f32 v225, v157
  v_mfma_f32_16x16x32_bf16 v[24:27], v[204:207], v[176:179], v[24:27]
  ds_read_b64_tr_b16 v[200:201], v231 offset:32768
  v_cvt_pk_bf16_f32 v187, v226, v227
  v_mfma_f32_16x16x32_bf16 v[28:31], v[204:207], v[180:183], v[28:31]
  ds_read_b64_tr_b16 v[202:203], v231 offset:36864
  s_waitcnt lgkmcnt(10)
  v_mfma_f32_16x16x32_bf16 v[32:35], v[208:211], v[176:179], v[32:35]
  ds_read_b64_tr_b16 v[204:205], v232 offset:32768
  v_add_f32 v243, v243, v227
  v_mfma_f32_16x16x32_bf16 v[36:39], v[208:211], v[180:183], v[36:39]
  ds_read_b64_tr_b16 v[206:207], v232 offset:36864
  v_exp_f32 v226, v158
  v_mfma_f32_16x16x32_bf16 v[40:43], v[212:215], v[176:179], v[40:43]
  ds_read_b64_tr_b16 v[208:209], v233 offset:32768
  v_add_f32 v244, v224, v225
  v_mfma_f32_16x16x32_bf16 v[44:47], v[212:215], v[180:183], v[44:47]
  ds_read_b64_tr_b16 v[210:211], v233 offset:36864
  v_exp_f32 v227, v159
  s_waitcnt lgkmcnt(10)
  v_mfma_f32_16x16x32_bf16 v[48:51], v[216:219], v[176:179], v[48:51]
  ds_read_b64_tr_b16 v[212:213], v234 offset:32768
  v_cvt_pk_bf16_f32 v188, v224, v225
  v_mfma_f32_16x16x32_bf16 v[52:55], v[216:219], v[180:183], v[52:55]
  ds_read_b64_tr_b16 v[214:215], v234 offset:36864
  v_mfma_f32_16x16x32_bf16 v[56:59], v[220:223], v[176:179], v[56:59]
  ds_read_b64_tr_b16 v[216:217], v235 offset:32768
  v_exp_f32 v224, v164
  v_mfma_f32_16x16x32_bf16 v[60:63], v[220:223], v[180:183], v[60:63]
  ds_read_b64_tr_b16 v[218:219], v235 offset:36864
  v_add_f32 v244, v244, v226
  s_waitcnt lgkmcnt(10)
  v_mfma_f32_16x16x32_bf16 a[128:131], v[192:195], v[96:99], a[128:131]
  ds_read_b64_tr_b16 v[220:221], v236 offset:32768
  v_exp_f32 v225, v165
  v_mfma_f32_16x16x32_bf16 a[132:135], v[192:195], v[100:103], a[132:135]
  ds_read_b64_tr_b16 v[222:223], v236 offset:36864
  v_cvt_pk_bf16_f32 v189, v226, v227
  v_mfma_f32_16x16x32_bf16 a[136:139], v[196:199], v[96:99], a[136:139]
  v_add_f32 v244, v244, v227
  v_mfma_f32_16x16x32_bf16 a[140:143], v[196:199], v[100:103], a[140:143]
  v_exp_f32 v226, v166
  s_waitcnt lgkmcnt(8)
  v_mfma_f32_16x16x32_bf16 a[144:147], v[200:203], v[96:99], a[144:147]
  v_add_f32 v244, v244, v224
  v_exp_f32 v227, v167
  v_mfma_f32_16x16x32_bf16 a[148:151], v[200:203], v[100:103], a[148:151]
  v_cvt_pk_bf16_f32 v190, v224, v225
  v_mfma_f32_16x16x32_bf16 a[152:155], v[204:207], v[96:99], a[152:155]
  v_add_f32 v244, v244, v225
  v_mfma_f32_16x16x32_bf16 a[156:159], v[204:207], v[100:103], a[156:159]
  s_waitcnt lgkmcnt(0)
  s_barrier
  ds_read_b128 v[192:195], v228 offset:8704
  ds_read_b128 v[196:199], v228 offset:8768
  ds_read_b128 v[200:203], v228 offset:8832
  ds_read_b128 v[204:207], v228 offset:8896
  v_mfma_f32_16x16x32_bf16 a[160:163], v[208:211], v[96:99], a[160:163]
  v_add_f32 v244, v244, v226
  v_mfma_f32_16x16x32_bf16 a[164:167], v[208:211], v[100:103], a[164:167]
  ds_read_b128 v[208:211], v228 offset:13056
  v_mfma_f32_16x16x32_bf16 a[168:171], v[212:215], v[96:99], a[168:171]
  v_cvt_pk_bf16_f32 v191, v226, v227
  v_mfma_f32_16x16x32_bf16 a[172:175], v[212:215], v[100:103], a[172:175]
  ds_read_b128 v[212:215], v228 offset:13120
  v_mfma_f32_16x16x32_bf16 a[176:179], v[216:219], v[96:99], a[176:179]
  v_add_f32 v244, v244, v227
  v_mfma_f32_16x16x32_bf16 a[180:183], v[216:219], v[100:103], a[180:183]
  ds_read_b128 v[216:219], v228 offset:13184
  v_add_f32 v245, v243, v244
  v_mfma_f32_16x16x32_bf16 a[184:187], v[220:223], v[96:99], a[184:187]
  v_cmp_nge_f32 vcc, s94, v245
  v_mfma_f32_16x16x32_bf16 a[188:191], v[220:223], v[100:103], a[188:191]
  s_cbranch_vccnz T_p0
  v_add_f32 v241, v241, v243
  v_add_f32 v242, v242, v244
R_p0:
  s_waitcnt lgkmcnt(5)
  v_mfma_f32_16x16x32_bf16 v[152:155], v[192:195], v[64:67], v[168:171]
  ds_read_b128 v[220:223], v228 offset:13248
  v_mfma_f32_16x16x32_bf16 v[156:159], v[192:195], v[80:83], v[172:175]
  v_exp_f32 v224, v136
  v_exp_f32 v225, v137
  v_mfma_f32_16x16x32_bf16 v[152:155], v[196:199], v[68:71], v[152:155]
  ds_read_b64_tr_b16 v[192:193], v229 offset:8192
  v_exp_f32 v226, v138
  v_mfma_f32_16x16x32_bf16 v[156:159], v[196:199], v[84:87], v[156:159]
  ds_read_b64_tr_b16 v[194:195], v229 offset:12288
  v_add_f32 v243, v224, v225
  s_waitcnt lgkmcnt(6)
  v_mfma_f32_16x16x32_bf16 v[152:155], v[200:203], v[72:75], v[152:155]
  ds_read_b64_tr_b16 v[196:197], v230 offset:8192
  v_exp_f32 v227, v139
  v_mfma_f32_16x16x32_bf16 v[156:159], v[200:203], v[88:91], v[156:159]
  ds_read_b64_tr_b16 v[198:199], v230 offset:12288
  v_cvt_pk_bf16_f32 v176, v224, v225
  v_mfma_f32_16x16x32_bf16 v[152:155], v[204:207], v[76:79], v[152:155]
  ds_read_b64_tr_b16 v[200:201], v231 offset:8192
  v_exp_f32 v224, v144
  v_mfma_f32_16x16x32_bf16 v[156:159], v[204:207], v[92:95], v[156:159]
  ds_read_b64_tr_b16 v[202:203], v231 offset:12288
  s_waitcnt lgkmcnt(8)
  v_mfma_f32_16x16x32_bf16 v[160:163], v[208:211], v[64:67], v[168:171]
  ds_read_b64_tr_b16 v[204:205], v232 offset:8192
  v_add_f32 v243, v243, v226
  v_mfma_f32_16x16x32_bf16 v[164:167], v[208:211], v[80:83], v[172:175]
  ds_read_b64_tr_b16 v[206:207], v232 offset:12288
  v_exp_f32 v225, v145
  v_mfma_f32_16x16x32_bf16 v[160:163], v[212:215], v[68:71], v[160:163]
  ds_read_b64_tr_b16 v[208:209], v233 offset:8192
  v_cvt_pk_bf16_f32 v177, v226, v227
  v_mfma_f32_16x16x32_bf16 v[164:167], v[212:215], v[84:87], v[164:167]
  ds_read_b64_tr_b16 v[210:211], v233 offset:12288
  v_add_f32 v243, v243, v227
  s_waitcnt lgkmcnt(10)
  v_mfma_f32_16x16x32_bf16 v[160:163], v[216:219], v[72:75], v[160:163]
  ds_read_b64_tr_b16 v[212:213], v234 offset:8192
  v_exp_f32 v226, v146
  v_mfma_f32_16x16x32_bf16 v[164:167], v[216:219], v[88:91], v[164:167]
  ds_read_b64_tr_b16 v[214:215], v234 offset:12288
  v_add_f32 v243, v243, v224
  v_mfma_f32_16x16x32_bf16 v[160:163], v[220:223], v[76:79], v[160:163]
  ds_read_b64_tr_b16 v[216:217], v235 offset:8192
  v_exp_f32 v227, v147
  v_mfma_f32_16x16x32_bf16 v[164:167], v[220:223], v[92:95], v[164:167]
  ds_read_b64_tr_b16 v[218:219], v235 offset:12288
  s_waitcnt lgkmcnt(10)
  v_mfma_f32_16x16x32_bf16 v[0:3], v[192:195], v[184:187], v[0:3]
  ds_read_b64_tr_b16 v[220:221], v236 offset:8192
  v_cvt_pk_bf16_f32 v178, v224, v225
  v_mfma_f32_16x16x32_bf16 v[4:7], v[192:195], v[188:191], v[4:7]
  ds_read_b64_tr_b16 v[222:223], v236 offset:12288
  v_add_f32 v243, v243, v225
  v_mfma_f32_16x16x32_bf16 v[8:11], v[196:199], v[184:187], v[8:11]
  ds_read_b64_tr_b16 v[192:193], v229 offset:40960
  v_exp_f32 v224, v140
  v_mfma_f32_16x16x32_bf16 v[12:15], v[196:199], v[188:191], v[12:15]
  ds_read_b64_tr_b16 v[194:195], v229 offset:45056
  v_add_f32 v243, v243, v226
  s_waitcnt lgkmcnt(10)
  v_mfma_f32_16x16x32_bf16 v[16:19], v[200:203], v[184:187], v[16:19]
  ds_read_b64_tr_b16 v[196:197], v230 offset:40960
  v_exp_f32 v225, v141
  v_mfma_f32_16x16x32_bf16 v[20:23], v[200:203], v[188:191], v[20:23]
  ds_read_b64_tr_b16 v[198:199], v230 offset:45056
  v_cvt_pk_bf16_f32 v179, v226, v227
  v_mfma_f32_16x16x32_bf16 v[24:27], v[204:207], v[184:187], v[24:27]
  ds_read_b64_tr_b16 v[200:201], v231 offset:40960
  v_add_f32 v243, v243, v227
  v_mfma_f32_16x16x32_bf16 v[28:31], v[204:207], v[188:191], v[28:31]
  ds_read_b64_tr_b16 v[202:203], v231 offset:45056
  s_waitcnt lgkmcnt(10)
  v_mfma_f32_16x16x32_bf16 v[32:35], v[208:211], v[184:187], v[32:35]
  ds_read_b64_tr_b16 v[204:205], v232 offset:40960
  v_exp_f32 v226, v142
  v_mfma_f32_16x16x32_bf16 v[36:39], v[208:211], v[188:191], v[36:39]
  ds_read_b64_tr_b16 v[206:207], v232 offset:45056
  v_add_f32 v244, v224, v225
  v_mfma_f32_16x16x32_bf16 v[40:43], v[212:215], v[184:187], v[40:43]
  ds_read_b64_tr_b16 v[208:209], v233 offset:40960
  v_exp_f32 v227, v143
  v_mfma_f32_16x16x32_bf16 v[44:47], v[212:215], v[188:191], v[44:47]
  ds_read_b64_tr_b16 v[210:211], v233 offset:45056
  v_cvt_pk_bf16_f32 v180, v224, v225
  s_waitcnt lgkmcnt(10)
  v_mfma_f32_16x16x32_bf16 v[48:51], v[216:219], v[184:187], v[48:51]
  ds_read_b64_tr_b16 v[212:213], v234 offset:40960
  v_exp_f32 v224, v148
  v_mfma_f32_16x16x32_bf16 v[52:55], v[216:219], v[188:191], v[52:55]
  ds_read_b64_tr_b16 v[214:215], v234 offset:45056
  v_add_f32 v244, v244, v226
  v_mfma_f32_16x16x32_bf16 v[56:59], v[220:223], v[184:187], v[56:59]
  ds_read_b64_tr_b16 v[216:217], v235 offset:40960
  v_exp_f32 v225, v149
  v_mfma_f32_16x16x32_bf16 v[60:63], v[220:223], v[188:191], v[60:63]
  ds_read_b64_tr_b16 v[218:219], v235 offset:45056
  s_waitcnt lgkmcnt(10)
  v_mfma_f32_16x16x32_bf16 a[192:195], v[192:195], v[96:99], a[192:195]
  ds_read_b64_tr_b16 v[220:221], v236 offset:40960
  v_cvt_pk_bf16_f32 v181, v226, v227
  v_mfma_f32_16x16x32_bf16 a[196:199], v[192:195], v[100:103], a[196:199]
  ds_read_b64_tr_b16 v[222:223], v236 offset:45056
  v_add_f32 v244, v244, v227
  v_mfma_f32_16x16x32_bf16 a[200:203], v[196:199], v[96:99], a[200:203]
  v_exp_f32 v226, v150
  v_add_f32 v244, v244, v224
  v_mfma_f32_16x16x32_bf16 a[204:207], v[196:199], v[100:103], a[204:207]
  v_exp_f32 v227, v151
  s_waitcnt lgkmcnt(8)
  v_mfma_f32_16x16x32_bf16 a[208:211], v[200:203], v[96:99], a[208:211]
  v_cvt_pk_bf16_f32 v182, v224, v225
  v_add_f32 v244, v244, v225
  v_mfma_f32_16x16x32_bf16 a[212:215], v[200:203], v[100:103], a[212:215]
  v_mfma_f32_16x16x32_bf16 a[216:219], v[204:207], v[96:99], a[216:219]
  v_add_f32 v244, v244, v226
  v_cvt_pk_bf16_f32 v183, v226, v227
  v_mfma_f32_16x16x32_bf16 a[220:223], v[204:207], v[100:103], a[220:223]
  s_waitcnt lgkmcnt(0)
  s_barrier
  ds_read_b128 v[192:195], v228 offset:17408
  ds_read_b128 v[196:199], v228 offset:17472
  ds_read_b128 v[200:203], v228 offset:17536
  ds_read_b128 v[204:207], v228 offset:17600
  v_mfma_f32_16x16x32_bf16 a[224:227], v[208:211], v[96:99], a[224:227]
  v_add_f32 v244, v244, v227
  v_mfma_f32_16x16x32_bf16 a[228:231], v[208:211], v[100:103], a[228:231]
  ds_read_b128 v[208:211], v228 offset:21760
  v_mfma_f32_16x16x32_bf16 a[232:235], v[212:215], v[96:99], a[232:235]
  v_add_f32 v245, v243, v244
  v_mfma_f32_16x16x32_bf16 a[236:239], v[212:215], v[100:103], a[236:239]
  ds_read_b128 v[212:215], v228 offset:21824
  v_mfma_f32_16x16x32_bf16 a[240:243], v[216:219], v[96:99], a[240:243]
  v_cmp_nge_f32 vcc, s94, v245
  v_mfma_f32_16x16x32_bf16 a[244:247], v[216:219], v[100:103], a[244:247]
  ds_read_b128 v[216:219], v228 offset:21888
  v_min_f32 v245, v243, v244
  v_mfma_f32_16x16x32_bf16 a[248:251], v[220:223], v[96:99], a[248:251]
  v_cmp_nle_f32 s[38:39], s40, v245
  v_mfma_f32_16x16x32_bf16 a[252:255], v[220:223], v[100:103], a[252:255]
  s_and_b32 s67, s64, 15
  s_cbranch_scc0 L_cfirst
  s_cbranch_vccnz T_p1
  v_add_f32 v241, v241, v243
  v_add_f32 v242, v242, v244
R_p1:
  s_waitcnt lgkmcnt(5)
  v_mfma_f32_16x16x32_bf16 v[136:139], v[192:195], v[64:67], v[168:171]
  ds_read_b128 v[220:223], v228 offset:21952
  v_mov_b32 v96, v104
  v_mov_b32 v97, v105
  v_mfma_f32_16x16x32_bf16 v[140:143], v[192:195], v[80:83], v[172:175]
  v_mov_b32 v98, v106
  v_mov_b32 v99, v107
  v_mov_b32 v100, v108
  v_mov_b32 v101, v109
  v_mfma_f32_16x16x32_bf16 v[136:139], v[196:199], v[68:71], v[136:139]
  ds_read_b64_tr_b16 v[192:193], v229 offset:16384
  v_mov_b32 v102, v110
  v_mov_b32 v103, v111
  v_mfma_f32_16x16x32_bf16 v[140:143], v[196:199], v[84:87], v[140:143]
  ds_read_b64_tr_b16 v[194:195], v229 offset:20480
  v_exp_f32 v224, v152
  s_waitcnt lgkmcnt(6)
  v_mfma_f32_16x16x32_bf16 v[136:139], v[200:203], v[72:75], v[136:139]
  ds_read_b64_tr_b16 v[196:197], v230 offset:16384
  v_exp_f32 v225, v153
  v_mfma_f32_16x16x32_bf16 v[140:143], v[200:203], v[88:91], v[140:143]
  ds_read_b64_tr_b16 v[198:199], v230 offset:20480
  v_exp_f32 v226, v154
  v_mfma_f32_16x16x32_bf16 v[136:139], v[204:207], v[76:79], v[136:139]
  ds_read_b64_tr_b16 v[200:201], v231 offset:16384
  v_add_f32 v243, v224, v225
  v_mfma_f32_16x16x32_bf16 v[140:143], v[204:207], v[92:95], v[140:143]
  ds_read_b64_tr_b16 v[202:203], v231 offset:20480
  v_exp_f32 v227, v155
  s_waitcnt lgkmcnt(8)
  v_mfma_f32_16x16x32_bf16 v[144:147], v[208:211], v[64:67], v[168:171]
  ds_read_b64_tr_b16 v[204:205], v232 offset:16384
  v_cvt_pk_bf16_f32 v184, v224, v225
  v_mfma_f32_16x16x32_bf16 v[148:151], v[208:211], v[80:83], v[172:175]
  ds_read_b64_tr_b16 v[206:207], v232 offset:20480
  v_exp_f32 v224, v160
  v_mfma_f32_16x16x32_bf16 v[144:147], v[212:215], v[68:71], v[144:147]
  ds_read_b64_tr_b16 v[208:209], v233 offset:16384
  v_add_f32 v243, v243, v226
  v_mfma_f32_16x16x32_bf16 v[148:151], v[212:215], v[84:87], v[148:151]
  ds_read_b64_tr_b16 v[210:211], v233 offset:20480
  v_exp_f32 v225, v161
  s_waitcnt lgkmcnt(10)
  v_mfma_f32_16x16x32_bf16 v[144:147], v[216:219], v[72:75], v[144:147]
  ds_read_b64_tr_b16 v[212:213], v234 offset:16384
  v_cvt_pk_bf16_f32 v185, v226, v227
  v_mfma_f32_16x16x32_bf16 v[148:151], v[216:219], v[88:91], v[148:151]
  ds_read_b64_tr_b16 v[214:215], v234 offset:20480
  v_mfma_f32_16x16x32_bf16 v[144:147], v[220:223], v[76:79], v[144:147]
  ds_read_b64_tr_b16 v[216:217], v235 offset:16384
  v_add_f32 v243, v243, v227
  v_mfma_f32_16x16x32_bf16 v[148:151], v[220:223], v[92:95], v[148:151]
  ds_read_b64_tr_b16 v[218:219], v235 offset:20480
  v_exp_f32 v226, v162
  s_waitcnt lgkmcnt(10)
  v_mfma_f32_16x16x32_bf16 v[0:3], v[192:195], v[176:179], v[0:3]
  ds_read_b64_tr_b16 v[220:221], v236 offset:16384
  v_add_f32 v243, v243, v224
  v_mfma_f32_16x16x32_bf16 v[4:7], v[192:195], v[180:183], v[4:7]
  ds_read_b64_tr_b16 v[222:223], v236 offset:20480
  v_exp_f32 v227, v163
  v_mfma_f32_16x16x32_bf16 v[8:11], v[196:199], v[176:179], v[8:11]
  ds_read_b64_tr_b16 v[192:193], v229 offset:49152
  v_cvt_pk_bf16_f32 v186, v224, v225
  v_mfma_f32_16x16x32_bf16 v[12:15], v[196:199], v[180:183], v[12:15]
  ds_read_b64_tr_b16 v[194:195], v229 offset:53248
  v_add_f32 v243, v243, v225
  s_waitcnt lgkmcnt(10)
  v_mfma_f32_16x16x32_bf16 v[16:19], v[200:203], v[176:179], v[16:19]
  ds_read_b64_tr_b16 v[196:197], v230 offset:49152
  v_exp_f32 v224, v156
  v_mfma_f32_16x16x32_bf16 v[20:23], v[200:203], v[180:183], v[20:23]
  ds_read_b64_tr_b16 v[198:199], v230 offset:53248
  v_add_f32 v243, v243, v226
  v_mfma_f32_16x16x32_bf16 v[24:27], v[204:207], v[176:179], v[24:27]
  ds_read_b64_tr_b16 v[200:201], v231 offset:49152
  v_exp_f32 v225, v157
  v_mfma_f32_16x16x32_bf16 v[28:31], v[204:207], v[180:183], v[28:31]
  ds_read_b64_tr_b16 v[202:203], v231 offset:53248
  v_cvt_pk_bf16_f32 v187, v226, v227
  s_waitcnt lgkmcnt(10)
  v_mfma_f32_16x16x32_bf16 v[32:35], v[208:211], v[176:179], v[32:35]
  ds_read_b64_tr_b16 v[204:205], v232 offset:49152
  v_mfma_f32_16x16x32_bf16 v[36:39], v[208:211], v[180:183], v[36:39]
  ds_read_b64_tr_b16 v[206:207], v232 offset:53248
  v_add_f32 v243, v243, v227
  v_mfma_f32_16x16x32_bf16 v[40:43], v[212:215], v[176:179], v[40:43]
  ds_read_b64_tr_b16 v[208:209], v233 offset:49152
  v_exp_f32 v226, v158
  v_mfma_f32_16x16x32_bf16 v[44:47], v[212:215], v[180:183], v[44:47]
  ds_read_b64_tr_b16 v[210:211], v233 offset:53248
  v_add_f32 v244, v224, v225
  s_waitcnt lgkmcnt(10)
  v_mfma_f32_16x16x32_bf16 v[48:51], v[216:219], v[176:179], v[48:51]
  ds_read_b64_tr_b16 v[212:213], v234 offset:49152
  v_exp_f32 v227, v159
  v_mfma_f32_16x16x32_bf16 v[52:55], v[216:219], v[180:183], v[52:55]
  ds_read_b64_tr_b16 v[214:215], v234 offset:53248
  v_cvt_pk_bf16_f32 v188, v224, v225
  v_mfma_f32_16x16x32_bf16 v[56:59], v[220:223], v[176:179], v[56:59]
  ds_read_b64_tr_b16 v[216:217], v235 offset:49152
  v_exp_f32 v224, v164
  v_mfma_f32_16x16x32_bf16 v[60:63], v[220:223], v[180:183], v[60:63]
  ds_read_b64_tr_b16 v[218:219], v235 offset:53248
  v_add_f32 v244, v244, v226
  s_waitcnt lgkmcnt(10)
  v_mfma_f32_16x16x32_bf16 a[0:3], v[192:195], v[96:99], a[0:3]
  ds_read_b64_tr_b16 v[220:221], v236 offset:49152
  v_exp_f32 v225, v165
  v_mfma_f32_16x16x32_bf16 a[4:7], v[192:195], v[100:103], a[4:7]
  ds_read_b64_tr_b16 v[222:223], v236 offset:53248
  v_cvt_pk_bf16_f32 v189, v226, v227
  v_mov_b32 v104, v112
  v_mov_b32 v105, v113
  v_mfma_f32_16x16x32_bf16 a[8:11], v[196:199], v[96:99], a[8:11]
  v_add_f32 v244, v244, v227
  v_mov_b32 v106, v114
  v_mov_b32 v107, v115
  v_mfma_f32_16x16x32_bf16 a[12:15], v[196:199], v[100:103], a[12:15]
  v_mov_b32 v108, v116
  v_mov_b32 v109, v117
  v_mov_b32 v110, v118
  s_waitcnt lgkmcnt(8)
  v_mfma_f32_16x16x32_bf16 a[16:19], v[200:203], v[96:99], a[16:19]
  v_exp_f32 v226, v166
  v_mov_b32 v111, v119
  v_mov_b32 v112, v120
  v_mfma_f32_16x16x32_bf16 a[20:23], v[200:203], v[100:103], a[20:23]
  v_add_f32 v244, v244, v224
  v_mov_b32 v113, v121
  v_mov_b32 v114, v122
  v_mov_b32 v115, v123
  v_mfma_f32_16x16x32_bf16 a[24:27], v[204:207], v[96:99], a[24:27]
  v_exp_f32 v227, v167
  v_mov_b32 v116, v124
  v_mov_b32 v117, v125
  v_mfma_f32_16x16x32_bf16 a[28:31], v[204:207], v[100:103], a[28:31]
  s_waitcnt lgkmcnt(0)
  s_barrier
  ds_read_b128 v[192:195], v228 offset:26112
  ds_read_b128 v[196:199], v228 offset:26176
  ds_read_b128 v[200:203], v228 offset:26240
  ds_read_b128 v[204:207], v228 offset:26304
  v_cvt_pk_bf16_f32 v190, v224, v225
  v_mfma_f32_16x16x32_bf16 a[32:35], v[208:211], v[96:99], a[32:35]
  v_add_f32 v244, v244, v225
  v_mov_b32 v118, v126
  v_mfma_f32_16x16x32_bf16 a[36:39], v[208:211], v[100:103], a[36:39]
  ds_read_b128 v[208:211], v228 offset:30464
  v_add_f32 v244, v244, v226
  v_mov_b32 v119, v127
  v_mfma_f32_16x16x32_bf16 a[40:43], v[212:215], v[96:99], a[40:43]
  v_cvt_pk_bf16_f32 v191, v226, v227
  v_mov_b32 v120, v128
  v_mov_b32 v121, v129
  v_mfma_f32_16x16x32_bf16 a[44:47], v[212:215], v[100:103], a[44:47]
  ds_read_b128 v[212:215], v228 offset:30528
  v_add_f32 v244, v244, v227
  v_mov_b32 v122, v130
  v_mfma_f32_16x16x32_bf16 a[48:51], v[216:219], v[96:99], a[48:51]
  v_add_f32 v245, v243, v244
  v_mov_b32 v123, v131
  v_mfma_f32_16x16x32_bf16 a[52:55], v[216:219], v[100:103], a[52:55]
  ds_read_b128 v[216:219], v228 offset:30592
  v_cmp_nge_f32 vcc, s94, v245
  v_mov_b32 v124, v132
  v_mfma_f32_16x16x32_bf16 a[56:59], v[220:223], v[96:99], a[56:59]
  v_mov_b32 v125, v133
  v_mfma_f32_16x16x32_bf16 a[60:63], v[220:223], v[100:103], a[60:63]
  v_mov_b32 v126, v134
  v_mov_b32 v127, v135
  s_cbranch_vccnz T_p2
  v_add_f32 v241, v241, v243
  v_add_f32 v242, v242, v244
R_p2:
  s_waitcnt lgkmcnt(5)
  v_mfma_f32_16x16x32_bf16 v[152:155], v[192:195], v[64:67], v[168:171]
  ds_read_b128 v[220:223], v228 offset:30656
  v_mfma_f32_16x16x32_bf16 v[156:159], v[192:195], v[80:83], v[172:175]
  v_exp_f32 v224, v136
  v_exp_f32 v225, v137
  v_mfma_f32_16x16x32_bf16 v[152:155], v[196:199], v[68:71], v[152:155]
  ds_read_b64_tr_b16 v[192:193], v229 offset:24576
  v_exp_f32 v226, v138
  v_mfma_f32_16x16x32_bf16 v[156:159], v[196:199], v[84:87], v[156:159]
  ds_read_b64_tr_b16 v[194:195], v229 offset:28672
  v_add_f32 v243, v224, v225
  s_waitcnt lgkmcnt(6)
  v_mfma_f32_16x16x32_bf16 v[152:155], v[200:203], v[72:75], v[152:155]
  ds_read_b64_tr_b16 v[196:197], v230 offset:24576
  v_exp_f32 v227, v139
  v_mfma_f32_16x16x32_bf16 v[156:159], v[200:203], v[88:91], v[156:159]
  ds_read_b64_tr_b16 v[198:199], v230 offset:28672
  v_mfma_f32_16x16x32_bf16 v[152:155], v[204:207], v[76:79], v[152:155]
  ds_read_b64_tr_b16 v[200:201], v231 offset:24576
  v_cvt_pk_bf16_f32 v176, v224, v225
  v_mfma_f32_16x16x32_bf16 v[156:159], v[204:207], v[92:95], v[156:159]
  ds_read_b64_tr_b16 v[202:203], v231 offset:28672
  v_exp_f32 v224, v144
  s_waitcnt lgkmcnt(8)
  v_mfma_f32_16x16x32_bf16 v[160:163], v[208:211], v[64:67], v[168:171]
  ds_read_b64_tr_b16 v[204:205], v232 offset:24576
  v_add_f32 v243, v243, v226
  v_mfma_f32_16x16x32_bf16 v[164:167], v[208:211], v[80:83], v[172:175]
  ds_read_b64_tr_b16 v[206:207], v232 offset:28672
  v_exp_f32 v225, v145
  v_mfma_f32_16x16x32_bf16 v[160:163], v[212:215], v[68:71], v[160:163]
  ds_read_b64_tr_b16 v[208:209], v233 offset:24576
  v_cvt_pk_bf16_f32 v177, v226, v227
  v_mfma_f32_16x16x32_bf16 v[164:167], v[212:215], v[84:87], v[164:167]
  ds_read_b64_tr_b16 v[210:211], v233 offset:28672
  s_waitcnt lgkmcnt(10)
  v_mfma_f32_16x16x32_bf16 v[160:163], v[216:219], v[72:75], v[160:163]
  ds_read_b64_tr_b16 v[212:213], v234 offset:24576
  v_add_f32 v243, v243, v227
  v_mfma_f32_16x16x32_bf16 v[164:167], v[216:219], v[88:91], v[164:167]
  ds_read_b64_tr_b16 v[214:215], v234 offset:28672
  v_exp_f32 v226, v146
  v_mfma_f32_16x16x32_bf16 v[160:163], v[220:223], v[76:79], v[160:163]
  ds_read_b64_tr_b16 v[216:217], v235 offset:24576
  v_add_f32 v243, v243, v224
  v_mfma_f32_16x16x32_bf16 v[164:167], v[220:223], v[92:95], v[164:167]
  ds_read_b64_tr_b16 v[218:219], v235 offset:28672
  v_exp_f32 v227, v147
  s_waitcnt lgkmcnt(10)
  v_mfma_f32_16x16x32_bf16 v[0:3], v[192:195], v[184:187], v[0:3]
  ds_read_b64_tr_b16 v[220:221], v236 offset:24576
  v_cvt_pk_bf16_f32 v178, v224, v225
  v_mfma_f32_16x16x32_bf16 v[4:7], v[192:195], v[188:191], v[4:7]
  ds_read_b64_tr_b16 v[222:223], v236 offset:28672
  v_mfma_f32_16x16x32_bf16 v[8:11], v[196:199], v[184:187], v[8:11]
  ds_read_b64_tr_b16 v[192:193], v229 offset:57344
  v_add_f32 v243, v243, v225
  v_mfma_f32_16x16x32_bf16 v[12:15], v[196:199], v[188:191], v[12:15]
  ds_read_b64_tr_b16 v[194:195], v229 offset:61440
  v_exp_f32 v224, v140
  s_waitcnt lgkmcnt(10)
  v_mfma_f32_16x16x32_bf16 v[16:19], v[200:203], v[184:187], v[16:19]
  ds_read_b64_tr_b16 v[196:197], v230 offset:57344
  v_add_f32 v243, v243, v226
  v_mfma_f32_16x16x32_bf16 v[20:23], v[200:203], v[188:191], v[20:23]
  ds_read_b64_tr_b16 v[198:199], v230 offset:61440
  v_exp_f32 v225, v141
  v_mfma_f32_16x16x32_bf16 v[24:27], v[204:207], v[184:187], v[24:27]
  ds_read_b64_tr_b16 v[200:201], v231 offset:57344
  v_cvt_pk_bf16_f32 v179, v226, v227
  v_mfma_f32_16x16x32_bf16 v[28:31], v[204:207], v[188:191], v[28:31]
  ds_read_b64_tr_b16 v[202:203], v231 offset:61440
  s_waitcnt lgkmcnt(10)
  v_mfma_f32_16x16x32_bf16 v[32:35], v[208:211], v[184:187], v[32:35]
  ds_read_b64_tr_b16 v[204:205], v232 offset:57344
  v_add_f32 v243, v243, v227
  v_mfma_f32_16x16x32_bf16 v[36:39], v[208:211], v[188:191], v[36:39]
  ds_read_b64_tr_b16 v[206:207], v232 offset:61440
  v_exp_f32 v226, v142
  v_mfma_f32_16x16x32_bf16 v[40:43], v[212:215], v[184:187], v[40:43]
  ds_read_b64_tr_b16 v[208:209], v233 offset:57344
  v_add_f32 v244, v224, v225
  v_mfma_f32_16x16x32_bf16 v[44:47], v[212:215], v[188:191], v[44:47]
  ds_read_b64_tr_b16 v[210:211], v233 offset:61440
  v_exp_f32 v227, v143
  s_waitcnt lgkmcnt(10)
  v_mfma_f32_16x16x32_bf16 v[48:51], v[216:219], v[184:187], v[48:51]
  ds_read_b64_tr_b16 v[212:213], v234 offset:57344
  v_cvt_pk_bf16_f32 v180, v224, v225
  v_mfma_f32_16x16x32_bf16 v[52:55], v[216:219], v[188:191], v[52:55]
  ds_read_b64_tr_b16 v[214:215], v234 offset:61440
  v_mfma_f32_16x16x32_bf16 v[56:59], v[220:223], v[184:187], v[56:59]
  ds_read_b64_tr_b16 v[216:217], v235 offset:57344
  v_exp_f32 v224, v148
  v_mfma_f32_16x16x32_bf16 v[60:63], v[220:223], v[188:191], v[60:63]
  ds_read_b64_tr_b16 v[218:219], v235 offset:61440
  v_add_f32 v244, v244, v226
  s_waitcnt lgkmcnt(10)
  v_mfma_f32_16x16x32_bf16 a[64:67], v[192:195], v[96:99], a[64:67]
  ds_read_b64_tr_b16 v[220:221], v236 offset:57344
  v_exp_f32 v225, v149
  v_mfma_f32_16x16x32_bf16 a[68:71], v[192:195], v[100:103], a[68:71]
  ds_read_b64_tr_b16 v[222:223], v236 offset:61440
  v_cvt_pk_bf16_f32 v181, v226, v227
  v_mfma_f32_16x16x32_bf16 a[72:75], v[196:199], v[96:99], a[72:75]
  v_add_f32 v244, v244, v227
  v_mfma_f32_16x16x32_bf16 a[76:79], v[196:199], v[100:103], a[76:79]
  v_exp_f32 v226, v150
  s_waitcnt lgkmcnt(8)
  v_mfma_f32_16x16x32_bf16 a[80:83], v[200:203], v[96:99], a[80:83]
  v_add_f32 v244, v244, v224
  v_exp_f32 v227, v151
  v_mfma_f32_16x16x32_bf16 a[84:87], v[200:203], v[100:103], a[84:87]
  v_cvt_pk_bf16_f32 v182, v224, v225
  v_mfma_f32_16x16x32_bf16 a[88:91], v[204:207], v[96:99], a[88:91]
  v_add_f32 v244, v244, v225
  v_mfma_f32_16x16x32_bf16 a[92:95], v[204:207], v[100:103], a[92:95]
  s_waitcnt lgkmcnt(0)
  s_barrier
  ds_read_b128 v[192:195], v228 offset:0
  ds_read_b128 v[196:199], v228 offset:64
  ds_read_b128 v[200:203], v228 offset:128
  ds_read_b128 v[204:207], v228 offset:192
  v_mfma_f32_16x16x32_bf16 a[96:99], v[208:211], v[96:99], a[96:99]
  v_add_f32 v244, v244, v226
  v_mfma_f32_16x16x32_bf16 a[100:103], v[208:211], v[100:103], a[100:103]
  ds_read_b128 v[208:211], v228 offset:4352
  v_mfma_f32_16x16x32_bf16 a[104:107], v[212:215], v[96:99], a[104:107]
  v_cvt_pk_bf16_f32 v183, v226, v227
  v_mfma_f32_16x16x32_bf16 a[108:111], v[212:215], v[100:103], a[108:111]
  ds_read_b128 v[212:215], v228 offset:4416
  v_mfma_f32_16x16x32_bf16 a[112:115], v[216:219], v[96:99], a[112:115]
  v_add_f32 v244, v244, v227
  v_mfma_f32_16x16x32_bf16 a[116:119], v[216:219], v[100:103], a[116:119]
  ds_read_b128 v[216:219], v228 offset:4480
  v_add_f32 v245, v243, v244
  v_mfma_f32_16x16x32_bf16 a[120:123], v[220:223], v[96:99], a[120:123]
  v_cmp_nge_f32 vcc, s94, v245
  v_mfma_f32_16x16x32_bf16 a[124:127], v[220:223], v[100:103], a[124:127]
  s_cbranch_vccnz T_p3
  v_add_f32 v241, v241, v243
  v_add_f32 v242, v242, v244
R_p3:
  s_add_u32 s64, s64, 4
  s_and_b32 s67, s64, 15
  s_cbranch_scc1 L_cq_skip
  ds_read_b128 v[64:67], v237 offset:0
  ds_read_b128 v[68:71], v237 offset:1024
  ds_read_b128 v[72:75], v237 offset:2048
  ds_read_b128 v[76:79], v237 offset:3072
  ds_read_b128 v[80:83], v237 offset:4096
  ds_read_b128 v[84:87], v237 offset:5120
  ds_read_b128 v[88:91], v237 offset:6144
  ds_read_b128 v[92:95], v237 offset:7168
  v_mov_b32 v168, 0
  v_mov_b32 v169, 0
  v_mov_b32 v170, 0
  v_mov_b32 v171, 0
  v_mov_b32 v172, 0
  v_mov_b32 v173, 0
  v_mov_b32 v174, 0
  v_mov_b32 v175, 0
  s_waitcnt lgkmcnt(0)
L_cq_skip:
  s_cmp_lt_u32 s64, 64
  s_cbranch_scc1 L_cloop
  s_waitcnt lgkmcnt(0)
  ds_read_b64_tr_b16 v[192:193], v229 offset:0
  ds_read_b64_tr_b16 v[194:195], v229 offset:4096
  ds_read_b64_tr_b16 v[196:197], v230 offset:0
  ds_read_b64_tr_b16 v[198:199], v230 offset:4096
  ds_read_b64_tr_b16 v[200:201], v231 offset:0
  ds_read_b64_tr_b16 v[202:203], v231 offset:4096
  ds_read_b64_tr_b16 v[204:205], v232 offset:0
  ds_read_b64_tr_b16 v[206:207], v232 offset:4096
  ds_read_b64_tr_b16 v[208:209], v233 offset:0
  ds_read_b64_tr_b16 v[210:211], v233 offset:4096
  ds_read_b64_tr_b16 v[212:213], v234 offset:0
  ds_read_b64_tr_b16 v[214:215], v234 offset:4096
  ds_read_b64_tr_b16 v[216:217], v235 offset:0
  ds_read_b64_tr_b16 v[218:219], v235 offset:4096
  v_subrev_u32 v64, 0x8800, v229
  v_subrev_u32 v65, 0x8800, v230
  v_subrev_u32 v66, 0x8800, v231
  v_subrev_u32 v67, 0x8800, v232
  v_subrev_u32 v68, 0x8800, v233
  v_subrev_u32 v69, 0x8800, v234
  v_subrev_u32 v70, 0x8800, v235
  v_subrev_u32 v71, 0x8800, v236
  v_exp_f32 v224, v152
  v_exp_f32 v225, v153
  s_waitcnt lgkmcnt(10)
  v_mfma_f32_16x16x32_bf16 v[0:3], v[192:195], v[176:179], v[0:3]
  ds_read_b64_tr_b16 v[220:221], v236 offset:0
  v_exp_f32 v226, v154
  v_add_f32 v243, v224, v225
  v_mfma_f32_16x16x32_bf16 v[4:7], v[192:195], v[180:183], v[4:7]
  ds_read_b64_tr_b16 v[222:223], v236 offset:4096
  v_exp_f32 v227, v155
  v_cvt_pk_bf16_f32 v184, v224, v225
  v_exp_f32 v224, v160
  v_mfma_f32_16x16x32_bf16 v[8:11], v[196:199], v[176:179], v[8:11]
  v_add_f32 v243, v243, v226
  v_exp_f32 v225, v161
  v_mfma_f32_16x16x32_bf16 v[12:15], v[196:199], v[180:183], v[12:15]
  v_cvt_pk_bf16_f32 v185, v226, v227
  v_add_f32 v243, v243, v227
  s_waitcnt lgkmcnt(8)
  v_mfma_f32_16x16x32_bf16 v[16:19], v[200:203], v[176:179], v[16:19]
  v_exp_f32 v226, v162
  v_add_f32 v243, v243, v224
  v_exp_f32 v227, v163
  v_mfma_f32_16x16x32_bf16 v[20:23], v[200:203], v[180:183], v[20:23]
  v_cvt_pk_bf16_f32 v186, v224, v225
  v_add_f32 v243, v243, v225
  v_mfma_f32_16x16x32_bf16 v[24:27], v[204:207], v[176:179], v[24:27]
  v_exp_f32 v224, v156
  v_add_f32 v243, v243, v226
  v_mfma_f32_16x16x32_bf16 v[28:31], v[204:207], v[180:183], v[28:31]
  s_waitcnt vmcnt(63) lgkmcnt(0)
  s_barrier
  ds_read_b64_tr_b16 v[192:193], v64 offset:0
  ds_read_b64_tr_b16 v[194:195], v64 offset:4096
  ds_read_b64_tr_b16 v[196:197], v65 offset:0
  ds_read_b64_tr_b16 v[198:199], v65 offset:4096
  ds_read_b64_tr_b16 v[200:201], v66 offset:0
  ds_read_b64_tr_b16 v[202:203], v66 offset:4096
  ds_read_b64_tr_b16 v[204:205], v67 offset:0
  ds_read_b64_tr_b16 v[206:207], v67 offset:4096
  v_exp_f32 v225, v157
  v_cvt_pk_bf16_f32 v187, v226, v227
  v_add_f32 v243, v243, v227
  v_mfma_f32_16x16x32_bf16 v[32:35], v[208:211], v[176:179], v[32:35]
  v_exp_f32 v226, v158
  v_add_f32 v244, v224, v225
  v_mfma_f32_16x16x32_bf16 v[36:39], v[208:211], v[180:183], v[36:39]
  ds_read_b64_tr_b16 v[208:209], v68 offset:0
  ds_read_b64_tr_b16 v[210:211], v68 offset:4096
  v_exp_f32 v227, v159
  v_cvt_pk_bf16_f32 v188, v224, v225
  v_mfma_f32_16x16x32_bf16 v[40:43], v[212:215], v[176:179], v[40:43]
  v_exp_f32 v224, v164
  v_add_f32 v244, v244, v226
  v_exp_f32 v225, v165
  v_mfma_f32_16x16x32_bf16 v[44:47], v[212:215], v[180:183], v[44:47]
  ds_read_b64_tr_b16 v[212:213], v69 offset:0
  ds_read_b64_tr_b16 v[214:215], v69 offset:4096
  v_cvt_pk_bf16_f32 v189, v226, v227
  v_add_f32 v244, v244, v227
  v_mfma_f32_16x16x32_bf16 v[48:51], v[216:219], v[176:179], v[48:51]
  v_exp_f32 v226, v166
  v_add_f32 v244, v244, v224
  v_mfma_f32_16x16x32_bf16 v[52:55], v[216:219], v[180:183], v[52:55]
  ds_read_b64_tr_b16 v[216:217], v70 offset:0
  ds_read_b64_tr_b16 v[218:219], v70 offset:4096
  v_exp_f32 v227, v167
  v_cvt_pk_bf16_f32 v190, v224, v225
  v_add_f32 v244, v244, v225
  v_mfma_f32_16x16x32_bf16 v[56:59], v[220:223], v[176:179], v[56:59]
  v_add_f32 v244, v244, v226
  v_cvt_pk_bf16_f32 v191, v226, v227
  v_mfma_f32_16x16x32_bf16 v[60:63], v[220:223], v[180:183], v[60:63]
  v_add_f32 v244, v244, v227
  v_add_f32 v245, v243, v244
  v_cmp_nge_f32 vcc, s94, v245
  s_nop 0
  s_cbranch_vccnz T_ep
  v_add_f32 v241, v241, v243
  v_add_f32 v242, v242, v244
R_ep:
  s_waitcnt lgkmcnt(10)
  v_mfma_f32_16x16x32_bf16 v[0:3], v[192:195], v[184:187], v[0:3]
  ds_read_b64_tr_b16 v[220:221], v71 offset:0
  v_mov_b32 v224, v241
  v_mov_b32 v226, v242
  v_mov_b32 v225, v224
  v_mfma_f32_16x16x32_bf16 v[4:7], v[192:195], v[188:191], v[4:7]
  ds_read_b64_tr_b16 v[222:223], v71 offset:4096
  v_mov_b32 v227, v226
  v_permlane32_swap_b32 v224, v225
  s_nop 0
  v_permlane32_swap_b32 v226, v227
  v_add_f32 v224, v224, v225
  v_mfma_f32_16x16x32_bf16 v[8:11], v[196:199], v[184:187], v[8:11]
  ds_read_b64_tr_b16 v[192:193], v229 offset:32768
  v_add_f32 v226, v226, v227
  v_mov_b32 v225, v224
  v_mov_b32 v227, v226
  s_nop 0
  v_permlane16_swap_b32 v224, v225
  v_mfma_f32_16x16x32_bf16 v[12:15], v[196:199], v[188:191], v[12:15]
  ds_read_b64_tr_b16 v[194:195], v229 offset:36864
  v_permlane16_swap_b32 v226, v227
  v_add_f32 v224, v224, v225
  v_add_f32 v226, v226, v227
  v_rcp_f32 v224, v224
  s_waitcnt lgkmcnt(10)
  v_mfma_f32_16x16x32_bf16 v[16:19], v[200:203], v[184:187], v[16:19]
  ds_read_b64_tr_b16 v[196:197], v230 offset:32768
  v_rcp_f32 v226, v226
  v_add_u32 v72, 0x10000, v229
  v_add_u32 v73, 0x10000, v230
  v_mfma_f32_16x16x32_bf16 v[20:23], v[200:203], v[188:191], v[20:23]
  ds_read_b64_tr_b16 v[198:199], v230 offset:36864
  v_add_u32 v74, 0x10000, v231
  v_add_u32 v75, 0x10000, v232
  v_add_u32 v76, 0x10000, v233
  v_add_u32 v77, 0x10000, v234
  v_mfma_f32_16x16x32_bf16 v[24:27], v[204:207], v[184:187], v[24:27]
  ds_read_b64_tr_b16 v[200:201], v231 offset:32768
  v_add_u32 v78, 0x10000, v235
  v_add_u32 v79, 0x10000, v236
  v_mbcnt_lo_u32_b32 v80, -1, 0
  v_mbcnt_hi_u32_b32 v80, -1, v80
  v_mfma_f32_16x16x32_bf16 v[28:31], v[204:207], v[188:191], v[28:31]
  ds_read_b64_tr_b16 v[202:203], v231 offset:36864
  v_lshlrev_b32 v80, 4, v80
  s_lshl_b32 s68, s63, 11
  s_add_u32 s68, s68, 34816
  v_add_u32 v81, s68, v80
  s_waitcnt lgkmcnt(10)
  v_mfma_f32_16x16x32_bf16 v[32:35], v[208:211], v[184:187], v[32:35]
  ds_read_b64_tr_b16 v[204:205], v232 offset:32768
  v_mul_f32 v0, v0, v224
  v_mul_f32 v1, v1, v224
  v_mfma_f32_16x16x32_bf16 v[36:39], v[208:211], v[188:191], v[36:39]
  ds_read_b64_tr_b16 v[206:207], v232 offset:36864
  v_mul_f32 v2, v2, v224
  v_mul_f32 v3, v3, v224
  v_mfma_f32_16x16x32_bf16 v[40:43], v[212:215], v[184:187], v[40:43]
  ds_read_b64_tr_b16 v[208:209], v233 offset:32768
  v_cvt_pk_bf16_f32 v104, v0, v1
  v_cvt_pk_bf16_f32 v105, v2, v3
  v_mul_f32 v4, v4, v226
  v_mfma_f32_16x16x32_bf16 v[44:47], v[212:215], v[188:191], v[44:47]
  ds_read_b64_tr_b16 v[210:211], v233 offset:36864
  v_mul_f32 v5, v5, v226
  v_mul_f32 v6, v6, v226
  s_waitcnt lgkmcnt(10)
  v_mfma_f32_16x16x32_bf16 v[48:51], v[216:219], v[184:187], v[48:51]
  ds_read_b64_tr_b16 v[212:213], v234 offset:32768
  v_mul_f32 v7, v7, v226
  v_cvt_pk_bf16_f32 v108, v4, v5
  v_cvt_pk_bf16_f32 v109, v6, v7
  v_mfma_f32_16x16x32_bf16 v[52:55], v[216:219], v[188:191], v[52:55]
  ds_read_b64_tr_b16 v[214:215], v234 offset:36864
  v_mul_f32 v8, v8, v224
  v_mul_f32 v9, v9, v224
  v_mfma_f32_16x16x32_bf16 v[56:59], v[220:223], v[184:187], v[56:59]
  ds_read_b64_tr_b16 v[216:217], v235 offset:32768
  v_mul_f32 v10, v10, v224
  v_mul_f32 v11, v11, v224
  v_mfma_f32_16x16x32_bf16 v[60:63], v[220:223], v[188:191], v[60:63]
  ds_read_b64_tr_b16 v[218:219], v235 offset:36864
  v_cvt_pk_bf16_f32 v106, v8, v9
  v_cvt_pk_bf16_f32 v107, v10, v11
  v_mul_f32 v12, v12, v226
  s_waitcnt lgkmcnt(10)
  v_mfma_f32_16x16x32_bf16 a[128:131], v[192:195], v[96:99], a[128:131]
  ds_read_b64_tr_b16 v[220:221], v236 offset:32768
  v_mul_f32 v13, v13, v226
  v_mul_f32 v14, v14, v226
  v_mfma_f32_16x16x32_bf16 a[132:135], v[192:195], v[100:103], a[132:135]
  ds_read_b64_tr_b16 v[222:223], v236 offset:36864
  v_mul_f32 v15, v15, v226
  v_cvt_pk_bf16_f32 v110, v12, v13
  v_cvt_pk_bf16_f32 v111, v14, v15
  v_mfma_f32_16x16x32_bf16 a[136:139], v[196:199], v[96:99], a[136:139]
  ds_read_b64_tr_b16 v[192:193], v229 offset:40960
  v_mul_f32 v16, v16, v224
  v_mul_f32 v17, v17, v224
  v_mfma_f32_16x16x32_bf16 a[140:143], v[196:199], v[100:103], a[140:143]
  ds_read_b64_tr_b16 v[194:195], v229 offset:45056
  v_mul_f32 v18, v18, v224
  v_mul_f32 v19, v19, v224
  s_waitcnt lgkmcnt(10)
  v_mfma_f32_16x16x32_bf16 a[144:147], v[200:203], v[96:99], a[144:147]
  ds_read_b64_tr_b16 v[196:197], v230 offset:40960
  v_cvt_pk_bf16_f32 v112, v16, v17
  v_cvt_pk_bf16_f32 v113, v18, v19
  v_mul_f32 v20, v20, v226
  v_mfma_f32_16x16x32_bf16 a[148:151], v[200:203], v[100:103], a[148:151]
  ds_read_b64_tr_b16 v[198:199], v230 offset:45056
  v_mul_f32 v21, v21, v226
  v_mul_f32 v22, v22, v226
  v_mfma_f32_16x16x32_bf16 a[152:155], v[204:207], v[96:99], a[152:155]
  ds_read_b64_tr_b16 v[200:201], v231 offset:40960
  v_mul_f32 v23, v23, v226
  v_cvt_pk_bf16_f32 v116, v20, v21
  v_cvt_pk_bf16_f32 v117, v22, v23
  v_mfma_f32_16x16x32_bf16 a[156:159], v[204:207], v[100:103], a[156:159]
  ds_read_b64_tr_b16 v[202:203], v231 offset:45056
  v_mul_f32 v24, v24, v224
  v_mul_f32 v25, v25, v224
  s_waitcnt lgkmcnt(10)
  v_mfma_f32_16x16x32_bf16 a[160:163], v[208:211], v[96:99], a[160:163]
  ds_read_b64_tr_b16 v[204:205], v232 offset:40960
  v_mul_f32 v26, v26, v224
  v_mul_f32 v27, v27, v224
  v_mfma_f32_16x16x32_bf16 a[164:167], v[208:211], v[100:103], a[164:167]
  ds_read_b64_tr_b16 v[206:207], v232 offset:45056
  v_cvt_pk_bf16_f32 v114, v24, v25
  v_cvt_pk_bf16_f32 v115, v26, v27
  v_mul_f32 v28, v28, v226
  v_mfma_f32_16x16x32_bf16 a[168:171], v[212:215], v[96:99], a[168:171]
  ds_read_b64_tr_b16 v[208:209], v233 offset:40960
  v_mul_f32 v29, v29, v226
  v_mul_f32 v30, v30, v226
  v_mfma_f32_16x16x32_bf16 a[172:175], v[212:215], v[100:103], a[172:175]
  ds_read_b64_tr_b16 v[210:211], v233 offset:45056
  v_mul_f32 v31, v31, v226
  v_cvt_pk_bf16_f32 v118, v28, v29
  v_cvt_pk_bf16_f32 v119, v30, v31
  s_waitcnt lgkmcnt(10)
  v_mfma_f32_16x16x32_bf16 a[176:179], v[216:219], v[96:99], a[176:179]
  ds_read_b64_tr_b16 v[212:213], v234 offset:40960
  v_mul_f32 v32, v32, v224
  v_mul_f32 v33, v33, v224
  v_mfma_f32_16x16x32_bf16 a[180:183], v[216:219], v[100:103], a[180:183]
  ds_read_b64_tr_b16 v[214:215], v234 offset:45056
  v_mul_f32 v34, v34, v224
  v_mul_f32 v35, v35, v224
  v_mfma_f32_16x16x32_bf16 a[184:187], v[220:223], v[96:99], a[184:187]
  ds_read_b64_tr_b16 v[216:217], v235 offset:40960
  v_cvt_pk_bf16_f32 v120, v32, v33
  v_cvt_pk_bf16_f32 v121, v34, v35
  v_mul_f32 v36, v36, v226
  v_mfma_f32_16x16x32_bf16 a[188:191], v[220:223], v[100:103], a[188:191]
  ds_read_b64_tr_b16 v[218:219], v235 offset:45056
  v_mul_f32 v37, v37, v226
  v_mul_f32 v38, v38, v226
  s_waitcnt lgkmcnt(10)
  v_mfma_f32_16x16x32_bf16 a[192:195], v[192:195], v[96:99], a[192:195]
  ds_read_b64_tr_b16 v[220:221], v236 offset:40960
  v_mul_f32 v39, v39, v226
  v_cvt_pk_bf16_f32 v124, v36, v37
  v_cvt_pk_bf16_f32 v125, v38, v39
  v_mfma_f32_16x16x32_bf16 a[196:199], v[192:195], v[100:103], a[196:199]
  ds_read_b64_tr_b16 v[222:223], v236 offset:45056
  v_mul_f32 v40, v40, v224
  v_mul_f32 v41, v41, v224
  v_mfma_f32_16x16x32_bf16 a[200:203], v[196:199], v[96:99], a[200:203]
  v_mul_f32 v42, v42, v224
  v_mul_f32 v43, v43, v224
  v_mfma_f32_16x16x32_bf16 a[204:207], v[196:199], v[100:103], a[204:207]
  v_cvt_pk_bf16_f32 v122, v40, v41
  v_cvt_pk_bf16_f32 v123, v42, v43
  v_mul_f32 v44, v44, v226
  s_waitcnt lgkmcnt(8)
  v_mfma_f32_16x16x32_bf16 a[208:211], v[200:203], v[96:99], a[208:211]
  v_mul_f32 v45, v45, v226
  v_mul_f32 v46, v46, v226
  v_mfma_f32_16x16x32_bf16 a[212:215], v[200:203], v[100:103], a[212:215]
  v_mul_f32 v47, v47, v226
  v_cvt_pk_bf16_f32 v126, v44, v45
  v_cvt_pk_bf16_f32 v127, v46, v47
  v_mfma_f32_16x16x32_bf16 a[216:219], v[204:207], v[96:99], a[216:219]
  v_mul_f32 v48, v48, v224
  v_mul_f32 v49, v49, v224
  v_mfma_f32_16x16x32_bf16 a[220:223], v[204:207], v[100:103], a[220:223]
  s_waitcnt vmcnt(63) lgkmcnt(0)
  s_barrier
  ds_read_b64_tr_b16 v[192:193], v229 offset:49152
  ds_read_b64_tr_b16 v[194:195], v229 offset:53248
  ds_read_b64_tr_b16 v[196:197], v72 offset:0
  ds_read_b64_tr_b16 v[198:199], v72 offset:4096
  ds_read_b64_tr_b16 v[200:201], v72 offset:8192
  ds_read_b64_tr_b16 v[202:203], v72 offset:12288
  ds_read_b64_tr_b16 v[204:205], v72 offset:16384
  ds_read_b64_tr_b16 v[206:207], v72 offset:20480
  v_mul_f32 v50, v50, v224
  v_mul_f32 v51, v51, v224
  v_mfma_f32_16x16x32_bf16 a[224:227], v[208:211], v[96:99], a[224:227]
  v_cvt_pk_bf16_f32 v128, v48, v49
  v_cvt_pk_bf16_f32 v129, v50, v51
  v_mul_f32 v52, v52, v226
  v_mfma_f32_16x16x32_bf16 a[228:231], v[208:211], v[100:103], a[228:231]
  ds_read_b64_tr_b16 v[208:209], v230 offset:49152
  ds_read_b64_tr_b16 v[210:211], v230 offset:53248
  v_mul_f32 v53, v53, v226
  v_mul_f32 v54, v54, v226
  v_mfma_f32_16x16x32_bf16 a[232:235], v[212:215], v[96:99], a[232:235]
  v_mul_f32 v55, v55, v226
  v_cvt_pk_bf16_f32 v132, v52, v53
  v_cvt_pk_bf16_f32 v133, v54, v55
  v_mfma_f32_16x16x32_bf16 a[236:239], v[212:215], v[100:103], a[236:239]
  ds_read_b64_tr_b16 v[212:213], v73 offset:0
  ds_read_b64_tr_b16 v[214:215], v73 offset:4096
  v_mul_f32 v56, v56, v224
  v_mul_f32 v57, v57, v224
  v_mfma_f32_16x16x32_bf16 a[240:243], v[216:219], v[96:99], a[240:243]
  v_mul_f32 v58, v58, v224
  v_mul_f32 v59, v59, v224
  v_mfma_f32_16x16x32_bf16 a[244:247], v[216:219], v[100:103], a[244:247]
  ds_read_b64_tr_b16 v[216:217], v73 offset:8192
  ds_read_b64_tr_b16 v[218:219], v73 offset:12288
  v_cvt_pk_bf16_f32 v130, v56, v57
  v_cvt_pk_bf16_f32 v131, v58, v59
  v_mul_f32 v60, v60, v226
  v_mfma_f32_16x16x32_bf16 a[248:251], v[220:223], v[96:99], a[248:251]
  v_mul_f32 v61, v61, v226
  v_mul_f32 v62, v62, v226
  v_mfma_f32_16x16x32_bf16 a[252:255], v[220:223], v[100:103], a[252:255]
  v_mul_f32 v63, v63, v226
  v_cvt_pk_bf16_f32 v134, v60, v61
  v_cvt_pk_bf16_f32 v135, v62, v63
  s_waitcnt lgkmcnt(10)
  v_mfma_f32_16x16x32_bf16 a[0:3], v[192:195], v[104:107], a[0:3]
  ds_read_b64_tr_b16 v[220:221], v73 offset:16384
  v_mfma_f32_16x16x32_bf16 a[4:7], v[192:195], v[108:111], a[4:7]
  ds_read_b64_tr_b16 v[222:223], v73 offset:20480
  v_mfma_f32_16x16x32_bf16 a[0:3], v[196:199], v[112:115], a[0:3]
  ds_read_b64_tr_b16 v[192:193], v231 offset:49152
  v_mfma_f32_16x16x32_bf16 a[4:7], v[196:199], v[116:119], a[4:7]
  ds_read_b64_tr_b16 v[194:195], v231 offset:53248
  s_waitcnt lgkmcnt(10)
  v_mfma_f32_16x16x32_bf16 a[0:3], v[200:203], v[120:123], a[0:3]
  ds_read_b64_tr_b16 v[196:197], v74 offset:0
  v_mfma_f32_16x16x32_bf16 a[4:7], v[200:203], v[124:127], a[4:7]
  ds_read_b64_tr_b16 v[198:199], v74 offset:4096
  v_mfma_f32_16x16x32_bf16 a[0:3], v[204:207], v[128:131], a[0:3]
  ds_read_b64_tr_b16 v[200:201], v74 offset:8192
  v_mfma_f32_16x16x32_bf16 a[4:7], v[204:207], v[132:135], a[4:7]
  ds_read_b64_tr_b16 v[202:203], v74 offset:12288
  s_waitcnt lgkmcnt(10)
  v_mfma_f32_16x16x32_bf16 a[8:11], v[208:211], v[104:107], a[8:11]
  ds_read_b64_tr_b16 v[204:205], v74 offset:16384
  v_mfma_f32_16x16x32_bf16 a[12:15], v[208:211], v[108:111], a[12:15]
  ds_read_b64_tr_b16 v[206:207], v74 offset:20480
  v_mfma_f32_16x16x32_bf16 a[8:11], v[212:215], v[112:115], a[8:11]
  ds_read_b64_tr_b16 v[208:209], v232 offset:49152
  v_mfma_f32_16x16x32_bf16 a[12:15], v[212:215], v[116:119], a[12:15]
  ds_read_b64_tr_b16 v[210:211], v232 offset:53248
  s_waitcnt lgkmcnt(10)
  v_mfma_f32_16x16x32_bf16 a[8:11], v[216:219], v[120:123], a[8:11]
  ds_read_b64_tr_b16 v[212:213], v75 offset:0
  v_mfma_f32_16x16x32_bf16 a[12:15], v[216:219], v[124:127], a[12:15]
  ds_read_b64_tr_b16 v[214:215], v75 offset:4096
  v_mfma_f32_16x16x32_bf16 a[8:11], v[220:223], v[128:131], a[8:11]
  ds_read_b64_tr_b16 v[216:217], v75 offset:8192
  v_mfma_f32_16x16x32_bf16 a[12:15], v[220:223], v[132:135], a[12:15]
  ds_read_b64_tr_b16 v[218:219], v75 offset:12288
  s_waitcnt lgkmcnt(10)
  v_mfma_f32_16x16x32_bf16 a[16:19], v[192:195], v[104:107], a[16:19]
  ds_read_b64_tr_b16 v[220:221], v75 offset:16384
  v_mfma_f32_16x16x32_bf16 a[20:23], v[192:195], v[108:111], a[20:23]
  ds_read_b64_tr_b16 v[222:223], v75 offset:20480
  v_mfma_f32_16x16x32_bf16 a[16:19], v[196:199], v[112:115], a[16:19]
  ds_read_b64_tr_b16 v[192:193], v233 offset:49152
  v_accvgpr_read_b32 v0, a0
  v_mfma_f32_16x16x32_bf16 a[20:23], v[196:199], v[116:119], a[20:23]
  ds_read_b64_tr_b16 v[194:195], v233 offset:53248
  v_accvgpr_read_b32 v1, a1
  v_accvgpr_read_b32 v2, a2
  s_waitcnt lgkmcnt(10)
  v_mfma_f32_16x16x32_bf16 a[16:19], v[200:203], v[120:123], a[16:19]
  ds_read_b64_tr_b16 v[196:197], v76 offset:0
  v_accvgpr_read_b32 v3, a3
  v_accvgpr_read_b32 v4, a8
  v_mfma_f32_16x16x32_bf16 a[20:23], v[200:203], v[124:127], a[20:23]
  ds_read_b64_tr_b16 v[198:199], v76 offset:4096
  v_accvgpr_read_b32 v5, a9
  v_accvgpr_read_b32 v6, a10
  v_mfma_f32_16x16x32_bf16 a[16:19], v[204:207], v[128:131], a[16:19]
  ds_read_b64_tr_b16 v[200:201], v76 offset:8192
  v_accvgpr_read_b32 v7, a11
  v_accvgpr_read_b32 v8, a4
  v_mfma_f32_16x16x32_bf16 a[20:23], v[204:207], v[132:135], a[20:23]
  ds_read_b64_tr_b16 v[202:203], v76 offset:12288
  v_accvgpr_read_b32 v9, a5
  v_accvgpr_read_b32 v10, a6
  s_waitcnt lgkmcnt(10)
  v_mfma_f32_16x16x32_bf16 a[24:27], v[208:211], v[104:107], a[24:27]
  ds_read_b64_tr_b16 v[204:205], v76 offset:16384
  v_accvgpr_read_b32 v11, a7
  v_accvgpr_read_b32 v12, a12
  v_mfma_f32_16x16x32_bf16 a[28:31], v[208:211], v[108:111], a[28:31]
  ds_read_b64_tr_b16 v[206:207], v76 offset:20480
  v_accvgpr_read_b32 v13, a13
  v_mfma_f32_16x16x32_bf16 a[24:27], v[212:215], v[112:115], a[24:27]
  ds_read_b64_tr_b16 v[208:209], v234 offset:49152
  v_accvgpr_read_b32 v14, a14
  v_accvgpr_read_b32 v15, a15
  v_mfma_f32_16x16x32_bf16 a[28:31], v[212:215], v[116:119], a[28:31]
  ds_read_b64_tr_b16 v[210:211], v234 offset:53248
  v_cvt_pk_bf16_f32 v0, v0, v1
  v_cvt_pk_bf16_f32 v1, v2, v3
  s_waitcnt lgkmcnt(10)
  v_mfma_f32_16x16x32_bf16 a[24:27], v[216:219], v[120:123], a[24:27]
  ds_read_b64_tr_b16 v[212:213], v77 offset:0
  v_cvt_pk_bf16_f32 v2, v4, v5
  v_cvt_pk_bf16_f32 v3, v6, v7
  v_mfma_f32_16x16x32_bf16 a[28:31], v[216:219], v[124:127], a[28:31]
  ds_read_b64_tr_b16 v[214:215], v77 offset:4096
  v_cvt_pk_bf16_f32 v4, v8, v9
  v_cvt_pk_bf16_f32 v5, v10, v11
  v_mfma_f32_16x16x32_bf16 a[24:27], v[220:223], v[128:131], a[24:27]
  ds_read_b64_tr_b16 v[216:217], v77 offset:8192
  v_cvt_pk_bf16_f32 v6, v12, v13
  v_cvt_pk_bf16_f32 v7, v14, v15
  v_mfma_f32_16x16x32_bf16 a[28:31], v[220:223], v[132:135], a[28:31]
  ds_read_b64_tr_b16 v[218:219], v77 offset:12288
  s_add_u32 s67, s92, 0
  s_cmp_eq_u32 s60, 0
  s_cbranch_scc1 L_own0
  buffer_store_dwordx4 v[0:3], v80, s[28:31], s67 offen sc1
  buffer_store_dwordx4 v[4:7], v80, s[28:31], s67 offen offset:1024 sc1
L_ownr0:
  s_waitcnt lgkmcnt(10)
  v_mfma_f32_16x16x32_bf16 a[32:35], v[192:195], v[104:107], a[32:35]
  ds_read_b64_tr_b16 v[220:221], v77 offset:16384
  v_mfma_f32_16x16x32_bf16 a[36:39], v[192:195], v[108:111], a[36:39]
  ds_read_b64_tr_b16 v[222:223], v77 offset:20480
  v_mfma_f32_16x16x32_bf16 a[32:35], v[196:199], v[112:115], a[32:35]
  ds_read_b64_tr_b16 v[192:193], v235 offset:49152
  v_accvgpr_read_b32 v16, a16
  v_mfma_f32_16x16x32_bf16 a[36:39], v[196:199], v[116:119], a[36:39]
  ds_read_b64_tr_b16 v[194:195], v235 offset:53248
  v_accvgpr_read_b32 v17, a17
  v_accvgpr_read_b32 v18, a18
  s_waitcnt lgkmcnt(10)
  v_mfma_f32_16x16x32_bf16 a[32:35], v[200:203], v[120:123], a[32:35]
  ds_read_b64_tr_b16 v[196:197], v78 offset:0
  v_accvgpr_read_b32 v19, a19
  v_accvgpr_read_b32 v20, a24
  v_mfma_f32_16x16x32_bf16 a[36:39], v[200:203], v[124:127], a[36:39]
  ds_read_b64_tr_b16 v[198:199], v78 offset:4096
  v_accvgpr_read_b32 v21, a25
  v_accvgpr_read_b32 v22, a26
  v_mfma_f32_16x16x32_bf16 a[32:35], v[204:207], v[128:131], a[32:35]
  ds_read_b64_tr_b16 v[200:201], v78 offset:8192
  v_accvgpr_read_b32 v23, a27
  v_accvgpr_read_b32 v24, a20
  v_mfma_f32_16x16x32_bf16 a[36:39], v[204:207], v[132:135], a[36:39]
  ds_read_b64_tr_b16 v[202:203], v78 offset:12288
  v_accvgpr_read_b32 v25, a21
  v_accvgpr_read_b32 v26, a22
  s_waitcnt lgkmcnt(10)
  v_mfma_f32_16x16x32_bf16 a[40:43], v[208:211], v[104:107], a[40:43]
  ds_read_b64_tr_b16 v[204:205], v78 offset:16384
  v_accvgpr_read_b32 v27, a23
  v_accvgpr_read_b32 v28, a28
  v_mfma_f32_16x16x32_bf16 a[44:47], v[208:211], v[108:111], a[44:47]
  ds_read_b64_tr_b16 v[206:207], v78 offset:20480
  v_accvgpr_read_b32 v29, a29
  v_mfma_f32_16x16x32_bf16 a[40:43], v[212:215], v[112:115], a[40:43]
  ds_read_b64_tr_b16 v[208:209], v236 offset:49152
  v_accvgpr_read_b32 v30, a30
  v_accvgpr_read_b32 v31, a31
  v_mfma_f32_16x16x32_bf16 a[44:47], v[212:215], v[116:119], a[44:47]
  ds_read_b64_tr_b16 v[210:211], v236 offset:53248
  v_cvt_pk_bf16_f32 v16, v16, v17
  v_cvt_pk_bf16_f32 v17, v18, v19
  s_waitcnt lgkmcnt(10)
  v_mfma_f32_16x16x32_bf16 a[40:43], v[216:219], v[120:123], a[40:43]
  ds_read_b64_tr_b16 v[212:213], v79 offset:0
  v_cvt_pk_bf16_f32 v18, v20, v21
  v_cvt_pk_bf16_f32 v19, v22, v23
  v_mfma_f32_16x16x32_bf16 a[44:47], v[216:219], v[124:127], a[44:47]
  ds_read_b64_tr_b16 v[214:215], v79 offset:4096
  v_cvt_pk_bf16_f32 v20, v24, v25
  v_cvt_pk_bf16_f32 v21, v26, v27
  v_mfma_f32_16x16x32_bf16 a[40:43], v[220:223], v[128:131], a[40:43]
  ds_read_b64_tr_b16 v[216:217], v79 offset:8192
  v_cvt_pk_bf16_f32 v22, v28, v29
  v_cvt_pk_bf16_f32 v23, v30, v31
  v_mfma_f32_16x16x32_bf16 a[44:47], v[220:223], v[132:135], a[44:47]
  ds_read_b64_tr_b16 v[218:219], v79 offset:12288
  s_add_u32 s67, s92, 2048
  s_cmp_eq_u32 s60, 1
  s_cbranch_scc1 L_own1
  buffer_store_dwordx4 v[16:19], v80, s[28:31], s67 offen sc1
  buffer_store_dwordx4 v[20:23], v80, s[28:31], s67 offen offset:1024 sc1
L_ownr1:
  s_waitcnt lgkmcnt(10)
  v_mfma_f32_16x16x32_bf16 a[48:51], v[192:195], v[104:107], a[48:51]
  ds_read_b64_tr_b16 v[220:221], v79 offset:16384
  v_mfma_f32_16x16x32_bf16 a[52:55], v[192:195], v[108:111], a[52:55]
  ds_read_b64_tr_b16 v[222:223], v79 offset:20480
  v_mfma_f32_16x16x32_bf16 a[48:51], v[196:199], v[112:115], a[48:51]
  ds_read_b64_tr_b16 v[192:193], v72 offset:24576
  v_accvgpr_read_b32 v32, a32
  v_mfma_f32_16x16x32_bf16 a[52:55], v[196:199], v[116:119], a[52:55]
  ds_read_b64_tr_b16 v[194:195], v72 offset:28672
  v_accvgpr_read_b32 v33, a33
  v_accvgpr_read_b32 v34, a34
  s_waitcnt lgkmcnt(10)
  v_mfma_f32_16x16x32_bf16 a[48:51], v[200:203], v[120:123], a[48:51]
  ds_read_b64_tr_b16 v[196:197], v72 offset:32768
  v_accvgpr_read_b32 v35, a35
  v_accvgpr_read_b32 v36, a40
  v_mfma_f32_16x16x32_bf16 a[52:55], v[200:203], v[124:127], a[52:55]
  ds_read_b64_tr_b16 v[198:199], v72 offset:36864
  v_accvgpr_read_b32 v37, a41
  v_accvgpr_read_b32 v38, a42
  v_mfma_f32_16x16x32_bf16 a[48:51], v[204:207], v[128:131], a[48:51]
  ds_read_b64_tr_b16 v[200:201], v72 offset:40960
  v_accvgpr_read_b32 v39, a43
  v_accvgpr_read_b32 v40, a36
  v_mfma_f32_16x16x32_bf16 a[52:55], v[204:207], v[132:135], a[52:55]
  ds_read_b64_tr_b16 v[202:203], v72 offset:45056
  v_accvgpr_read_b32 v41, a37
  v_accvgpr_read_b32 v42, a38
  s_waitcnt lgkmcnt(10)
  v_mfma_f32_16x16x32_bf16 a[56:59], v[208:211], v[104:107], a[56:59]
  ds_read_b64_tr_b16 v[204:205], v72 offset:49152
  v_accvgpr_read_b32 v43, a39
  v_accvgpr_read_b32 v44, a44
  v_mfma_f32_16x16x32_bf16 a[60:63], v[208:211], v[108:111], a[60:63]
  ds_read_b64_tr_b16 v[206:207], v72 offset:53248
  v_accvgpr_read_b32 v45, a45
  v_mfma_f32_16x16x32_bf16 a[56:59], v[212:215], v[112:115], a[56:59]
  ds_read_b64_tr_b16 v[208:209], v73 offset:24576
  v_accvgpr_read_b32 v46, a46
  v_accvgpr_read_b32 v47, a47
  v_mfma_f32_16x16x32_bf16 a[60:63], v[212:215], v[116:119], a[60:63]
  ds_read_b64_tr_b16 v[210:211], v73 offset:28672
  v_cvt_pk_bf16_f32 v32, v32, v33
  v_cvt_pk_bf16_f32 v33, v34, v35
  s_waitcnt lgkmcnt(10)
  v_mfma_f32_16x16x32_bf16 a[56:59], v[216:219], v[120:123], a[56:59]
  ds_read_b64_tr_b16 v[212:213], v73 offset:32768
  v_cvt_pk_bf16_f32 v34, v36, v37
  v_cvt_pk_bf16_f32 v35, v38, v39
  v_mfma_f32_16x16x32_bf16 a[60:63], v[216:219], v[124:127], a[60:63]
  ds_read_b64_tr_b16 v[214:215], v73 offset:36864
  v_cvt_pk_bf16_f32 v36, v40, v41
  v_cvt_pk_bf16_f32 v37, v42, v43
  v_mfma_f32_16x16x32_bf16 a[56:59], v[220:223], v[128:131], a[56:59]
  ds_read_b64_tr_b16 v[216:217], v73 offset:40960
  v_cvt_pk_bf16_f32 v38, v44, v45
  v_cvt_pk_bf16_f32 v39, v46, v47
  v_mfma_f32_16x16x32_bf16 a[60:63], v[220:223], v[132:135], a[60:63]
  ds_read_b64_tr_b16 v[218:219], v73 offset:45056
  s_add_u32 s67, s92, 4096
  s_cmp_eq_u32 s60, 2
  s_cbranch_scc1 L_own2
  buffer_store_dwordx4 v[32:35], v80, s[28:31], s67 offen sc1
  buffer_store_dwordx4 v[36:39], v80, s[28:31], s67 offen offset:1024 sc1
L_ownr2:
  s_waitcnt lgkmcnt(10)
  v_mfma_f32_16x16x32_bf16 a[64:67], v[192:195], v[104:107], a[64:67]
  ds_read_b64_tr_b16 v[220:221], v73 offset:49152
  v_mfma_f32_16x16x32_bf16 a[68:71], v[192:195], v[108:111], a[68:71]
  ds_read_b64_tr_b16 v[222:223], v73 offset:53248
  v_mfma_f32_16x16x32_bf16 a[64:67], v[196:199], v[112:115], a[64:67]
  ds_read_b64_tr_b16 v[192:193], v74 offset:24576
  v_accvgpr_read_b32 v48, a48
  v_mfma_f32_16x16x32_bf16 a[68:71], v[196:199], v[116:119], a[68:71]
  ds_read_b64_tr_b16 v[194:195], v74 offset:28672
  v_accvgpr_read_b32 v49, a49
  v_accvgpr_read_b32 v50, a50
  s_waitcnt lgkmcnt(10)
  v_mfma_f32_16x16x32_bf16 a[64:67], v[200:203], v[120:123], a[64:67]
  ds_read_b64_tr_b16 v[196:197], v74 offset:32768
  v_accvgpr_read_b32 v51, a51
  v_accvgpr_read_b32 v52, a56
  v_mfma_f32_16x16x32_bf16 a[68:71], v[200:203], v[124:127], a[68:71]
  ds_read_b64_tr_b16 v[198:199], v74 offset:36864
  v_accvgpr_read_b32 v53, a57
  v_accvgpr_read_b32 v54, a58
  v_mfma_f32_16x16x32_bf16 a[64:67], v[204:207], v[128:131], a[64:67]
  ds_read_b64_tr_b16 v[200:201], v74 offset:40960
  v_accvgpr_read_b32 v55, a59
  v_accvgpr_read_b32 v56, a52
  v_mfma_f32_16x16x32_bf16 a[68:71], v[204:207], v[132:135], a[68:71]
  ds_read_b64_tr_b16 v[202:203], v74 offset:45056
  v_accvgpr_read_b32 v57, a53
  v_accvgpr_read_b32 v58, a54
  s_waitcnt lgkmcnt(10)
  v_mfma_f32_16x16x32_bf16 a[72:75], v[208:211], v[104:107], a[72:75]
  ds_read_b64_tr_b16 v[204:205], v74 offset:49152
  v_accvgpr_read_b32 v59, a55
  v_accvgpr_read_b32 v60, a60
  v_mfma_f32_16x16x32_bf16 a[76:79], v[208:211], v[108:111], a[76:79]
  ds_read_b64_tr_b16 v[206:207], v74 offset:53248
  v_accvgpr_read_b32 v61, a61
  v_mfma_f32_16x16x32_bf16 a[72:75], v[212:215], v[112:115], a[72:75]
  ds_read_b64_tr_b16 v[208:209], v75 offset:24576
  v_accvgpr_read_b32 v62, a62
  v_accvgpr_read_b32 v63, a63
  v_mfma_f32_16x16x32_bf16 a[76:79], v[212:215], v[116:119], a[76:79]
  ds_read_b64_tr_b16 v[210:211], v75 offset:28672
  v_cvt_pk_bf16_f32 v48, v48, v49
  v_cvt_pk_bf16_f32 v49, v50, v51
  s_waitcnt lgkmcnt(10)
  v_mfma_f32_16x16x32_bf16 a[72:75], v[216:219], v[120:123], a[72:75]
  ds_read_b64_tr_b16 v[212:213], v75 offset:32768
  v_cvt_pk_bf16_f32 v50, v52, v53
  v_cvt_pk_bf16_f32 v51, v54, v55
  v_mfma_f32_16x16x32_bf16 a[76:79], v[216:219], v[124:127], a[76:79]
  ds_read_b64_tr_b16 v[214:215], v75 offset:36864
  v_cvt_pk_bf16_f32 v52, v56, v57
  v_cvt_pk_bf16_f32 v53, v58, v59
  v_mfma_f32_16x16x32_bf16 a[72:75], v[220:223], v[128:131], a[72:75]
  ds_read_b64_tr_b16 v[216:217], v75 offset:40960
  v_cvt_pk_bf16_f32 v54, v60, v61
  v_cvt_pk_bf16_f32 v55, v62, v63
  v_mfma_f32_16x16x32_bf16 a[76:79], v[220:223], v[132:135], a[76:79]
  ds_read_b64_tr_b16 v[218:219], v75 offset:45056
  s_add_u32 s67, s92, 6144
  s_cmp_eq_u32 s60, 3
  s_cbranch_scc1 L_own3
  buffer_store_dwordx4 v[48:51], v80, s[28:31], s67 offen sc1
  buffer_store_dwordx4 v[52:55], v80, s[28:31], s67 offen offset:1024 sc1
L_ownr3:
  s_waitcnt lgkmcnt(10)
  v_mfma_f32_16x16x32_bf16 a[80:83], v[192:195], v[104:107], a[80:83]
  ds_read_b64_tr_b16 v[220:221], v75 offset:49152
  v_mfma_f32_16x16x32_bf16 a[84:87], v[192:195], v[108:111], a[84:87]
  ds_read_b64_tr_b16 v[222:223], v75 offset:53248
  v_mfma_f32_16x16x32_bf16 a[80:83], v[196:199], v[112:115], a[80:83]
  ds_read_b64_tr_b16 v[192:193], v76 offset:24576
  v_accvgpr_read_b32 v0, a64
  v_mfma_f32_16x16x32_bf16 a[84:87], v[196:199], v[116:119], a[84:87]
  ds_read_b64_tr_b16 v[194:195], v76 offset:28672
  v_accvgpr_read_b32 v1, a65
  v_accvgpr_read_b32 v2, a66
  s_waitcnt lgkmcnt(10)
  v_mfma_f32_16x16x32_bf16 a[80:83], v[200:203], v[120:123], a[80:83]
  ds_read_b64_tr_b16 v[196:197], v76 offset:32768
  v_accvgpr_read_b32 v3, a67
  v_accvgpr_read_b32 v4, a72
  v_mfma_f32_16x16x32_bf16 a[84:87], v[200:203], v[124:127], a[84:87]
  ds_read_b64_tr_b16 v[198:199], v76 offset:36864
  v_accvgpr_read_b32 v5, a73
  v_accvgpr_read_b32 v6, a74
  v_mfma_f32_16x16x32_bf16 a[80:83], v[204:207], v[128:131], a[80:83]
  ds_read_b64_tr_b16 v[200:201], v76 offset:40960
  v_accvgpr_read_b32 v7, a75
  v_accvgpr_read_b32 v8, a68
  v_mfma_f32_16x16x32_bf16 a[84:87], v[204:207], v[132:135], a[84:87]
  ds_read_b64_tr_b16 v[202:203], v76 offset:45056
  v_accvgpr_read_b32 v9, a69
  v_accvgpr_read_b32 v10, a70
  s_waitcnt lgkmcnt(10)
  v_mfma_f32_16x16x32_bf16 a[88:91], v[208:211], v[104:107], a[88:91]
  ds_read_b64_tr_b16 v[204:205], v76 offset:49152
  v_accvgpr_read_b32 v11, a71
  v_accvgpr_read_b32 v12, a76
  v_mfma_f32_16x16x32_bf16 a[92:95], v[208:211], v[108:111], a[92:95]
  ds_read_b64_tr_b16 v[206:207], v76 offset:53248
  v_accvgpr_read_b32 v13, a77
  v_mfma_f32_16x16x32_bf16 a[88:91], v[212:215], v[112:115], a[88:91]
  ds_read_b64_tr_b16 v[208:209], v77 offset:24576
  v_accvgpr_read_b32 v14, a78
  v_accvgpr_read_b32 v15, a79
  v_mfma_f32_16x16x32_bf16 a[92:95], v[212:215], v[116:119], a[92:95]
  ds_read_b64_tr_b16 v[210:211], v77 offset:28672
  v_cvt_pk_bf16_f32 v0, v0, v1
  v_cvt_pk_bf16_f32 v1, v2, v3
  s_waitcnt lgkmcnt(10)
  v_mfma_f32_16x16x32_bf16 a[88:91], v[216:219], v[120:123], a[88:91]
  ds_read_b64_tr_b16 v[212:213], v77 offset:32768
  v_cvt_pk_bf16_f32 v2, v4, v5
  v_cvt_pk_bf16_f32 v3, v6, v7
  v_mfma_f32_16x16x32_bf16 a[92:95], v[216:219], v[124:127], a[92:95]
  ds_read_b64_tr_b16 v[214:215], v77 offset:36864
  v_cvt_pk_bf16_f32 v4, v8, v9
  v_cvt_pk_bf16_f32 v5, v10, v11
  v_mfma_f32_16x16x32_bf16 a[88:91], v[220:223], v[128:131], a[88:91]
  ds_read_b64_tr_b16 v[216:217], v77 offset:40960
  v_cvt_pk_bf16_f32 v6, v12, v13
  v_cvt_pk_bf16_f32 v7, v14, v15
  v_mfma_f32_16x16x32_bf16 a[92:95], v[220:223], v[132:135], a[92:95]
  ds_read_b64_tr_b16 v[218:219], v77 offset:45056
  s_add_u32 s67, s92, 8192
  s_cmp_eq_u32 s60, 4
  s_cbranch_scc1 L_own4
  buffer_store_dwordx4 v[0:3], v80, s[28:31], s67 offen sc1
  buffer_store_dwordx4 v[4:7], v80, s[28:31], s67 offen offset:1024 sc1
L_ownr4:
  s_waitcnt lgkmcnt(10)
  v_mfma_f32_16x16x32_bf16 a[96:99], v[192:195], v[104:107], a[96:99]
  ds_read_b64_tr_b16 v[220:221], v77 offset:49152
  v_mfma_f32_16x16x32_bf16 a[100:103], v[192:195], v[108:111], a[100:103]
  ds_read_b64_tr_b16 v[222:223], v77 offset:53248
  v_mfma_f32_16x16x32_bf16 a[96:99], v[196:199], v[112:115], a[96:99]
  ds_read_b64_tr_b16 v[192:193], v78 offset:24576
  v_accvgpr_read_b32 v16, a80
  v_mfma_f32_16x16x32_bf16 a[100:103], v[196:199], v[116:119], a[100:103]
  ds_read_b64_tr_b16 v[194:195], v78 offset:28672
  v_accvgpr_read_b32 v17, a81
  v_accvgpr_read_b32 v18, a82
  s_waitcnt lgkmcnt(10)
  v_mfma_f32_16x16x32_bf16 a[96:99], v[200:203], v[120:123], a[96:99]
  ds_read_b64_tr_b16 v[196:197], v78 offset:32768
  v_accvgpr_read_b32 v19, a83
  v_accvgpr_read_b32 v20, a88
  v_mfma_f32_16x16x32_bf16 a[100:103], v[200:203], v[124:127], a[100:103]
  ds_read_b64_tr_b16 v[198:199], v78 offset:36864
  v_accvgpr_read_b32 v21, a89
  v_accvgpr_read_b32 v22, a90
  v_mfma_f32_16x16x32_bf16 a[96:99], v[204:207], v[128:131], a[96:99]
  ds_read_b64_tr_b16 v[200:201], v78 offset:40960
  v_accvgpr_read_b32 v23, a91
  v_accvgpr_read_b32 v24, a84
  v_mfma_f32_16x16x32_bf16 a[100:103], v[204:207], v[132:135], a[100:103]
  ds_read_b64_tr_b16 v[202:203], v78 offset:45056
  v_accvgpr_read_b32 v25, a85
  v_accvgpr_read_b32 v26, a86
  s_waitcnt lgkmcnt(10)
  v_mfma_f32_16x16x32_bf16 a[104:107], v[208:211], v[104:107], a[104:107]
  ds_read_b64_tr_b16 v[204:205], v78 offset:49152
  v_accvgpr_read_b32 v27, a87
  v_accvgpr_read_b32 v28, a92
  v_mfma_f32_16x16x32_bf16 a[108:111], v[208:211], v[108:111], a[108:111]
  ds_read_b64_tr_b16 v[206:207], v78 offset:53248
  v_accvgpr_read_b32 v29, a93
  v_mfma_f32_16x16x32_bf16 a[104:107], v[212:215], v[112:115], a[104:107]
  ds_read_b64_tr_b16 v[208:209], v79 offset:24576
  v_accvgpr_read_b32 v30, a94
  v_accvgpr_read_b32 v31, a95
  v_mfma_f32_16x16x32_bf16 a[108:111], v[212:215], v[116:119], a[108:111]
  ds_read_b64_tr_b16 v[210:211], v79 offset:28672
  v_cvt_pk_bf16_f32 v16, v16, v17
  v_cvt_pk_bf16_f32 v17, v18, v19
  s_waitcnt lgkmcnt(10)
  v_mfma_f32_16x16x32_bf16 a[104:107], v[216:219], v[120:123], a[104:107]
  ds_read_b64_tr_b16 v[212:213], v79 offset:32768
  v_cvt_pk_bf16_f32 v18, v20, v21
  v_cvt_pk_bf16_f32 v19, v22, v23
  v_mfma_f32_16x16x32_bf16 a[108:111], v[216:219], v[124:127], a[108:111]
  ds_read_b64_tr_b16 v[214:215], v79 offset:36864
  v_cvt_pk_bf16_f32 v20, v24, v25
  v_cvt_pk_bf16_f32 v21, v26, v27
  v_mfma_f32_16x16x32_bf16 a[104:107], v[220:223], v[128:131], a[104:107]
  ds_read_b64_tr_b16 v[216:217], v79 offset:40960
  v_cvt_pk_bf16_f32 v22, v28, v29
  v_cvt_pk_bf16_f32 v23, v30, v31
  v_mfma_f32_16x16x32_bf16 a[108:111], v[220:223], v[132:135], a[108:111]
  ds_read_b64_tr_b16 v[218:219], v79 offset:45056
  s_add_u32 s67, s92, 10240
  s_cmp_eq_u32 s60, 5
  s_cbranch_scc1 L_own5
  buffer_store_dwordx4 v[16:19], v80, s[28:31], s67 offen sc1
  buffer_store_dwordx4 v[20:23], v80, s[28:31], s67 offen offset:1024 sc1
L_ownr5:
  s_waitcnt lgkmcnt(10)
  v_mfma_f32_16x16x32_bf16 a[112:115], v[192:195], v[104:107], a[112:115]
  ds_read_b64_tr_b16 v[220:221], v79 offset:49152
  v_mfma_f32_16x16x32_bf16 a[116:119], v[192:195], v[108:111], a[116:119]
  ds_read_b64_tr_b16 v[222:223], v79 offset:53248
  v_mfma_f32_16x16x32_bf16 a[112:115], v[196:199], v[112:115], a[112:115]
  v_accvgpr_read_b32 v32, a96
  v_mfma_f32_16x16x32_bf16 a[116:119], v[196:199], v[116:119], a[116:119]
  v_accvgpr_read_b32 v33, a97
  v_accvgpr_read_b32 v34, a98
  s_waitcnt lgkmcnt(8)
  v_mfma_f32_16x16x32_bf16 a[112:115], v[200:203], v[120:123], a[112:115]
  v_accvgpr_read_b32 v35, a99
  v_accvgpr_read_b32 v36, a104
  v_mfma_f32_16x16x32_bf16 a[116:119], v[200:203], v[124:127], a[116:119]
  v_accvgpr_read_b32 v37, a105
  v_accvgpr_read_b32 v38, a106
  v_mfma_f32_16x16x32_bf16 a[112:115], v[204:207], v[128:131], a[112:115]
  v_accvgpr_read_b32 v39, a107
  v_accvgpr_read_b32 v40, a100
  v_mfma_f32_16x16x32_bf16 a[116:119], v[204:207], v[132:135], a[116:119]
  s_waitcnt vmcnt(63) lgkmcnt(0)
  s_barrier
  ds_read_b64_tr_b16 v[192:193], v64 offset:8704
  ds_read_b64_tr_b16 v[194:195], v64 offset:12800
  ds_read_b64_tr_b16 v[196:197], v229 offset:8192
  ds_read_b64_tr_b16 v[198:199], v229 offset:12288
  ds_read_b64_tr_b16 v[200:201], v64 offset:17408
  ds_read_b64_tr_b16 v[202:203], v64 offset:21504
  ds_read_b64_tr_b16 v[204:205], v229 offset:16384
  ds_read_b64_tr_b16 v[206:207], v229 offset:20480
  v_accvgpr_read_b32 v41, a101
  v_accvgpr_read_b32 v42, a102
  v_mfma_f32_16x16x32_bf16 a[120:123], v[208:211], v[104:107], a[120:123]
  v_accvgpr_read_b32 v43, a103
  v_accvgpr_read_b32 v44, a108
  v_mfma_f32_16x16x32_bf16 a[124:127], v[208:211], v[108:111], a[124:127]
  ds_read_b64_tr_b16 v[208:209], v65 offset:8704
  ds_read_b64_tr_b16 v[210:211], v65 offset:12800
  v_accvgpr_read_b32 v45, a109
  v_mfma_f32_16x16x32_bf16 a[120:123], v[212:215], v[112:115], a[120:123]
  v_accvgpr_read_b32 v46, a110
  v_accvgpr_read_b32 v47, a111
  v_mfma_f32_16x16x32_bf16 a[124:127], v[212:215], v[116:119], a[124:127]
  ds_read_b64_tr_b16 v[212:213], v230 offset:8192
  ds_read_b64_tr_b16 v[214:215], v230 offset:12288
  v_cvt_pk_bf16_f32 v32, v32, v33
  v_cvt_pk_bf16_f32 v33, v34, v35
  v_mfma_f32_16x16x32_bf16 a[120:123], v[216:219], v[120:123], a[120:123]
  v_cvt_pk_bf16_f32 v34, v36, v37
  v_cvt_pk_bf16_f32 v35, v38, v39
  v_mfma_f32_16x16x32_bf16 a[124:127], v[216:219], v[124:127], a[124:127]
  ds_read_b64_tr_b16 v[216:217], v65 offset:17408
  ds_read_b64_tr_b16 v[218:219], v65 offset:21504
  v_cvt_pk_bf16_f32 v36, v40, v41
  v_cvt_pk_bf16_f32 v37, v42, v43
  v_mfma_f32_16x16x32_bf16 a[120:123], v[220:223], v[128:131], a[120:123]
  v_cvt_pk_bf16_f32 v38, v44, v45
  v_cvt_pk_bf16_f32 v39, v46, v47
  v_mfma_f32_16x16x32_bf16 a[124:127], v[220:223], v[132:135], a[124:127]
  s_add_u32 s67, s92, 12288
  s_cmp_eq_u32 s60, 6
  s_cbranch_scc1 L_own6
  buffer_store_dwordx4 v[32:35], v80, s[28:31], s67 offen sc1
  buffer_store_dwordx4 v[36:39], v80, s[28:31], s67 offen offset:1024 sc1
L_ownr6:
  s_waitcnt lgkmcnt(10)
  v_mfma_f32_16x16x32_bf16 a[128:131], v[192:195], v[104:107], a[128:131]
  ds_read_b64_tr_b16 v[220:221], v230 offset:16384
  v_mfma_f32_16x16x32_bf16 a[132:135], v[192:195], v[108:111], a[132:135]
  ds_read_b64_tr_b16 v[222:223], v230 offset:20480
  v_mfma_f32_16x16x32_bf16 a[128:131], v[196:199], v[112:115], a[128:131]
  ds_read_b64_tr_b16 v[192:193], v66 offset:8704
  v_accvgpr_read_b32 v48, a112
  v_mfma_f32_16x16x32_bf16 a[132:135], v[196:199], v[116:119], a[132:135]
  ds_read_b64_tr_b16 v[194:195], v66 offset:12800
  v_accvgpr_read_b32 v49, a113
  v_accvgpr_read_b32 v50, a114
  s_waitcnt lgkmcnt(10)
  v_mfma_f32_16x16x32_bf16 a[128:131], v[200:203], v[120:123], a[128:131]
  ds_read_b64_tr_b16 v[196:197], v231 offset:8192
  v_accvgpr_read_b32 v51, a115
  v_accvgpr_read_b32 v52, a120
  v_mfma_f32_16x16x32_bf16 a[132:135], v[200:203], v[124:127], a[132:135]
  ds_read_b64_tr_b16 v[198:199], v231 offset:12288
  v_accvgpr_read_b32 v53, a121
  v_accvgpr_read_b32 v54, a122
  v_mfma_f32_16x16x32_bf16 a[128:131], v[204:207], v[128:131], a[128:131]
  ds_read_b64_tr_b16 v[200:201], v66 offset:17408
  v_accvgpr_read_b32 v55, a123
  v_accvgpr_read_b32 v56, a116
  v_mfma_f32_16x16x32_bf16 a[132:135], v[204:207], v[132:135], a[132:135]
  ds_read_b64_tr_b16 v[202:203], v66 offset:21504
  v_accvgpr_read_b32 v57, a117
  v_accvgpr_read_b32 v58, a118
  s_waitcnt lgkmcnt(10)
  v_mfma_f32_16x16x32_bf16 a[136:139], v[208:211], v[104:107], a[136:139]
  ds_read_b64_tr_b16 v[204:205], v231 offset:16384
  v_accvgpr_read_b32 v59, a119
  v_accvgpr_read_b32 v60, a124
  v_mfma_f32_16x16x32_bf16 a[140:143], v[208:211], v[108:111], a[140:143]
  ds_read_b64_tr_b16 v[206:207], v231 offset:20480
  v_accvgpr_read_b32 v61, a125
  v_mfma_f32_16x16x32_bf16 a[136:139], v[212:215], v[112:115], a[136:139]
  ds_read_b64_tr_b16 v[208:209], v67 offset:8704
  v_accvgpr_read_b32 v62, a126
  v_accvgpr_read_b32 v63, a127
  v_mfma_f32_16x16x32_bf16 a[140:143], v[212:215], v[116:119], a[140:143]
  ds_read_b64_tr_b16 v[210:211], v67 offset:12800
  v_cvt_pk_bf16_f32 v48, v48, v49
  v_cvt_pk_bf16_f32 v49, v50, v51
  s_waitcnt lgkmcnt(10)
  v_mfma_f32_16x16x32_bf16 a[136:139], v[216:219], v[120:123], a[136:139]
  ds_read_b64_tr_b16 v[212:213], v232 offset:8192
  v_cvt_pk_bf16_f32 v50, v52, v53
  v_cvt_pk_bf16_f32 v51, v54, v55
  v_mfma_f32_16x16x32_bf16 a[140:143], v[216:219], v[124:127], a[140:143]
  ds_read_b64_tr_b16 v[214:215], v232 offset:12288
  v_cvt_pk_bf16_f32 v52, v56, v57
  v_cvt_pk_bf16_f32 v53, v58, v59
  v_mfma_f32_16x16x32_bf16 a[136:139], v[220:223], v[128:131], a[136:139]
  ds_read_b64_tr_b16 v[216:217], v67 offset:17408
  v_cvt_pk_bf16_f32 v54, v60, v61
  v_cvt_pk_bf16_f32 v55, v62, v63
  v_mfma_f32_16x16x32_bf16 a[140:143], v[220:223], v[132:135], a[140:143]
  ds_read_b64_tr_b16 v[218:219], v67 offset:21504
  s_add_u32 s67, s92, 14336
  s_cmp_eq_u32 s60, 7
  s_cbranch_scc1 L_own7
  buffer_store_dwordx4 v[48:51], v80, s[28:31], s67 offen sc1
  buffer_store_dwordx4 v[52:55], v80, s[28:31], s67 offen offset:1024 sc1
L_ownr7:
  s_waitcnt lgkmcnt(10)
  v_mfma_f32_16x16x32_bf16 a[144:147], v[192:195], v[104:107], a[144:147]
  ds_read_b64_tr_b16 v[220:221], v232 offset:16384
  v_mfma_f32_16x16x32_bf16 a[148:151], v[192:195], v[108:111], a[148:151]
  ds_read_b64_tr_b16 v[222:223], v232 offset:20480
  v_mfma_f32_16x16x32_bf16 a[144:147], v[196:199], v[112:115], a[144:147]
  ds_read_b64_tr_b16 v[192:193], v68 offset:8704
  v_accvgpr_read_b32 v0, a128
  v_mfma_f32_16x16x32_bf16 a[148:151], v[196:199], v[116:119], a[148:151]
  ds_read_b64_tr_b16 v[194:195], v68 offset:12800
  v_accvgpr_read_b32 v1, a129
  v_accvgpr_read_b32 v2, a130
  s_waitcnt lgkmcnt(10)
  v_mfma_f32_16x16x32_bf16 a[144:147], v[200:203], v[120:123], a[144:147]
  ds_read_b64_tr_b16 v[196:197], v233 offset:8192
  v_accvgpr_read_b32 v3, a131
  v_accvgpr_read_b32 v4, a136
  v_mfma_f32_16x16x32_bf16 a[148:151], v[200:203], v[124:127], a[148:151]
  ds_read_b64_tr_b16 v[198:199], v233 offset:12288
  v_accvgpr_read_b32 v5, a137
  v_accvgpr_read_b32 v6, a138
  v_mfma_f32_16x16x32_bf16 a[144:147], v[204:207], v[128:131], a[144:147]
  ds_read_b64_tr_b16 v[200:201], v68 offset:17408
  v_accvgpr_read_b32 v7, a139
  v_accvgpr_read_b32 v8, a132
  v_mfma_f32_16x16x32_bf16 a[148:151], v[204:207], v[132:135], a[148:151]
  ds_read_b64_tr_b16 v[202:203], v68 offset:21504
  v_accvgpr_read_b32 v9, a133
  v_accvgpr_read_b32 v10, a134
  s_waitcnt lgkmcnt(10)
  v_mfma_f32_16x16x32_bf16 a[152:155], v[208:211], v[104:107], a[152:155]
  ds_read_b64_tr_b16 v[204:205], v233 offset:16384
  v_accvgpr_read_b32 v11, a135
  v_accvgpr_read_b32 v12, a140
  v_mfma_f32_16x16x32_bf16 a[156:159], v[208:211], v[108:111], a[156:159]
  ds_read_b64_tr_b16 v[206:207], v233 offset:20480
  v_accvgpr_read_b32 v13, a141
  v_mfma_f32_16x16x32_bf16 a[152:155], v[212:215], v[112:115], a[152:155]
  ds_read_b64_tr_b16 v[208:209], v69 offset:8704
  v_accvgpr_read_b32 v14, a142
  v_accvgpr_read_b32 v15, a143
  v_mfma_f32_16x16x32_bf16 a[156:159], v[212:215], v[116:119], a[156:159]
  ds_read_b64_tr_b16 v[210:211], v69 offset:12800
  v_cvt_pk_bf16_f32 v0, v0, v1
  v_cvt_pk_bf16_f32 v1, v2, v3
  s_waitcnt lgkmcnt(10)
  v_mfma_f32_16x16x32_bf16 a[152:155], v[216:219], v[120:123], a[152:155]
  ds_read_b64_tr_b16 v[212:213], v234 offset:8192
  v_cvt_pk_bf16_f32 v2, v4, v5
  v_cvt_pk_bf16_f32 v3, v6, v7
  v_mfma_f32_16x16x32_bf16 a[156:159], v[216:219], v[124:127], a[156:159]
  ds_read_b64_tr_b16 v[214:215], v234 offset:12288
  v_cvt_pk_bf16_f32 v4, v8, v9
  v_cvt_pk_bf16_f32 v5, v10, v11
  v_mfma_f32_16x16x32_bf16 a[152:155], v[220:223], v[128:131], a[152:155]
  ds_read_b64_tr_b16 v[216:217], v69 offset:17408
  v_cvt_pk_bf16_f32 v6, v12, v13
  v_cvt_pk_bf16_f32 v7, v14, v15
  v_mfma_f32_16x16x32_bf16 a[156:159], v[220:223], v[132:135], a[156:159]
  ds_read_b64_tr_b16 v[218:219], v69 offset:21504
  s_add_u32 s67, s92, 16384
  s_cmp_eq_u32 s60, 0
  s_cbranch_scc1 L_own8
  buffer_store_dwordx4 v[0:3], v80, s[28:31], s67 offen sc1
  buffer_store_dwordx4 v[4:7], v80, s[28:31], s67 offen offset:1024 sc1
L_ownr8:
  s_waitcnt lgkmcnt(10)
  v_mfma_f32_16x16x32_bf16 a[160:163], v[192:195], v[104:107], a[160:163]
  ds_read_b64_tr_b16 v[220:221], v234 offset:16384
  v_mfma_f32_16x16x32_bf16 a[164:167], v[192:195], v[108:111], a[164:167]
  ds_read_b64_tr_b16 v[222:223], v234 offset:20480
  v_mfma_f32_16x16x32_bf16 a[160:163], v[196:199], v[112:115], a[160:163]
  ds_read_b64_tr_b16 v[192:193], v70 offset:8704
  v_accvgpr_read_b32 v16, a144
  v_mfma_f32_16x16x32_bf16 a[164:167], v[196:199], v[116:119], a[164:167]
  ds_read_b64_tr_b16 v[194:195], v70 offset:12800
  v_accvgpr_read_b32 v17, a145
  v_accvgpr_read_b32 v18, a146
  s_waitcnt lgkmcnt(10)
  v_mfma_f32_16x16x32_bf16 a[160:163], v[200:203], v[120:123], a[160:163]
  ds_read_b64_tr_b16 v[196:197], v235 offset:8192
  v_accvgpr_read_b32 v19, a147
  v_accvgpr_read_b32 v20, a152
  v_mfma_f32_16x16x32_bf16 a[164:167], v[200:203], v[124:127], a[164:167]
  ds_read_b64_tr_b16 v[198:199], v235 offset:12288
  v_accvgpr_read_b32 v21, a153
  v_accvgpr_read_b32 v22, a154
  v_mfma_f32_16x16x32_bf16 a[160:163], v[204:207], v[128:131], a[160:163]
  ds_read_b64_tr_b16 v[200:201], v70 offset:17408
  v_accvgpr_read_b32 v23, a155
  v_accvgpr_read_b32 v24, a148
  v_mfma_f32_16x16x32_bf16 a[164:167], v[204:207], v[132:135], a[164:167]
  ds_read_b64_tr_b16 v[202:203], v70 offset:21504
  v_accvgpr_read_b32 v25, a149
  v_accvgpr_read_b32 v26, a150
  s_waitcnt lgkmcnt(10)
  v_mfma_f32_16x16x32_bf16 a[168:171], v[208:211], v[104:107], a[168:171]
  ds_read_b64_tr_b16 v[204:205], v235 offset:16384
  v_accvgpr_read_b32 v27, a151
  v_accvgpr_read_b32 v28, a156
  v_mfma_f32_16x16x32_bf16 a[172:175], v[208:211], v[108:111], a[172:175]
  ds_read_b64_tr_b16 v[206:207], v235 offset:20480
  v_accvgpr_read_b32 v29, a157
  v_mfma_f32_16x16x32_bf16 a[168:171], v[212:215], v[112:115], a[168:171]
  ds_read_b64_tr_b16 v[208:209], v71 offset:8704
  v_accvgpr_read_b32 v30, a158
  v_accvgpr_read_b32 v31, a159
  v_mfma_f32_16x16x32_bf16 a[172:175], v[212:215], v[116:119], a[172:175]
  ds_read_b64_tr_b16 v[210:211], v71 offset:12800
  v_cvt_pk_bf16_f32 v16, v16, v17
  v_cvt_pk_bf16_f32 v17, v18, v19
  s_waitcnt lgkmcnt(10)
  v_mfma_f32_16x16x32_bf16 a[168:171], v[216:219], v[120:123], a[168:171]
  ds_read_b64_tr_b16 v[212:213], v236 offset:8192
  v_cvt_pk_bf16_f32 v18, v20, v21
  v_cvt_pk_bf16_f32 v19, v22, v23
  v_mfma_f32_16x16x32_bf16 a[172:175], v[216:219], v[124:127], a[172:175]
  ds_read_b64_tr_b16 v[214:215], v236 offset:12288
  v_cvt_pk_bf16_f32 v20, v24, v25
  v_cvt_pk_bf16_f32 v21, v26, v27
  v_mfma_f32_16x16x32_bf16 a[168:171], v[220:223], v[128:131], a[168:171]
  ds_read_b64_tr_b16 v[216:217], v71 offset:17408
  v_cvt_pk_bf16_f32 v22, v28, v29
  v_cvt_pk_bf16_f32 v23, v30, v31
  v_mfma_f32_16x16x32_bf16 a[172:175], v[220:223], v[132:135], a[172:175]
  ds_read_b64_tr_b16 v[218:219], v71 offset:21504
  s_add_u32 s67, s92, 18432
  s_cmp_eq_u32 s60, 1
  s_cbranch_scc1 L_own9
  buffer_store_dwordx4 v[16:19], v80, s[28:31], s67 offen sc1
  buffer_store_dwordx4 v[20:23], v80, s[28:31], s67 offen offset:1024 sc1
L_ownr9:
  s_waitcnt lgkmcnt(10)
  v_mfma_f32_16x16x32_bf16 a[176:179], v[192:195], v[104:107], a[176:179]
  ds_read_b64_tr_b16 v[220:221], v236 offset:16384
  v_mfma_f32_16x16x32_bf16 a[180:183], v[192:195], v[108:111], a[180:183]
  ds_read_b64_tr_b16 v[222:223], v236 offset:20480
  v_mfma_f32_16x16x32_bf16 a[176:179], v[196:199], v[112:115], a[176:179]
  ds_read_b64_tr_b16 v[192:193], v64 offset:26112
  v_accvgpr_read_b32 v32, a160
  v_mfma_f32_16x16x32_bf16 a[180:183], v[196:199], v[116:119], a[180:183]
  ds_read_b64_tr_b16 v[194:195], v64 offset:30208
  v_accvgpr_read_b32 v33, a161
  v_accvgpr_read_b32 v34, a162
  s_waitcnt lgkmcnt(10)
  v_mfma_f32_16x16x32_bf16 a[176:179], v[200:203], v[120:123], a[176:179]
  ds_read_b64_tr_b16 v[196:197], v229 offset:24576
  v_accvgpr_read_b32 v35, a163
  v_accvgpr_read_b32 v36, a168
  v_mfma_f32_16x16x32_bf16 a[180:183], v[200:203], v[124:127], a[180:183]
  ds_read_b64_tr_b16 v[198:199], v229 offset:28672
  v_accvgpr_read_b32 v37, a169
  v_accvgpr_read_b32 v38, a170
  v_mfma_f32_16x16x32_bf16 a[176:179], v[204:207], v[128:131], a[176:179]
  ds_read_b64_tr_b16 v[200:201], v229 offset:57344
  v_accvgpr_read_b32 v39, a171
  v_accvgpr_read_b32 v40, a164
  v_mfma_f32_16x16x32_bf16 a[180:183], v[204:207], v[132:135], a[180:183]
  ds_read_b64_tr_b16 v[202:203], v229 offset:61440
  v_accvgpr_read_b32 v41, a165
  v_accvgpr_read_b32 v42, a166
  s_waitcnt lgkmcnt(10)
  v_mfma_f32_16x16x32_bf16 a[184:187], v[208:211], v[104:107], a[184:187]
  ds_read_b64_tr_b16 v[204:205], v64 offset:0
  v_accvgpr_read_b32 v43, a167
  v_accvgpr_read_b32 v44, a172
  v_mfma_f32_16x16x32_bf16 a[188:191], v[208:211], v[108:111], a[188:191]
  ds_read_b64_tr_b16 v[206:207], v64 offset:4096
  v_accvgpr_read_b32 v45, a173
  v_mfma_f32_16x16x32_bf16 a[184:187], v[212:215], v[112:115], a[184:187]
  ds_read_b64_tr_b16 v[208:209], v65 offset:26112
  v_accvgpr_read_b32 v46, a174
  v_accvgpr_read_b32 v47, a175
  v_mfma_f32_16x16x32_bf16 a[188:191], v[212:215], v[116:119], a[188:191]
  ds_read_b64_tr_b16 v[210:211], v65 offset:30208
  v_cvt_pk_bf16_f32 v32, v32, v33
  v_cvt_pk_bf16_f32 v33, v34, v35
  s_waitcnt lgkmcnt(10)
  v_mfma_f32_16x16x32_bf16 a[184:187], v[216:219], v[120:123], a[184:187]
  ds_read_b64_tr_b16 v[212:213], v230 offset:24576
  v_cvt_pk_bf16_f32 v34, v36, v37
  v_cvt_pk_bf16_f32 v35, v38, v39
  v_mfma_f32_16x16x32_bf16 a[188:191], v[216:219], v[124:127], a[188:191]
  ds_read_b64_tr_b16 v[214:215], v230 offset:28672
  v_cvt_pk_bf16_f32 v36, v40, v41
  v_cvt_pk_bf16_f32 v37, v42, v43
  v_mfma_f32_16x16x32_bf16 a[184:187], v[220:223], v[128:131], a[184:187]
  ds_read_b64_tr_b16 v[216:217], v230 offset:57344
  v_cvt_pk_bf16_f32 v38, v44, v45
  v_cvt_pk_bf16_f32 v39, v46, v47
  v_mfma_f32_16x16x32_bf16 a[188:191], v[220:223], v[132:135], a[188:191]
  ds_read_b64_tr_b16 v[218:219], v230 offset:61440
  s_add_u32 s67, s92, 20480
  s_cmp_eq_u32 s60, 2
  s_cbranch_scc1 L_own10
  buffer_store_dwordx4 v[32:35], v80, s[28:31], s67 offen sc1
  buffer_store_dwordx4 v[36:39], v80, s[28:31], s67 offen offset:1024 sc1
L_ownr10:
  s_waitcnt lgkmcnt(10)
  v_mfma_f32_16x16x32_bf16 a[192:195], v[192:195], v[104:107], a[192:195]
  ds_read_b64_tr_b16 v[220:221], v65 offset:0
  v_mfma_f32_16x16x32_bf16 a[196:199], v[192:195], v[108:111], a[196:199]
  ds_read_b64_tr_b16 v[222:223], v65 offset:4096
  v_mfma_f32_16x16x32_bf16 a[192:195], v[196:199], v[112:115], a[192:195]
  ds_read_b64_tr_b16 v[192:193], v66 offset:26112
  v_accvgpr_read_b32 v48, a176
  v_mfma_f32_16x16x32_bf16 a[196:199], v[196:199], v[116:119], a[196:199]
  ds_read_b64_tr_b16 v[194:195], v66 offset:30208
  v_accvgpr_read_b32 v49, a177
  v_accvgpr_read_b32 v50, a178
  s_waitcnt lgkmcnt(10)
  v_mfma_f32_16x16x32_bf16 a[192:195], v[200:203], v[120:123], a[192:195]
  ds_read_b64_tr_b16 v[196:197], v231 offset:24576
  v_accvgpr_read_b32 v51, a179
  v_accvgpr_read_b32 v52, a184
  v_mfma_f32_16x16x32_bf16 a[196:199], v[200:203], v[124:127], a[196:199]
  ds_read_b64_tr_b16 v[198:199], v231 offset:28672
  v_accvgpr_read_b32 v53, a185
  v_accvgpr_read_b32 v54, a186
  v_mfma_f32_16x16x32_bf16 a[192:195], v[204:207], v[128:131], a[192:195]
  ds_read_b64_tr_b16 v[200:201], v231 offset:57344
  v_accvgpr_read_b32 v55, a187
  v_accvgpr_read_b32 v56, a180
  v_mfma_f32_16x16x32_bf16 a[196:199], v[204:207], v[132:135], a[196:199]
  ds_read_b64_tr_b16 v[202:203], v231 offset:61440
  v_accvgpr_read_b32 v57, a181
  v_accvgpr_read_b32 v58, a182
  s_waitcnt lgkmcnt(10)
  v_mfma_f32_16x16x32_bf16 a[200:203], v[208:211], v[104:107], a[200:203]
  ds_read_b64_tr_b16 v[204:205], v66 offset:0
  v_accvgpr_read_b32 v59, a183
  v_accvgpr_read_b32 v60, a188
  v_mfma_f32_16x16x32_bf16 a[204:207], v[208:211], v[108:111], a[204:207]
  ds_read_b64_tr_b16 v[206:207], v66 offset:4096
  v_accvgpr_read_b32 v61, a189
  v_mfma_f32_16x16x32_bf16 a[200:203], v[212:215], v[112:115], a[200:203]
  ds_read_b64_tr_b16 v[208:209], v67 offset:26112
  v_accvgpr_read_b32 v62, a190
  v_accvgpr_read_b32 v63, a191
  v_mfma_f32_16x16x32_bf16 a[204:207], v[212:215], v[116:119], a[204:207]
  ds_read_b64_tr_b16 v[210:211], v67 offset:30208
  v_cvt_pk_bf16_f32 v48, v48, v49
  v_cvt_pk_bf16_f32 v49, v50, v51
  s_waitcnt lgkmcnt(10)
  v_mfma_f32_16x16x32_bf16 a[200:203], v[216:219], v[120:123], a[200:203]
  ds_read_b64_tr_b16 v[212:213], v232 offset:24576
  v_cvt_pk_bf16_f32 v50, v52, v53
  v_cvt_pk_bf16_f32 v51, v54, v55
  v_mfma_f32_16x16x32_bf16 a[204:207], v[216:219], v[124:127], a[204:207]
  ds_read_b64_tr_b16 v[214:215], v232 offset:28672
  v_cvt_pk_bf16_f32 v52, v56, v57
  v_cvt_pk_bf16_f32 v53, v58, v59
  v_mfma_f32_16x16x32_bf16 a[200:203], v[220:223], v[128:131], a[200:203]
  ds_read_b64_tr_b16 v[216:217], v232 offset:57344
  v_cvt_pk_bf16_f32 v54, v60, v61
  v_cvt_pk_bf16_f32 v55, v62, v63
  v_mfma_f32_16x16x32_bf16 a[204:207], v[220:223], v[132:135], a[204:207]
  ds_read_b64_tr_b16 v[218:219], v232 offset:61440
  s_add_u32 s67, s92, 22528
  s_cmp_eq_u32 s60, 3
  s_cbranch_scc1 L_own11
  buffer_store_dwordx4 v[48:51], v80, s[28:31], s67 offen sc1
  buffer_store_dwordx4 v[52:55], v80, s[28:31], s67 offen offset:1024 sc1
L_ownr11:
  s_waitcnt lgkmcnt(10)
  v_mfma_f32_16x16x32_bf16 a[208:211], v[192:195], v[104:107], a[208:211]
  ds_read_b64_tr_b16 v[220:221], v67 offset:0
  v_mfma_f32_16x16x32_bf16 a[212:215], v[192:195], v[108:111], a[212:215]
  ds_read_b64_tr_b16 v[222:223], v67 offset:4096
  v_mfma_f32_16x16x32_bf16 a[208:211], v[196:199], v[112:115], a[208:211]
  ds_read_b64_tr_b16 v[192:193], v68 offset:26112
  v_accvgpr_read_b32 v0, a192
  v_mfma_f32_16x16x32_bf16 a[212:215], v[196:199], v[116:119], a[212:215]
  ds_read_b64_tr_b16 v[194:195], v68 offset:30208
  v_accvgpr_read_b32 v1, a193
  v_accvgpr_read_b32 v2, a194
  s_waitcnt lgkmcnt(10)
  v_mfma_f32_16x16x32_bf16 a[208:211], v[200:203], v[120:123], a[208:211]
  ds_read_b64_tr_b16 v[196:197], v233 offset:24576
  v_accvgpr_read_b32 v3, a195
  v_accvgpr_read_b32 v4, a200
  v_mfma_f32_16x16x32_bf16 a[212:215], v[200:203], v[124:127], a[212:215]
  ds_read_b64_tr_b16 v[198:199], v233 offset:28672
  v_accvgpr_read_b32 v5, a201
  v_accvgpr_read_b32 v6, a202
  v_mfma_f32_16x16x32_bf16 a[208:211], v[204:207], v[128:131], a[208:211]
  ds_read_b64_tr_b16 v[200:201], v233 offset:57344
  v_accvgpr_read_b32 v7, a203
  v_accvgpr_read_b32 v8, a196
  v_mfma_f32_16x16x32_bf16 a[212:215], v[204:207], v[132:135], a[212:215]
  ds_read_b64_tr_b16 v[202:203], v233 offset:61440
  v_accvgpr_read_b32 v9, a197
  v_accvgpr_read_b32 v10, a198
  s_waitcnt lgkmcnt(10)
  v_mfma_f32_16x16x32_bf16 a[216:219], v[208:211], v[104:107], a[216:219]
  ds_read_b64_tr_b16 v[204:205], v68 offset:0
  v_accvgpr_read_b32 v11, a199
  v_accvgpr_read_b32 v12, a204
  v_mfma_f32_16x16x32_bf16 a[220:223], v[208:211], v[108:111], a[220:223]
  ds_read_b64_tr_b16 v[206:207], v68 offset:4096
  v_accvgpr_read_b32 v13, a205
  v_mfma_f32_16x16x32_bf16 a[216:219], v[212:215], v[112:115], a[216:219]
  ds_read_b64_tr_b16 v[208:209], v69 offset:26112
  v_accvgpr_read_b32 v14, a206
  v_accvgpr_read_b32 v15, a207
  v_mfma_f32_16x16x32_bf16 a[220:223], v[212:215], v[116:119], a[220:223]
  ds_read_b64_tr_b16 v[210:211], v69 offset:30208
  v_cvt_pk_bf16_f32 v0, v0, v1
  v_cvt_pk_bf16_f32 v1, v2, v3
  s_waitcnt lgkmcnt(10)
  v_mfma_f32_16x16x32_bf16 a[216:219], v[216:219], v[120:123], a[216:219]
  ds_read_b64_tr_b16 v[212:213], v234 offset:24576
  v_cvt_pk_bf16_f32 v2, v4, v5
  v_cvt_pk_bf16_f32 v3, v6, v7
  v_mfma_f32_16x16x32_bf16 a[220:223], v[216:219], v[124:127], a[220:223]
  ds_read_b64_tr_b16 v[214:215], v234 offset:28672
  v_cvt_pk_bf16_f32 v4, v8, v9
  v_cvt_pk_bf16_f32 v5, v10, v11
  v_mfma_f32_16x16x32_bf16 a[216:219], v[220:223], v[128:131], a[216:219]
  ds_read_b64_tr_b16 v[216:217], v234 offset:57344
  v_cvt_pk_bf16_f32 v6, v12, v13
  v_cvt_pk_bf16_f32 v7, v14, v15
  v_mfma_f32_16x16x32_bf16 a[220:223], v[220:223], v[132:135], a[220:223]
  ds_read_b64_tr_b16 v[218:219], v234 offset:61440
  s_add_u32 s67, s92, 24576
  s_cmp_eq_u32 s60, 4
  s_cbranch_scc1 L_own12
  buffer_store_dwordx4 v[0:3], v80, s[28:31], s67 offen sc1
  buffer_store_dwordx4 v[4:7], v80, s[28:31], s67 offen offset:1024 sc1
L_ownr12:
  s_waitcnt lgkmcnt(10)
  v_mfma_f32_16x16x32_bf16 a[224:227], v[192:195], v[104:107], a[224:227]
  ds_read_b64_tr_b16 v[220:221], v69 offset:0
  v_mfma_f32_16x16x32_bf16 a[228:231], v[192:195], v[108:111], a[228:231]
  ds_read_b64_tr_b16 v[222:223], v69 offset:4096
  v_mfma_f32_16x16x32_bf16 a[224:227], v[196:199], v[112:115], a[224:227]
  ds_read_b64_tr_b16 v[192:193], v70 offset:26112
  v_accvgpr_read_b32 v16, a208
  v_mfma_f32_16x16x32_bf16 a[228:231], v[196:199], v[116:119], a[228:231]
  ds_read_b64_tr_b16 v[194:195], v70 offset:30208
  v_accvgpr_read_b32 v17, a209
  v_accvgpr_read_b32 v18, a210
  s_waitcnt lgkmcnt(10)
  v_mfma_f32_16x16x32_bf16 a[224:227], v[200:203], v[120:123], a[224:227]
  ds_read_b64_tr_b16 v[196:197], v235 offset:24576
  v_accvgpr_read_b32 v19, a211
  v_accvgpr_read_b32 v20, a216
  v_mfma_f32_16x16x32_bf16 a[228:231], v[200:203], v[124:127], a[228:231]
  ds_read_b64_tr_b16 v[198:199], v235 offset:28672
  v_accvgpr_read_b32 v21, a217
  v_accvgpr_read_b32 v22, a218
  v_mfma_f32_16x16x32_bf16 a[224:227], v[204:207], v[128:131], a[224:227]
  ds_read_b64_tr_b16 v[200:201], v235 offset:57344
  v_accvgpr_read_b32 v23, a219
  v_accvgpr_read_b32 v24, a212
  v_mfma_f32_16x16x32_bf16 a[228:231], v[204:207], v[132:135], a[228:231]
  ds_read_b64_tr_b16 v[202:203], v235 offset:61440
  v_accvgpr_read_b32 v25, a213
  v_accvgpr_read_b32 v26, a214
  s_waitcnt lgkmcnt(10)
  v_mfma_f32_16x16x32_bf16 a[232:235], v[208:211], v[104:107], a[232:235]
  ds_read_b64_tr_b16 v[204:205], v70 offset:0
  v_accvgpr_read_b32 v27, a215
  v_accvgpr_read_b32 v28, a220
  v_mfma_f32_16x16x32_bf16 a[236:239], v[208:211], v[108:111], a[236:239]
  ds_read_b64_tr_b16 v[206:207], v70 offset:4096
  v_accvgpr_read_b32 v29, a221
  v_mfma_f32_16x16x32_bf16 a[232:235], v[212:215], v[112:115], a[232:235]
  ds_read_b64_tr_b16 v[208:209], v71 offset:26112
  v_accvgpr_read_b32 v30, a222
  v_accvgpr_read_b32 v31, a223
  v_mfma_f32_16x16x32_bf16 a[236:239], v[212:215], v[116:119], a[236:239]
  ds_read_b64_tr_b16 v[210:211], v71 offset:30208
  v_cvt_pk_bf16_f32 v16, v16, v17
  v_cvt_pk_bf16_f32 v17, v18, v19
  s_waitcnt lgkmcnt(10)
  v_mfma_f32_16x16x32_bf16 a[232:235], v[216:219], v[120:123], a[232:235]
  ds_read_b64_tr_b16 v[212:213], v236 offset:24576
  v_cvt_pk_bf16_f32 v18, v20, v21
  v_cvt_pk_bf16_f32 v19, v22, v23
  v_mfma_f32_16x16x32_bf16 a[236:239], v[216:219], v[124:127], a[236:239]
  ds_read_b64_tr_b16 v[214:215], v236 offset:28672
  v_cvt_pk_bf16_f32 v20, v24, v25
  v_cvt_pk_bf16_f32 v21, v26, v27
  v_mfma_f32_16x16x32_bf16 a[232:235], v[220:223], v[128:131], a[232:235]
  ds_read_b64_tr_b16 v[216:217], v236 offset:57344
  v_cvt_pk_bf16_f32 v22, v28, v29
  v_cvt_pk_bf16_f32 v23, v30, v31
  v_mfma_f32_16x16x32_bf16 a[236:239], v[220:223], v[132:135], a[236:239]
  ds_read_b64_tr_b16 v[218:219], v236 offset:61440
  s_add_u32 s67, s92, 26624
  s_cmp_eq_u32 s60, 5
  s_cbranch_scc1 L_own13
  buffer_store_dwordx4 v[16:19], v80, s[28:31], s67 offen sc1
  buffer_store_dwordx4 v[20:23], v80, s[28:31], s67 offen offset:1024 sc1
L_ownr13:
  s_waitcnt lgkmcnt(10)
  v_mfma_f32_16x16x32_bf16 a[240:243], v[192:195], v[104:107], a[240:243]
  ds_read_b64_tr_b16 v[220:221], v71 offset:0
  v_mfma_f32_16x16x32_bf16 a[244:247], v[192:195], v[108:111], a[244:247]
  ds_read_b64_tr_b16 v[222:223], v71 offset:4096
  v_mfma_f32_16x16x32_bf16 a[240:243], v[196:199], v[112:115], a[240:243]
  v_accvgpr_read_b32 v32, a224
  v_mfma_f32_16x16x32_bf16 a[244:247], v[196:199], v[116:119], a[244:247]
  v_accvgpr_read_b32 v33, a225
  v_accvgpr_read_b32 v34, a226
  s_waitcnt lgkmcnt(8)
  v_mfma_f32_16x16x32_bf16 a[240:243], v[200:203], v[120:123], a[240:243]
  v_accvgpr_read_b32 v35, a227
  v_accvgpr_read_b32 v36, a232
  v_mfma_f32_16x16x32_bf16 a[244:247], v[200:203], v[124:127], a[244:247]
  v_accvgpr_read_b32 v37, a233
  v_accvgpr_read_b32 v38, a234
  v_mfma_f32_16x16x32_bf16 a[240:243], v[204:207], v[128:131], a[240:243]
  v_accvgpr_read_b32 v39, a235
  v_accvgpr_read_b32 v40, a228
  v_mfma_f32_16x16x32_bf16 a[244:247], v[204:207], v[132:135], a[244:247]
  v_accvgpr_read_b32 v41, a229
  v_accvgpr_read_b32 v42, a230
  s_waitcnt lgkmcnt(4)
  v_mfma_f32_16x16x32_bf16 a[248:251], v[208:211], v[104:107], a[248:251]
  v_accvgpr_read_b32 v43, a231
  v_accvgpr_read_b32 v44, a236
  v_mfma_f32_16x16x32_bf16 a[252:255], v[208:211], v[108:111], a[252:255]
  v_accvgpr_read_b32 v45, a237
  v_mfma_f32_16x16x32_bf16 a[248:251], v[212:215], v[112:115], a[248:251]
  v_accvgpr_read_b32 v46, a238
  v_accvgpr_read_b32 v47, a239
  v_mfma_f32_16x16x32_bf16 a[252:255], v[212:215], v[116:119], a[252:255]
  v_cvt_pk_bf16_f32 v32, v32, v33
  v_cvt_pk_bf16_f32 v33, v34, v35
  s_waitcnt lgkmcnt(0)
  v_mfma_f32_16x16x32_bf16 a[248:251], v[216:219], v[120:123], a[248:251]
  v_cvt_pk_bf16_f32 v34, v36, v37
  v_cvt_pk_bf16_f32 v35, v38, v39
  v_mfma_f32_16x16x32_bf16 a[252:255], v[216:219], v[124:127], a[252:255]
  v_cvt_pk_bf16_f32 v36, v40, v41
  v_cvt_pk_bf16_f32 v37, v42, v43
  v_mfma_f32_16x16x32_bf16 a[248:251], v[220:223], v[128:131], a[248:251]
  v_cvt_pk_bf16_f32 v38, v44, v45
  v_cvt_pk_bf16_f32 v39, v46, v47
  v_mfma_f32_16x16x32_bf16 a[252:255], v[220:223], v[132:135], a[252:255]
  s_add_u32 s67, s92, 28672
  s_cmp_eq_u32 s60, 6
  s_cbranch_scc1 L_own14
  buffer_store_dwordx4 v[32:35], v80, s[28:31], s67 offen sc1
  buffer_store_dwordx4 v[36:39], v80, s[28:31], s67 offen offset:1024 sc1
L_ownr14:
  v_accvgpr_read_b32 v48, a240
  v_accvgpr_read_b32 v49, a241
  v_accvgpr_read_b32 v50, a242
  v_accvgpr_read_b32 v51, a243
  v_accvgpr_read_b32 v52, a248
  v_accvgpr_read_b32 v53, a249
  v_accvgpr_read_b32 v54, a250
  v_accvgpr_read_b32 v55, a251
  v_accvgpr_read_b32 v56, a244
  v_accvgpr_read_b32 v57, a245
  v_accvgpr_read_b32 v58, a246
  v_accvgpr_read_b32 v59, a247
  v_accvgpr_read_b32 v60, a252
  v_accvgpr_read_b32 v61, a253
  v_accvgpr_read_b32 v62, a254
  v_accvgpr_read_b32 v63, a255
  v_cvt_pk_bf16_f32 v48, v48, v49
  v_cvt_pk_bf16_f32 v49, v50, v51
  v_cvt_pk_bf16_f32 v50, v52, v53
  v_cvt_pk_bf16_f32 v51, v54, v55
  v_cvt_pk_bf16_f32 v52, v56, v57
  v_cvt_pk_bf16_f32 v53, v58, v59
  v_cvt_pk_bf16_f32 v54, v60, v61
  v_cvt_pk_bf16_f32 v55, v62, v63
  s_add_u32 s67, s92, 30720
  s_cmp_eq_u32 s60, 7
  s_cbranch_scc1 L_own15
  buffer_store_dwordx4 v[48:51], v80, s[28:31], s67 offen sc1
  buffer_store_dwordx4 v[52:55], v80, s[28:31], s67 offen offset:1024 sc1
L_ownr15:
  v_mbcnt_lo_u32_b32 v96, -1, 0
  v_mbcnt_hi_u32_b32 v96, -1, v96
  v_lshlrev_b32 v97, 4, v96
  v_bfe_u32 v109, v96, 4, 1
  v_lshrrev_b32 v108, 5, v96
  v_lshl_add_u32 v108, v109, 1, v108
  v_and_b32 v98, 15, v96
  v_lshlrev_b32 v98, 11, v98
  v_lshl_add_u32 v98, v108, 4, v98
  s_mul_i32 s74, s3, 786432
  s_lshl_b32 s68, s60, 11
  s_add_u32 s74, s74, s68
  s_mul_i32 s75, s61, 196608
  s_lshl_b32 s68, s62, 10
  s_add_u32 s75, s75, s68
  s_xor_b32 s67, s60, s52
  s_lshl_b32 s68, s67, 6
  s_add_u32 s75, s75, s68
  s_lshl_b32 s68, s63, 15
  s_add_u32 s74, s74, s68
  s_lshl_b32 s68, s63, 16
  s_add_u32 s75, s75, s68
  s_mov_b32 s76, 0xffff0000
  s_mov_b32 s77, 0x00003f80
  s_mov_b32 s78, 0x3f800000
  v_add_u32 v99, 34816, v97
  s_lshl_b32 s68, s63, 11
  v_add_u32 v99, s68, v99
  s_xor_b32 s68, s60, 1
  s_mul_i32 s68, s68, 98304
  s_add_u32 s80, s74, s68
  s_xor_b32 s68, s60, 2
  s_mul_i32 s68, s68, 98304
  s_add_u32 s81, s74, s68
  s_xor_b32 s68, s60, 3
  s_mul_i32 s68, s68, 98304
  s_add_u32 s82, s74, s68
  s_xor_b32 s68, s60, 4
  s_mul_i32 s68, s68, 98304
  s_add_u32 s83, s74, s68
  s_xor_b32 s68, s60, 5
  s_mul_i32 s68, s68, 98304
  s_add_u32 s84, s74, s68
  s_xor_b32 s68, s60, 6
  s_mul_i32 s68, s68, 98304
  s_add_u32 s85, s74, s68
  s_xor_b32 s68, s60, 7
  s_mul_i32 s68, s68, 98304
  s_add_u32 s86, s74, s68
  v_mov_b32 v84, 157696
  v_mov_b32 v85, 1
  s_waitcnt vmcnt(0) lgkmcnt(0)
  s_mov_b64 exec, 1
  ds_add_rtn_u32 v86, v84, v85
  s_waitcnt lgkmcnt(0)
  v_readfirstlane_b32 s67, v86
  s_nop 2
  s_cmp_lt_u32 s67, 2
  s_cbranch_scc1 L_cpoll_done
  s_lshl_b32 s67, s3, 8
  s_add_u32 s67, s67, 25165824
  v_mov_b32 v87, s67
  v_mov_b32 v88, 1
  buffer_atomic_add v88, v87, s[28:31], 0 offen sc0 sc1
  s_waitcnt vmcnt(0)
  v_readfirstlane_b32 s67, v88
  s_nop 2
  s_cmp_ge_u32 s67, 7
  s_cbranch_scc1 L_cpoll_done
L_cpoll:
  buffer_load_dword v89, v87, s[28:31], 0 offen sc1
  s_waitcnt vmcnt(0)
  v_readfirstlane_b32 s67, v89
  s_nop 2
  s_cmp_ge_u32 s67, 8
  s_cbranch_scc1 L_cpoll_done
  s_sleep 2
  s_branch L_cpoll
L_cpoll_done:
  s_mov_b64 exec, -1
  s_barrier
  s_add_u32 s67, s80, 16384
  buffer_load_dwordx4 v[116:119], v97, s[28:31], s67 offen offset:0 sc1
  s_add_u32 s67, s81, 16384
  buffer_load_dwordx4 v[120:123], v97, s[28:31], s67 offen offset:0 sc1
  s_add_u32 s67, s82, 16384
  buffer_load_dwordx4 v[124:127], v97, s[28:31], s67 offen offset:0 sc1
  s_add_u32 s67, s83, 16384
  buffer_load_dwordx4 v[128:131], v97, s[28:31], s67 offen offset:0 sc1
  s_add_u32 s67, s84, 16384
  buffer_load_dwordx4 v[132:135], v97, s[28:31], s67 offen offset:0 sc1
  s_add_u32 s67, s85, 16384
  buffer_load_dwordx4 v[136:139], v97, s[28:31], s67 offen offset:0 sc1
  s_add_u32 s67, s86, 16384
  buffer_load_dwordx4 v[140:143], v97, s[28:31], s67 offen offset:0 sc1
  s_add_u32 s67, s80, 16384
  buffer_load_dwordx4 v[148:151], v97, s[28:31], s67 offen offset:1024 sc1
  s_add_u32 s67, s81, 16384
  buffer_load_dwordx4 v[152:155], v97, s[28:31], s67 offen offset:1024 sc1
  s_add_u32 s67, s82, 16384
  buffer_load_dwordx4 v[156:159], v97, s[28:31], s67 offen offset:1024 sc1
  s_add_u32 s67, s83, 16384
  buffer_load_dwordx4 v[160:163], v97, s[28:31], s67 offen offset:1024 sc1
  s_add_u32 s67, s84, 16384
  buffer_load_dwordx4 v[164:167], v97, s[28:31], s67 offen offset:1024 sc1
  s_add_u32 s67, s85, 16384
  buffer_load_dwordx4 v[168:171], v97, s[28:31], s67 offen offset:1024 sc1
  s_add_u32 s67, s86, 16384
  buffer_load_dwordx4 v[172:175], v97, s[28:31], s67 offen offset:1024 sc1
  s_add_u32 s67, s80, 0
  buffer_load_dwordx4 v[180:183], v97, s[28:31], s67 offen offset:0 sc1
  s_add_u32 s67, s81, 0
  buffer_load_dwordx4 v[184:187], v97, s[28:31], s67 offen offset:0 sc1
  s_add_u32 s67, s82, 0
  buffer_load_dwordx4 v[188:191], v97, s[28:31], s67 offen offset:0 sc1
  s_add_u32 s67, s83, 0
  buffer_load_dwordx4 v[192:195], v97, s[28:31], s67 offen offset:0 sc1
  s_add_u32 s67, s84, 0
  buffer_load_dwordx4 v[196:199], v97, s[28:31], s67 offen offset:0 sc1
  s_add_u32 s67, s85, 0
  buffer_load_dwordx4 v[200:203], v97, s[28:31], s67 offen offset:0 sc1
  s_add_u32 s67, s86, 0
  buffer_load_dwordx4 v[204:207], v97, s[28:31], s67 offen offset:0 sc1
  ds_read_b128 v[112:115], v99 offset:32768
  ds_read_b128 v[144:147], v99 offset:33792
  ds_read_b128 v[176:179], v99 offset:0
  s_waitcnt lgkmcnt(2)
  v_lshlrev_b32 v100, 16, v112
  v_and_b32 v101, s76, v112
  v_lshlrev_b32 v102, 16, v113
  v_and_b32 v103, s76, v113
  v_lshlrev_b32 v104, 16, v114
  v_and_b32 v105, s76, v114
  v_lshlrev_b32 v106, 16, v115
  v_and_b32 v107, s76, v115
  s_waitcnt vmcnt(20)
  v_dot2_f32_bf16 v100, v116, s77, v100
  v_dot2_f32_bf16 v101, v116, s78, v101
  v_dot2_f32_bf16 v102, v117, s77, v102
  v_dot2_f32_bf16 v103, v117, s78, v103
  v_dot2_f32_bf16 v104, v118, s77, v104
  v_dot2_f32_bf16 v105, v118, s78, v105
  v_dot2_f32_bf16 v106, v119, s77, v106
  v_dot2_f32_bf16 v107, v119, s78, v107
  s_waitcnt vmcnt(19)
  v_dot2_f32_bf16 v100, v120, s77, v100
  v_dot2_f32_bf16 v101, v120, s78, v101
  v_dot2_f32_bf16 v102, v121, s77, v102
  v_dot2_f32_bf16 v103, v121, s78, v103
  v_dot2_f32_bf16 v104, v122, s77, v104
  v_dot2_f32_bf16 v105, v122, s78, v105
  v_dot2_f32_bf16 v106, v123, s77, v106
  v_dot2_f32_bf16 v107, v123, s78, v107
  s_waitcnt vmcnt(18)
  v_dot2_f32_bf16 v100, v124, s77, v100
  v_dot2_f32_bf16 v101, v124, s78, v101
  v_dot2_f32_bf16 v102, v125, s77, v102
  v_dot2_f32_bf16 v103, v125, s78, v103
  v_dot2_f32_bf16 v104, v126, s77, v104
  v_dot2_f32_bf16 v105, v126, s78, v105
  v_dot2_f32_bf16 v106, v127, s77, v106
  v_dot2_f32_bf16 v107, v127, s78, v107
  s_waitcnt vmcnt(17)
  v_dot2_f32_bf16 v100, v128, s77, v100
  v_dot2_f32_bf16 v101, v128, s78, v101
  v_dot2_f32_bf16 v102, v129, s77, v102
  v_dot2_f32_bf16 v103, v129, s78, v103
  v_dot2_f32_bf16 v104, v130, s77, v104
  v_dot2_f32_bf16 v105, v130, s78, v105
  v_dot2_f32_bf16 v106, v131, s77, v106
  v_dot2_f32_bf16 v107, v131, s78, v107
  s_waitcnt vmcnt(16)
  v_dot2_f32_bf16 v100, v132, s77, v100
  v_dot2_f32_bf16 v101, v132, s78, v101
  v_dot2_f32_bf16 v102, v133, s77, v102
  v_dot2_f32_bf16 v103, v133, s78, v103
  v_dot2_f32_bf16 v104, v134, s77, v104
  v_dot2_f32_bf16 v105, v134, s78, v105
  v_dot2_f32_bf16 v106, v135, s77, v106
  v_dot2_f32_bf16 v107, v135, s78, v107
  s_waitcnt vmcnt(15)
  v_dot2_f32_bf16 v100, v136, s77, v100
  v_dot2_f32_bf16 v101, v136, s78, v101
  v_dot2_f32_bf16 v102, v137, s77, v102
  v_dot2_f32_bf16 v103, v137, s78, v103
  v_dot2_f32_bf16 v104, v138, s77, v104
  v_dot2_f32_bf16 v105, v138, s78, v105
  v_dot2_f32_bf16 v106, v139, s77, v106
  v_dot2_f32_bf16 v107, v139, s78, v107
  s_waitcnt vmcnt(14)
  v_dot2_f32_bf16 v100, v140, s77, v100
  v_dot2_f32_bf16 v101, v140, s78, v101
  v_dot2_f32_bf16 v102, v141, s77, v102
  v_dot2_f32_bf16 v103, v141, s78, v103
  v_dot2_f32_bf16 v104, v142, s77, v104
  v_dot2_f32_bf16 v105, v142, s78, v105
  v_dot2_f32_bf16 v106, v143, s77, v106
  v_dot2_f32_bf16 v107, v143, s78, v107
  s_add_u32 s67, s75, 512
  s_nop 2
  v_cvt_pk_bf16_f32 v112, v100, v101
  v_cvt_pk_bf16_f32 v113, v102, v103
  v_cvt_pk_bf16_f32 v114, v104, v105
  v_cvt_pk_bf16_f32 v115, v106, v107
  s_nop 0
  v_permlane16_swap_b32 v112, v114
  v_permlane16_swap_b32 v113, v115
  buffer_store_dwordx4 v[112:115], v98, s[32:35], s67 offen
  s_waitcnt lgkmcnt(1)
  v_lshlrev_b32 v100, 16, v144
  v_and_b32 v101, s76, v144
  v_lshlrev_b32 v102, 16, v145
  v_and_b32 v103, s76, v145
  v_lshlrev_b32 v104, 16, v146
  v_and_b32 v105, s76, v146
  v_lshlrev_b32 v106, 16, v147
  v_and_b32 v107, s76, v147
  s_waitcnt vmcnt(14)
  v_dot2_f32_bf16 v100, v148, s77, v100
  v_dot2_f32_bf16 v101, v148, s78, v101
  v_dot2_f32_bf16 v102, v149, s77, v102
  v_dot2_f32_bf16 v103, v149, s78, v103
  v_dot2_f32_bf16 v104, v150, s77, v104
  v_dot2_f32_bf16 v105, v150, s78, v105
  v_dot2_f32_bf16 v106, v151, s77, v106
  v_dot2_f32_bf16 v107, v151, s78, v107
  s_waitcnt vmcnt(13)
  v_dot2_f32_bf16 v100, v152, s77, v100
  v_dot2_f32_bf16 v101, v152, s78, v101
  v_dot2_f32_bf16 v102, v153, s77, v102
  v_dot2_f32_bf16 v103, v153, s78, v103
  v_dot2_f32_bf16 v104, v154, s77, v104
  v_dot2_f32_bf16 v105, v154, s78, v105
  v_dot2_f32_bf16 v106, v155, s77, v106
  v_dot2_f32_bf16 v107, v155, s78, v107
  s_waitcnt vmcnt(12)
  v_dot2_f32_bf16 v100, v156, s77, v100
  v_dot2_f32_bf16 v101, v156, s78, v101
  v_dot2_f32_bf16 v102, v157, s77, v102
  v_dot2_f32_bf16 v103, v157, s78, v103
  v_dot2_f32_bf16 v104, v158, s77, v104
  v_dot2_f32_bf16 v105, v158, s78, v105
  v_dot2_f32_bf16 v106, v159, s77, v106
  v_dot2_f32_bf16 v107, v159, s78, v107
  s_waitcnt vmcnt(11)
  v_dot2_f32_bf16 v100, v160, s77, v100
  v_dot2_f32_bf16 v101, v160, s78, v101
  v_dot2_f32_bf16 v102, v161, s77, v102
  v_dot2_f32_bf16 v103, v161, s78, v103
  v_dot2_f32_bf16 v104, v162, s77, v104
  v_dot2_f32_bf16 v105, v162, s78, v105
  v_dot2_f32_bf16 v106, v163, s77, v106
  v_dot2_f32_bf16 v107, v163, s78, v107
  s_waitcnt vmcnt(10)
  v_dot2_f32_bf16 v100, v164, s77, v100
  v_dot2_f32_bf16 v101, v164, s78, v101
  v_dot2_f32_bf16 v102, v165, s77, v102
  v_dot2_f32_bf16 v103, v165, s78, v103
  v_dot2_f32_bf16 v104, v166, s77, v104
  v_dot2_f32_bf16 v105, v166, s78, v105
  v_dot2_f32_bf16 v106, v167, s77, v106
  v_dot2_f32_bf16 v107, v167, s78, v107
  s_waitcnt vmcnt(9)
  v_dot2_f32_bf16 v100, v168, s77, v100
  v_dot2_f32_bf16 v101, v168, s78, v101
  v_dot2_f32_bf16 v102, v169, s77, v102
  v_dot2_f32_bf16 v103, v169, s78, v103
  v_dot2_f32_bf16 v104, v170, s77, v104
  v_dot2_f32_bf16 v105, v170, s78, v105
  v_dot2_f32_bf16 v106, v171, s77, v106
  v_dot2_f32_bf16 v107, v171, s78, v107
  s_waitcnt vmcnt(8)
  v_dot2_f32_bf16 v100, v172, s77, v100
  v_dot2_f32_bf16 v101, v172, s78, v101
  v_dot2_f32_bf16 v102, v173, s77, v102
  v_dot2_f32_bf16 v103, v173, s78, v103
  v_dot2_f32_bf16 v104, v174, s77, v104
  v_dot2_f32_bf16 v105, v174, s78, v105
  v_dot2_f32_bf16 v106, v175, s77, v106
  v_dot2_f32_bf16 v107, v175, s78, v107
  s_add_u32 s67, s75, 33280
  s_nop 2
  v_cvt_pk_bf16_f32 v144, v100, v101
  v_cvt_pk_bf16_f32 v145, v102, v103
  v_cvt_pk_bf16_f32 v146, v104, v105
  v_cvt_pk_bf16_f32 v147, v106, v107
  s_nop 0
  v_permlane16_swap_b32 v144, v146
  v_permlane16_swap_b32 v145, v147
  buffer_store_dwordx4 v[144:147], v98, s[32:35], s67 offen
  s_waitcnt lgkmcnt(0)
  v_lshlrev_b32 v100, 16, v176
  v_and_b32 v101, s76, v176
  v_lshlrev_b32 v102, 16, v177
  v_and_b32 v103, s76, v177
  v_lshlrev_b32 v104, 16, v178
  v_and_b32 v105, s76, v178
  v_lshlrev_b32 v106, 16, v179
  v_and_b32 v107, s76, v179
  s_waitcnt vmcnt(8)
  v_dot2_f32_bf16 v100, v180, s77, v100
  v_dot2_f32_bf16 v101, v180, s78, v101
  v_dot2_f32_bf16 v102, v181, s77, v102
  v_dot2_f32_bf16 v103, v181, s78, v103
  v_dot2_f32_bf16 v104, v182, s77, v104
  v_dot2_f32_bf16 v105, v182, s78, v105
  v_dot2_f32_bf16 v106, v183, s77, v106
  v_dot2_f32_bf16 v107, v183, s78, v107
  s_waitcnt vmcnt(7)
  v_dot2_f32_bf16 v100, v184, s77, v100
  v_dot2_f32_bf16 v101, v184, s78, v101
  v_dot2_f32_bf16 v102, v185, s77, v102
  v_dot2_f32_bf16 v103, v185, s78, v103
  v_dot2_f32_bf16 v104, v186, s77, v104
  v_dot2_f32_bf16 v105, v186, s78, v105
  v_dot2_f32_bf16 v106, v187, s77, v106
  v_dot2_f32_bf16 v107, v187, s78, v107
  s_waitcnt vmcnt(6)
  v_dot2_f32_bf16 v100, v188, s77, v100
  v_dot2_f32_bf16 v101, v188, s78, v101
  v_dot2_f32_bf16 v102, v189, s77, v102
  v_dot2_f32_bf16 v103, v189, s78, v103
  v_dot2_f32_bf16 v104, v190, s77, v104
  v_dot2_f32_bf16 v105, v190, s78, v105
  v_dot2_f32_bf16 v106, v191, s77, v106
  v_dot2_f32_bf16 v107, v191, s78, v107
  s_waitcnt vmcnt(5)
  v_dot2_f32_bf16 v100, v192, s77, v100
  v_dot2_f32_bf16 v101, v192, s78, v101
  v_dot2_f32_bf16 v102, v193, s77, v102
  v_dot2_f32_bf16 v103, v193, s78, v103
  v_dot2_f32_bf16 v104, v194, s77, v104
  v_dot2_f32_bf16 v105, v194, s78, v105
  v_dot2_f32_bf16 v106, v195, s77, v106
  v_dot2_f32_bf16 v107, v195, s78, v107
  s_waitcnt vmcnt(4)
  v_dot2_f32_bf16 v100, v196, s77, v100
  v_dot2_f32_bf16 v101, v196, s78, v101
  v_dot2_f32_bf16 v102, v197, s77, v102
  v_dot2_f32_bf16 v103, v197, s78, v103
  v_dot2_f32_bf16 v104, v198, s77, v104
  v_dot2_f32_bf16 v105, v198, s78, v105
  v_dot2_f32_bf16 v106, v199, s77, v106
  v_dot2_f32_bf16 v107, v199, s78, v107
  s_waitcnt vmcnt(3)
  v_dot2_f32_bf16 v100, v200, s77, v100
  v_dot2_f32_bf16 v101, v200, s78, v101
  v_dot2_f32_bf16 v102, v201, s77, v102
  v_dot2_f32_bf16 v103, v201, s78, v103
  v_dot2_f32_bf16 v104, v202, s77, v104
  v_dot2_f32_bf16 v105, v202, s78, v105
  v_dot2_f32_bf16 v106, v203, s77, v106
  v_dot2_f32_bf16 v107, v203, s78, v107
  s_waitcnt vmcnt(2)
  v_dot2_f32_bf16 v100, v204, s77, v100
  v_dot2_f32_bf16 v101, v204, s78, v101
  v_dot2_f32_bf16 v102, v205, s77, v102
  v_dot2_f32_bf16 v103, v205, s78, v103
  v_dot2_f32_bf16 v104, v206, s77, v104
  v_dot2_f32_bf16 v105, v206, s78, v105
  v_dot2_f32_bf16 v106, v207, s77, v106
  v_dot2_f32_bf16 v107, v207, s78, v107
  s_add_u32 s67, s75, 0
  s_nop 2
  v_cvt_pk_bf16_f32 v176, v100, v101
  v_cvt_pk_bf16_f32 v177, v102, v103
  v_cvt_pk_bf16_f32 v178, v104, v105
  v_cvt_pk_bf16_f32 v179, v106, v107
  s_nop 0
  v_permlane16_swap_b32 v176, v178
  v_permlane16_swap_b32 v177, v179
  buffer_store_dwordx4 v[176:179], v98, s[32:35], s67 offen
  s_endpgm
L_own0:
  s_waitcnt lgkmcnt(8)
  ds_write_b128 v81, v[0:3] offset:0
  ds_write_b128 v81, v[4:7] offset:1024
  s_waitcnt lgkmcnt(0)
  s_branch L_ownr0
L_own1:
  s_waitcnt lgkmcnt(8)
  ds_write_b128 v81, v[16:19] offset:0
  ds_write_b128 v81, v[20:23] offset:1024
  s_waitcnt lgkmcnt(0)
  s_branch L_ownr1
L_own2:
  s_waitcnt lgkmcnt(8)
  ds_write_b128 v81, v[32:35] offset:0
  ds_write_b128 v81, v[36:39] offset:1024
  s_waitcnt lgkmcnt(0)
  s_branch L_ownr2
L_own3:
  s_waitcnt lgkmcnt(8)
  ds_write_b128 v81, v[48:51] offset:0
  ds_write_b128 v81, v[52:55] offset:1024
  s_waitcnt lgkmcnt(0)
  s_branch L_ownr3
L_own4:
  s_waitcnt lgkmcnt(8)
  ds_write_b128 v81, v[0:3] offset:0
  ds_write_b128 v81, v[4:7] offset:1024
  s_waitcnt lgkmcnt(0)
  s_branch L_ownr4
L_own5:
  s_waitcnt lgkmcnt(8)
  ds_write_b128 v81, v[16:19] offset:0
  ds_write_b128 v81, v[20:23] offset:1024
  s_waitcnt lgkmcnt(0)
  s_branch L_ownr5
L_own6:
  s_waitcnt lgkmcnt(8)
  ds_write_b128 v81, v[32:35] offset:0
  ds_write_b128 v81, v[36:39] offset:1024
  s_waitcnt lgkmcnt(0)
  s_branch L_ownr6
L_own7:
  s_waitcnt lgkmcnt(8)
  ds_write_b128 v81, v[48:51] offset:0
  ds_write_b128 v81, v[52:55] offset:1024
  s_waitcnt lgkmcnt(0)
  s_branch L_ownr7
L_own8:
  s_waitcnt lgkmcnt(8)
  ds_write_b128 v81, v[0:3] offset:32768
  ds_write_b128 v81, v[4:7] offset:33792
  s_waitcnt lgkmcnt(0)
  s_branch L_ownr8
L_own9:
  s_waitcnt lgkmcnt(8)
  ds_write_b128 v81, v[16:19] offset:32768
  ds_write_b128 v81, v[20:23] offset:33792
  s_waitcnt lgkmcnt(0)
  s_branch L_ownr9
L_own10:
  s_waitcnt lgkmcnt(8)
  ds_write_b128 v81, v[32:35] offset:32768
  ds_write_b128 v81, v[36:39] offset:33792
  s_waitcnt lgkmcnt(0)
  s_branch L_ownr10
L_own11:
  s_waitcnt lgkmcnt(8)
  ds_write_b128 v81, v[48:51] offset:32768
  ds_write_b128 v81, v[52:55] offset:33792
  s_waitcnt lgkmcnt(0)
  s_branch L_ownr11
L_own12:
  s_waitcnt lgkmcnt(8)
  ds_write_b128 v81, v[0:3] offset:32768
  ds_write_b128 v81, v[4:7] offset:33792
  s_waitcnt lgkmcnt(0)
  s_branch L_ownr12
L_own13:
  s_waitcnt lgkmcnt(8)
  ds_write_b128 v81, v[16:19] offset:32768
  ds_write_b128 v81, v[20:23] offset:33792
  s_waitcnt lgkmcnt(0)
  s_branch L_ownr13
L_own14:
  s_waitcnt lgkmcnt(8)
  ds_write_b128 v81, v[32:35] offset:32768
  ds_write_b128 v81, v[36:39] offset:33792
  s_waitcnt lgkmcnt(0)
  s_branch L_ownr14
L_own15:
  s_waitcnt lgkmcnt(8)
  ds_write_b128 v81, v[48:51] offset:32768
  ds_write_b128 v81, v[52:55] offset:33792
  s_waitcnt lgkmcnt(0)
  s_branch L_ownr15
L_cfirst:
  v_mov_b32 v224, v241
  v_mov_b32 v226, v242
  v_mov_b32 v225, v224
  v_mov_b32 v227, v226
  s_nop 0
  v_permlane32_swap_b32 v224, v225
  v_permlane32_swap_b32 v226, v227
  v_add_f32 v224, v224, v225
  v_add_f32 v226, v226, v227
  v_mov_b32 v225, v224
  v_mov_b32 v227, v226
  s_nop 0
  v_permlane16_swap_b32 v224, v225
  v_permlane16_swap_b32 v226, v227
  v_add_f32 v224, v224, v225
  v_add_f32 v226, v226, v227
  v_rcp_f32 v224, v224
  v_rcp_f32 v226, v226
  v_pk_mul_f32 v[0:1], v[0:1], v[224:225] op_sel_hi:[1,0]
  v_pk_mul_f32 v[2:3], v[2:3], v[224:225] op_sel_hi:[1,0]
  v_cvt_pk_bf16_f32 v104, v0, v1
  v_cvt_pk_bf16_f32 v105, v2, v3
  v_pk_mul_f32 v[4:5], v[4:5], v[226:227] op_sel_hi:[1,0]
  v_pk_mul_f32 v[6:7], v[6:7], v[226:227] op_sel_hi:[1,0]
  v_cvt_pk_bf16_f32 v108, v4, v5
  v_cvt_pk_bf16_f32 v109, v6, v7
  v_pk_mul_f32 v[8:9], v[8:9], v[224:225] op_sel_hi:[1,0]
  v_pk_mul_f32 v[10:11], v[10:11], v[224:225] op_sel_hi:[1,0]
  v_cvt_pk_bf16_f32 v106, v8, v9
  v_cvt_pk_bf16_f32 v107, v10, v11
  v_pk_mul_f32 v[12:13], v[12:13], v[226:227] op_sel_hi:[1,0]
  v_pk_mul_f32 v[14:15], v[14:15], v[226:227] op_sel_hi:[1,0]
  v_cvt_pk_bf16_f32 v110, v12, v13
  v_cvt_pk_bf16_f32 v111, v14, v15
  v_pk_mul_f32 v[16:17], v[16:17], v[224:225] op_sel_hi:[1,0]
  v_pk_mul_f32 v[18:19], v[18:19], v[224:225] op_sel_hi:[1,0]
  v_cvt_pk_bf16_f32 v112, v16, v17
  v_cvt_pk_bf16_f32 v113, v18, v19
  v_pk_mul_f32 v[20:21], v[20:21], v[226:227] op_sel_hi:[1,0]
  v_pk_mul_f32 v[22:23], v[22:23], v[226:227] op_sel_hi:[1,0]
  v_cvt_pk_bf16_f32 v116, v20, v21
  v_cvt_pk_bf16_f32 v117, v22, v23
  v_pk_mul_f32 v[24:25], v[24:25], v[224:225] op_sel_hi:[1,0]
  v_pk_mul_f32 v[26:27], v[26:27], v[224:225] op_sel_hi:[1,0]
  v_cvt_pk_bf16_f32 v114, v24, v25
  v_cvt_pk_bf16_f32 v115, v26, v27
  v_pk_mul_f32 v[28:29], v[28:29], v[226:227] op_sel_hi:[1,0]
  v_pk_mul_f32 v[30:31], v[30:31], v[226:227] op_sel_hi:[1,0]
  v_cvt_pk_bf16_f32 v118, v28, v29
  v_cvt_pk_bf16_f32 v119, v30, v31
  v_pk_mul_f32 v[32:33], v[32:33], v[224:225] op_sel_hi:[1,0]
  v_pk_mul_f32 v[34:35], v[34:35], v[224:225] op_sel_hi:[1,0]
  v_cvt_pk_bf16_f32 v120, v32, v33
  v_cvt_pk_bf16_f32 v121, v34, v35
  v_pk_mul_f32 v[36:37], v[36:37], v[226:227] op_sel_hi:[1,0]
  v_pk_mul_f32 v[38:39], v[38:39], v[226:227] op_sel_hi:[1,0]
  v_cvt_pk_bf16_f32 v124, v36, v37
  v_cvt_pk_bf16_f32 v125, v38, v39
  v_pk_mul_f32 v[40:41], v[40:41], v[224:225] op_sel_hi:[1,0]
  v_pk_mul_f32 v[42:43], v[42:43], v[224:225] op_sel_hi:[1,0]
  v_cvt_pk_bf16_f32 v122, v40, v41
  v_cvt_pk_bf16_f32 v123, v42, v43
  v_pk_mul_f32 v[44:45], v[44:45], v[226:227] op_sel_hi:[1,0]
  v_pk_mul_f32 v[46:47], v[46:47], v[226:227] op_sel_hi:[1,0]
  v_cvt_pk_bf16_f32 v126, v44, v45
  v_cvt_pk_bf16_f32 v127, v46, v47
  v_pk_mul_f32 v[48:49], v[48:49], v[224:225] op_sel_hi:[1,0]
  v_pk_mul_f32 v[50:51], v[50:51], v[224:225] op_sel_hi:[1,0]
  v_cvt_pk_bf16_f32 v128, v48, v49
  v_cvt_pk_bf16_f32 v129, v50, v51
  v_pk_mul_f32 v[52:53], v[52:53], v[226:227] op_sel_hi:[1,0]
  v_pk_mul_f32 v[54:55], v[54:55], v[226:227] op_sel_hi:[1,0]
  v_cvt_pk_bf16_f32 v132, v52, v53
  v_cvt_pk_bf16_f32 v133, v54, v55
  v_pk_mul_f32 v[56:57], v[56:57], v[224:225] op_sel_hi:[1,0]
  v_pk_mul_f32 v[58:59], v[58:59], v[224:225] op_sel_hi:[1,0]
  v_cvt_pk_bf16_f32 v130, v56, v57
  v_cvt_pk_bf16_f32 v131, v58, v59
  v_pk_mul_f32 v[60:61], v[60:61], v[226:227] op_sel_hi:[1,0]
  v_pk_mul_f32 v[62:63], v[62:63], v[226:227] op_sel_hi:[1,0]
  v_cvt_pk_bf16_f32 v134, v60, v61
  v_cvt_pk_bf16_f32 v135, v62, v63
  s_or_b64 s[38:39], s[38:39], vcc
  s_cbranch_scc1 T_f1
  v_pk_mul_f32 v[0:1], v[168:169], v[168:169]
  v_pk_mul_f32 v[2:3], v[168:169], v[168:169]
  v_pk_mul_f32 v[4:5], v[168:169], v[168:169]
  v_pk_mul_f32 v[6:7], v[168:169], v[168:169]
  v_pk_mul_f32 v[8:9], v[168:169], v[168:169]
  v_pk_mul_f32 v[10:11], v[168:169], v[168:169]
  v_pk_mul_f32 v[12:13], v[168:169], v[168:169]
  v_pk_mul_f32 v[14:15], v[168:169], v[168:169]
  v_pk_mul_f32 v[16:17], v[168:169], v[168:169]
  v_pk_mul_f32 v[18:19], v[168:169], v[168:169]
  v_pk_mul_f32 v[20:21], v[168:169], v[168:169]
  v_pk_mul_f32 v[22:23], v[168:169], v[168:169]
  v_pk_mul_f32 v[24:25], v[168:169], v[168:169]
  v_pk_mul_f32 v[26:27], v[168:169], v[168:169]
  v_pk_mul_f32 v[28:29], v[168:169], v[168:169]
  v_pk_mul_f32 v[30:31], v[168:169], v[168:169]
  v_pk_mul_f32 v[32:33], v[168:169], v[168:169]
  v_pk_mul_f32 v[34:35], v[168:169], v[168:169]
  v_pk_mul_f32 v[36:37], v[168:169], v[168:169]
  v_pk_mul_f32 v[38:39], v[168:169], v[168:169]
  v_pk_mul_f32 v[40:41], v[168:169], v[168:169]
  v_pk_mul_f32 v[42:43], v[168:169], v[168:169]
  v_pk_mul_f32 v[44:45], v[168:169], v[168:169]
  v_pk_mul_f32 v[46:47], v[168:169], v[168:169]
  v_pk_mul_f32 v[48:49], v[168:169], v[168:169]
  v_pk_mul_f32 v[50:51], v[168:169], v[168:169]
  v_pk_mul_f32 v[52:53], v[168:169], v[168:169]
  v_pk_mul_f32 v[54:55], v[168:169], v[168:169]
  v_pk_mul_f32 v[56:57], v[168:169], v[168:169]
  v_pk_mul_f32 v[58:59], v[168:169], v[168:169]
  v_pk_mul_f32 v[60:61], v[168:169], v[168:169]
  v_pk_mul_f32 v[62:63], v[168:169], v[168:169]
  v_mov_b32 v241, v243
  v_mov_b32 v242, v244
  s_nop 1
  s_branch R_p1
T_h1:
  s_mov_b32 s95, 0
  s_mov_b32 s36, 1.0
  s_mov_b32 s66, 0xff800000
  s_branch L_rare0
T_h3:
  s_mov_b32 s95, 1
  s_mov_b32 s36, 1.0
  s_branch L_rare0
T_h5:
  s_mov_b32 s95, 2
  s_mov_b32 s36, 1.0
  s_branch L_rare0
T_h7:
  s_mov_b32 s95, 3
  s_mov_b32 s36, 1.0
  s_branch L_rare0
T_h9:
  s_mov_b32 s95, 4
  s_mov_b32 s36, 1.0
  s_branch L_rare0
T_h11:
  s_mov_b32 s95, 5
  s_mov_b32 s36, 1.0
  s_branch L_rare0
T_h13:
  s_mov_b32 s95, 6
  s_mov_b32 s36, 1.0
  s_branch L_rare0
T_h15:
  s_mov_b32 s95, 7
  s_mov_b32 s36, 1.0
  s_branch L_rare0
T_p1:
  s_mov_b32 s95, 8
  s_mov_b32 s36, 1.0
  s_branch L_rare0
T_p3:
  s_mov_b32 s95, 9
  s_mov_b32 s36, 1.0
  s_branch L_rare0
T_f1:
  s_mov_b32 s95, 10
  s_mov_b32 s36, 1.0
  s_mov_b32 s66, 0xff800000
  s_branch L_rare0
L_rare0:
  v_max3_f32 v224, v136, v137, v138
  v_max3_f32 v226, v140, v141, v142
  v_max3_f32 v225, v139, v144, v145
  v_max3_f32 v227, v143, v148, v149
  v_max3_f32 v224, v224, v146, v147
  v_max3_f32 v226, v226, v150, v151
  v_max3_f32 v224, v224, v225, s66
  v_max3_f32 v226, v226, v227, s66
  v_mov_b32 v225, v224
  v_mov_b32 v227, v226
  s_nop 0
  v_permlane32_swap_b32 v224, v225
  v_permlane32_swap_b32 v226, v227
  v_max_f32 v224, v224, v225
  v_max_f32 v226, v226, v227
  v_mov_b32 v225, v224
  v_mov_b32 v227, v226
  s_nop 0
  v_permlane16_swap_b32 v224, v225
  v_permlane16_swap_b32 v226, v227
  v_max_f32 v224, v224, v225
  v_max_f32 v226, v226, v227
  v_sub_f32 v246, s66, v224
  v_sub_f32 v248, s66, v226
  v_sub_f32 v224, 0, v224
  v_sub_f32 v226, 0, v226
  v_exp_f32 v246, v246
  v_exp_f32 v248, v248
  v_pk_add_f32 v[136:137], v[136:137], v[224:225] op_sel_hi:[1,0]
  v_pk_add_f32 v[140:141], v[140:141], v[226:227] op_sel_hi:[1,0]
  v_pk_add_f32 v[138:139], v[138:139], v[224:225] op_sel_hi:[1,0]
  v_pk_add_f32 v[142:143], v[142:143], v[226:227] op_sel_hi:[1,0]
  v_pk_add_f32 v[144:145], v[144:145], v[224:225] op_sel_hi:[1,0]
  v_pk_add_f32 v[148:149], v[148:149], v[226:227] op_sel_hi:[1,0]
  v_pk_add_f32 v[146:147], v[146:147], v[224:225] op_sel_hi:[1,0]
  v_pk_add_f32 v[150:151], v[150:151], v[226:227] op_sel_hi:[1,0]
  v_mul_f32 v224, s36, v224
  v_mul_f32 v226, s36, v226
  v_pk_add_f32 v[168:169], v[168:169], v[224:225] op_sel_hi:[1,0]
  v_pk_add_f32 v[172:173], v[172:173], v[226:227] op_sel_hi:[1,0]
  v_pk_add_f32 v[170:171], v[170:171], v[224:225] op_sel_hi:[1,0]
  v_pk_add_f32 v[174:175], v[174:175], v[226:227] op_sel_hi:[1,0]
  v_pk_add_f32 v[152:153], v[152:153], v[224:225] op_sel_hi:[1,0]
  v_pk_add_f32 v[156:157], v[156:157], v[226:227] op_sel_hi:[1,0]
  v_pk_add_f32 v[154:155], v[154:155], v[224:225] op_sel_hi:[1,0]
  v_pk_add_f32 v[158:159], v[158:159], v[226:227] op_sel_hi:[1,0]
  v_pk_add_f32 v[160:161], v[160:161], v[224:225] op_sel_hi:[1,0]
  v_pk_add_f32 v[164:165], v[164:165], v[226:227] op_sel_hi:[1,0]
  v_pk_add_f32 v[162:163], v[162:163], v[224:225] op_sel_hi:[1,0]
  v_pk_add_f32 v[166:167], v[166:167], v[226:227] op_sel_hi:[1,0]
  v_exp_f32 v136, v136
  v_exp_f32 v137, v137
  v_exp_f32 v138, v138
  v_add_f32 v243, v136, v137
  v_exp_f32 v139, v139
  v_cvt_pk_bf16_f32 v176, v136, v137
  v_exp_f32 v144, v144
  v_add_f32 v243, v243, v138
  v_exp_f32 v145, v145
  v_cvt_pk_bf16_f32 v177, v138, v139
  v_add_f32 v243, v243, v139
  v_exp_f32 v146, v146
  v_add_f32 v243, v243, v144
  v_exp_f32 v147, v147
  v_cvt_pk_bf16_f32 v178, v144, v145
  v_add_f32 v243, v243, v145
  v_exp_f32 v140, v140
  v_add_f32 v243, v243, v146
  v_exp_f32 v141, v141
  v_cvt_pk_bf16_f32 v179, v146, v147
  v_add_f32 v243, v243, v147
  v_exp_f32 v142, v142
  v_add_f32 v244, v140, v141
  v_exp_f32 v143, v143
  v_cvt_pk_bf16_f32 v180, v140, v141
  v_exp_f32 v148, v148
  v_add_f32 v244, v244, v142
  v_exp_f32 v149, v149
  v_cvt_pk_bf16_f32 v181, v142, v143
  v_add_f32 v244, v244, v143
  v_exp_f32 v150, v150
  v_add_f32 v244, v244, v148
  v_exp_f32 v151, v151
  v_cvt_pk_bf16_f32 v182, v148, v149
  v_add_f32 v244, v244, v149
  v_add_f32 v244, v244, v150
  v_cvt_pk_bf16_f32 v183, v150, v151
  v_add_f32 v244, v244, v151
  v_add_f32 v245, v243, v244
  v_pk_mul_f32 v[0:1], v[0:1], v[246:247] op_sel_hi:[1,0]
  v_pk_mul_f32 v[2:3], v[2:3], v[246:247] op_sel_hi:[1,0]
  v_pk_mul_f32 v[4:5], v[4:5], v[248:249] op_sel_hi:[1,0]
  v_pk_mul_f32 v[6:7], v[6:7], v[248:249] op_sel_hi:[1,0]
  v_pk_mul_f32 v[8:9], v[8:9], v[246:247] op_sel_hi:[1,0]
  v_pk_mul_f32 v[10:11], v[10:11], v[246:247] op_sel_hi:[1,0]
  v_pk_mul_f32 v[12:13], v[12:13], v[248:249] op_sel_hi:[1,0]
  v_pk_mul_f32 v[14:15], v[14:15], v[248:249] op_sel_hi:[1,0]
  v_pk_mul_f32 v[16:17], v[16:17], v[246:247] op_sel_hi:[1,0]
  v_pk_mul_f32 v[18:19], v[18:19], v[246:247] op_sel_hi:[1,0]
  v_pk_mul_f32 v[20:21], v[20:21], v[248:249] op_sel_hi:[1,0]
  v_pk_mul_f32 v[22:23], v[22:23], v[248:249] op_sel_hi:[1,0]
  v_pk_mul_f32 v[24:25], v[24:25], v[246:247] op_sel_hi:[1,0]
  v_pk_mul_f32 v[26:27], v[26:27], v[246:247] op_sel_hi:[1,0]
  v_pk_mul_f32 v[28:29], v[28:29], v[248:249] op_sel_hi:[1,0]
  v_pk_mul_f32 v[30:31], v[30:31], v[248:249] op_sel_hi:[1,0]
  v_pk_mul_f32 v[32:33], v[32:33], v[246:247] op_sel_hi:[1,0]
  v_pk_mul_f32 v[34:35], v[34:35], v[246:247] op_sel_hi:[1,0]
  v_pk_mul_f32 v[36:37], v[36:37], v[248:249] op_sel_hi:[1,0]
  v_pk_mul_f32 v[38:39], v[38:39], v[248:249] op_sel_hi:[1,0]
  v_pk_mul_f32 v[40:41], v[40:41], v[246:247] op_sel_hi:[1,0]
  v_pk_mul_f32 v[42:43], v[42:43], v[246:247] op_sel_hi:[1,0]
  v_pk_mul_f32 v[44:45], v[44:45], v[248:249] op_sel_hi:[1,0]
  v_pk_mul_f32 v[46:47], v[46:47], v[248:249] op_sel_hi:[1,0]
  v_pk_mul_f32 v[48:49], v[48:49], v[246:247] op_sel_hi:[1,0]
  v_pk_mul_f32 v[50:51], v[50:51], v[246:247] op_sel_hi:[1,0]
  v_pk_mul_f32 v[52:53], v[52:53], v[248:249] op_sel_hi:[1,0]
  v_pk_mul_f32 v[54:55], v[54:55], v[248:249] op_sel_hi:[1,0]
  v_pk_mul_f32 v[56:57], v[56:57], v[246:247] op_sel_hi:[1,0]
  v_pk_mul_f32 v[58:59], v[58:59], v[246:247] op_sel_hi:[1,0]
  v_pk_mul_f32 v[60:61], v[60:61], v[248:249] op_sel_hi:[1,0]
  v_pk_mul_f32 v[62:63], v[62:63], v[248:249] op_sel_hi:[1,0]
  v_fma_f32 v241, v241, v246, v243
  v_fma_f32 v242, v242, v248, v244
  s_mov_b32 s66, 0
  s_nop 0
  s_cmp_eq_u32 s95, 0
  s_cbranch_scc1 R_h1
  s_cmp_eq_u32 s95, 1
  s_cbranch_scc1 R_h3
  s_cmp_eq_u32 s95, 2
  s_cbranch_scc1 R_h5
  s_cmp_eq_u32 s95, 3
  s_cbranch_scc1 R_h7
  s_cmp_eq_u32 s95, 4
  s_cbranch_scc1 R_h9
  s_cmp_eq_u32 s95, 5
  s_cbranch_scc1 R_h11
  s_cmp_eq_u32 s95, 6
  s_cbranch_scc1 R_h13
  s_cmp_eq_u32 s95, 7
  s_cbranch_scc1 R_h15
  s_cmp_eq_u32 s95, 8
  s_cbranch_scc1 R_p1
  s_cmp_eq_u32 s95, 9
  s_cbranch_scc1 R_p3
  s_branch R_p1
T_h2:
  s_mov_b32 s95, 0
  s_mov_b32 s36, 1.0
  s_branch L_rare1
T_h4:
  s_mov_b32 s95, 1
  s_mov_b32 s36, 1.0
  s_branch L_rare1
T_h6:
  s_mov_b32 s95, 2
  s_mov_b32 s36, 1.0
  s_branch L_rare1
T_h8:
  s_mov_b32 s95, 3
  s_mov_b32 s36, 1.0
  s_branch L_rare1
T_h10:
  s_mov_b32 s95, 4
  s_mov_b32 s36, 1.0
  s_branch L_rare1
T_h12:
  s_mov_b32 s95, 5
  s_mov_b32 s36, 1.0
  s_branch L_rare1
T_h14:
  s_mov_b32 s95, 6
  s_mov_b32 s36, 1.0
  s_branch L_rare1
T_p0:
  s_mov_b32 s95, 7
  s_and_b32 s67, s64, 15
  s_cselect_b32 s36, 1.0, 0
  s_branch L_rare1
T_p2:
  s_mov_b32 s95, 8
  s_mov_b32 s36, 1.0
  s_branch L_rare1
T_ep:
  s_mov_b32 s95, 9
  s_mov_b32 s36, 1.0
  s_branch L_rare1
L_rare1:
  v_max3_f32 v224, v152, v153, v154
  v_max3_f32 v226, v156, v157, v158
  v_max3_f32 v225, v155, v160, v161
  v_max3_f32 v227, v159, v164, v165
  v_max3_f32 v224, v224, v162, v163
  v_max3_f32 v226, v226, v166, v167
  v_max3_f32 v224, v224, v225, s66
  v_max3_f32 v226, v226, v227, s66
  v_mov_b32 v225, v224
  v_mov_b32 v227, v226
  s_nop 0
  v_permlane32_swap_b32 v224, v225
  v_permlane32_swap_b32 v226, v227
  v_max_f32 v224, v224, v225
  v_max_f32 v226, v226, v227
  v_mov_b32 v225, v224
  v_mov_b32 v227, v226
  s_nop 0
  v_permlane16_swap_b32 v224, v225
  v_permlane16_swap_b32 v226, v227
  v_max_f32 v224, v224, v225
  v_max_f32 v226, v226, v227
  v_sub_f32 v246, s66, v224
  v_sub_f32 v248, s66, v226
  v_sub_f32 v224, 0, v224
  v_sub_f32 v226, 0, v226
  v_exp_f32 v246, v246
  v_exp_f32 v248, v248
  v_pk_add_f32 v[152:153], v[152:153], v[224:225] op_sel_hi:[1,0]
  v_pk_add_f32 v[156:157], v[156:157], v[226:227] op_sel_hi:[1,0]
  v_pk_add_f32 v[154:155], v[154:155], v[224:225] op_sel_hi:[1,0]
  v_pk_add_f32 v[158:159], v[158:159], v[226:227] op_sel_hi:[1,0]
  v_pk_add_f32 v[160:161], v[160:161], v[224:225] op_sel_hi:[1,0]
  v_pk_add_f32 v[164:165], v[164:165], v[226:227] op_sel_hi:[1,0]
  v_pk_add_f32 v[162:163], v[162:163], v[224:225] op_sel_hi:[1,0]
  v_pk_add_f32 v[166:167], v[166:167], v[226:227] op_sel_hi:[1,0]
  v_mul_f32 v224, s36, v224
  v_mul_f32 v226, s36, v226
  v_pk_add_f32 v[168:169], v[168:169], v[224:225] op_sel_hi:[1,0]
  v_pk_add_f32 v[172:173], v[172:173], v[226:227] op_sel_hi:[1,0]
  v_pk_add_f32 v[170:171], v[170:171], v[224:225] op_sel_hi:[1,0]
  v_pk_add_f32 v[174:175], v[174:175], v[226:227] op_sel_hi:[1,0]
  v_pk_add_f32 v[136:137], v[136:137], v[224:225] op_sel_hi:[1,0]
  v_pk_add_f32 v[140:141], v[140:141], v[226:227] op_sel_hi:[1,0]
  v_pk_add_f32 v[138:139], v[138:139], v[224:225] op_sel_hi:[1,0]
  v_pk_add_f32 v[142:143], v[142:143], v[226:227] op_sel_hi:[1,0]
  v_pk_add_f32 v[144:145], v[144:145], v[224:225] op_sel_hi:[1,0]
  v_pk_add_f32 v[148:149], v[148:149], v[226:227] op_sel_hi:[1,0]
  v_pk_add_f32 v[146:147], v[146:147], v[224:225] op_sel_hi:[1,0]
  v_pk_add_f32 v[150:151], v[150:151], v[226:227] op_sel_hi:[1,0]
  v_exp_f32 v152, v152
  v_exp_f32 v153, v153
  v_exp_f32 v154, v154
  v_add_f32 v243, v152, v153
  v_exp_f32 v155, v155
  v_cvt_pk_bf16_f32 v184, v152, v153
  v_exp_f32 v160, v160
  v_add_f32 v243, v243, v154
  v_exp_f32 v161, v161
  v_cvt_pk_bf16_f32 v185, v154, v155
  v_add_f32 v243, v243, v155
  v_exp_f32 v162, v162
  v_add_f32 v243, v243, v160
  v_exp_f32 v163, v163
  v_cvt_pk_bf16_f32 v186, v160, v161
  v_add_f32 v243, v243, v161
  v_exp_f32 v156, v156
  v_add_f32 v243, v243, v162
  v_exp_f32 v157, v157
  v_cvt_pk_bf16_f32 v187, v162, v163
  v_add_f32 v243, v243, v163
  v_exp_f32 v158, v158
  v_add_f32 v244, v156, v157
  v_exp_f32 v159, v159
  v_cvt_pk_bf16_f32 v188, v156, v157
  v_exp_f32 v164, v164
  v_add_f32 v244, v244, v158
  v_exp_f32 v165, v165
  v_cvt_pk_bf16_f32 v189, v158, v159
  v_add_f32 v244, v244, v159
  v_exp_f32 v166, v166
  v_add_f32 v244, v244, v164
  v_exp_f32 v167, v167
  v_cvt_pk_bf16_f32 v190, v164, v165
  v_add_f32 v244, v244, v165
  v_add_f32 v244, v244, v166
  v_cvt_pk_bf16_f32 v191, v166, v167
  v_add_f32 v244, v244, v167
  v_add_f32 v245, v243, v244
  v_pk_mul_f32 v[0:1], v[0:1], v[246:247] op_sel_hi:[1,0]
  v_pk_mul_f32 v[2:3], v[2:3], v[246:247] op_sel_hi:[1,0]
  v_pk_mul_f32 v[4:5], v[4:5], v[248:249] op_sel_hi:[1,0]
  v_pk_mul_f32 v[6:7], v[6:7], v[248:249] op_sel_hi:[1,0]
  v_pk_mul_f32 v[8:9], v[8:9], v[246:247] op_sel_hi:[1,0]
  v_pk_mul_f32 v[10:11], v[10:11], v[246:247] op_sel_hi:[1,0]
  v_pk_mul_f32 v[12:13], v[12:13], v[248:249] op_sel_hi:[1,0]
  v_pk_mul_f32 v[14:15], v[14:15], v[248:249] op_sel_hi:[1,0]
  v_pk_mul_f32 v[16:17], v[16:17], v[246:247] op_sel_hi:[1,0]
  v_pk_mul_f32 v[18:19], v[18:19], v[246:247] op_sel_hi:[1,0]
  v_pk_mul_f32 v[20:21], v[20:21], v[248:249] op_sel_hi:[1,0]
  v_pk_mul_f32 v[22:23], v[22:23], v[248:249] op_sel_hi:[1,0]
  v_pk_mul_f32 v[24:25], v[24:25], v[246:247] op_sel_hi:[1,0]
  v_pk_mul_f32 v[26:27], v[26:27], v[246:247] op_sel_hi:[1,0]
  v_pk_mul_f32 v[28:29], v[28:29], v[248:249] op_sel_hi:[1,0]
  v_pk_mul_f32 v[30:31], v[30:31], v[248:249] op_sel_hi:[1,0]
  v_pk_mul_f32 v[32:33], v[32:33], v[246:247] op_sel_hi:[1,0]
  v_pk_mul_f32 v[34:35], v[34:35], v[246:247] op_sel_hi:[1,0]
  v_pk_mul_f32 v[36:37], v[36:37], v[248:249] op_sel_hi:[1,0]
  v_pk_mul_f32 v[38:39], v[38:39], v[248:249] op_sel_hi:[1,0]
  v_pk_mul_f32 v[40:41], v[40:41], v[246:247] op_sel_hi:[1,0]
  v_pk_mul_f32 v[42:43], v[42:43], v[246:247] op_sel_hi:[1,0]
  v_pk_mul_f32 v[44:45], v[44:45], v[248:249] op_sel_hi:[1,0]
  v_pk_mul_f32 v[46:47], v[46:47], v[248:249] op_sel_hi:[1,0]
  v_pk_mul_f32 v[48:49], v[48:49], v[246:247] op_sel_hi:[1,0]
  v_pk_mul_f32 v[50:51], v[50:51], v[246:247] op_sel_hi:[1,0]
  v_pk_mul_f32 v[52:53], v[52:53], v[248:249] op_sel_hi:[1,0]
  v_pk_mul_f32 v[54:55], v[54:55], v[248:249] op_sel_hi:[1,0]
  v_pk_mul_f32 v[56:57], v[56:57], v[246:247] op_sel_hi:[1,0]
  v_pk_mul_f32 v[58:59], v[58:59], v[246:247] op_sel_hi:[1,0]
  v_pk_mul_f32 v[60:61], v[60:61], v[248:249] op_sel_hi:[1,0]
  v_pk_mul_f32 v[62:63], v[62:63], v[248:249] op_sel_hi:[1,0]
  v_fma_f32 v241, v241, v246, v243
  v_fma_f32 v242, v242, v248, v244
  s_mov_b32 s66, 0
  s_nop 0
  s_cmp_eq_u32 s95, 0
  s_cbranch_scc1 R_h2
  s_cmp_eq_u32 s95, 1
  s_cbranch_scc1 R_h4
  s_cmp_eq_u32 s95, 2
  s_cbranch_scc1 R_h6
  s_cmp_eq_u32 s95, 3
  s_cbranch_scc1 R_h8
  s_cmp_eq_u32 s95, 4
  s_cbranch_scc1 R_h10
  s_cmp_eq_u32 s95, 5
  s_cbranch_scc1 R_h12
  s_cmp_eq_u32 s95, 6
  s_cbranch_scc1 R_h14
  s_cmp_eq_u32 s95, 7
  s_cbranch_scc1 R_p0
  s_cmp_eq_u32 s95, 8
  s_cbranch_scc1 R_p2
  s_branch R_ep
L_loader:
  s_nop 1
  v_bfe_u32 v96, v100, 4, 1
  v_lshlrev_b32 v96, 1, v96
  v_and_b32 v97, 7, v100
  v_xor_b32 v96, v96, v97
  v_lshlrev_b32 v96, 4, v96
  v_lshrrev_b32 v97, 3, v100
  v_lshl_add_u32 v118, v97, 13, v96
  v_xor_b32 v96, 64, v118
  v_add_u32 v119, 64512, v96
  v_add_u32 v120, 129024, v118
  v_add_u32 v121, 193536, v96
  v_lshrrev_b32 v96, 4, v100
  v_and_b32 v97, 7, v100
  v_xor_b32 v96, v96, v97
  v_lshlrev_b32 v96, 4, v96
  v_lshrrev_b32 v97, 3, v100
  v_lshl_add_u32 v16, v97, 10, v96
  v_xor_b32 v96, 64, v16
  v_add_u32 v17, 7168, v96
  v_add_u32 v18, 14336, v16
  v_add_u32 v19, 21504, v96
  s_mul_i32 s90, s61, 98304
  s_or_b32 s90, s90, s51
  s_lshl_b32 s91, s60, 10
  s_or_b32 s91, s91, s50
  s_mov_b32 m0, 34816
  s_xor_b32 s67, s90, 0
  buffer_load_dwordx4 v16, s[24:27], s67 offen offset:0 lds
  buffer_load_dwordx4 v17, s[24:27], s67 offen offset:1024 lds
  buffer_load_dwordx4 v18, s[24:27], s67 offen offset:2048 lds
  buffer_load_dwordx4 v19, s[24:27], s67 offen offset:3072 lds
  s_mov_b32 m0, 38912
  s_xor_b32 s67, s90, 0
  s_add_u32 s67, s67, 32768
  buffer_load_dwordx4 v16, s[24:27], s67 offen offset:0 lds
  buffer_load_dwordx4 v17, s[24:27], s67 offen offset:1024 lds
  buffer_load_dwordx4 v18, s[24:27], s67 offen offset:2048 lds
  buffer_load_dwordx4 v19, s[24:27], s67 offen offset:3072 lds
  s_mov_b32 m0, 43008
  s_xor_b32 s67, s90, 0
  s_add_u32 s67, s67, 65536
  buffer_load_dwordx4 v16, s[24:27], s67 offen offset:0 lds
  buffer_load_dwordx4 v17, s[24:27], s67 offen offset:1024 lds
  buffer_load_dwordx4 v18, s[24:27], s67 offen offset:2048 lds
  buffer_load_dwordx4 v19, s[24:27], s67 offen offset:3072 lds
  s_mov_b32 m0, 67584
  s_xor_b32 s67, s91, 0
  buffer_load_dwordx4 v118, s[16:19], s67 offen offset:0 lds
  buffer_load_dwordx4 v119, s[16:19], s67 offen offset:1024 lds
  buffer_load_dwordx4 v120, s[16:19], s67 offen offset:2048 lds
  buffer_load_dwordx4 v121, s[16:19], s67 offen offset:3072 lds
  s_mov_b32 m0, 71680
  s_xor_b32 s67, s91, 262144
  buffer_load_dwordx4 v118, s[16:19], s67 offen offset:0 lds
  buffer_load_dwordx4 v119, s[16:19], s67 offen offset:1024 lds
  buffer_load_dwordx4 v120, s[16:19], s67 offen offset:2048 lds
  buffer_load_dwordx4 v121, s[16:19], s67 offen offset:3072 lds
  s_mov_b32 m0, 75776
  s_xor_b32 s67, s91, 128
  buffer_load_dwordx4 v118, s[16:19], s67 offen offset:0 lds
  buffer_load_dwordx4 v119, s[16:19], s67 offen offset:1024 lds
  buffer_load_dwordx4 v120, s[16:19], s67 offen offset:2048 lds
  buffer_load_dwordx4 v121, s[16:19], s67 offen offset:3072 lds
  s_mov_b32 m0, 79872
  s_xor_b32 s67, s91, 262272
  buffer_load_dwordx4 v118, s[16:19], s67 offen offset:0 lds
  buffer_load_dwordx4 v119, s[16:19], s67 offen offset:1024 lds
  buffer_load_dwordx4 v120, s[16:19], s67 offen offset:2048 lds
  buffer_load_dwordx4 v121, s[16:19], s67 offen offset:3072 lds
  s_mov_b32 m0, 47104
  s_xor_b32 s67, s90, 128
  buffer_load_dwordx4 v16, s[24:27], s67 offen offset:0 lds
  buffer_load_dwordx4 v17, s[24:27], s67 offen offset:1024 lds
  buffer_load_dwordx4 v18, s[24:27], s67 offen offset:2048 lds
  buffer_load_dwordx4 v19, s[24:27], s67 offen offset:3072 lds
  s_mov_b32 m0, 51200
  s_xor_b32 s67, s90, 128
  s_add_u32 s67, s67, 32768
  buffer_load_dwordx4 v16, s[24:27], s67 offen offset:0 lds
  buffer_load_dwordx4 v17, s[24:27], s67 offen offset:1024 lds
  buffer_load_dwordx4 v18, s[24:27], s67 offen offset:2048 lds
  buffer_load_dwordx4 v19, s[24:27], s67 offen offset:3072 lds
  s_mov_b32 m0, 55296
  s_xor_b32 s67, s90, 128
  s_add_u32 s67, s67, 65536
  buffer_load_dwordx4 v16, s[24:27], s67 offen offset:0 lds
  buffer_load_dwordx4 v17, s[24:27], s67 offen offset:1024 lds
  buffer_load_dwordx4 v18, s[24:27], s67 offen offset:2048 lds
  buffer_load_dwordx4 v19, s[24:27], s67 offen offset:3072 lds
  s_mov_b32 m0, 100352
  s_xor_b32 s67, s91, 524288
  buffer_load_dwordx4 v118, s[16:19], s67 offen offset:0 lds
  buffer_load_dwordx4 v119, s[16:19], s67 offen offset:1024 lds
  buffer_load_dwordx4 v120, s[16:19], s67 offen offset:2048 lds
  buffer_load_dwordx4 v121, s[16:19], s67 offen offset:3072 lds
  s_mov_b32 m0, 104448
  s_xor_b32 s67, s91, 786432
  buffer_load_dwordx4 v118, s[16:19], s67 offen offset:0 lds
  buffer_load_dwordx4 v119, s[16:19], s67 offen offset:1024 lds
  buffer_load_dwordx4 v120, s[16:19], s67 offen offset:2048 lds
  buffer_load_dwordx4 v121, s[16:19], s67 offen offset:3072 lds
  s_mov_b32 m0, 108544
  s_xor_b32 s67, s91, 524416
  buffer_load_dwordx4 v118, s[16:19], s67 offen offset:0 lds
  buffer_load_dwordx4 v119, s[16:19], s67 offen offset:1024 lds
  buffer_load_dwordx4 v120, s[16:19], s67 offen offset:2048 lds
  buffer_load_dwordx4 v121, s[16:19], s67 offen offset:3072 lds
  s_mov_b32 m0, 112640
  s_xor_b32 s67, s91, 786560
  buffer_load_dwordx4 v118, s[16:19], s67 offen offset:0 lds
  buffer_load_dwordx4 v119, s[16:19], s67 offen offset:1024 lds
  buffer_load_dwordx4 v120, s[16:19], s67 offen offset:2048 lds
  buffer_load_dwordx4 v121, s[16:19], s67 offen offset:3072 lds
  v_lshrrev_b32 v96, 4, v100
  v_and_b32 v97, 15, v100
  v_xor_b32 v126, v96, v97
  v_lshlrev_b32 v126, 4, v126
  v_lshl_add_u32 v126, v96, 8, v126
  v_lshrrev_b32 v96, 4, v100
  v_lshlrev_b32 v97, 1, v96
  v_and_b32 v112, 15, v100
  v_xor_b32 v112, v112, v97
  v_lshlrev_b32 v112, 4, v112
  v_lshl_add_u32 v112, v96, 10, v112
  v_xor_b32 v96, 0x80, v112
  v_add_u32 v113, 3072, v96
  v_add_u32 v114, 6144, v112
  v_add_u32 v115, 9216, v96
  s_mov_b32 s70, s93
  v_lshrrev_b32 v96, 4, v100
  v_lshlrev_b32 v97, 1, v96
  v_and_b32 v116, 15, v100
  v_xor_b32 v116, v116, v97
  v_lshlrev_b32 v116, 4, v116
  v_lshl_add_u32 v116, v96, 8, v116
  v_xor_b32 v117, 0x80, v116
  s_lshl_b32 s86, s61, 22
  s_add_u32 s86, s86, s93
  s_mov_b32 s87, s86
  s_lshl_b32 s69, s60, 10
  s_add_u32 s69, s69, 256
  s_xor_b32 s37, s69, s50
  s_add_u32 s69, s69, 256
  s_xor_b32 s88, s69, s50
  s_add_u32 s69, s69, 128
  s_xor_b32 s89, s69, s50
  v_lshrrev_b32 v122, 4, v100
  v_lshlrev_b32 v122, 10, v122
  v_bfe_u32 v96, v100, 2, 2
  v_lshl_add_u32 v122, v96, 7, v122
  v_bfe_u32 v96, v100, 3, 2
  v_lshl_add_u32 v122, v96, 5, v122
  v_and_b32 v96, 3, v100
  v_lshl_add_u32 v122, v96, 3, v122
  v_add_u32 v122, 100352, v122
  v_xor_b32 v123, 32, v122
  v_xor_b32 v124, 64, v122
  v_xor_b32 v125, 96, v122
  v_lshrrev_b32 v127, 5, v100
  v_lshlrev_b32 v127, 9, v127
  v_and_b32 v96, 15, v100
  v_lshl_add_u32 v127, v96, 4, v127
  v_bfe_u32 v96, v100, 4, 1
  v_lshl_add_u32 v127, v96, 3, v127
  v_add_u32 v127, 0x20800, v127
  s_mov_b32 s41, 2048
  v_bfe_u32 v96, v100, 1, 3
  v_lshrrev_b32 v97, 4, v100
  v_xor_b32 v96, v96, v97
  v_lshlrev_b32 v96, 4, v96
  v_and_b32 v97, 15, v100
  v_lshl_add_u32 v104, v97, 7, v96
  v_add_u32 v104, 34816, v104
  v_xor_b32 v105, 64, v104
  v_add_u32 v106, 98304, v104
  v_add_u32 v107, 98304, v105
  s_cmp_lg_u32 s60, 0
  s_cbranch_scc1 L_noz
  s_lshl_b32 s67, s3, 8
  s_add_u32 s67, s67, 25165824
  v_lshlrev_b32 v8, 2, v100
  v_mov_b32 v9, 0
  buffer_store_dword v9, v8, s[28:31], s67 offen sc1
L_noz:
  s_waitcnt vmcnt(28)
  s_barrier
  ds_read_b128 a[0:3], v104 offset:0
  ds_read_b128 a[4:7], v104 offset:2048
  ds_read_b128 a[8:11], v104 offset:4096
  ds_read_b128 a[12:15], v104 offset:6144
  ds_read_b128 a[16:19], v104 offset:8192
  ds_read_b128 a[20:23], v104 offset:10240
  ds_read_b128 a[24:27], v105 offset:0
  ds_read_b128 a[28:31], v105 offset:2048
  ds_read_b128 a[32:35], v105 offset:4096
  ds_read_b128 a[36:39], v105 offset:6144
  ds_read_b128 a[40:43], v105 offset:8192
  ds_read_b128 a[44:47], v105 offset:10240
  s_waitcnt lgkmcnt(0)
  s_waitcnt vmcnt(0)
  s_barrier
  ds_read_b128 a[48:51], v104 offset:12288
  ds_read_b128 a[52:55], v104 offset:14336
  ds_read_b128 a[56:59], v104 offset:16384
  ds_read_b128 a[60:63], v104 offset:18432
  ds_read_b128 a[64:67], v104 offset:20480
  ds_read_b128 a[68:71], v104 offset:22528
  ds_read_b128 a[72:75], v105 offset:12288
  ds_read_b128 a[76:79], v105 offset:14336
  ds_read_b128 a[80:83], v105 offset:16384
  ds_read_b128 a[84:87], v105 offset:18432
  ds_read_b128 a[88:91], v105 offset:20480
  ds_read_b128 a[92:95], v105 offset:22528
  s_mov_b32 m0, 34816
  s_xor_b32 s67, s90, 512
  buffer_load_dwordx4 v16, s[24:27], s67 offen offset:0 lds
  buffer_load_dwordx4 v17, s[24:27], s67 offen offset:1024 lds
  buffer_load_dwordx4 v18, s[24:27], s67 offen offset:2048 lds
  buffer_load_dwordx4 v19, s[24:27], s67 offen offset:3072 lds
  s_mov_b32 m0, 38912
  s_xor_b32 s67, s90, 512
  s_add_u32 s67, s67, 32768
  buffer_load_dwordx4 v16, s[24:27], s67 offen offset:0 lds
  buffer_load_dwordx4 v17, s[24:27], s67 offen offset:1024 lds
  buffer_load_dwordx4 v18, s[24:27], s67 offen offset:2048 lds
  buffer_load_dwordx4 v19, s[24:27], s67 offen offset:3072 lds
  s_mov_b32 m0, 43008
  s_xor_b32 s67, s90, 512
  s_add_u32 s67, s67, 65536
  buffer_load_dwordx4 v16, s[24:27], s67 offen offset:0 lds
  buffer_load_dwordx4 v17, s[24:27], s67 offen offset:1024 lds
  buffer_load_dwordx4 v18, s[24:27], s67 offen offset:2048 lds
  buffer_load_dwordx4 v19, s[24:27], s67 offen offset:3072 lds
  s_mov_b32 m0, 67584
  s_xor_b32 s67, s91, 2097152
  buffer_load_dwordx4 v118, s[16:19], s67 offen offset:0 lds
  buffer_load_dwordx4 v119, s[16:19], s67 offen offset:1024 lds
  buffer_load_dwordx4 v120, s[16:19], s67 offen offset:2048 lds
  buffer_load_dwordx4 v121, s[16:19], s67 offen offset:3072 lds
  s_mov_b32 m0, 71680
  s_xor_b32 s67, s91, 2359296
  buffer_load_dwordx4 v118, s[16:19], s67 offen offset:0 lds
  buffer_load_dwordx4 v119, s[16:19], s67 offen offset:1024 lds
  buffer_load_dwordx4 v120, s[16:19], s67 offen offset:2048 lds
  buffer_load_dwordx4 v121, s[16:19], s67 offen offset:3072 lds
  s_mov_b32 m0, 75776
  s_xor_b32 s67, s91, 2097280
  buffer_load_dwordx4 v118, s[16:19], s67 offen offset:0 lds
  buffer_load_dwordx4 v119, s[16:19], s67 offen offset:1024 lds
  buffer_load_dwordx4 v120, s[16:19], s67 offen offset:2048 lds
  buffer_load_dwordx4 v121, s[16:19], s67 offen offset:3072 lds
  s_mov_b32 m0, 79872
  s_xor_b32 s67, s91, 2359424
  buffer_load_dwordx4 v118, s[16:19], s67 offen offset:0 lds
  buffer_load_dwordx4 v119, s[16:19], s67 offen offset:1024 lds
  buffer_load_dwordx4 v120, s[16:19], s67 offen offset:2048 lds
  buffer_load_dwordx4 v121, s[16:19], s67 offen offset:3072 lds
  s_waitcnt lgkmcnt(0)
  s_barrier
  ds_read_b128 a[96:99], v106 offset:0
  ds_read_b128 a[100:103], v106 offset:2048
  ds_read_b128 a[104:107], v106 offset:4096
  ds_read_b128 a[108:111], v106 offset:6144
  ds_read_b128 a[112:115], v106 offset:8192
  ds_read_b128 a[116:119], v106 offset:10240
  ds_read_b128 a[120:123], v107 offset:0
  ds_read_b128 a[124:127], v107 offset:2048
  ds_read_b128 a[128:131], v107 offset:4096
  ds_read_b128 a[132:135], v107 offset:6144
  ds_read_b128 a[136:139], v107 offset:8192
  ds_read_b128 a[140:143], v107 offset:10240
  s_mov_b32 m0, 47104
  s_xor_b32 s67, s90, 640
  buffer_load_dwordx4 v16, s[24:27], s67 offen offset:0 lds
  buffer_load_dwordx4 v17, s[24:27], s67 offen offset:1024 lds
  buffer_load_dwordx4 v18, s[24:27], s67 offen offset:2048 lds
  buffer_load_dwordx4 v19, s[24:27], s67 offen offset:3072 lds
  s_mov_b32 m0, 51200
  s_xor_b32 s67, s90, 640
  s_add_u32 s67, s67, 32768
  buffer_load_dwordx4 v16, s[24:27], s67 offen offset:0 lds
  buffer_load_dwordx4 v17, s[24:27], s67 offen offset:1024 lds
  buffer_load_dwordx4 v18, s[24:27], s67 offen offset:2048 lds
  buffer_load_dwordx4 v19, s[24:27], s67 offen offset:3072 lds
  s_mov_b32 m0, 55296
  s_xor_b32 s67, s90, 640
  s_add_u32 s67, s67, 65536
  buffer_load_dwordx4 v16, s[24:27], s67 offen offset:0 lds
  buffer_load_dwordx4 v17, s[24:27], s67 offen offset:1024 lds
  buffer_load_dwordx4 v18, s[24:27], s67 offen offset:2048 lds
  buffer_load_dwordx4 v19, s[24:27], s67 offen offset:3072 lds
  s_mov_b32 m0, 100352
  s_xor_b32 s67, s91, 2621440
  buffer_load_dwordx4 v118, s[16:19], s67 offen offset:0 lds
  buffer_load_dwordx4 v119, s[16:19], s67 offen offset:1024 lds
  buffer_load_dwordx4 v120, s[16:19], s67 offen offset:2048 lds
  buffer_load_dwordx4 v121, s[16:19], s67 offen offset:3072 lds
  s_mov_b32 m0, 104448
  s_xor_b32 s67, s91, 2883584
  buffer_load_dwordx4 v118, s[16:19], s67 offen offset:0 lds
  buffer_load_dwordx4 v119, s[16:19], s67 offen offset:1024 lds
  buffer_load_dwordx4 v120, s[16:19], s67 offen offset:2048 lds
  buffer_load_dwordx4 v121, s[16:19], s67 offen offset:3072 lds
  s_mov_b32 m0, 108544
  s_xor_b32 s67, s91, 2621568
  buffer_load_dwordx4 v118, s[16:19], s67 offen offset:0 lds
  buffer_load_dwordx4 v119, s[16:19], s67 offen offset:1024 lds
  buffer_load_dwordx4 v120, s[16:19], s67 offen offset:2048 lds
  buffer_load_dwordx4 v121, s[16:19], s67 offen offset:3072 lds
  s_mov_b32 m0, 112640
  s_xor_b32 s67, s91, 2883712
  buffer_load_dwordx4 v118, s[16:19], s67 offen offset:0 lds
  buffer_load_dwordx4 v119, s[16:19], s67 offen offset:1024 lds
  buffer_load_dwordx4 v120, s[16:19], s67 offen offset:2048 lds
  buffer_load_dwordx4 v121, s[16:19], s67 offen offset:3072 lds
  s_waitcnt lgkmcnt(0)
  s_barrier
  ds_read_b128 a[144:147], v106 offset:12288
  ds_read_b128 a[148:151], v106 offset:14336
  ds_read_b128 a[152:155], v106 offset:16384
  ds_read_b128 a[156:159], v106 offset:18432
  ds_read_b128 a[160:163], v106 offset:20480
  ds_read_b128 a[164:167], v106 offset:22528
  ds_read_b128 a[168:171], v107 offset:12288
  ds_read_b128 a[172:175], v107 offset:14336
  ds_read_b128 a[176:179], v107 offset:16384
  ds_read_b128 a[180:183], v107 offset:18432
  ds_read_b128 a[184:187], v107 offset:20480
  ds_read_b128 a[188:191], v107 offset:22528
  s_mov_b32 m0, 133120
  s_xor_b32 s67, s90, 768
  buffer_load_dwordx4 v16, s[24:27], s67 offen offset:0 lds
  buffer_load_dwordx4 v17, s[24:27], s67 offen offset:1024 lds
  buffer_load_dwordx4 v18, s[24:27], s67 offen offset:2048 lds
  buffer_load_dwordx4 v19, s[24:27], s67 offen offset:3072 lds
  s_mov_b32 m0, 137216
  s_xor_b32 s67, s90, 768
  s_add_u32 s67, s67, 32768
  buffer_load_dwordx4 v16, s[24:27], s67 offen offset:0 lds
  buffer_load_dwordx4 v17, s[24:27], s67 offen offset:1024 lds
  s_waitcnt vmcnt(59)
  buffer_load_dwordx4 v18, s[24:27], s67 offen offset:2048 lds
  buffer_load_dwordx4 v19, s[24:27], s67 offen offset:3072 lds
  s_mov_b32 m0, 141312
  s_xor_b32 s67, s90, 768
  s_add_u32 s67, s67, 65536
  buffer_load_dwordx4 v16, s[24:27], s67 offen offset:0 lds
  s_waitcnt vmcnt(59)
  buffer_load_dwordx4 v17, s[24:27], s67 offen offset:1024 lds
  buffer_load_dwordx4 v18, s[24:27], s67 offen offset:2048 lds
  buffer_load_dwordx4 v19, s[24:27], s67 offen offset:3072 lds
  s_mov_b32 m0, 17408
  s_xor_b32 s67, s91, 3145728
  s_waitcnt vmcnt(59)
  buffer_load_dwordx4 v118, s[16:19], s67 offen offset:0 lds
  buffer_load_dwordx4 v119, s[16:19], s67 offen offset:1024 lds
  buffer_load_dwordx4 v120, s[16:19], s67 offen offset:2048 lds
  s_waitcnt vmcnt(59)
  buffer_load_dwordx4 v121, s[16:19], s67 offen offset:3072 lds
  s_mov_b32 m0, 21504
  s_xor_b32 s67, s91, 3407872
  buffer_load_dwordx4 v118, s[16:19], s67 offen offset:0 lds
  buffer_load_dwordx4 v119, s[16:19], s67 offen offset:1024 lds
  s_waitcnt vmcnt(59)
  buffer_load_dwordx4 v120, s[16:19], s67 offen offset:2048 lds
  buffer_load_dwordx4 v121, s[16:19], s67 offen offset:3072 lds
  s_mov_b32 m0, 25600
  s_xor_b32 s67, s91, 3145856
  buffer_load_dwordx4 v118, s[16:19], s67 offen offset:0 lds
  s_waitcnt vmcnt(59)
  buffer_load_dwordx4 v119, s[16:19], s67 offen offset:1024 lds
  buffer_load_dwordx4 v120, s[16:19], s67 offen offset:2048 lds
  buffer_load_dwordx4 v121, s[16:19], s67 offen offset:3072 lds
  s_mov_b32 m0, 29696
  s_xor_b32 s67, s91, 3408000
  s_waitcnt vmcnt(59)
  buffer_load_dwordx4 v118, s[16:19], s67 offen offset:0 lds
  buffer_load_dwordx4 v119, s[16:19], s67 offen offset:1024 lds
  buffer_load_dwordx4 v120, s[16:19], s67 offen offset:2048 lds
  s_waitcnt vmcnt(59)
  buffer_load_dwordx4 v121, s[16:19], s67 offen offset:3072 lds
  s_waitcnt lgkmcnt(0)
  s_waitcnt vmcnt(56)
  s_barrier
  ds_read_b128 a[192:195], v104 offset:0
  ds_read_b128 a[196:199], v104 offset:2048
  ds_read_b128 a[200:203], v104 offset:4096
  ds_read_b128 a[204:207], v104 offset:6144
  ds_read_b128 a[208:211], v104 offset:8192
  ds_read_b128 a[212:215], v104 offset:10240
  ds_read_b128 a[216:219], v105 offset:0
  ds_read_b128 a[220:223], v105 offset:2048
  ds_read_b128 a[224:227], v105 offset:4096
  ds_read_b128 a[228:231], v105 offset:6144
  ds_read_b128 a[232:235], v105 offset:8192
  ds_read_b128 a[236:239], v105 offset:10240
  s_mov_b32 m0, 145408
  s_xor_b32 s67, s90, 896
  buffer_load_dwordx4 v16, s[24:27], s67 offen offset:0 lds
  buffer_load_dwordx4 v17, s[24:27], s67 offen offset:1024 lds
  buffer_load_dwordx4 v18, s[24:27], s67 offen offset:2048 lds
  buffer_load_dwordx4 v19, s[24:27], s67 offen offset:3072 lds
  s_mov_b32 m0, 149504
  s_xor_b32 s67, s90, 896
  s_add_u32 s67, s67, 32768
  buffer_load_dwordx4 v16, s[24:27], s67 offen offset:0 lds
  buffer_load_dwordx4 v17, s[24:27], s67 offen offset:1024 lds
  s_waitcnt vmcnt(59)
  buffer_load_dwordx4 v18, s[24:27], s67 offen offset:2048 lds
  buffer_load_dwordx4 v19, s[24:27], s67 offen offset:3072 lds
  s_mov_b32 m0, 153600
  s_xor_b32 s67, s90, 896
  s_add_u32 s67, s67, 65536
  buffer_load_dwordx4 v16, s[24:27], s67 offen offset:0 lds
  s_waitcnt vmcnt(59)
  buffer_load_dwordx4 v17, s[24:27], s67 offen offset:1024 lds
  buffer_load_dwordx4 v18, s[24:27], s67 offen offset:2048 lds
  buffer_load_dwordx4 v19, s[24:27], s67 offen offset:3072 lds
  s_mov_b32 m0, 116736
  s_xor_b32 s67, s91, 3670016
  s_waitcnt vmcnt(59)
  buffer_load_dwordx4 v118, s[16:19], s67 offen offset:0 lds
  buffer_load_dwordx4 v119, s[16:19], s67 offen offset:1024 lds
  buffer_load_dwordx4 v120, s[16:19], s67 offen offset:2048 lds
  s_waitcnt vmcnt(59)
  buffer_load_dwordx4 v121, s[16:19], s67 offen offset:3072 lds
  s_mov_b32 m0, 120832
  s_xor_b32 s67, s91, 3932160
  buffer_load_dwordx4 v118, s[16:19], s67 offen offset:0 lds
  buffer_load_dwordx4 v119, s[16:19], s67 offen offset:1024 lds
  s_waitcnt vmcnt(59)
  buffer_load_dwordx4 v120, s[16:19], s67 offen offset:2048 lds
  buffer_load_dwordx4 v121, s[16:19], s67 offen offset:3072 lds
  s_mov_b32 m0, 124928
  s_xor_b32 s67, s91, 3670144
  buffer_load_dwordx4 v118, s[16:19], s67 offen offset:0 lds
  s_waitcnt vmcnt(59)
  buffer_load_dwordx4 v119, s[16:19], s67 offen offset:1024 lds
  buffer_load_dwordx4 v120, s[16:19], s67 offen offset:2048 lds
  buffer_load_dwordx4 v121, s[16:19], s67 offen offset:3072 lds
  s_mov_b32 m0, 129024
  s_xor_b32 s67, s91, 3932288
  s_waitcnt vmcnt(59)
  buffer_load_dwordx4 v118, s[16:19], s67 offen offset:0 lds
  buffer_load_dwordx4 v119, s[16:19], s67 offen offset:1024 lds
  buffer_load_dwordx4 v120, s[16:19], s67 offen offset:2048 lds
  s_waitcnt vmcnt(59)
  buffer_load_dwordx4 v121, s[16:19], s67 offen offset:3072 lds
  s_xor_b32 s53, s86, s48
  s_mov_b32 m0, 0
  s_nop 0
  buffer_load_dwordx4 v126, s[8:11], s53 offen offset:0 nt lds
  s_mov_b32 m0, 64
  s_nop 0
  buffer_load_dwordx4 v126, s[8:11], s53 offen offset:1024 nt lds
  s_mov_b32 m0, 128
  s_waitcnt vmcnt(59)
  buffer_load_dwordx4 v126, s[8:11], s53 offen offset:2048 nt lds
  s_mov_b32 m0, 192
  s_add_u32 s86, s86, 4096
  buffer_load_dwordx4 v126, s[8:11], s53 offen offset:3072 nt lds
  s_xor_b32 s53, s86, s48
  s_mov_b32 m0, 4352
  s_nop 0
  buffer_load_dwordx4 v126, s[8:11], s53 offen offset:0 nt lds
  s_mov_b32 m0, 4416
  s_waitcnt vmcnt(59)
  buffer_load_dwordx4 v126, s[8:11], s53 offen offset:1024 nt lds
  s_mov_b32 m0, 4480
  s_nop 0
  buffer_load_dwordx4 v126, s[8:11], s53 offen offset:2048 nt lds
  s_mov_b32 m0, 4544
  s_add_u32 s86, s86, 4096
  buffer_load_dwordx4 v126, s[8:11], s53 offen offset:3072 nt lds
  s_xor_b32 s53, s86, s48
  s_mov_b32 m0, 8704
  s_waitcnt vmcnt(59)
  buffer_load_dwordx4 v126, s[8:11], s53 offen offset:0 nt lds
  s_mov_b32 m0, 8768
  s_nop 0
  buffer_load_dwordx4 v126, s[8:11], s53 offen offset:1024 nt lds
  s_mov_b32 m0, 8832
  s_nop 0
  buffer_load_dwordx4 v126, s[8:11], s53 offen offset:2048 nt lds
  s_mov_b32 m0, 8896
  s_add_u32 s86, s86, 4096
  s_waitcnt vmcnt(59)
  buffer_load_dwordx4 v126, s[8:11], s53 offen offset:3072 nt lds
  s_xor_b32 s53, s86, s48
  s_mov_b32 m0, 13056
  s_nop 0
  buffer_load_dwordx4 v126, s[8:11], s53 offen offset:0 nt lds
  s_mov_b32 m0, 13120
  s_nop 0
  buffer_load_dwordx4 v126, s[8:11], s53 offen offset:1024 nt lds
  s_mov_b32 m0, 13184
  s_waitcnt vmcnt(59)
  buffer_load_dwordx4 v126, s[8:11], s53 offen offset:2048 nt lds
  s_mov_b32 m0, 13248
  s_add_u32 s86, s86, 4096
  buffer_load_dwordx4 v126, s[8:11], s53 offen offset:3072 nt lds
  s_waitcnt lgkmcnt(0)
  s_barrier
  ds_read_b128 a[240:243], v104 offset:12288
  ds_read_b128 a[244:247], v104 offset:14336
  ds_read_b128 a[248:251], v104 offset:16384
  ds_read_b128 a[252:255], v104 offset:18432
  ds_read_b128 v[128:131], v104 offset:20480
  ds_read_b128 v[132:135], v104 offset:22528
  ds_read_b128 v[136:139], v105 offset:12288
  ds_read_b128 v[140:143], v105 offset:14336
  ds_read_b128 v[144:147], v105 offset:16384
  ds_read_b128 v[148:151], v105 offset:18432
  ds_read_b128 v[152:155], v105 offset:20480
  ds_read_b128 v[156:159], v105 offset:22528
  s_mov_b32 m0, 67584
  s_xor_b32 s67, s37, 0
  buffer_load_dwordx4 v118, s[16:19], s67 offen offset:0 lds
  s_waitcnt vmcnt(59)
  buffer_load_dwordx4 v119, s[16:19], s67 offen offset:1024 lds
  buffer_load_dwordx4 v120, s[16:19], s67 offen offset:2048 lds
  buffer_load_dwordx4 v121, s[16:19], s67 offen offset:3072 lds
  s_mov_b32 m0, 71680
  s_xor_b32 s67, s37, 262144
  s_waitcnt vmcnt(59)
  buffer_load_dwordx4 v118, s[16:19], s67 offen offset:0 lds
  buffer_load_dwordx4 v119, s[16:19], s67 offen offset:1024 lds
  buffer_load_dwordx4 v120, s[16:19], s67 offen offset:2048 lds
  s_waitcnt vmcnt(59)
  buffer_load_dwordx4 v121, s[16:19], s67 offen offset:3072 lds
  s_mov_b32 m0, 75776
  s_xor_b32 s67, s37, 524288
  buffer_load_dwordx4 v118, s[16:19], s67 offen offset:0 lds
  buffer_load_dwordx4 v119, s[16:19], s67 offen offset:1024 lds
  s_waitcnt vmcnt(59)
  buffer_load_dwordx4 v120, s[16:19], s67 offen offset:2048 lds
  buffer_load_dwordx4 v121, s[16:19], s67 offen offset:3072 lds
  s_mov_b32 m0, 79872
  s_xor_b32 s67, s37, 786432
  buffer_load_dwordx4 v118, s[16:19], s67 offen offset:0 lds
  s_waitcnt vmcnt(59)
  buffer_load_dwordx4 v119, s[16:19], s67 offen offset:1024 lds
  buffer_load_dwordx4 v120, s[16:19], s67 offen offset:2048 lds
  buffer_load_dwordx4 v121, s[16:19], s67 offen offset:3072 lds
  s_mov_b32 m0, 83968
  s_xor_b32 s67, s37, 1048576
  s_waitcnt vmcnt(59)
  buffer_load_dwordx4 v118, s[16:19], s67 offen offset:0 lds
  buffer_load_dwordx4 v119, s[16:19], s67 offen offset:1024 lds
  buffer_load_dwordx4 v120, s[16:19], s67 offen offset:2048 lds
  s_waitcnt vmcnt(59)
  buffer_load_dwordx4 v121, s[16:19], s67 offen offset:3072 lds
  s_mov_b32 m0, 88064
  s_xor_b32 s67, s37, 1310720
  buffer_load_dwordx4 v118, s[16:19], s67 offen offset:0 lds
  buffer_load_dwordx4 v119, s[16:19], s67 offen offset:1024 lds
  s_waitcnt vmcnt(59)
  buffer_load_dwordx4 v120, s[16:19], s67 offen offset:2048 lds
  buffer_load_dwordx4 v121, s[16:19], s67 offen offset:3072 lds
  s_waitcnt lgkmcnt(0)
  s_barrier
  ds_read_b128 v[160:163], v106 offset:0
  ds_read_b128 v[164:167], v106 offset:2048
  ds_read_b128 v[168:171], v106 offset:4096
  ds_read_b128 v[172:175], v106 offset:6144
  ds_read_b128 v[176:179], v106 offset:8192
  ds_read_b128 v[180:183], v106 offset:10240
  ds_read_b128 v[184:187], v107 offset:0
  ds_read_b128 v[188:191], v107 offset:2048
  ds_read_b128 v[192:195], v107 offset:4096
  ds_read_b128 v[196:199], v107 offset:6144
  ds_read_b128 v[200:203], v107 offset:8192
  ds_read_b128 v[204:207], v107 offset:10240
  s_waitcnt lgkmcnt(0)
  s_waitcnt vmcnt(40)
  s_barrier
  ds_read_b128 v[208:211], v106 offset:12288
  ds_read_b128 v[212:215], v106 offset:14336
  ds_read_b128 v[216:219], v106 offset:16384
  ds_read_b128 v[220:223], v106 offset:18432
  ds_read_b128 v[224:227], v106 offset:20480
  ds_read_b128 v[228:231], v106 offset:22528
  ds_read_b128 v[232:235], v107 offset:12288
  ds_read_b128 v[236:239], v107 offset:14336
  ds_read_b128 v[240:243], v107 offset:16384
  ds_read_b128 v[244:247], v107 offset:18432
  ds_read_b128 v[248:251], v107 offset:20480
  ds_read_b128 v[252:255], v107 offset:22528
  s_xor_b32 s53, s86, s48
  s_mov_b32 m0, 17408
  s_nop 0
  buffer_load_dwordx4 v126, s[8:11], s53 offen offset:0 nt lds
  s_mov_b32 m0, 17472
  s_nop 0
  buffer_load_dwordx4 v126, s[8:11], s53 offen offset:1024 nt lds
  s_mov_b32 m0, 17536
  s_nop 0
  buffer_load_dwordx4 v126, s[8:11], s53 offen offset:2048 nt lds
  s_mov_b32 m0, 17600
  s_add_u32 s86, s86, 4096
  buffer_load_dwordx4 v126, s[8:11], s53 offen offset:3072 nt lds
  s_xor_b32 s53, s86, s48
  s_mov_b32 m0, 21760
  s_nop 0
  buffer_load_dwordx4 v126, s[8:11], s53 offen offset:0 nt lds
  s_mov_b32 m0, 21824
  s_nop 0
  buffer_load_dwordx4 v126, s[8:11], s53 offen offset:1024 nt lds
  s_mov_b32 m0, 21888
  s_nop 0
  buffer_load_dwordx4 v126, s[8:11], s53 offen offset:2048 nt lds
  s_mov_b32 m0, 21952
  s_add_u32 s86, s86, 4096
  buffer_load_dwordx4 v126, s[8:11], s53 offen offset:3072 nt lds
  s_mov_b32 m0, 51200
  s_xor_b32 s53, s87, s48
  buffer_load_dwordx4 v116, s[12:15], s53 offen offset:0 nt lds
  buffer_load_dwordx4 v117, s[12:15], s53 offen offset:1024 nt lds
  buffer_load_dwordx4 v116, s[12:15], s53 offen offset:2048 nt lds
  buffer_load_dwordx4 v117, s[12:15], s53 offen offset:3072 nt lds
  s_add_u32 s87, s87, 4096
  s_mov_b32 m0, 55296
  s_xor_b32 s53, s87, s48
  buffer_load_dwordx4 v116, s[12:15], s53 offen offset:0 nt lds
  buffer_load_dwordx4 v117, s[12:15], s53 offen offset:1024 nt lds
  buffer_load_dwordx4 v116, s[12:15], s53 offen offset:2048 nt lds
  buffer_load_dwordx4 v117, s[12:15], s53 offen offset:3072 nt lds
  s_add_u32 s87, s87, 4096
  s_waitcnt lgkmcnt(0)
  s_waitcnt vmcnt(32)
  s_cmp_lg_u32 s60, 0
  s_cbranch_scc1 L_noz2
  s_lshl_b32 s67, s3, 3
  v_mov_b32 v91, s67
  v_mov_b32 v92, 1
  s_mov_b64 exec, 1
  buffer_atomic_add v92, v91, s[4:7], 0 offen sc1
  s_mov_b64 exec, -1
L_noz2:
  s_barrier
  s_xor_b32 s70, s93, s49
  s_mov_b32 m0, 92160
  s_xor_b32 s67, s37, 1572864
  buffer_load_dwordx4 v118, s[16:19], s67 offen offset:0 lds
  buffer_load_dwordx4 v119, s[16:19], s67 offen offset:1024 lds
  buffer_load_dwordx4 v120, s[16:19], s67 offen offset:2048 lds
  buffer_load_dwordx4 v121, s[16:19], s67 offen offset:3072 lds
  s_mov_b32 m0, 96256
  s_xor_b32 s67, s37, 1835008
  buffer_load_dwordx4 v118, s[16:19], s67 offen offset:0 lds
  buffer_load_dwordx4 v119, s[16:19], s67 offen offset:1024 lds
  buffer_load_dwordx4 v120, s[16:19], s67 offen offset:2048 lds
  buffer_load_dwordx4 v121, s[16:19], s67 offen offset:3072 lds
  s_xor_b32 s53, s86, s48
  s_mov_b32 m0, 26112
  s_nop 0
  buffer_load_dwordx4 v126, s[8:11], s53 offen offset:0 nt lds
  s_mov_b32 m0, 26176
  s_nop 0
  buffer_load_dwordx4 v126, s[8:11], s53 offen offset:1024 nt lds
  s_mov_b32 m0, 26240
  s_nop 0
  buffer_load_dwordx4 v126, s[8:11], s53 offen offset:2048 nt lds
  s_mov_b32 m0, 26304
  s_add_u32 s86, s86, 4096
  buffer_load_dwordx4 v126, s[8:11], s53 offen offset:3072 nt lds
  s_xor_b32 s53, s86, s48
  s_mov_b32 m0, 30464
  s_nop 0
  buffer_load_dwordx4 v126, s[8:11], s53 offen offset:0 nt lds
  s_mov_b32 m0, 30528
  s_nop 0
  buffer_load_dwordx4 v126, s[8:11], s53 offen offset:1024 nt lds
  s_mov_b32 m0, 30592
  s_nop 0
  buffer_load_dwordx4 v126, s[8:11], s53 offen offset:2048 nt lds
  s_mov_b32 m0, 30656
  s_add_u32 s86, s86, 4096
  buffer_load_dwordx4 v126, s[8:11], s53 offen offset:3072 nt lds
  s_mov_b32 m0, 59392
  s_xor_b32 s53, s87, s48
  buffer_load_dwordx4 v116, s[12:15], s53 offen offset:0 nt lds
  buffer_load_dwordx4 v117, s[12:15], s53 offen offset:1024 nt lds
  buffer_load_dwordx4 v116, s[12:15], s53 offen offset:2048 nt lds
  buffer_load_dwordx4 v117, s[12:15], s53 offen offset:3072 nt lds
  s_add_u32 s87, s87, 4096
  s_mov_b32 m0, 63488
  s_xor_b32 s53, s87, s48
  buffer_load_dwordx4 v116, s[12:15], s53 offen offset:0 nt lds
  buffer_load_dwordx4 v117, s[12:15], s53 offen offset:1024 nt lds
  buffer_load_dwordx4 v116, s[12:15], s53 offen offset:2048 nt lds
  buffer_load_dwordx4 v117, s[12:15], s53 offen offset:3072 nt lds
  s_add_u32 s87, s87, 4096
  s_waitcnt vmcnt(48)
  s_barrier
  s_mov_b32 m0, 67584
  s_xor_b32 s67, s37, 2097152
  buffer_load_dwordx4 v118, s[16:19], s67 offen offset:0 lds
  buffer_load_dwordx4 v119, s[16:19], s67 offen offset:1024 lds
  buffer_load_dwordx4 v120, s[16:19], s67 offen offset:2048 lds
  buffer_load_dwordx4 v121, s[16:19], s67 offen offset:3072 lds
  s_mov_b32 m0, 71680
  s_xor_b32 s67, s37, 2359296
  buffer_load_dwordx4 v118, s[16:19], s67 offen offset:0 lds
  buffer_load_dwordx4 v119, s[16:19], s67 offen offset:1024 lds
  buffer_load_dwordx4 v120, s[16:19], s67 offen offset:2048 lds
  buffer_load_dwordx4 v121, s[16:19], s67 offen offset:3072 lds
  s_xor_b32 s53, s86, s48
  s_mov_b32 m0, 0
  s_nop 0
  buffer_load_dwordx4 v126, s[8:11], s53 offen offset:0 nt lds
  s_mov_b32 m0, 64
  s_nop 0
  buffer_load_dwordx4 v126, s[8:11], s53 offen offset:1024 nt lds
  s_mov_b32 m0, 128
  s_nop 0
  buffer_load_dwordx4 v126, s[8:11], s53 offen offset:2048 nt lds
  s_mov_b32 m0, 192
  s_add_u32 s86, s86, 4096
  buffer_load_dwordx4 v126, s[8:11], s53 offen offset:3072 nt lds
  s_xor_b32 s53, s86, s48
  s_mov_b32 m0, 4352
  s_nop 0
  buffer_load_dwordx4 v126, s[8:11], s53 offen offset:0 nt lds
  s_mov_b32 m0, 4416
  s_nop 0
  buffer_load_dwordx4 v126, s[8:11], s53 offen offset:1024 nt lds
  s_mov_b32 m0, 4480
  s_waitcnt vmcnt(59)
  buffer_load_dwordx4 v126, s[8:11], s53 offen offset:2048 nt lds
  s_mov_b32 m0, 4544
  s_add_u32 s86, s86, 4096
  buffer_load_dwordx4 v126, s[8:11], s53 offen offset:3072 nt lds
  s_mov_b32 m0, 34816
  s_xor_b32 s53, s87, s48
  buffer_load_dwordx4 v116, s[12:15], s53 offen offset:0 nt lds
  s_waitcnt vmcnt(59)
  buffer_load_dwordx4 v117, s[12:15], s53 offen offset:1024 nt lds
  buffer_load_dwordx4 v116, s[12:15], s53 offen offset:2048 nt lds
  buffer_load_dwordx4 v117, s[12:15], s53 offen offset:3072 nt lds
  s_add_u32 s87, s87, 4096
  s_mov_b32 m0, 38912
  s_xor_b32 s53, s87, s48
  s_waitcnt vmcnt(59)
  buffer_load_dwordx4 v116, s[12:15], s53 offen offset:0 nt lds
  buffer_load_dwordx4 v117, s[12:15], s53 offen offset:1024 nt lds
  buffer_load_dwordx4 v116, s[12:15], s53 offen offset:2048 nt lds
  s_waitcnt vmcnt(59)
  buffer_load_dwordx4 v117, s[12:15], s53 offen offset:3072 nt lds
  s_add_u32 s87, s87, 4096
  s_waitcnt vmcnt(48)
  s_barrier
  s_mov_b32 m0, 75776
  s_xor_b32 s67, s37, 2621440
  buffer_load_dwordx4 v118, s[16:19], s67 offen offset:0 lds
  buffer_load_dwordx4 v119, s[16:19], s67 offen offset:1024 lds
  buffer_load_dwordx4 v120, s[16:19], s67 offen offset:2048 lds
  buffer_load_dwordx4 v121, s[16:19], s67 offen offset:3072 lds
  s_mov_b32 m0, 79872
  s_xor_b32 s67, s37, 2883584
  buffer_load_dwordx4 v118, s[16:19], s67 offen offset:0 lds
  buffer_load_dwordx4 v119, s[16:19], s67 offen offset:1024 lds
  buffer_load_dwordx4 v120, s[16:19], s67 offen offset:2048 lds
  buffer_load_dwordx4 v121, s[16:19], s67 offen offset:3072 lds
  s_xor_b32 s53, s86, s48
  s_mov_b32 m0, 8704
  s_nop 0
  buffer_load_dwordx4 v126, s[8:11], s53 offen offset:0 nt lds
  s_mov_b32 m0, 8768
  s_nop 0
  buffer_load_dwordx4 v126, s[8:11], s53 offen offset:1024 nt lds
  s_mov_b32 m0, 8832
  s_nop 0
  buffer_load_dwordx4 v126, s[8:11], s53 offen offset:2048 nt lds
  s_mov_b32 m0, 8896
  s_add_u32 s86, s86, 4096
  buffer_load_dwordx4 v126, s[8:11], s53 offen offset:3072 nt lds
  s_xor_b32 s53, s86, s48
  s_mov_b32 m0, 13056
  s_nop 0
  buffer_load_dwordx4 v126, s[8:11], s53 offen offset:0 nt lds
  s_mov_b32 m0, 13120
  s_nop 0
  buffer_load_dwordx4 v126, s[8:11], s53 offen offset:1024 nt lds
  s_mov_b32 m0, 13184
  s_waitcnt vmcnt(59)
  buffer_load_dwordx4 v126, s[8:11], s53 offen offset:2048 nt lds
  s_mov_b32 m0, 13248
  s_add_u32 s86, s86, 4096
  buffer_load_dwordx4 v126, s[8:11], s53 offen offset:3072 nt lds
  s_mov_b32 m0, 43008
  s_xor_b32 s53, s87, s48
  buffer_load_dwordx4 v116, s[12:15], s53 offen offset:0 nt lds
  s_waitcnt vmcnt(59)
  buffer_load_dwordx4 v117, s[12:15], s53 offen offset:1024 nt lds
  buffer_load_dwordx4 v116, s[12:15], s53 offen offset:2048 nt lds
  buffer_load_dwordx4 v117, s[12:15], s53 offen offset:3072 nt lds
  s_add_u32 s87, s87, 4096
  s_mov_b32 m0, 47104
  s_xor_b32 s53, s87, s48
  s_waitcnt vmcnt(59)
  buffer_load_dwordx4 v116, s[12:15], s53 offen offset:0 nt lds
  buffer_load_dwordx4 v117, s[12:15], s53 offen offset:1024 nt lds
  buffer_load_dwordx4 v116, s[12:15], s53 offen offset:2048 nt lds
  s_waitcnt vmcnt(59)
  buffer_load_dwordx4 v117, s[12:15], s53 offen offset:3072 nt lds
  s_add_u32 s87, s87, 4096
  s_waitcnt vmcnt(48)
  s_barrier
  s_mov_b32 m0, 83968
  s_xor_b32 s67, s37, 3145728
  buffer_load_dwordx4 v118, s[16:19], s67 offen offset:0 lds
  buffer_load_dwordx4 v119, s[16:19], s67 offen offset:1024 lds
  buffer_load_dwordx4 v120, s[16:19], s67 offen offset:2048 lds
  buffer_load_dwordx4 v121, s[16:19], s67 offen offset:3072 lds
  s_mov_b32 m0, 88064
  s_xor_b32 s67, s37, 3407872
  buffer_load_dwordx4 v118, s[16:19], s67 offen offset:0 lds
  buffer_load_dwordx4 v119, s[16:19], s67 offen offset:1024 lds
  buffer_load_dwordx4 v120, s[16:19], s67 offen offset:2048 lds
  buffer_load_dwordx4 v121, s[16:19], s67 offen offset:3072 lds
  s_xor_b32 s53, s86, s48
  s_mov_b32 m0, 17408
  s_nop 0
  buffer_load_dwordx4 v126, s[8:11], s53 offen offset:0 nt lds
  s_mov_b32 m0, 17472
  s_nop 0
  buffer_load_dwordx4 v126, s[8:11], s53 offen offset:1024 nt lds
  s_mov_b32 m0, 17536
  s_nop 0
  buffer_load_dwordx4 v126, s[8:11], s53 offen offset:2048 nt lds
  s_mov_b32 m0, 17600
  s_add_u32 s86, s86, 4096
  buffer_load_dwordx4 v126, s[8:11], s53 offen offset:3072 nt lds
  s_xor_b32 s53, s86, s48
  s_mov_b32 m0, 21760
  s_nop 0
  buffer_load_dwordx4 v126, s[8:11], s53 offen offset:0 nt lds
  s_mov_b32 m0, 21824
  s_nop 0
  buffer_load_dwordx4 v126, s[8:11], s53 offen offset:1024 nt lds
  s_mov_b32 m0, 21888
  s_waitcnt vmcnt(59)
  buffer_load_dwordx4 v126, s[8:11], s53 offen offset:2048 nt lds
  s_mov_b32 m0, 21952
  s_add_u32 s86, s86, 4096
  buffer_load_dwordx4 v126, s[8:11], s53 offen offset:3072 nt lds
  s_mov_b32 m0, 51200
  s_xor_b32 s53, s87, s48
  buffer_load_dwordx4 v116, s[12:15], s53 offen offset:0 nt lds
  s_waitcnt vmcnt(59)
  buffer_load_dwordx4 v117, s[12:15], s53 offen offset:1024 nt lds
  buffer_load_dwordx4 v116, s[12:15], s53 offen offset:2048 nt lds
  buffer_load_dwordx4 v117, s[12:15], s53 offen offset:3072 nt lds
  s_add_u32 s87, s87, 4096
  s_mov_b32 m0, 55296
  s_xor_b32 s53, s87, s48
  s_waitcnt vmcnt(59)
  buffer_load_dwordx4 v116, s[12:15], s53 offen offset:0 nt lds
  buffer_load_dwordx4 v117, s[12:15], s53 offen offset:1024 nt lds
  buffer_load_dwordx4 v116, s[12:15], s53 offen offset:2048 nt lds
  s_waitcnt vmcnt(59)
  buffer_load_dwordx4 v117, s[12:15], s53 offen offset:3072 nt lds
  s_add_u32 s87, s87, 4096
  s_waitcnt vmcnt(48)
  s_barrier
  s_mov_b32 m0, 92160
  s_xor_b32 s67, s37, 3670016
  buffer_load_dwordx4 v118, s[16:19], s67 offen offset:0 lds
  buffer_load_dwordx4 v119, s[16:19], s67 offen offset:1024 lds
  buffer_load_dwordx4 v120, s[16:19], s67 offen offset:2048 lds
  buffer_load_dwordx4 v121, s[16:19], s67 offen offset:3072 lds
  s_mov_b32 m0, 96256
  s_xor_b32 s67, s37, 3932160
  buffer_load_dwordx4 v118, s[16:19], s67 offen offset:0 lds
  buffer_load_dwordx4 v119, s[16:19], s67 offen offset:1024 lds
  buffer_load_dwordx4 v120, s[16:19], s67 offen offset:2048 lds
  buffer_load_dwordx4 v121, s[16:19], s67 offen offset:3072 lds
  s_xor_b32 s53, s86, s48
  s_mov_b32 m0, 26112
  s_nop 0
  buffer_load_dwordx4 v126, s[8:11], s53 offen offset:0 nt lds
  s_mov_b32 m0, 26176
  s_nop 0
  buffer_load_dwordx4 v126, s[8:11], s53 offen offset:1024 nt lds
  s_mov_b32 m0, 26240
  s_nop 0
  buffer_load_dwordx4 v126, s[8:11], s53 offen offset:2048 nt lds
  s_mov_b32 m0, 26304
  s_add_u32 s86, s86, 4096
  buffer_load_dwordx4 v126, s[8:11], s53 offen offset:3072 nt lds
  s_xor_b32 s53, s86, s48
  s_mov_b32 m0, 30464
  s_nop 0
  buffer_load_dwordx4 v126, s[8:11], s53 offen offset:0 nt lds
  s_mov_b32 m0, 30528
  s_nop 0
  buffer_load_dwordx4 v126, s[8:11], s53 offen offset:1024 nt lds
  s_mov_b32 m0, 30592
  s_waitcnt vmcnt(59)
  buffer_load_dwordx4 v126, s[8:11], s53 offen offset:2048 nt lds
  s_mov_b32 m0, 30656
  s_add_u32 s86, s86, 4096
  buffer_load_dwordx4 v126, s[8:11], s53 offen offset:3072 nt lds
  s_mov_b32 m0, 59392
  s_xor_b32 s53, s87, s48
  buffer_load_dwordx4 v116, s[12:15], s53 offen offset:0 nt lds
  s_waitcnt vmcnt(59)
  buffer_load_dwordx4 v117, s[12:15], s53 offen offset:1024 nt lds
  buffer_load_dwordx4 v116, s[12:15], s53 offen offset:2048 nt lds
  buffer_load_dwordx4 v117, s[12:15], s53 offen offset:3072 nt lds
  s_add_u32 s87, s87, 4096
  s_mov_b32 m0, 63488
  s_xor_b32 s53, s87, s48
  s_waitcnt vmcnt(59)
  buffer_load_dwordx4 v116, s[12:15], s53 offen offset:0 nt lds
  buffer_load_dwordx4 v117, s[12:15], s53 offen offset:1024 nt lds
  buffer_load_dwordx4 v116, s[12:15], s53 offen offset:2048 nt lds
  s_waitcnt vmcnt(59)
  buffer_load_dwordx4 v117, s[12:15], s53 offen offset:3072 nt lds
  s_add_u32 s87, s87, 4096
  s_waitcnt vmcnt(48)
  s_barrier
  s_mov_b32 m0, 67584
  s_xor_b32 s67, s37, 128
  buffer_load_dwordx4 v118, s[16:19], s67 offen offset:0 lds
  buffer_load_dwordx4 v119, s[16:19], s67 offen offset:1024 lds
  buffer_load_dwordx4 v120, s[16:19], s67 offen offset:2048 lds
  buffer_load_dwordx4 v121, s[16:19], s67 offen offset:3072 lds
  s_mov_b32 m0, 71680
  s_xor_b32 s67, s37, 262272
  buffer_load_dwordx4 v118, s[16:19], s67 offen offset:0 lds
  buffer_load_dwordx4 v119, s[16:19], s67 offen offset:1024 lds
  buffer_load_dwordx4 v120, s[16:19], s67 offen offset:2048 lds
  buffer_load_dwordx4 v121, s[16:19], s67 offen offset:3072 lds
  s_xor_b32 s53, s86, s48
  s_mov_b32 m0, 0
  s_nop 0
  buffer_load_dwordx4 v126, s[8:11], s53 offen offset:0 nt lds
  s_mov_b32 m0, 64
  s_nop 0
  buffer_load_dwordx4 v126, s[8:11], s53 offen offset:1024 nt lds
  s_mov_b32 m0, 128
  s_nop 0
  buffer_load_dwordx4 v126, s[8:11], s53 offen offset:2048 nt lds
  s_mov_b32 m0, 192
  s_add_u32 s86, s86, 4096
  buffer_load_dwordx4 v126, s[8:11], s53 offen offset:3072 nt lds
  s_xor_b32 s53, s86, s48
  s_mov_b32 m0, 4352
  s_nop 0
  buffer_load_dwordx4 v126, s[8:11], s53 offen offset:0 nt lds
  s_mov_b32 m0, 4416
  s_nop 0
  buffer_load_dwordx4 v126, s[8:11], s53 offen offset:1024 nt lds
  s_mov_b32 m0, 4480
  s_waitcnt vmcnt(59)
  buffer_load_dwordx4 v126, s[8:11], s53 offen offset:2048 nt lds
  s_mov_b32 m0, 4544
  s_add_u32 s86, s86, 4096
  buffer_load_dwordx4 v126, s[8:11], s53 offen offset:3072 nt lds
  s_mov_b32 m0, 34816
  s_xor_b32 s53, s87, s48
  buffer_load_dwordx4 v116, s[12:15], s53 offen offset:0 nt lds
  s_waitcnt vmcnt(59)
  buffer_load_dwordx4 v117, s[12:15], s53 offen offset:1024 nt lds
  buffer_load_dwordx4 v116, s[12:15], s53 offen offset:2048 nt lds
  buffer_load_dwordx4 v117, s[12:15], s53 offen offset:3072 nt lds
  s_add_u32 s87, s87, 4096
  s_mov_b32 m0, 38912
  s_xor_b32 s53, s87, s48
  s_waitcnt vmcnt(59)
  buffer_load_dwordx4 v116, s[12:15], s53 offen offset:0 nt lds
  buffer_load_dwordx4 v117, s[12:15], s53 offen offset:1024 nt lds
  buffer_load_dwordx4 v116, s[12:15], s53 offen offset:2048 nt lds
  s_waitcnt vmcnt(59)
  buffer_load_dwordx4 v117, s[12:15], s53 offen offset:3072 nt lds
  s_add_u32 s87, s87, 4096
  s_waitcnt vmcnt(48)
  s_barrier
  s_mov_b32 m0, 75776
  s_xor_b32 s67, s37, 524416
  buffer_load_dwordx4 v118, s[16:19], s67 offen offset:0 lds
  buffer_load_dwordx4 v119, s[16:19], s67 offen offset:1024 lds
  buffer_load_dwordx4 v120, s[16:19], s67 offen offset:2048 lds
  buffer_load_dwordx4 v121, s[16:19], s67 offen offset:3072 lds
  s_mov_b32 m0, 79872
  s_xor_b32 s67, s37, 786560
  buffer_load_dwordx4 v118, s[16:19], s67 offen offset:0 lds
  buffer_load_dwordx4 v119, s[16:19], s67 offen offset:1024 lds
  buffer_load_dwordx4 v120, s[16:19], s67 offen offset:2048 lds
  buffer_load_dwordx4 v121, s[16:19], s67 offen offset:3072 lds
  s_xor_b32 s53, s86, s48
  s_mov_b32 m0, 8704
  s_nop 0
  buffer_load_dwordx4 v126, s[8:11], s53 offen offset:0 nt lds
  s_mov_b32 m0, 8768
  s_nop 0
  buffer_load_dwordx4 v126, s[8:11], s53 offen offset:1024 nt lds
  s_mov_b32 m0, 8832
  s_nop 0
  buffer_load_dwordx4 v126, s[8:11], s53 offen offset:2048 nt lds
  s_mov_b32 m0, 8896
  s_add_u32 s86, s86, 4096
  buffer_load_dwordx4 v126, s[8:11], s53 offen offset:3072 nt lds
  s_xor_b32 s53, s86, s48
  s_mov_b32 m0, 13056
  s_nop 0
  buffer_load_dwordx4 v126, s[8:11], s53 offen offset:0 nt lds
  s_mov_b32 m0, 13120
  s_nop 0
  buffer_load_dwordx4 v126, s[8:11], s53 offen offset:1024 nt lds
  s_mov_b32 m0, 13184
  s_waitcnt vmcnt(59)
  buffer_load_dwordx4 v126, s[8:11], s53 offen offset:2048 nt lds
  s_mov_b32 m0, 13248
  s_add_u32 s86, s86, 4096
  buffer_load_dwordx4 v126, s[8:11], s53 offen offset:3072 nt lds
  s_mov_b32 m0, 43008
  s_xor_b32 s53, s87, s48
  buffer_load_dwordx4 v116, s[12:15], s53 offen offset:0 nt lds
  s_waitcnt vmcnt(59)
  buffer_load_dwordx4 v117, s[12:15], s53 offen offset:1024 nt lds
  buffer_load_dwordx4 v116, s[12:15], s53 offen offset:2048 nt lds
  buffer_load_dwordx4 v117, s[12:15], s53 offen offset:3072 nt lds
  s_add_u32 s87, s87, 4096
  s_mov_b32 m0, 47104
  s_xor_b32 s53, s87, s48
  s_waitcnt vmcnt(59)
  buffer_load_dwordx4 v116, s[12:15], s53 offen offset:0 nt lds
  buffer_load_dwordx4 v117, s[12:15], s53 offen offset:1024 nt lds
  buffer_load_dwordx4 v116, s[12:15], s53 offen offset:2048 nt lds
  s_waitcnt vmcnt(59)
  buffer_load_dwordx4 v117, s[12:15], s53 offen offset:3072 nt lds
  s_add_u32 s87, s87, 4096
  s_waitcnt vmcnt(48)
  s_barrier
  s_mov_b32 m0, 83968
  s_xor_b32 s67, s37, 1048704
  buffer_load_dwordx4 v118, s[16:19], s67 offen offset:0 lds
  buffer_load_dwordx4 v119, s[16:19], s67 offen offset:1024 lds
  buffer_load_dwordx4 v120, s[16:19], s67 offen offset:2048 lds
  buffer_load_dwordx4 v121, s[16:19], s67 offen offset:3072 lds
  s_mov_b32 m0, 88064
  s_xor_b32 s67, s37, 1310848
  buffer_load_dwordx4 v118, s[16:19], s67 offen offset:0 lds
  buffer_load_dwordx4 v119, s[16:19], s67 offen offset:1024 lds
  buffer_load_dwordx4 v120, s[16:19], s67 offen offset:2048 lds
  buffer_load_dwordx4 v121, s[16:19], s67 offen offset:3072 lds
  s_xor_b32 s53, s86, s48
  s_mov_b32 m0, 17408
  s_nop 0
  buffer_load_dwordx4 v126, s[8:11], s53 offen offset:0 nt lds
  s_mov_b32 m0, 17472
  s_nop 0
  buffer_load_dwordx4 v126, s[8:11], s53 offen offset:1024 nt lds
  s_mov_b32 m0, 17536
  s_nop 0
  buffer_load_dwordx4 v126, s[8:11], s53 offen offset:2048 nt lds
  s_mov_b32 m0, 17600
  s_add_u32 s86, s86, 4096
  buffer_load_dwordx4 v126, s[8:11], s53 offen offset:3072 nt lds
  s_xor_b32 s53, s86, s48
  s_mov_b32 m0, 21760
  s_nop 0
  buffer_load_dwordx4 v126, s[8:11], s53 offen offset:0 nt lds
  s_mov_b32 m0, 21824
  s_nop 0
  buffer_load_dwordx4 v126, s[8:11], s53 offen offset:1024 nt lds
  s_mov_b32 m0, 21888
  s_waitcnt vmcnt(59)
  buffer_load_dwordx4 v126, s[8:11], s53 offen offset:2048 nt lds
  s_mov_b32 m0, 21952
  s_add_u32 s86, s86, 4096
  buffer_load_dwordx4 v126, s[8:11], s53 offen offset:3072 nt lds
  s_mov_b32 m0, 51200
  s_xor_b32 s53, s87, s48
  buffer_load_dwordx4 v116, s[12:15], s53 offen offset:0 nt lds
  s_waitcnt vmcnt(59)
  buffer_load_dwordx4 v117, s[12:15], s53 offen offset:1024 nt lds
  buffer_load_dwordx4 v116, s[12:15], s53 offen offset:2048 nt lds
  buffer_load_dwordx4 v117, s[12:15], s53 offen offset:3072 nt lds
  s_add_u32 s87, s87, 4096
  s_mov_b32 m0, 55296
  s_xor_b32 s53, s87, s48
  s_waitcnt vmcnt(59)
  buffer_load_dwordx4 v116, s[12:15], s53 offen offset:0 nt lds
  buffer_load_dwordx4 v117, s[12:15], s53 offen offset:1024 nt lds
  buffer_load_dwordx4 v116, s[12:15], s53 offen offset:2048 nt lds
  s_waitcnt vmcnt(59)
  buffer_load_dwordx4 v117, s[12:15], s53 offen offset:3072 nt lds
  s_add_u32 s87, s87, 4096
  s_waitcnt vmcnt(48)
  s_barrier
  s_mov_b32 m0, 92160
  s_xor_b32 s67, s37, 1572992
  buffer_load_dwordx4 v118, s[16:19], s67 offen offset:0 lds
  buffer_load_dwordx4 v119, s[16:19], s67 offen offset:1024 lds
  buffer_load_dwordx4 v120, s[16:19], s67 offen offset:2048 lds
  buffer_load_dwordx4 v121, s[16:19], s67 offen offset:3072 lds
  s_mov_b32 m0, 96256
  s_xor_b32 s67, s37, 1835136
  buffer_load_dwordx4 v118, s[16:19], s67 offen offset:0 lds
  buffer_load_dwordx4 v119, s[16:19], s67 offen offset:1024 lds
  buffer_load_dwordx4 v120, s[16:19], s67 offen offset:2048 lds
  buffer_load_dwordx4 v121, s[16:19], s67 offen offset:3072 lds
  s_xor_b32 s53, s86, s48
  s_mov_b32 m0, 26112
  s_nop 0
  buffer_load_dwordx4 v126, s[8:11], s53 offen offset:0 nt lds
  s_mov_b32 m0, 26176
  s_nop 0
  buffer_load_dwordx4 v126, s[8:11], s53 offen offset:1024 nt lds
  s_mov_b32 m0, 26240
  s_nop 0
  buffer_load_dwordx4 v126, s[8:11], s53 offen offset:2048 nt lds
  s_mov_b32 m0, 26304
  s_add_u32 s86, s86, 4096
  buffer_load_dwordx4 v126, s[8:11], s53 offen offset:3072 nt lds
  s_xor_b32 s53, s86, s48
  s_mov_b32 m0, 30464
  s_nop 0
  buffer_load_dwordx4 v126, s[8:11], s53 offen offset:0 nt lds
  s_mov_b32 m0, 30528
  s_nop 0
  buffer_load_dwordx4 v126, s[8:11], s53 offen offset:1024 nt lds
  s_mov_b32 m0, 30592
  s_waitcnt vmcnt(59)
  buffer_load_dwordx4 v126, s[8:11], s53 offen offset:2048 nt lds
  s_mov_b32 m0, 30656
  s_add_u32 s86, s86, 4096
  buffer_load_dwordx4 v126, s[8:11], s53 offen offset:3072 nt lds
  s_mov_b32 m0, 59392
  s_xor_b32 s53, s87, s48
  buffer_load_dwordx4 v116, s[12:15], s53 offen offset:0 nt lds
  s_waitcnt vmcnt(59)
  buffer_load_dwordx4 v117, s[12:15], s53 offen offset:1024 nt lds
  buffer_load_dwordx4 v116, s[12:15], s53 offen offset:2048 nt lds
  buffer_load_dwordx4 v117, s[12:15], s53 offen offset:3072 nt lds
  s_add_u32 s87, s87, 4096
  s_mov_b32 m0, 63488
  s_xor_b32 s53, s87, s48
  s_waitcnt vmcnt(59)
  buffer_load_dwordx4 v116, s[12:15], s53 offen offset:0 nt lds
  buffer_load_dwordx4 v117, s[12:15], s53 offen offset:1024 nt lds
  buffer_load_dwordx4 v116, s[12:15], s53 offen offset:2048 nt lds
  s_waitcnt vmcnt(59)
  buffer_load_dwordx4 v117, s[12:15], s53 offen offset:3072 nt lds
  s_add_u32 s87, s87, 4096
  s_waitcnt vmcnt(48)
  s_barrier
  s_mov_b32 m0, 67584
  s_xor_b32 s67, s37, 2097280
  buffer_load_dwordx4 v118, s[16:19], s67 offen offset:0 lds
  buffer_load_dwordx4 v119, s[16:19], s67 offen offset:1024 lds
  buffer_load_dwordx4 v120, s[16:19], s67 offen offset:2048 lds
  buffer_load_dwordx4 v121, s[16:19], s67 offen offset:3072 lds
  s_mov_b32 m0, 71680
  s_xor_b32 s67, s37, 2359424
  buffer_load_dwordx4 v118, s[16:19], s67 offen offset:0 lds
  buffer_load_dwordx4 v119, s[16:19], s67 offen offset:1024 lds
  buffer_load_dwordx4 v120, s[16:19], s67 offen offset:2048 lds
  buffer_load_dwordx4 v121, s[16:19], s67 offen offset:3072 lds
  s_xor_b32 s53, s86, s48
  s_mov_b32 m0, 0
  s_nop 0
  buffer_load_dwordx4 v126, s[8:11], s53 offen offset:0 nt lds
  s_mov_b32 m0, 64
  s_nop 0
  buffer_load_dwordx4 v126, s[8:11], s53 offen offset:1024 nt lds
  s_mov_b32 m0, 128
  s_nop 0
  buffer_load_dwordx4 v126, s[8:11], s53 offen offset:2048 nt lds
  s_mov_b32 m0, 192
  s_add_u32 s86, s86, 4096
  buffer_load_dwordx4 v126, s[8:11], s53 offen offset:3072 nt lds
  s_xor_b32 s53, s86, s48
  s_mov_b32 m0, 4352
  s_nop 0
  buffer_load_dwordx4 v126, s[8:11], s53 offen offset:0 nt lds
  s_mov_b32 m0, 4416
  s_nop 0
  buffer_load_dwordx4 v126, s[8:11], s53 offen offset:1024 nt lds
  s_mov_b32 m0, 4480
  s_waitcnt vmcnt(59)
  buffer_load_dwordx4 v126, s[8:11], s53 offen offset:2048 nt lds
  s_mov_b32 m0, 4544
  s_add_u32 s86, s86, 4096
  buffer_load_dwordx4 v126, s[8:11], s53 offen offset:3072 nt lds
  s_mov_b32 m0, 34816
  s_xor_b32 s53, s87, s48
  buffer_load_dwordx4 v116, s[12:15], s53 offen offset:0 nt lds
  s_waitcnt vmcnt(59)
  buffer_load_dwordx4 v117, s[12:15], s53 offen offset:1024 nt lds
  buffer_load_dwordx4 v116, s[12:15], s53 offen offset:2048 nt lds
  buffer_load_dwordx4 v117, s[12:15], s53 offen offset:3072 nt lds
  s_add_u32 s87, s87, 4096
  s_mov_b32 m0, 38912
  s_xor_b32 s53, s87, s48
  s_waitcnt vmcnt(59)
  buffer_load_dwordx4 v116, s[12:15], s53 offen offset:0 nt lds
  buffer_load_dwordx4 v117, s[12:15], s53 offen offset:1024 nt lds
  buffer_load_dwordx4 v116, s[12:15], s53 offen offset:2048 nt lds
  s_waitcnt vmcnt(59)
  buffer_load_dwordx4 v117, s[12:15], s53 offen offset:3072 nt lds
  s_add_u32 s87, s87, 4096
  s_waitcnt vmcnt(48)
  s_barrier
  s_mov_b32 m0, 75776
  s_xor_b32 s67, s37, 2621568
  buffer_load_dwordx4 v118, s[16:19], s67 offen offset:0 lds
  buffer_load_dwordx4 v119, s[16:19], s67 offen offset:1024 lds
  buffer_load_dwordx4 v120, s[16:19], s67 offen offset:2048 lds
  buffer_load_dwordx4 v121, s[16:19], s67 offen offset:3072 lds
  s_mov_b32 m0, 79872
  s_xor_b32 s67, s37, 2883712
  buffer_load_dwordx4 v118, s[16:19], s67 offen offset:0 lds
  buffer_load_dwordx4 v119, s[16:19], s67 offen offset:1024 lds
  buffer_load_dwordx4 v120, s[16:19], s67 offen offset:2048 lds
  buffer_load_dwordx4 v121, s[16:19], s67 offen offset:3072 lds
  s_xor_b32 s53, s86, s48
  s_mov_b32 m0, 8704
  s_nop 0
  buffer_load_dwordx4 v126, s[8:11], s53 offen offset:0 nt lds
  s_mov_b32 m0, 8768
  s_nop 0
  buffer_load_dwordx4 v126, s[8:11], s53 offen offset:1024 nt lds
  s_mov_b32 m0, 8832
  s_nop 0
  buffer_load_dwordx4 v126, s[8:11], s53 offen offset:2048 nt lds
  s_mov_b32 m0, 8896
  s_add_u32 s86, s86, 4096
  buffer_load_dwordx4 v126, s[8:11], s53 offen offset:3072 nt lds
  s_xor_b32 s53, s86, s48
  s_mov_b32 m0, 13056
  s_nop 0
  buffer_load_dwordx4 v126, s[8:11], s53 offen offset:0 nt lds
  s_mov_b32 m0, 13120
  s_nop 0
  buffer_load_dwordx4 v126, s[8:11], s53 offen offset:1024 nt lds
  s_mov_b32 m0, 13184
  s_waitcnt vmcnt(59)
  buffer_load_dwordx4 v126, s[8:11], s53 offen offset:2048 nt lds
  s_mov_b32 m0, 13248
  s_add_u32 s86, s86, 4096
  buffer_load_dwordx4 v126, s[8:11], s53 offen offset:3072 nt lds
  s_mov_b32 m0, 43008
  s_xor_b32 s53, s87, s48
  buffer_load_dwordx4 v116, s[12:15], s53 offen offset:0 nt lds
  s_waitcnt vmcnt(59)
  buffer_load_dwordx4 v117, s[12:15], s53 offen offset:1024 nt lds
  buffer_load_dwordx4 v116, s[12:15], s53 offen offset:2048 nt lds
  buffer_load_dwordx4 v117, s[12:15], s53 offen offset:3072 nt lds
  s_add_u32 s87, s87, 4096
  s_mov_b32 m0, 47104
  s_xor_b32 s53, s87, s48
  s_waitcnt vmcnt(59)
  buffer_load_dwordx4 v116, s[12:15], s53 offen offset:0 nt lds
  buffer_load_dwordx4 v117, s[12:15], s53 offen offset:1024 nt lds
  buffer_load_dwordx4 v116, s[12:15], s53 offen offset:2048 nt lds
  s_waitcnt vmcnt(59)
  buffer_load_dwordx4 v117, s[12:15], s53 offen offset:3072 nt lds
  s_add_u32 s87, s87, 4096
  s_waitcnt vmcnt(48)
  s_barrier
  s_mov_b32 m0, 83968
  s_xor_b32 s67, s37, 3145856
  buffer_load_dwordx4 v118, s[16:19], s67 offen offset:0 lds
  buffer_load_dwordx4 v119, s[16:19], s67 offen offset:1024 lds
  buffer_load_dwordx4 v120, s[16:19], s67 offen offset:2048 lds
  buffer_load_dwordx4 v121, s[16:19], s67 offen offset:3072 lds
  s_mov_b32 m0, 88064
  s_xor_b32 s67, s37, 3408000
  buffer_load_dwordx4 v118, s[16:19], s67 offen offset:0 lds
  buffer_load_dwordx4 v119, s[16:19], s67 offen offset:1024 lds
  buffer_load_dwordx4 v120, s[16:19], s67 offen offset:2048 lds
  buffer_load_dwordx4 v121, s[16:19], s67 offen offset:3072 lds
  s_xor_b32 s53, s86, s48
  s_mov_b32 m0, 17408
  s_nop 0
  buffer_load_dwordx4 v126, s[8:11], s53 offen offset:0 nt lds
  s_mov_b32 m0, 17472
  s_nop 0
  buffer_load_dwordx4 v126, s[8:11], s53 offen offset:1024 nt lds
  s_mov_b32 m0, 17536
  s_nop 0
  buffer_load_dwordx4 v126, s[8:11], s53 offen offset:2048 nt lds
  s_mov_b32 m0, 17600
  s_add_u32 s86, s86, 4096
  buffer_load_dwordx4 v126, s[8:11], s53 offen offset:3072 nt lds
  s_xor_b32 s53, s86, s48
  s_mov_b32 m0, 21760
  s_nop 0
  buffer_load_dwordx4 v126, s[8:11], s53 offen offset:0 nt lds
  s_mov_b32 m0, 21824
  s_nop 0
  buffer_load_dwordx4 v126, s[8:11], s53 offen offset:1024 nt lds
  s_mov_b32 m0, 21888
  s_waitcnt vmcnt(59)
  buffer_load_dwordx4 v126, s[8:11], s53 offen offset:2048 nt lds
  s_mov_b32 m0, 21952
  s_add_u32 s86, s86, 4096
  buffer_load_dwordx4 v126, s[8:11], s53 offen offset:3072 nt lds
  s_mov_b32 m0, 51200
  s_xor_b32 s53, s87, s48
  buffer_load_dwordx4 v116, s[12:15], s53 offen offset:0 nt lds
  s_waitcnt vmcnt(59)
  buffer_load_dwordx4 v117, s[12:15], s53 offen offset:1024 nt lds
  buffer_load_dwordx4 v116, s[12:15], s53 offen offset:2048 nt lds
  buffer_load_dwordx4 v117, s[12:15], s53 offen offset:3072 nt lds
  s_add_u32 s87, s87, 4096
  s_mov_b32 m0, 55296
  s_xor_b32 s53, s87, s48
  s_waitcnt vmcnt(59)
  buffer_load_dwordx4 v116, s[12:15], s53 offen offset:0 nt lds
  buffer_load_dwordx4 v117, s[12:15], s53 offen offset:1024 nt lds
  buffer_load_dwordx4 v116, s[12:15], s53 offen offset:2048 nt lds
  s_waitcnt vmcnt(59)
  buffer_load_dwordx4 v117, s[12:15], s53 offen offset:3072 nt lds
  s_add_u32 s87, s87, 4096
  s_mov_b32 m0, 100352
  s_xor_b32 s67, s88, 0
  buffer_load_dwordx4 v118, s[16:19], s67 offen offset:0 lds
  buffer_load_dwordx4 v119, s[16:19], s67 offen offset:1024 lds
  s_waitcnt vmcnt(59)
  buffer_load_dwordx4 v120, s[16:19], s67 offen offset:2048 lds
  buffer_load_dwordx4 v121, s[16:19], s67 offen offset:3072 lds
  s_mov_b32 m0, 104448
  s_xor_b32 s67, s88, 262144
  buffer_load_dwordx4 v118, s[16:19], s67 offen offset:0 lds
  s_waitcnt vmcnt(59)
  buffer_load_dwordx4 v119, s[16:19], s67 offen offset:1024 lds
  buffer_load_dwordx4 v120, s[16:19], s67 offen offset:2048 lds
  buffer_load_dwordx4 v121, s[16:19], s67 offen offset:3072 lds
  s_waitcnt vmcnt(56)
  s_barrier
  s_mov_b32 m0, 92160
  s_xor_b32 s67, s37, 3670144
  buffer_load_dwordx4 v118, s[16:19], s67 offen offset:0 lds
  buffer_load_dwordx4 v119, s[16:19], s67 offen offset:1024 lds
  buffer_load_dwordx4 v120, s[16:19], s67 offen offset:2048 lds
  buffer_load_dwordx4 v121, s[16:19], s67 offen offset:3072 lds
  s_mov_b32 m0, 96256
  s_xor_b32 s67, s37, 3932288
  buffer_load_dwordx4 v118, s[16:19], s67 offen offset:0 lds
  buffer_load_dwordx4 v119, s[16:19], s67 offen offset:1024 lds
  s_waitcnt vmcnt(59)
  buffer_load_dwordx4 v120, s[16:19], s67 offen offset:2048 lds
  buffer_load_dwordx4 v121, s[16:19], s67 offen offset:3072 lds
  s_xor_b32 s53, s86, s48
  s_mov_b32 m0, 26112
  s_nop 0
  buffer_load_dwordx4 v126, s[8:11], s53 offen offset:0 nt lds
  s_mov_b32 m0, 26176
  s_waitcnt vmcnt(59)
  buffer_load_dwordx4 v126, s[8:11], s53 offen offset:1024 nt lds
  s_mov_b32 m0, 26240
  s_nop 0
  buffer_load_dwordx4 v126, s[8:11], s53 offen offset:2048 nt lds
  s_mov_b32 m0, 26304
  s_add_u32 s86, s86, 4096
  buffer_load_dwordx4 v126, s[8:11], s53 offen offset:3072 nt lds
  s_xor_b32 s53, s86, s48
  s_mov_b32 m0, 30464
  s_waitcnt vmcnt(59)
  buffer_load_dwordx4 v126, s[8:11], s53 offen offset:0 nt lds
  s_mov_b32 m0, 30528
  s_nop 0
  buffer_load_dwordx4 v126, s[8:11], s53 offen offset:1024 nt lds
  s_mov_b32 m0, 30592
  s_nop 0
  buffer_load_dwordx4 v126, s[8:11], s53 offen offset:2048 nt lds
  s_mov_b32 m0, 30656
  s_add_u32 s86, s86, 4096
  s_waitcnt vmcnt(59)
  buffer_load_dwordx4 v126, s[8:11], s53 offen offset:3072 nt lds
  s_mov_b32 m0, 59392
  s_xor_b32 s53, s87, s48
  buffer_load_dwordx4 v116, s[12:15], s53 offen offset:0 nt lds
  buffer_load_dwordx4 v117, s[12:15], s53 offen offset:1024 nt lds
  s_waitcnt vmcnt(59)
  buffer_load_dwordx4 v116, s[12:15], s53 offen offset:2048 nt lds
  buffer_load_dwordx4 v117, s[12:15], s53 offen offset:3072 nt lds
  s_add_u32 s87, s87, 4096
  s_mov_b32 m0, 63488
  s_xor_b32 s53, s87, s48
  buffer_load_dwordx4 v116, s[12:15], s53 offen offset:0 nt lds
  s_waitcnt vmcnt(59)
  buffer_load_dwordx4 v117, s[12:15], s53 offen offset:1024 nt lds
  buffer_load_dwordx4 v116, s[12:15], s53 offen offset:2048 nt lds
  buffer_load_dwordx4 v117, s[12:15], s53 offen offset:3072 nt lds
  s_add_u32 s87, s87, 4096
  s_mov_b32 m0, 108544
  s_xor_b32 s67, s88, 524288
  s_waitcnt vmcnt(59)
  buffer_load_dwordx4 v118, s[16:19], s67 offen offset:0 lds
  buffer_load_dwordx4 v119, s[16:19], s67 offen offset:1024 lds
  buffer_load_dwordx4 v120, s[16:19], s67 offen offset:2048 lds
  s_waitcnt vmcnt(59)
  buffer_load_dwordx4 v121, s[16:19], s67 offen offset:3072 lds
  s_mov_b32 m0, 112640
  s_xor_b32 s67, s88, 786432
  buffer_load_dwordx4 v118, s[16:19], s67 offen offset:0 lds
  buffer_load_dwordx4 v119, s[16:19], s67 offen offset:1024 lds
  s_waitcnt vmcnt(59)
  buffer_load_dwordx4 v120, s[16:19], s67 offen offset:2048 lds
  buffer_load_dwordx4 v121, s[16:19], s67 offen offset:3072 lds
  s_barrier
  s_xor_b32 s53, s86, s48
  s_mov_b32 m0, 0
  s_nop 0
  buffer_load_dwordx4 v126, s[8:11], s53 offen offset:0 nt lds
  s_mov_b32 m0, 64
  s_waitcnt vmcnt(59)
  buffer_load_dwordx4 v126, s[8:11], s53 offen offset:1024 nt lds
  s_mov_b32 m0, 128
  s_nop 0
  buffer_load_dwordx4 v126, s[8:11], s53 offen offset:2048 nt lds
  s_mov_b32 m0, 192
  s_add_u32 s86, s86, 4096
  buffer_load_dwordx4 v126, s[8:11], s53 offen offset:3072 nt lds
  s_xor_b32 s53, s86, s48
  s_mov_b32 m0, 4352
  s_waitcnt vmcnt(59)
  buffer_load_dwordx4 v126, s[8:11], s53 offen offset:0 nt lds
  s_mov_b32 m0, 4416
  s_nop 0
  buffer_load_dwordx4 v126, s[8:11], s53 offen offset:1024 nt lds
  s_mov_b32 m0, 4480
  s_nop 0
  buffer_load_dwordx4 v126, s[8:11], s53 offen offset:2048 nt lds
  s_mov_b32 m0, 4544
  s_add_u32 s86, s86, 4096
  s_waitcnt vmcnt(59)
  buffer_load_dwordx4 v126, s[8:11], s53 offen offset:3072 nt lds
  s_mov_b32 m0, 34816
  s_xor_b32 s53, s87, s48
  buffer_load_dwordx4 v116, s[12:15], s53 offen offset:0 nt lds
  buffer_load_dwordx4 v117, s[12:15], s53 offen offset:1024 nt lds
  s_waitcnt vmcnt(59)
  buffer_load_dwordx4 v116, s[12:15], s53 offen offset:2048 nt lds
  buffer_load_dwordx4 v117, s[12:15], s53 offen offset:3072 nt lds
  s_add_u32 s87, s87, 4096
  s_mov_b32 m0, 38912
  s_xor_b32 s53, s87, s48
  buffer_load_dwordx4 v116, s[12:15], s53 offen offset:0 nt lds
  s_waitcnt vmcnt(59)
  buffer_load_dwordx4 v117, s[12:15], s53 offen offset:1024 nt lds
  buffer_load_dwordx4 v116, s[12:15], s53 offen offset:2048 nt lds
  buffer_load_dwordx4 v117, s[12:15], s53 offen offset:3072 nt lds
  s_add_u32 s87, s87, 4096
  s_mov_b32 m0, 116736
  s_xor_b32 s67, s88, 1048576
  s_waitcnt vmcnt(59)
  buffer_load_dwordx4 v118, s[16:19], s67 offen offset:0 lds
  buffer_load_dwordx4 v119, s[16:19], s67 offen offset:1024 lds
  buffer_load_dwordx4 v120, s[16:19], s67 offen offset:2048 lds
  s_waitcnt vmcnt(59)
  buffer_load_dwordx4 v121, s[16:19], s67 offen offset:3072 lds
  s_mov_b32 m0, 120832
  s_xor_b32 s67, s88, 1310720
  buffer_load_dwordx4 v118, s[16:19], s67 offen offset:0 lds
  buffer_load_dwordx4 v119, s[16:19], s67 offen offset:1024 lds
  s_waitcnt vmcnt(59)
  buffer_load_dwordx4 v120, s[16:19], s67 offen offset:2048 lds
  buffer_load_dwordx4 v121, s[16:19], s67 offen offset:3072 lds
  s_barrier
  s_xor_b32 s53, s86, s48
  s_mov_b32 m0, 8704
  s_nop 0
  buffer_load_dwordx4 v126, s[8:11], s53 offen offset:0 nt lds
  s_mov_b32 m0, 8768
  s_waitcnt vmcnt(59)
  buffer_load_dwordx4 v126, s[8:11], s53 offen offset:1024 nt lds
  s_mov_b32 m0, 8832
  s_nop 0
  buffer_load_dwordx4 v126, s[8:11], s53 offen offset:2048 nt lds
  s_mov_b32 m0, 8896
  s_add_u32 s86, s86, 4096
  buffer_load_dwordx4 v126, s[8:11], s53 offen offset:3072 nt lds
  s_xor_b32 s53, s86, s48
  s_mov_b32 m0, 13056
  s_waitcnt vmcnt(59)
  buffer_load_dwordx4 v126, s[8:11], s53 offen offset:0 nt lds
  s_mov_b32 m0, 13120
  s_nop 0
  buffer_load_dwordx4 v126, s[8:11], s53 offen offset:1024 nt lds
  s_mov_b32 m0, 13184
  s_nop 0
  buffer_load_dwordx4 v126, s[8:11], s53 offen offset:2048 nt lds
  s_mov_b32 m0, 13248
  s_add_u32 s86, s86, 4096
  s_waitcnt vmcnt(59)
  buffer_load_dwordx4 v126, s[8:11], s53 offen offset:3072 nt lds
  s_mov_b32 m0, 43008
  s_xor_b32 s53, s87, s48
  buffer_load_dwordx4 v116, s[12:15], s53 offen offset:0 nt lds
  buffer_load_dwordx4 v117, s[12:15], s53 offen offset:1024 nt lds
  s_waitcnt vmcnt(59)
  buffer_load_dwordx4 v116, s[12:15], s53 offen offset:2048 nt lds
  buffer_load_dwordx4 v117, s[12:15], s53 offen offset:3072 nt lds
  s_add_u32 s87, s87, 4096
  s_mov_b32 m0, 47104
  s_xor_b32 s53, s87, s48
  buffer_load_dwordx4 v116, s[12:15], s53 offen offset:0 nt lds
  s_waitcnt vmcnt(59)
  buffer_load_dwordx4 v117, s[12:15], s53 offen offset:1024 nt lds
  buffer_load_dwordx4 v116, s[12:15], s53 offen offset:2048 nt lds
  buffer_load_dwordx4 v117, s[12:15], s53 offen offset:3072 nt lds
  s_add_u32 s87, s87, 4096
  s_mov_b32 m0, 124928
  s_xor_b32 s67, s88, 1572864
  s_waitcnt vmcnt(59)
  buffer_load_dwordx4 v118, s[16:19], s67 offen offset:0 lds
  buffer_load_dwordx4 v119, s[16:19], s67 offen offset:1024 lds
  buffer_load_dwordx4 v120, s[16:19], s67 offen offset:2048 lds
  s_waitcnt vmcnt(59)
  buffer_load_dwordx4 v121, s[16:19], s67 offen offset:3072 lds
  s_mov_b32 m0, 129024
  s_xor_b32 s67, s88, 1835008
  buffer_load_dwordx4 v118, s[16:19], s67 offen offset:0 lds
  buffer_load_dwordx4 v119, s[16:19], s67 offen offset:1024 lds
  s_waitcnt vmcnt(59)
  buffer_load_dwordx4 v120, s[16:19], s67 offen offset:2048 lds
  buffer_load_dwordx4 v121, s[16:19], s67 offen offset:3072 lds
  s_waitcnt vmcnt(56)
  s_barrier
  s_mov_b32 m0, 83968
  s_xor_b32 s67, s70, 0
  buffer_load_dwordx4 v112, s[20:23], s67 offen offset:0 lds
  buffer_load_dwordx4 v113, s[20:23], s67 offen offset:1024 lds
  buffer_load_dwordx4 v114, s[20:23], s67 offen offset:2048 lds
  buffer_load_dwordx4 v115, s[20:23], s67 offen offset:3072 lds
  s_mov_b32 m0, 88064
  s_xor_b32 s67, s70, 16384
  buffer_load_dwordx4 v112, s[20:23], s67 offen offset:0 lds
  buffer_load_dwordx4 v113, s[20:23], s67 offen offset:1024 lds
  s_waitcnt vmcnt(59)
  buffer_load_dwordx4 v114, s[20:23], s67 offen offset:2048 lds
  buffer_load_dwordx4 v115, s[20:23], s67 offen offset:3072 lds
  s_xor_b32 s53, s86, s48
  s_mov_b32 m0, 17408
  s_nop 0
  buffer_load_dwordx4 v126, s[8:11], s53 offen offset:0 nt lds
  s_mov_b32 m0, 17472
  s_waitcnt vmcnt(59)
  buffer_load_dwordx4 v126, s[8:11], s53 offen offset:1024 nt lds
  s_mov_b32 m0, 17536
  s_nop 0
  buffer_load_dwordx4 v126, s[8:11], s53 offen offset:2048 nt lds
  s_mov_b32 m0, 17600
  s_add_u32 s86, s86, 4096
  buffer_load_dwordx4 v126, s[8:11], s53 offen offset:3072 nt lds
  s_xor_b32 s53, s86, s48
  s_mov_b32 m0, 21760
  s_waitcnt vmcnt(59)
  buffer_load_dwordx4 v126, s[8:11], s53 offen offset:0 nt lds
  s_mov_b32 m0, 21824
  s_nop 0
  buffer_load_dwordx4 v126, s[8:11], s53 offen offset:1024 nt lds
  s_mov_b32 m0, 21888
  s_nop 0
  buffer_load_dwordx4 v126, s[8:11], s53 offen offset:2048 nt lds
  s_mov_b32 m0, 21952
  s_add_u32 s86, s86, 4096
  s_waitcnt vmcnt(59)
  buffer_load_dwordx4 v126, s[8:11], s53 offen offset:3072 nt lds
  s_mov_b32 m0, 51200
  s_xor_b32 s53, s87, s48
  buffer_load_dwordx4 v116, s[12:15], s53 offen offset:0 nt lds
  buffer_load_dwordx4 v117, s[12:15], s53 offen offset:1024 nt lds
  s_waitcnt vmcnt(59)
  buffer_load_dwordx4 v116, s[12:15], s53 offen offset:2048 nt lds
  buffer_load_dwordx4 v117, s[12:15], s53 offen offset:3072 nt lds
  s_add_u32 s87, s87, 4096
  s_mov_b32 m0, 55296
  s_xor_b32 s53, s87, s48
  buffer_load_dwordx4 v116, s[12:15], s53 offen offset:0 nt lds
  s_waitcnt vmcnt(59)
  buffer_load_dwordx4 v117, s[12:15], s53 offen offset:1024 nt lds
  buffer_load_dwordx4 v116, s[12:15], s53 offen offset:2048 nt lds
  buffer_load_dwordx4 v117, s[12:15], s53 offen offset:3072 nt lds
  s_add_u32 s87, s87, 4096
  ds_read_b64_tr_b16 v[96:97], v122 offset:0
  ds_read_b64_tr_b16 v[98:99], v122 offset:512
  ds_read_b64_tr_b16 v[100:101], v122 offset:4096
  ds_read_b64_tr_b16 v[102:103], v122 offset:4608
  ds_read_b64_tr_b16 v[104:105], v123 offset:0
  ds_read_b64_tr_b16 v[106:107], v123 offset:512
  s_waitcnt lgkmcnt(4)
  v_mfma_f32_16x16x32_bf16 v[0:3], v[96:99], a[0:3], 0
  ds_read_b64_tr_b16 v[108:109], v123 offset:4096
  v_mfma_f32_16x16x32_bf16 v[4:7], v[96:99], a[4:7], 0
  v_mfma_f32_16x16x32_bf16 v[8:11], v[96:99], a[8:11], 0
  ds_read_b64_tr_b16 v[110:111], v123 offset:4608
  v_mfma_f32_16x16x32_bf16 v[12:15], v[96:99], a[12:15], 0
  v_mfma_f32_16x16x32_bf16 v[16:19], v[96:99], a[16:19], 0
  v_mfma_f32_16x16x32_bf16 v[20:23], v[96:99], a[20:23], 0
  s_waitcnt lgkmcnt(4)
  v_mfma_f32_16x16x32_bf16 v[0:3], v[100:103], a[24:27], v[0:3]
  ds_read_b64_tr_b16 v[96:97], v124 offset:0
  v_mfma_f32_16x16x32_bf16 v[4:7], v[100:103], a[28:31], v[4:7]
  v_mfma_f32_16x16x32_bf16 v[8:11], v[100:103], a[32:35], v[8:11]
  ds_read_b64_tr_b16 v[98:99], v124 offset:512
  v_mfma_f32_16x16x32_bf16 v[12:15], v[100:103], a[36:39], v[12:15]
  v_mfma_f32_16x16x32_bf16 v[16:19], v[100:103], a[40:43], v[16:19]
  v_mfma_f32_16x16x32_bf16 v[20:23], v[100:103], a[44:47], v[20:23]
  s_waitcnt lgkmcnt(4)
  v_mfma_f32_16x16x32_bf16 v[24:27], v[104:107], a[0:3], 0
  ds_read_b64_tr_b16 v[100:101], v124 offset:4096
  v_mfma_f32_16x16x32_bf16 v[28:31], v[104:107], a[4:7], 0
  v_mfma_f32_16x16x32_bf16 v[32:35], v[104:107], a[8:11], 0
  ds_read_b64_tr_b16 v[102:103], v124 offset:4608
  v_mfma_f32_16x16x32_bf16 v[36:39], v[104:107], a[12:15], 0
  v_mfma_f32_16x16x32_bf16 v[40:43], v[104:107], a[16:19], 0
  v_mfma_f32_16x16x32_bf16 v[44:47], v[104:107], a[20:23], 0
  s_waitcnt lgkmcnt(4)
  v_mfma_f32_16x16x32_bf16 v[24:27], v[108:111], a[24:27], v[24:27]
  ds_read_b64_tr_b16 v[104:105], v125 offset:0
  v_mfma_f32_16x16x32_bf16 v[28:31], v[108:111], a[28:31], v[28:31]
  v_mfma_f32_16x16x32_bf16 v[32:35], v[108:111], a[32:35], v[32:35]
  ds_read_b64_tr_b16 v[106:107], v125 offset:512
  v_mfma_f32_16x16x32_bf16 v[36:39], v[108:111], a[36:39], v[36:39]
  v_mfma_f32_16x16x32_bf16 v[40:43], v[108:111], a[40:43], v[40:43]
  v_mfma_f32_16x16x32_bf16 v[44:47], v[108:111], a[44:47], v[44:47]
  s_waitcnt lgkmcnt(4)
  v_mfma_f32_16x16x32_bf16 v[48:51], v[96:99], a[0:3], 0
  ds_read_b64_tr_b16 v[108:109], v125 offset:4096
  v_mfma_f32_16x16x32_bf16 v[52:55], v[96:99], a[4:7], 0
  v_mfma_f32_16x16x32_bf16 v[56:59], v[96:99], a[8:11], 0
  ds_read_b64_tr_b16 v[110:111], v125 offset:4608
  v_mfma_f32_16x16x32_bf16 v[60:63], v[96:99], a[12:15], 0
  v_mfma_f32_16x16x32_bf16 v[64:67], v[96:99], a[16:19], 0
  v_mfma_f32_16x16x32_bf16 v[68:71], v[96:99], a[20:23], 0
  s_waitcnt lgkmcnt(4)
  v_mfma_f32_16x16x32_bf16 v[48:51], v[100:103], a[24:27], v[48:51]
  ds_read_b64_tr_b16 v[96:97], v122 offset:8192
  v_mfma_f32_16x16x32_bf16 v[52:55], v[100:103], a[28:31], v[52:55]
  v_mfma_f32_16x16x32_bf16 v[56:59], v[100:103], a[32:35], v[56:59]
  ds_read_b64_tr_b16 v[98:99], v122 offset:8704
  v_mfma_f32_16x16x32_bf16 v[60:63], v[100:103], a[36:39], v[60:63]
  v_mfma_f32_16x16x32_bf16 v[64:67], v[100:103], a[40:43], v[64:67]
  v_mfma_f32_16x16x32_bf16 v[68:71], v[100:103], a[44:47], v[68:71]
  s_waitcnt vmcnt(48) lgkmcnt(0)
  s_barrier
  s_mov_b32 s64, 16
  s_mov_b32 s71, s93
L_lloop:
  v_mfma_f32_16x16x32_bf16 v[72:75], v[104:107], a[0:3], 0
  ds_read_b64_tr_b16 v[100:101], v122 offset:12288
  v_mfma_f32_16x16x32_bf16 v[76:79], v[104:107], a[4:7], 0
  s_mov_b32 m0, 92160
  s_xor_b32 s67, s70, 256
  buffer_load_dwordx4 v112, s[20:23], s67 offen offset:0 lds
  v_mfma_f32_16x16x32_bf16 v[80:83], v[104:107], a[8:11], 0
  ds_read_b64_tr_b16 v[102:103], v122 offset:12800
  buffer_load_dwordx4 v113, s[20:23], s67 offen offset:1024 lds
  v_mfma_f32_16x16x32_bf16 v[84:87], v[104:107], a[12:15], 0
  s_waitcnt vmcnt(59)
  buffer_load_dwordx4 v114, s[20:23], s67 offen offset:2048 lds
  v_mfma_f32_16x16x32_bf16 v[88:91], v[104:107], a[16:19], 0
  v_mfma_f32_16x16x32_bf16 v[92:95], v[104:107], a[20:23], 0
  buffer_load_dwordx4 v115, s[20:23], s67 offen offset:3072 lds
  v_mfma_f32_16x16x32_bf16 v[72:75], v[108:111], a[24:27], v[72:75]
  ds_read_b64_tr_b16 v[104:105], v123 offset:8192
  s_mov_b32 m0, 96256
  s_xor_b32 s67, s70, 16640
  buffer_load_dwordx4 v112, s[20:23], s67 offen offset:0 lds
  v_mfma_f32_16x16x32_bf16 v[76:79], v[108:111], a[28:31], v[76:79]
  s_waitcnt vmcnt(59)
  buffer_load_dwordx4 v113, s[20:23], s67 offen offset:1024 lds
  v_mfma_f32_16x16x32_bf16 v[80:83], v[108:111], a[32:35], v[80:83]
  ds_read_b64_tr_b16 v[106:107], v123 offset:8704
  v_mfma_f32_16x16x32_bf16 v[84:87], v[108:111], a[36:39], v[84:87]
  buffer_load_dwordx4 v114, s[20:23], s67 offen offset:2048 lds
  v_mfma_f32_16x16x32_bf16 v[88:91], v[108:111], a[40:43], v[88:91]
  buffer_load_dwordx4 v115, s[20:23], s67 offen offset:3072 lds
  v_mfma_f32_16x16x32_bf16 v[92:95], v[108:111], a[44:47], v[92:95]
  s_xor_b32 s53, s86, s48
  s_mov_b32 m0, 26112
  s_waitcnt vmcnt(59)
  buffer_load_dwordx4 v126, s[8:11], s53 offen offset:0 nt lds
  v_mfma_f32_16x16x32_bf16 v[0:3], v[96:99], a[48:51], v[0:3]
  ds_read_b64_tr_b16 v[108:109], v123 offset:12288
  v_mfma_f32_16x16x32_bf16 v[4:7], v[96:99], a[52:55], v[4:7]
  s_mov_b32 m0, 26176
  s_nop 0
  buffer_load_dwordx4 v126, s[8:11], s53 offen offset:1024 nt lds
  v_mfma_f32_16x16x32_bf16 v[8:11], v[96:99], a[56:59], v[8:11]
  ds_read_b64_tr_b16 v[110:111], v123 offset:12800
  s_mov_b32 m0, 26240
  s_nop 0
  buffer_load_dwordx4 v126, s[8:11], s53 offen offset:2048 nt lds
  v_mfma_f32_16x16x32_bf16 v[12:15], v[96:99], a[60:63], v[12:15]
  s_mov_b32 m0, 26304
  s_add_u32 s86, s86, 4096
  s_waitcnt vmcnt(59)
  buffer_load_dwordx4 v126, s[8:11], s53 offen offset:3072 nt lds
  v_mfma_f32_16x16x32_bf16 v[16:19], v[96:99], a[64:67], v[16:19]
  v_mfma_f32_16x16x32_bf16 v[20:23], v[96:99], a[68:71], v[20:23]
  s_xor_b32 s53, s86, s48
  s_mov_b32 m0, 30464
  s_nop 0
  buffer_load_dwordx4 v126, s[8:11], s53 offen offset:0 nt lds
  s_waitcnt lgkmcnt(4)
  v_mfma_f32_16x16x32_bf16 v[0:3], v[100:103], a[72:75], v[0:3]
  ds_read_b64_tr_b16 v[96:97], v124 offset:8192
  s_mov_b32 m0, 30528
  s_nop 0
  buffer_load_dwordx4 v126, s[8:11], s53 offen offset:1024 nt lds
  v_mfma_f32_16x16x32_bf16 v[4:7], v[100:103], a[76:79], v[4:7]
  s_mov_b32 m0, 30592
  s_waitcnt vmcnt(59)
  buffer_load_dwordx4 v126, s[8:11], s53 offen offset:2048 nt lds
  v_mfma_f32_16x16x32_bf16 v[8:11], v[100:103], a[80:83], v[8:11]
  ds_read_b64_tr_b16 v[98:99], v124 offset:8704
  v_mfma_f32_16x16x32_bf16 v[12:15], v[100:103], a[84:87], v[12:15]
  s_mov_b32 m0, 30656
  s_add_u32 s86, s86, 4096
  buffer_load_dwordx4 v126, s[8:11], s53 offen offset:3072 nt lds
  v_mfma_f32_16x16x32_bf16 v[16:19], v[100:103], a[88:91], v[16:19]
  s_mov_b32 m0, 59392
  s_xor_b32 s53, s87, s48
  buffer_load_dwordx4 v116, s[12:15], s53 offen offset:0 nt lds
  v_mfma_f32_16x16x32_bf16 v[20:23], v[100:103], a[92:95], v[20:23]
  s_waitcnt vmcnt(59)
  buffer_load_dwordx4 v117, s[12:15], s53 offen offset:1024 nt lds
  s_waitcnt lgkmcnt(4)
  v_mfma_f32_16x16x32_bf16 v[24:27], v[104:107], a[48:51], v[24:27]
  ds_read_b64_tr_b16 v[100:101], v124 offset:12288
  v_mfma_f32_16x16x32_bf16 v[28:31], v[104:107], a[52:55], v[28:31]
  buffer_load_dwordx4 v116, s[12:15], s53 offen offset:2048 nt lds
  v_mfma_f32_16x16x32_bf16 v[32:35], v[104:107], a[56:59], v[32:35]
  ds_read_b64_tr_b16 v[102:103], v124 offset:12800
  buffer_load_dwordx4 v117, s[12:15], s53 offen offset:3072 nt lds
  v_mfma_f32_16x16x32_bf16 v[36:39], v[104:107], a[60:63], v[36:39]
  s_add_u32 s87, s87, 4096
  s_mov_b32 m0, 63488
  s_xor_b32 s53, s87, s48
  s_waitcnt vmcnt(59)
  buffer_load_dwordx4 v116, s[12:15], s53 offen offset:0 nt lds
  v_mfma_f32_16x16x32_bf16 v[40:43], v[104:107], a[64:67], v[40:43]
  v_mfma_f32_16x16x32_bf16 v[44:47], v[104:107], a[68:71], v[44:47]
  buffer_load_dwordx4 v117, s[12:15], s53 offen offset:1024 nt lds
  s_waitcnt lgkmcnt(4)
  v_mfma_f32_16x16x32_bf16 v[24:27], v[108:111], a[72:75], v[24:27]
  ds_read_b64_tr_b16 v[104:105], v125 offset:8192
  buffer_load_dwordx4 v116, s[12:15], s53 offen offset:2048 nt lds
  v_mfma_f32_16x16x32_bf16 v[28:31], v[108:111], a[76:79], v[28:31]
  s_waitcnt vmcnt(59)
  buffer_load_dwordx4 v117, s[12:15], s53 offen offset:3072 nt lds
  s_add_u32 s87, s87, 4096
  v_mfma_f32_16x16x32_bf16 v[32:35], v[108:111], a[80:83], v[32:35]
  ds_read_b64_tr_b16 v[106:107], v125 offset:8704
  v_mfma_f32_16x16x32_bf16 v[36:39], v[108:111], a[84:87], v[36:39]
  s_mov_b32 m0, 100352
  s_xor_b32 s67, s88, 2097152
  buffer_load_dwordx4 v118, s[16:19], s67 offen offset:0 lds
  v_mfma_f32_16x16x32_bf16 v[40:43], v[108:111], a[88:91], v[40:43]
  buffer_load_dwordx4 v119, s[16:19], s67 offen offset:1024 lds
  v_mfma_f32_16x16x32_bf16 v[44:47], v[108:111], a[92:95], v[44:47]
  s_waitcnt vmcnt(59)
  buffer_load_dwordx4 v120, s[16:19], s67 offen offset:2048 lds
  s_waitcnt lgkmcnt(4)
  v_mfma_f32_16x16x32_bf16 v[48:51], v[96:99], a[48:51], v[48:51]
  ds_read_b64_tr_b16 v[108:109], v125 offset:12288
  v_mfma_f32_16x16x32_bf16 v[52:55], v[96:99], a[52:55], v[52:55]
  buffer_load_dwordx4 v121, s[16:19], s67 offen offset:3072 lds
  v_mfma_f32_16x16x32_bf16 v[56:59], v[96:99], a[56:59], v[56:59]
  ds_read_b64_tr_b16 v[110:111], v125 offset:12800
  s_mov_b32 m0, 104448
  s_xor_b32 s67, s88, 2359296
  buffer_load_dwordx4 v118, s[16:19], s67 offen offset:0 lds
  v_mfma_f32_16x16x32_bf16 v[60:63], v[96:99], a[60:63], v[60:63]
  s_waitcnt vmcnt(59)
  buffer_load_dwordx4 v119, s[16:19], s67 offen offset:1024 lds
  v_mfma_f32_16x16x32_bf16 v[64:67], v[96:99], a[64:67], v[64:67]
  v_mfma_f32_16x16x32_bf16 v[68:71], v[96:99], a[68:71], v[68:71]
  buffer_load_dwordx4 v120, s[16:19], s67 offen offset:2048 lds
  s_waitcnt lgkmcnt(4)
  v_mfma_f32_16x16x32_bf16 v[48:51], v[100:103], a[72:75], v[48:51]
  ds_read_b64_tr_b16 v[96:97], v122 offset:16384
  buffer_load_dwordx4 v121, s[16:19], s67 offen offset:3072 lds
  v_mfma_f32_16x16x32_bf16 v[52:55], v[100:103], a[76:79], v[52:55]
  v_mfma_f32_16x16x32_bf16 v[56:59], v[100:103], a[80:83], v[56:59]
  ds_read_b64_tr_b16 v[98:99], v122 offset:16896
  v_mfma_f32_16x16x32_bf16 v[60:63], v[100:103], a[84:87], v[60:63]
  v_mfma_f32_16x16x32_bf16 v[64:67], v[100:103], a[88:91], v[64:67]
  v_mfma_f32_16x16x32_bf16 v[68:71], v[100:103], a[92:95], v[68:71]
  s_waitcnt lgkmcnt(4)
  v_mfma_f32_16x16x32_bf16 v[72:75], v[104:107], a[48:51], v[72:75]
  ds_read_b64_tr_b16 v[100:101], v122 offset:20480
  v_mfma_f32_16x16x32_bf16 v[76:79], v[104:107], a[52:55], v[76:79]
  v_mfma_f32_16x16x32_bf16 v[80:83], v[104:107], a[56:59], v[80:83]
  ds_read_b64_tr_b16 v[102:103], v122 offset:20992
  v_mfma_f32_16x16x32_bf16 v[84:87], v[104:107], a[60:63], v[84:87]
  v_mfma_f32_16x16x32_bf16 v[88:91], v[104:107], a[64:67], v[88:91]
  v_mfma_f32_16x16x32_bf16 v[92:95], v[104:107], a[68:71], v[92:95]
  s_waitcnt lgkmcnt(4)
  v_mfma_f32_16x16x32_bf16 v[72:75], v[108:111], a[72:75], v[72:75]
  ds_read_b64_tr_b16 v[104:105], v123 offset:16384
  v_mfma_f32_16x16x32_bf16 v[76:79], v[108:111], a[76:79], v[76:79]
  v_mfma_f32_16x16x32_bf16 v[80:83], v[108:111], a[80:83], v[80:83]
  ds_read_b64_tr_b16 v[106:107], v123 offset:16896
  v_mfma_f32_16x16x32_bf16 v[84:87], v[108:111], a[84:87], v[84:87]
  s_barrier
  s_mov_b32 m0, 67584
  s_xor_b32 s67, s70, 512
  s_waitcnt vmcnt(59)
  buffer_load_dwordx4 v112, s[20:23], s67 offen offset:0 lds
  v_mfma_f32_16x16x32_bf16 v[88:91], v[108:111], a[88:91], v[88:91]
  buffer_load_dwordx4 v113, s[20:23], s67 offen offset:1024 lds
  v_mfma_f32_16x16x32_bf16 v[92:95], v[108:111], a[92:95], v[92:95]
  buffer_load_dwordx4 v114, s[20:23], s67 offen offset:2048 lds
  s_waitcnt lgkmcnt(4)
  v_mfma_f32_16x16x32_bf16 v[0:3], v[96:99], a[96:99], v[0:3]
  ds_read_b64_tr_b16 v[108:109], v123 offset:20480
  v_mfma_f32_16x16x32_bf16 v[4:7], v[96:99], a[100:103], v[4:7]
  s_waitcnt vmcnt(59)
  buffer_load_dwordx4 v115, s[20:23], s67 offen offset:3072 lds
  v_mfma_f32_16x16x32_bf16 v[8:11], v[96:99], a[104:107], v[8:11]
  ds_read_b64_tr_b16 v[110:111], v123 offset:20992
  s_mov_b32 m0, 71680
  s_xor_b32 s67, s70, 16896
  buffer_load_dwordx4 v112, s[20:23], s67 offen offset:0 lds
  v_mfma_f32_16x16x32_bf16 v[12:15], v[96:99], a[108:111], v[12:15]
  buffer_load_dwordx4 v113, s[20:23], s67 offen offset:1024 lds
  v_mfma_f32_16x16x32_bf16 v[16:19], v[96:99], a[112:115], v[16:19]
  v_mfma_f32_16x16x32_bf16 v[20:23], v[96:99], a[116:119], v[20:23]
  s_waitcnt vmcnt(59)
  buffer_load_dwordx4 v114, s[20:23], s67 offen offset:2048 lds
  s_waitcnt lgkmcnt(4)
  v_mfma_f32_16x16x32_bf16 v[0:3], v[100:103], a[120:123], v[0:3]
  ds_read_b64_tr_b16 v[96:97], v124 offset:16384
  buffer_load_dwordx4 v115, s[20:23], s67 offen offset:3072 lds
  v_mfma_f32_16x16x32_bf16 v[4:7], v[100:103], a[124:127], v[4:7]
  s_xor_b32 s53, s86, s48
  s_mov_b32 m0, 0
  s_nop 0
  buffer_load_dwordx4 v126, s[8:11], s53 offen offset:0 nt lds
  v_mfma_f32_16x16x32_bf16 v[8:11], v[100:103], a[128:131], v[8:11]
  ds_read_b64_tr_b16 v[98:99], v124 offset:16896
  v_mfma_f32_16x16x32_bf16 v[12:15], v[100:103], a[132:135], v[12:15]
  s_mov_b32 m0, 64
  s_waitcnt vmcnt(59)
  buffer_load_dwordx4 v126, s[8:11], s53 offen offset:1024 nt lds
  v_mfma_f32_16x16x32_bf16 v[16:19], v[100:103], a[136:139], v[16:19]
  s_mov_b32 m0, 128
  s_nop 0
  buffer_load_dwordx4 v126, s[8:11], s53 offen offset:2048 nt lds
  v_mfma_f32_16x16x32_bf16 v[20:23], v[100:103], a[140:143], v[20:23]
  s_mov_b32 m0, 192
  s_add_u32 s86, s86, 4096
  buffer_load_dwordx4 v126, s[8:11], s53 offen offset:3072 nt lds
  s_waitcnt lgkmcnt(4)
  v_mfma_f32_16x16x32_bf16 v[24:27], v[104:107], a[96:99], v[24:27]
  ds_read_b64_tr_b16 v[100:101], v124 offset:20480
  v_mfma_f32_16x16x32_bf16 v[28:31], v[104:107], a[100:103], v[28:31]
  s_xor_b32 s53, s86, s48
  s_mov_b32 m0, 4352
  s_waitcnt vmcnt(59)
  buffer_load_dwordx4 v126, s[8:11], s53 offen offset:0 nt lds
  v_mfma_f32_16x16x32_bf16 v[32:35], v[104:107], a[104:107], v[32:35]
  ds_read_b64_tr_b16 v[102:103], v124 offset:20992
  s_mov_b32 m0, 4416
  s_nop 0
  buffer_load_dwordx4 v126, s[8:11], s53 offen offset:1024 nt lds
  v_mfma_f32_16x16x32_bf16 v[36:39], v[104:107], a[108:111], v[36:39]
  s_mov_b32 m0, 4480
  s_nop 0
  buffer_load_dwordx4 v126, s[8:11], s53 offen offset:2048 nt lds
  v_mfma_f32_16x16x32_bf16 v[40:43], v[104:107], a[112:115], v[40:43]
  v_mfma_f32_16x16x32_bf16 v[44:47], v[104:107], a[116:119], v[44:47]
  s_mov_b32 m0, 4544
  s_add_u32 s86, s86, 4096
  s_waitcnt vmcnt(59)
  buffer_load_dwordx4 v126, s[8:11], s53 offen offset:3072 nt lds
  s_waitcnt lgkmcnt(4)
  v_mfma_f32_16x16x32_bf16 v[24:27], v[108:111], a[120:123], v[24:27]
  ds_read_b64_tr_b16 v[104:105], v125 offset:16384
  s_mov_b32 m0, 34816
  s_xor_b32 s53, s87, s48
  buffer_load_dwordx4 v116, s[12:15], s53 offen offset:0 nt lds
  v_mfma_f32_16x16x32_bf16 v[28:31], v[108:111], a[124:127], v[28:31]
  buffer_load_dwordx4 v117, s[12:15], s53 offen offset:1024 nt lds
  v_mfma_f32_16x16x32_bf16 v[32:35], v[108:111], a[128:131], v[32:35]
  ds_read_b64_tr_b16 v[106:107], v125 offset:16896
  v_mfma_f32_16x16x32_bf16 v[36:39], v[108:111], a[132:135], v[36:39]
  s_waitcnt vmcnt(59)
  buffer_load_dwordx4 v116, s[12:15], s53 offen offset:2048 nt lds
  v_mfma_f32_16x16x32_bf16 v[40:43], v[108:111], a[136:139], v[40:43]
  buffer_load_dwordx4 v117, s[12:15], s53 offen offset:3072 nt lds
  v_mfma_f32_16x16x32_bf16 v[44:47], v[108:111], a[140:143], v[44:47]
  s_add_u32 s87, s87, 4096
  s_mov_b32 m0, 38912
  s_xor_b32 s53, s87, s48
  buffer_load_dwordx4 v116, s[12:15], s53 offen offset:0 nt lds
  s_waitcnt lgkmcnt(4)
  v_mfma_f32_16x16x32_bf16 v[48:51], v[96:99], a[96:99], v[48:51]
  ds_read_b64_tr_b16 v[108:109], v125 offset:20480
  v_mfma_f32_16x16x32_bf16 v[52:55], v[96:99], a[100:103], v[52:55]
  s_waitcnt vmcnt(59)
  buffer_load_dwordx4 v117, s[12:15], s53 offen offset:1024 nt lds
  v_mfma_f32_16x16x32_bf16 v[56:59], v[96:99], a[104:107], v[56:59]
  ds_read_b64_tr_b16 v[110:111], v125 offset:20992
  buffer_load_dwordx4 v116, s[12:15], s53 offen offset:2048 nt lds
  v_mfma_f32_16x16x32_bf16 v[60:63], v[96:99], a[108:111], v[60:63]
  buffer_load_dwordx4 v117, s[12:15], s53 offen offset:3072 nt lds
  s_add_u32 s87, s87, 4096
  v_mfma_f32_16x16x32_bf16 v[64:67], v[96:99], a[112:115], v[64:67]
  v_mfma_f32_16x16x32_bf16 v[68:71], v[96:99], a[116:119], v[68:71]
  s_mov_b32 m0, 108544
  s_xor_b32 s67, s88, 2621440
  s_waitcnt vmcnt(59)
  buffer_load_dwordx4 v118, s[16:19], s67 offen offset:0 lds
  s_waitcnt lgkmcnt(4)
  v_mfma_f32_16x16x32_bf16 v[48:51], v[100:103], a[120:123], v[48:51]
  ds_read_b64_tr_b16 v[96:97], v122 offset:24576
  buffer_load_dwordx4 v119, s[16:19], s67 offen offset:1024 lds
  v_mfma_f32_16x16x32_bf16 v[52:55], v[100:103], a[124:127], v[52:55]
  buffer_load_dwordx4 v120, s[16:19], s67 offen offset:2048 lds
  v_mfma_f32_16x16x32_bf16 v[56:59], v[100:103], a[128:131], v[56:59]
  ds_read_b64_tr_b16 v[98:99], v122 offset:25088
  v_mfma_f32_16x16x32_bf16 v[60:63], v[100:103], a[132:135], v[60:63]
  s_waitcnt vmcnt(59)
  buffer_load_dwordx4 v121, s[16:19], s67 offen offset:3072 lds
  v_mfma_f32_16x16x32_bf16 v[64:67], v[100:103], a[136:139], v[64:67]
  s_mov_b32 m0, 112640
  s_xor_b32 s67, s88, 2883584
  buffer_load_dwordx4 v118, s[16:19], s67 offen offset:0 lds
  v_mfma_f32_16x16x32_bf16 v[68:71], v[100:103], a[140:143], v[68:71]
  buffer_load_dwordx4 v119, s[16:19], s67 offen offset:1024 lds
  s_waitcnt lgkmcnt(4)
  v_mfma_f32_16x16x32_bf16 v[72:75], v[104:107], a[96:99], v[72:75]
  ds_read_b64_tr_b16 v[100:101], v122 offset:28672
  v_mfma_f32_16x16x32_bf16 v[76:79], v[104:107], a[100:103], v[76:79]
  s_waitcnt vmcnt(59)
  buffer_load_dwordx4 v120, s[16:19], s67 offen offset:2048 lds
  v_mfma_f32_16x16x32_bf16 v[80:83], v[104:107], a[104:107], v[80:83]
  ds_read_b64_tr_b16 v[102:103], v122 offset:29184
  buffer_load_dwordx4 v121, s[16:19], s67 offen offset:3072 lds
  v_mfma_f32_16x16x32_bf16 v[84:87], v[104:107], a[108:111], v[84:87]
  v_mfma_f32_16x16x32_bf16 v[88:91], v[104:107], a[112:115], v[88:91]
  v_mfma_f32_16x16x32_bf16 v[92:95], v[104:107], a[116:119], v[92:95]
  s_waitcnt lgkmcnt(4)
  v_mfma_f32_16x16x32_bf16 v[72:75], v[108:111], a[120:123], v[72:75]
  ds_read_b64_tr_b16 v[104:105], v123 offset:24576
  v_mfma_f32_16x16x32_bf16 v[76:79], v[108:111], a[124:127], v[76:79]
  v_mfma_f32_16x16x32_bf16 v[80:83], v[108:111], a[128:131], v[80:83]
  ds_read_b64_tr_b16 v[106:107], v123 offset:25088
  v_mfma_f32_16x16x32_bf16 v[84:87], v[108:111], a[132:135], v[84:87]
  v_mfma_f32_16x16x32_bf16 v[88:91], v[108:111], a[136:139], v[88:91]
  v_mfma_f32_16x16x32_bf16 v[92:95], v[108:111], a[140:143], v[92:95]
  s_waitcnt lgkmcnt(4)
  v_mfma_f32_16x16x32_bf16 v[0:3], v[96:99], a[144:147], v[0:3]
  ds_read_b64_tr_b16 v[108:109], v123 offset:28672
  v_mfma_f32_16x16x32_bf16 v[4:7], v[96:99], a[148:151], v[4:7]
  s_mov_b32 m0, 116736
  s_xor_b32 s67, s88, 3145728
  buffer_load_dwordx4 v118, s[16:19], s67 offen offset:0 lds
  v_mfma_f32_16x16x32_bf16 v[8:11], v[96:99], a[152:155], v[8:11]
  ds_read_b64_tr_b16 v[110:111], v123 offset:29184
  s_waitcnt vmcnt(59)
  buffer_load_dwordx4 v119, s[16:19], s67 offen offset:1024 lds
  v_mfma_f32_16x16x32_bf16 v[12:15], v[96:99], a[156:159], v[12:15]
  buffer_load_dwordx4 v120, s[16:19], s67 offen offset:2048 lds
  v_mfma_f32_16x16x32_bf16 v[16:19], v[96:99], a[160:163], v[16:19]
  v_mfma_f32_16x16x32_bf16 v[20:23], v[96:99], a[164:167], v[20:23]
  buffer_load_dwordx4 v121, s[16:19], s67 offen offset:3072 lds
  s_waitcnt lgkmcnt(4)
  v_mfma_f32_16x16x32_bf16 v[0:3], v[100:103], a[168:171], v[0:3]
  ds_read_b64_tr_b16 v[96:97], v124 offset:24576
  s_mov_b32 m0, 120832
  s_xor_b32 s67, s88, 3407872
  s_waitcnt vmcnt(59)
  buffer_load_dwordx4 v118, s[16:19], s67 offen offset:0 lds
  buffer_load_dwordx4 v119, s[16:19], s67 offen offset:1024 lds
  buffer_load_dwordx4 v120, s[16:19], s67 offen offset:2048 lds
  s_waitcnt vmcnt(59)
  buffer_load_dwordx4 v121, s[16:19], s67 offen offset:3072 lds
  s_barrier
  s_mov_b32 m0, 75776
  s_xor_b32 s67, s70, 768
  buffer_load_dwordx4 v112, s[20:23], s67 offen offset:0 lds
  v_mfma_f32_16x16x32_bf16 v[4:7], v[100:103], a[172:175], v[4:7]
  buffer_load_dwordx4 v113, s[20:23], s67 offen offset:1024 lds
  v_mfma_f32_16x16x32_bf16 v[8:11], v[100:103], a[176:179], v[8:11]
  ds_read_b64_tr_b16 v[98:99], v124 offset:25088
  v_mfma_f32_16x16x32_bf16 v[12:15], v[100:103], a[180:183], v[12:15]
  s_waitcnt vmcnt(59)
  buffer_load_dwordx4 v114, s[20:23], s67 offen offset:2048 lds
  v_mfma_f32_16x16x32_bf16 v[16:19], v[100:103], a[184:187], v[16:19]
  buffer_load_dwordx4 v115, s[20:23], s67 offen offset:3072 lds
  v_mfma_f32_16x16x32_bf16 v[20:23], v[100:103], a[188:191], v[20:23]
  s_mov_b32 m0, 79872
  s_xor_b32 s67, s70, 17152
  buffer_load_dwordx4 v112, s[20:23], s67 offen offset:0 lds
  s_waitcnt lgkmcnt(4)
  v_mfma_f32_16x16x32_bf16 v[24:27], v[104:107], a[144:147], v[24:27]
  ds_read_b64_tr_b16 v[100:101], v124 offset:28672
  v_mfma_f32_16x16x32_bf16 v[28:31], v[104:107], a[148:151], v[28:31]
  s_waitcnt vmcnt(59)
  buffer_load_dwordx4 v113, s[20:23], s67 offen offset:1024 lds
  v_mfma_f32_16x16x32_bf16 v[32:35], v[104:107], a[152:155], v[32:35]
  ds_read_b64_tr_b16 v[102:103], v124 offset:29184
  buffer_load_dwordx4 v114, s[20:23], s67 offen offset:2048 lds
  v_mfma_f32_16x16x32_bf16 v[36:39], v[104:107], a[156:159], v[36:39]
  buffer_load_dwordx4 v115, s[20:23], s67 offen offset:3072 lds
  v_mfma_f32_16x16x32_bf16 v[40:43], v[104:107], a[160:163], v[40:43]
  v_mfma_f32_16x16x32_bf16 v[44:47], v[104:107], a[164:167], v[44:47]
  s_xor_b32 s53, s86, s48
  s_mov_b32 m0, 8704
  s_waitcnt vmcnt(59)
  buffer_load_dwordx4 v126, s[8:11], s53 offen offset:0 nt lds
  s_waitcnt lgkmcnt(4)
  v_mfma_f32_16x16x32_bf16 v[24:27], v[108:111], a[168:171], v[24:27]
  ds_read_b64_tr_b16 v[104:105], v125 offset:24576
  s_mov_b32 m0, 8768
  s_nop 0
  buffer_load_dwordx4 v126, s[8:11], s53 offen offset:1024 nt lds
  v_mfma_f32_16x16x32_bf16 v[28:31], v[108:111], a[172:175], v[28:31]
  s_mov_b32 m0, 8832
  s_nop 0
  buffer_load_dwordx4 v126, s[8:11], s53 offen offset:2048 nt lds
  v_mfma_f32_16x16x32_bf16 v[32:35], v[108:111], a[176:179], v[32:35]
  ds_read_b64_tr_b16 v[106:107], v125 offset:25088
  v_mfma_f32_16x16x32_bf16 v[36:39], v[108:111], a[180:183], v[36:39]
  s_mov_b32 m0, 8896
  s_add_u32 s86, s86, 4096
  s_waitcnt vmcnt(59)
  buffer_load_dwordx4 v126, s[8:11], s53 offen offset:3072 nt lds
  v_mfma_f32_16x16x32_bf16 v[40:43], v[108:111], a[184:187], v[40:43]
  s_xor_b32 s53, s86, s48
  s_mov_b32 m0, 13056
  s_nop 0
  buffer_load_dwordx4 v126, s[8:11], s53 offen offset:0 nt lds
  v_mfma_f32_16x16x32_bf16 v[44:47], v[108:111], a[188:191], v[44:47]
  s_mov_b32 m0, 13120
  s_nop 0
  buffer_load_dwordx4 v126, s[8:11], s53 offen offset:1024 nt lds
  s_waitcnt lgkmcnt(4)
  v_mfma_f32_16x16x32_bf16 v[48:51], v[96:99], a[144:147], v[48:51]
  ds_read_b64_tr_b16 v[108:109], v125 offset:28672
  v_mfma_f32_16x16x32_bf16 v[52:55], v[96:99], a[148:151], v[52:55]
  s_mov_b32 m0, 13184
  s_waitcnt vmcnt(59)
  buffer_load_dwordx4 v126, s[8:11], s53 offen offset:2048 nt lds
  v_mfma_f32_16x16x32_bf16 v[56:59], v[96:99], a[152:155], v[56:59]
  ds_read_b64_tr_b16 v[110:111], v125 offset:29184
  s_mov_b32 m0, 13248
  s_add_u32 s86, s86, 4096
  buffer_load_dwordx4 v126, s[8:11], s53 offen offset:3072 nt lds
  v_mfma_f32_16x16x32_bf16 v[60:63], v[96:99], a[156:159], v[60:63]
  s_mov_b32 m0, 43008
  s_xor_b32 s53, s87, s48
  buffer_load_dwordx4 v116, s[12:15], s53 offen offset:0 nt lds
  v_mfma_f32_16x16x32_bf16 v[64:67], v[96:99], a[160:163], v[64:67]
  v_mfma_f32_16x16x32_bf16 v[68:71], v[96:99], a[164:167], v[68:71]
  s_waitcnt vmcnt(59)
  buffer_load_dwordx4 v117, s[12:15], s53 offen offset:1024 nt lds
  s_waitcnt lgkmcnt(4)
  v_mfma_f32_16x16x32_bf16 v[48:51], v[100:103], a[168:171], v[48:51]
  s_waitcnt vmcnt(58)
  ds_read_b64_tr_b16 v[96:97], v122 offset:0
  buffer_load_dwordx4 v116, s[12:15], s53 offen offset:2048 nt lds
  v_mfma_f32_16x16x32_bf16 v[52:55], v[100:103], a[172:175], v[52:55]
  buffer_load_dwordx4 v117, s[12:15], s53 offen offset:3072 nt lds
  v_mfma_f32_16x16x32_bf16 v[56:59], v[100:103], a[176:179], v[56:59]
  ds_read_b64_tr_b16 v[98:99], v122 offset:512
  v_mfma_f32_16x16x32_bf16 v[60:63], v[100:103], a[180:183], v[60:63]
  s_add_u32 s87, s87, 4096
  s_mov_b32 m0, 47104
  s_xor_b32 s53, s87, s48
  buffer_load_dwordx4 v116, s[12:15], s53 offen offset:0 nt lds
  v_mfma_f32_16x16x32_bf16 v[64:67], v[100:103], a[184:187], v[64:67]
  buffer_load_dwordx4 v117, s[12:15], s53 offen offset:1024 nt lds
  v_mfma_f32_16x16x32_bf16 v[68:71], v[100:103], a[188:191], v[68:71]
  s_waitcnt vmcnt(59)
  buffer_load_dwordx4 v116, s[12:15], s53 offen offset:2048 nt lds
  s_waitcnt lgkmcnt(4)
  v_mfma_f32_16x16x32_bf16 v[72:75], v[104:107], a[144:147], v[72:75]
  ds_read_b64_tr_b16 v[100:101], v122 offset:4096
  v_mfma_f32_16x16x32_bf16 v[76:79], v[104:107], a[148:151], v[76:79]
  buffer_load_dwordx4 v117, s[12:15], s53 offen offset:3072 nt lds
  s_add_u32 s87, s87, 4096
  v_mfma_f32_16x16x32_bf16 v[80:83], v[104:107], a[152:155], v[80:83]
  ds_read_b64_tr_b16 v[102:103], v122 offset:4608
  v_mfma_f32_16x16x32_bf16 v[84:87], v[104:107], a[156:159], v[84:87]
  v_mfma_f32_16x16x32_bf16 v[88:91], v[104:107], a[160:163], v[88:91]
  v_mfma_f32_16x16x32_bf16 v[92:95], v[104:107], a[164:167], v[92:95]
  s_waitcnt lgkmcnt(4)
  v_mfma_f32_16x16x32_bf16 v[72:75], v[108:111], a[168:171], v[72:75]
  ds_read_b64_tr_b16 v[104:105], v123 offset:0
  v_mfma_f32_16x16x32_bf16 v[76:79], v[108:111], a[172:175], v[76:79]
  v_mfma_f32_16x16x32_bf16 v[80:83], v[108:111], a[176:179], v[80:83]
  ds_read_b64_tr_b16 v[106:107], v123 offset:512
  v_mfma_f32_16x16x32_bf16 v[84:87], v[108:111], a[180:183], v[84:87]
  v_mfma_f32_16x16x32_bf16 v[88:91], v[108:111], a[184:187], v[88:91]
  v_mfma_f32_16x16x32_bf16 v[92:95], v[108:111], a[188:191], v[92:95]
  s_waitcnt lgkmcnt(4)
  v_mfma_f32_16x16x32_bf16 v[0:3], v[96:99], a[192:195], v[0:3]
  ds_read_b64_tr_b16 v[108:109], v123 offset:4096
  v_mfma_f32_16x16x32_bf16 v[4:7], v[96:99], a[196:199], v[4:7]
  s_mov_b32 m0, 124928
  s_xor_b32 s67, s88, 3670016
  buffer_load_dwordx4 v118, s[16:19], s67 offen offset:0 lds
  v_mfma_f32_16x16x32_bf16 v[8:11], v[96:99], a[200:203], v[8:11]
  ds_read_b64_tr_b16 v[110:111], v123 offset:4608
  s_waitcnt vmcnt(59)
  buffer_load_dwordx4 v119, s[16:19], s67 offen offset:1024 lds
  v_mfma_f32_16x16x32_bf16 v[12:15], v[96:99], a[204:207], v[12:15]
  buffer_load_dwordx4 v120, s[16:19], s67 offen offset:2048 lds
  v_mfma_f32_16x16x32_bf16 v[16:19], v[96:99], a[208:211], v[16:19]
  v_mfma_f32_16x16x32_bf16 v[20:23], v[96:99], a[212:215], v[20:23]
  buffer_load_dwordx4 v121, s[16:19], s67 offen offset:3072 lds
  s_waitcnt lgkmcnt(4)
  v_mfma_f32_16x16x32_bf16 v[0:3], v[100:103], a[216:219], v[0:3]
  ds_read_b64_tr_b16 v[96:97], v124 offset:0
  s_mov_b32 m0, 129024
  s_xor_b32 s67, s88, 3932160
  s_waitcnt vmcnt(59)
  buffer_load_dwordx4 v118, s[16:19], s67 offen offset:0 lds
  v_mfma_f32_16x16x32_bf16 v[4:7], v[100:103], a[220:223], v[4:7]
  buffer_load_dwordx4 v119, s[16:19], s67 offen offset:1024 lds
  v_mfma_f32_16x16x32_bf16 v[8:11], v[100:103], a[224:227], v[8:11]
  ds_read_b64_tr_b16 v[98:99], v124 offset:512
  v_mfma_f32_16x16x32_bf16 v[12:15], v[100:103], a[228:231], v[12:15]
  buffer_load_dwordx4 v120, s[16:19], s67 offen offset:2048 lds
  v_mfma_f32_16x16x32_bf16 v[16:19], v[100:103], a[232:235], v[16:19]
  s_waitcnt vmcnt(59)
  buffer_load_dwordx4 v121, s[16:19], s67 offen offset:3072 lds
  v_mfma_f32_16x16x32_bf16 v[20:23], v[100:103], a[236:239], v[20:23]
  s_waitcnt lgkmcnt(4)
  v_mfma_f32_16x16x32_bf16 v[24:27], v[104:107], a[192:195], v[24:27]
  ds_read_b64_tr_b16 v[100:101], v124 offset:4096
  v_mfma_f32_16x16x32_bf16 v[28:31], v[104:107], a[196:199], v[28:31]
  v_mfma_f32_16x16x32_bf16 v[32:35], v[104:107], a[200:203], v[32:35]
  ds_read_b64_tr_b16 v[102:103], v124 offset:4608
  v_mfma_f32_16x16x32_bf16 v[36:39], v[104:107], a[204:207], v[36:39]
  s_barrier
  s_mov_b32 m0, 83968
  s_xor_b32 s67, s70, 32768
  buffer_load_dwordx4 v112, s[20:23], s67 offen offset:0 lds
  v_mfma_f32_16x16x32_bf16 v[40:43], v[104:107], a[208:211], v[40:43]
  v_mfma_f32_16x16x32_bf16 v[44:47], v[104:107], a[212:215], v[44:47]
  buffer_load_dwordx4 v113, s[20:23], s67 offen offset:1024 lds
  s_waitcnt lgkmcnt(4)
  v_mfma_f32_16x16x32_bf16 v[24:27], v[108:111], a[216:219], v[24:27]
  ds_read_b64_tr_b16 v[104:105], v125 offset:0
  s_waitcnt vmcnt(59)
  buffer_load_dwordx4 v114, s[20:23], s67 offen offset:2048 lds
  v_mfma_f32_16x16x32_bf16 v[28:31], v[108:111], a[220:223], v[28:31]
  buffer_load_dwordx4 v115, s[20:23], s67 offen offset:3072 lds
  v_mfma_f32_16x16x32_bf16 v[32:35], v[108:111], a[224:227], v[32:35]
  ds_read_b64_tr_b16 v[106:107], v125 offset:512
  v_mfma_f32_16x16x32_bf16 v[36:39], v[108:111], a[228:231], v[36:39]
  s_mov_b32 m0, 88064
  s_xor_b32 s67, s70, 49152
  buffer_load_dwordx4 v112, s[20:23], s67 offen offset:0 lds
  v_mfma_f32_16x16x32_bf16 v[40:43], v[108:111], a[232:235], v[40:43]
  s_waitcnt vmcnt(59)
  buffer_load_dwordx4 v113, s[20:23], s67 offen offset:1024 lds
  v_mfma_f32_16x16x32_bf16 v[44:47], v[108:111], a[236:239], v[44:47]
  buffer_load_dwordx4 v114, s[20:23], s67 offen offset:2048 lds
  s_waitcnt lgkmcnt(4)
  v_mfma_f32_16x16x32_bf16 v[48:51], v[96:99], a[192:195], v[48:51]
  ds_read_b64_tr_b16 v[108:109], v125 offset:4096
  v_mfma_f32_16x16x32_bf16 v[52:55], v[96:99], a[196:199], v[52:55]
  buffer_load_dwordx4 v115, s[20:23], s67 offen offset:3072 lds
  v_mfma_f32_16x16x32_bf16 v[56:59], v[96:99], a[200:203], v[56:59]
  ds_read_b64_tr_b16 v[110:111], v125 offset:4608
  s_xor_b32 s53, s86, s48
  s_mov_b32 m0, 17408
  s_waitcnt vmcnt(59)
  buffer_load_dwordx4 v126, s[8:11], s53 offen offset:0 nt lds
  v_mfma_f32_16x16x32_bf16 v[60:63], v[96:99], a[204:207], v[60:63]
  s_mov_b32 m0, 17472
  s_nop 0
  buffer_load_dwordx4 v126, s[8:11], s53 offen offset:1024 nt lds
  v_mfma_f32_16x16x32_bf16 v[64:67], v[96:99], a[208:211], v[64:67]
  v_mfma_f32_16x16x32_bf16 v[68:71], v[96:99], a[212:215], v[68:71]
  s_mov_b32 m0, 17536
  s_nop 0
  buffer_load_dwordx4 v126, s[8:11], s53 offen offset:2048 nt lds
  s_waitcnt lgkmcnt(4)
  v_mfma_f32_16x16x32_bf16 v[48:51], v[100:103], a[216:219], v[48:51]
  s_waitcnt vmcnt(51)
  ds_read_b64_tr_b16 v[96:97], v122 offset:8192
  s_mov_b32 m0, 17600
  s_add_u32 s86, s86, 4096
  buffer_load_dwordx4 v126, s[8:11], s53 offen offset:3072 nt lds
  v_mfma_f32_16x16x32_bf16 v[52:55], v[100:103], a[220:223], v[52:55]
  s_xor_b32 s53, s86, s48
  s_mov_b32 m0, 21760
  s_nop 0
  buffer_load_dwordx4 v126, s[8:11], s53 offen offset:0 nt lds
  v_mfma_f32_16x16x32_bf16 v[56:59], v[100:103], a[224:227], v[56:59]
  ds_read_b64_tr_b16 v[98:99], v122 offset:8704
  v_mfma_f32_16x16x32_bf16 v[60:63], v[100:103], a[228:231], v[60:63]
  s_mov_b32 m0, 21824
  s_nop 0
  buffer_load_dwordx4 v126, s[8:11], s53 offen offset:1024 nt lds
  v_mfma_f32_16x16x32_bf16 v[64:67], v[100:103], a[232:235], v[64:67]
  s_mov_b32 m0, 21888
  s_nop 0
  buffer_load_dwordx4 v126, s[8:11], s53 offen offset:2048 nt lds
  v_mfma_f32_16x16x32_bf16 v[68:71], v[100:103], a[236:239], v[68:71]
  s_mov_b32 m0, 21952
  s_add_u32 s86, s86, 4096
  buffer_load_dwordx4 v126, s[8:11], s53 offen offset:3072 nt lds
  s_waitcnt lgkmcnt(4)
  v_mfma_f32_16x16x32_bf16 v[72:75], v[104:107], a[192:195], v[72:75]
  ds_read_b64_tr_b16 v[100:101], v122 offset:12288
  v_mfma_f32_16x16x32_bf16 v[76:79], v[104:107], a[196:199], v[76:79]
  s_mov_b32 m0, 51200
  s_xor_b32 s53, s87, s48
  buffer_load_dwordx4 v116, s[12:15], s53 offen offset:0 nt lds
  v_mfma_f32_16x16x32_bf16 v[80:83], v[104:107], a[200:203], v[80:83]
  ds_read_b64_tr_b16 v[102:103], v122 offset:12800
  buffer_load_dwordx4 v117, s[12:15], s53 offen offset:1024 nt lds
  v_mfma_f32_16x16x32_bf16 v[84:87], v[104:107], a[204:207], v[84:87]
  buffer_load_dwordx4 v116, s[12:15], s53 offen offset:2048 nt lds
  v_mfma_f32_16x16x32_bf16 v[88:91], v[104:107], a[208:211], v[88:91]
  v_mfma_f32_16x16x32_bf16 v[92:95], v[104:107], a[212:215], v[92:95]
  buffer_load_dwordx4 v117, s[12:15], s53 offen offset:3072 nt lds
  s_waitcnt lgkmcnt(4)
  v_mfma_f32_16x16x32_bf16 v[72:75], v[108:111], a[216:219], v[72:75]
  ds_read_b64_tr_b16 v[104:105], v123 offset:8192
  s_add_u32 s87, s87, 4096
  s_mov_b32 m0, 55296
  s_xor_b32 s53, s87, s48
  buffer_load_dwordx4 v116, s[12:15], s53 offen offset:0 nt lds
  v_mfma_f32_16x16x32_bf16 v[76:79], v[108:111], a[220:223], v[76:79]
  buffer_load_dwordx4 v117, s[12:15], s53 offen offset:1024 nt lds
  v_mfma_f32_16x16x32_bf16 v[80:83], v[108:111], a[224:227], v[80:83]
  ds_read_b64_tr_b16 v[106:107], v123 offset:8704
  v_mfma_f32_16x16x32_bf16 v[84:87], v[108:111], a[228:231], v[84:87]
  s_waitcnt vmcnt(59)
  buffer_load_dwordx4 v116, s[12:15], s53 offen offset:2048 nt lds
  v_mfma_f32_16x16x32_bf16 v[88:91], v[108:111], a[232:235], v[88:91]
  buffer_load_dwordx4 v117, s[12:15], s53 offen offset:3072 nt lds
  s_add_u32 s87, s87, 4096
  v_mfma_f32_16x16x32_bf16 v[92:95], v[108:111], a[236:239], v[92:95]
  s_waitcnt lgkmcnt(4)
  v_mfma_f32_16x16x32_bf16 v[0:3], v[96:99], a[240:243], v[0:3]
  ds_read_b64_tr_b16 v[108:109], v123 offset:12288
  v_mfma_f32_16x16x32_bf16 v[4:7], v[96:99], a[244:247], v[4:7]
  s_mov_b32 m0, 100352
  s_xor_b32 s67, s89, 0
  buffer_load_dwordx4 v118, s[16:19], s67 offen offset:0 lds
  v_mfma_f32_16x16x32_bf16 v[8:11], v[96:99], a[248:251], v[8:11]
  ds_read_b64_tr_b16 v[110:111], v123 offset:12800
  s_waitcnt vmcnt(59)
  buffer_load_dwordx4 v119, s[16:19], s67 offen offset:1024 lds
  v_mfma_f32_16x16x32_bf16 v[12:15], v[96:99], a[252:255], v[12:15]
  buffer_load_dwordx4 v120, s[16:19], s67 offen offset:2048 lds
  v_mfma_f32_16x16x32_bf16 v[16:19], v[96:99], v[128:131], v[16:19]
  v_mfma_f32_16x16x32_bf16 v[20:23], v[96:99], v[132:135], v[20:23]
  buffer_load_dwordx4 v121, s[16:19], s67 offen offset:3072 lds
  s_waitcnt lgkmcnt(4)
  v_mfma_f32_16x16x32_bf16 v[0:3], v[100:103], v[136:139], v[0:3]
  ds_read_b64_tr_b16 v[96:97], v124 offset:8192
  s_mov_b32 m0, 104448
  s_xor_b32 s67, s89, 262144
  s_waitcnt vmcnt(59)
  buffer_load_dwordx4 v118, s[16:19], s67 offen offset:0 lds
  v_mfma_f32_16x16x32_bf16 v[4:7], v[100:103], v[140:143], v[4:7]
  buffer_load_dwordx4 v119, s[16:19], s67 offen offset:1024 lds
  v_mfma_f32_16x16x32_bf16 v[8:11], v[100:103], v[144:147], v[8:11]
  ds_read_b64_tr_b16 v[98:99], v124 offset:8704
  v_mfma_f32_16x16x32_bf16 v[12:15], v[100:103], v[148:151], v[12:15]
  buffer_load_dwordx4 v120, s[16:19], s67 offen offset:2048 lds
  v_mfma_f32_16x16x32_bf16 v[16:19], v[100:103], v[152:155], v[16:19]
  s_waitcnt vmcnt(59)
  buffer_load_dwordx4 v121, s[16:19], s67 offen offset:3072 lds
  v_mfma_f32_16x16x32_bf16 v[20:23], v[100:103], v[156:159], v[20:23]
  s_waitcnt lgkmcnt(4)
  v_mfma_f32_16x16x32_bf16 v[24:27], v[104:107], a[240:243], v[24:27]
  ds_read_b64_tr_b16 v[100:101], v124 offset:12288
  v_mfma_f32_16x16x32_bf16 v[28:31], v[104:107], a[244:247], v[28:31]
  v_mfma_f32_16x16x32_bf16 v[32:35], v[104:107], a[248:251], v[32:35]
  ds_read_b64_tr_b16 v[102:103], v124 offset:12800
  v_mfma_f32_16x16x32_bf16 v[36:39], v[104:107], a[252:255], v[36:39]
  v_mfma_f32_16x16x32_bf16 v[40:43], v[104:107], v[128:131], v[40:43]
  v_mfma_f32_16x16x32_bf16 v[44:47], v[104:107], v[132:135], v[44:47]
  s_waitcnt lgkmcnt(4)
  v_mfma_f32_16x16x32_bf16 v[24:27], v[108:111], v[136:139], v[24:27]
  ds_read_b64_tr_b16 v[104:105], v125 offset:8192
  v_mfma_f32_16x16x32_bf16 v[28:31], v[108:111], v[140:143], v[28:31]
  v_mfma_f32_16x16x32_bf16 v[32:35], v[108:111], v[144:147], v[32:35]
  ds_read_b64_tr_b16 v[106:107], v125 offset:8704
  v_mfma_f32_16x16x32_bf16 v[36:39], v[108:111], v[148:151], v[36:39]
  v_mfma_f32_16x16x32_bf16 v[40:43], v[108:111], v[152:155], v[40:43]
  v_mfma_f32_16x16x32_bf16 v[44:47], v[108:111], v[156:159], v[44:47]
  s_waitcnt lgkmcnt(4)
  v_mfma_f32_16x16x32_bf16 v[48:51], v[96:99], a[240:243], v[48:51]
  ds_read_b64_tr_b16 v[108:109], v125 offset:12288
  s_barrier
  v_mfma_f32_16x16x32_bf16 v[52:55], v[96:99], a[244:247], v[52:55]
  s_mov_b32 m0, 92160
  s_xor_b32 s67, s70, 33024
  buffer_load_dwordx4 v112, s[20:23], s67 offen offset:0 lds
  v_mfma_f32_16x16x32_bf16 v[56:59], v[96:99], a[248:251], v[56:59]
  ds_read_b64_tr_b16 v[110:111], v125 offset:12800
  buffer_load_dwordx4 v113, s[20:23], s67 offen offset:1024 lds
  v_mfma_f32_16x16x32_bf16 v[60:63], v[96:99], a[252:255], v[60:63]
  s_waitcnt vmcnt(59)
  buffer_load_dwordx4 v114, s[20:23], s67 offen offset:2048 lds
  v_mfma_f32_16x16x32_bf16 v[64:67], v[96:99], v[128:131], v[64:67]
  v_mfma_f32_16x16x32_bf16 v[68:71], v[96:99], v[132:135], v[68:71]
  buffer_load_dwordx4 v115, s[20:23], s67 offen offset:3072 lds
  s_waitcnt lgkmcnt(4)
  v_mfma_f32_16x16x32_bf16 v[48:51], v[100:103], v[136:139], v[48:51]
  ds_read_b64_tr_b16 v[96:97], v122 offset:16384
  s_mov_b32 m0, 96256
  s_xor_b32 s67, s70, 49408
  buffer_load_dwordx4 v112, s[20:23], s67 offen offset:0 lds
  v_mfma_f32_16x16x32_bf16 v[52:55], v[100:103], v[140:143], v[52:55]
  s_waitcnt vmcnt(59)
  buffer_load_dwordx4 v113, s[20:23], s67 offen offset:1024 lds
  v_mfma_f32_16x16x32_bf16 v[56:59], v[100:103], v[144:147], v[56:59]
  ds_read_b64_tr_b16 v[98:99], v122 offset:16896
  v_mfma_f32_16x16x32_bf16 v[60:63], v[100:103], v[148:151], v[60:63]
  buffer_load_dwordx4 v114, s[20:23], s67 offen offset:2048 lds
  v_mfma_f32_16x16x32_bf16 v[64:67], v[100:103], v[152:155], v[64:67]
  buffer_load_dwordx4 v115, s[20:23], s67 offen offset:3072 lds
  v_mfma_f32_16x16x32_bf16 v[68:71], v[100:103], v[156:159], v[68:71]
  s_xor_b32 s53, s86, s48
  s_mov_b32 m0, 26112
  s_waitcnt vmcnt(59)
  buffer_load_dwordx4 v126, s[8:11], s53 offen offset:0 nt lds
  s_waitcnt lgkmcnt(4)
  v_mfma_f32_16x16x32_bf16 v[72:75], v[104:107], a[240:243], v[72:75]
  ds_read_b64_tr_b16 v[100:101], v122 offset:20480
  v_mfma_f32_16x16x32_bf16 v[76:79], v[104:107], a[244:247], v[76:79]
  s_mov_b32 m0, 26176
  s_nop 0
  buffer_load_dwordx4 v126, s[8:11], s53 offen offset:1024 nt lds
  v_mfma_f32_16x16x32_bf16 v[80:83], v[104:107], a[248:251], v[80:83]
  ds_read_b64_tr_b16 v[102:103], v122 offset:20992
  s_mov_b32 m0, 26240
  s_nop 0
  buffer_load_dwordx4 v126, s[8:11], s53 offen offset:2048 nt lds
  v_mfma_f32_16x16x32_bf16 v[84:87], v[104:107], a[252:255], v[84:87]
  s_mov_b32 m0, 26304
  s_add_u32 s86, s86, 4096
  s_waitcnt vmcnt(59)
  buffer_load_dwordx4 v126, s[8:11], s53 offen offset:3072 nt lds
  v_mfma_f32_16x16x32_bf16 v[88:91], v[104:107], v[128:131], v[88:91]
  v_mfma_f32_16x16x32_bf16 v[92:95], v[104:107], v[132:135], v[92:95]
  s_xor_b32 s53, s86, s48
  s_mov_b32 m0, 30464
  s_nop 0
  buffer_load_dwordx4 v126, s[8:11], s53 offen offset:0 nt lds
  s_waitcnt lgkmcnt(4)
  v_mfma_f32_16x16x32_bf16 v[72:75], v[108:111], v[136:139], v[72:75]
  ds_read_b64_tr_b16 v[104:105], v123 offset:16384
  s_mov_b32 m0, 30528
  s_nop 0
  buffer_load_dwordx4 v126, s[8:11], s53 offen offset:1024 nt lds
  v_mfma_f32_16x16x32_bf16 v[76:79], v[108:111], v[140:143], v[76:79]
  s_mov_b32 m0, 30592
  s_waitcnt vmcnt(59)
  buffer_load_dwordx4 v126, s[8:11], s53 offen offset:2048 nt lds
  v_mfma_f32_16x16x32_bf16 v[80:83], v[108:111], v[144:147], v[80:83]
  ds_read_b64_tr_b16 v[106:107], v123 offset:16896
  v_mfma_f32_16x16x32_bf16 v[84:87], v[108:111], v[148:151], v[84:87]
  s_mov_b32 m0, 30656
  s_add_u32 s86, s86, 4096
  buffer_load_dwordx4 v126, s[8:11], s53 offen offset:3072 nt lds
  v_mfma_f32_16x16x32_bf16 v[88:91], v[108:111], v[152:155], v[88:91]
  s_mov_b32 m0, 59392
  s_xor_b32 s53, s87, s48
  buffer_load_dwordx4 v116, s[12:15], s53 offen offset:0 nt lds
  v_mfma_f32_16x16x32_bf16 v[92:95], v[108:111], v[156:159], v[92:95]
  s_waitcnt vmcnt(59)
  buffer_load_dwordx4 v117, s[12:15], s53 offen offset:1024 nt lds
  s_waitcnt lgkmcnt(4)
  v_mfma_f32_16x16x32_bf16 v[0:3], v[96:99], v[160:163], v[0:3]
  ds_read_b64_tr_b16 v[108:109], v123 offset:20480
  v_mfma_f32_16x16x32_bf16 v[4:7], v[96:99], v[164:167], v[4:7]
  buffer_load_dwordx4 v116, s[12:15], s53 offen offset:2048 nt lds
  v_mfma_f32_16x16x32_bf16 v[8:11], v[96:99], v[168:171], v[8:11]
  ds_read_b64_tr_b16 v[110:111], v123 offset:20992
  buffer_load_dwordx4 v117, s[12:15], s53 offen offset:3072 nt lds
  v_mfma_f32_16x16x32_bf16 v[12:15], v[96:99], v[172:175], v[12:15]
  s_add_u32 s87, s87, 4096
  s_mov_b32 m0, 63488
  s_xor_b32 s53, s87, s48
  s_waitcnt vmcnt(59)
  buffer_load_dwordx4 v116, s[12:15], s53 offen offset:0 nt lds
  v_mfma_f32_16x16x32_bf16 v[16:19], v[96:99], v[176:179], v[16:19]
  v_mfma_f32_16x16x32_bf16 v[20:23], v[96:99], v[180:183], v[20:23]
  buffer_load_dwordx4 v117, s[12:15], s53 offen offset:1024 nt lds
  s_waitcnt lgkmcnt(4)
  v_mfma_f32_16x16x32_bf16 v[0:3], v[100:103], v[184:187], v[0:3]
  ds_read_b64_tr_b16 v[96:97], v124 offset:16384
  buffer_load_dwordx4 v116, s[12:15], s53 offen offset:2048 nt lds
  v_mfma_f32_16x16x32_bf16 v[4:7], v[100:103], v[188:191], v[4:7]
  s_waitcnt vmcnt(59)
  buffer_load_dwordx4 v117, s[12:15], s53 offen offset:3072 nt lds
  s_add_u32 s87, s87, 4096
  v_mfma_f32_16x16x32_bf16 v[8:11], v[100:103], v[192:195], v[8:11]
  ds_read_b64_tr_b16 v[98:99], v124 offset:16896
  v_mfma_f32_16x16x32_bf16 v[12:15], v[100:103], v[196:199], v[12:15]
  s_mov_b32 m0, 108544
  s_xor_b32 s67, s89, 524288
  buffer_load_dwordx4 v118, s[16:19], s67 offen offset:0 lds
  v_mfma_f32_16x16x32_bf16 v[16:19], v[100:103], v[200:203], v[16:19]
  buffer_load_dwordx4 v119, s[16:19], s67 offen offset:1024 lds
  v_mfma_f32_16x16x32_bf16 v[20:23], v[100:103], v[204:207], v[20:23]
  s_waitcnt vmcnt(59)
  buffer_load_dwordx4 v120, s[16:19], s67 offen offset:2048 lds
  s_waitcnt lgkmcnt(4)
  v_mfma_f32_16x16x32_bf16 v[24:27], v[104:107], v[160:163], v[24:27]
  ds_read_b64_tr_b16 v[100:101], v124 offset:20480
  v_mfma_f32_16x16x32_bf16 v[28:31], v[104:107], v[164:167], v[28:31]
  buffer_load_dwordx4 v121, s[16:19], s67 offen offset:3072 lds
  v_mfma_f32_16x16x32_bf16 v[32:35], v[104:107], v[168:171], v[32:35]
  ds_read_b64_tr_b16 v[102:103], v124 offset:20992
  s_mov_b32 m0, 112640
  s_xor_b32 s67, s89, 786432
  buffer_load_dwordx4 v118, s[16:19], s67 offen offset:0 lds
  v_mfma_f32_16x16x32_bf16 v[36:39], v[104:107], v[172:175], v[36:39]
  s_waitcnt vmcnt(59)
  buffer_load_dwordx4 v119, s[16:19], s67 offen offset:1024 lds
  v_mfma_f32_16x16x32_bf16 v[40:43], v[104:107], v[176:179], v[40:43]
  v_mfma_f32_16x16x32_bf16 v[44:47], v[104:107], v[180:183], v[44:47]
  buffer_load_dwordx4 v120, s[16:19], s67 offen offset:2048 lds
  s_waitcnt lgkmcnt(4)
  v_mfma_f32_16x16x32_bf16 v[24:27], v[108:111], v[184:187], v[24:27]
  ds_read_b64_tr_b16 v[104:105], v125 offset:16384
  buffer_load_dwordx4 v121, s[16:19], s67 offen offset:3072 lds
  v_mfma_f32_16x16x32_bf16 v[28:31], v[108:111], v[188:191], v[28:31]
  v_mfma_f32_16x16x32_bf16 v[32:35], v[108:111], v[192:195], v[32:35]
  ds_read_b64_tr_b16 v[106:107], v125 offset:16896
  v_mfma_f32_16x16x32_bf16 v[36:39], v[108:111], v[196:199], v[36:39]
  v_mfma_f32_16x16x32_bf16 v[40:43], v[108:111], v[200:203], v[40:43]
  v_mfma_f32_16x16x32_bf16 v[44:47], v[108:111], v[204:207], v[44:47]
  s_waitcnt lgkmcnt(4)
  v_mfma_f32_16x16x32_bf16 v[48:51], v[96:99], v[160:163], v[48:51]
  ds_read_b64_tr_b16 v[108:109], v125 offset:20480
  v_mfma_f32_16x16x32_bf16 v[52:55], v[96:99], v[164:167], v[52:55]
  v_mfma_f32_16x16x32_bf16 v[56:59], v[96:99], v[168:171], v[56:59]
  ds_read_b64_tr_b16 v[110:111], v125 offset:20992
  v_mfma_f32_16x16x32_bf16 v[60:63], v[96:99], v[172:175], v[60:63]
  v_mfma_f32_16x16x32_bf16 v[64:67], v[96:99], v[176:179], v[64:67]
  v_mfma_f32_16x16x32_bf16 v[68:71], v[96:99], v[180:183], v[68:71]
  s_waitcnt lgkmcnt(4)
  v_mfma_f32_16x16x32_bf16 v[48:51], v[100:103], v[184:187], v[48:51]
  ds_read_b64_tr_b16 v[96:97], v122 offset:24576
  v_mfma_f32_16x16x32_bf16 v[52:55], v[100:103], v[188:191], v[52:55]
  v_mfma_f32_16x16x32_bf16 v[56:59], v[100:103], v[192:195], v[56:59]
  ds_read_b64_tr_b16 v[98:99], v122 offset:25088
  v_mfma_f32_16x16x32_bf16 v[60:63], v[100:103], v[196:199], v[60:63]
  s_barrier
  s_mov_b32 m0, 67584
  s_xor_b32 s67, s70, 33280
  s_waitcnt vmcnt(59)
  buffer_load_dwordx4 v112, s[20:23], s67 offen offset:0 lds
  v_mfma_f32_16x16x32_bf16 v[64:67], v[100:103], v[200:203], v[64:67]
  buffer_load_dwordx4 v113, s[20:23], s67 offen offset:1024 lds
  v_mfma_f32_16x16x32_bf16 v[68:71], v[100:103], v[204:207], v[68:71]
  buffer_load_dwordx4 v114, s[20:23], s67 offen offset:2048 lds
  s_waitcnt lgkmcnt(4)
  v_mfma_f32_16x16x32_bf16 v[72:75], v[104:107], v[160:163], v[72:75]
  ds_read_b64_tr_b16 v[100:101], v122 offset:28672
  v_mfma_f32_16x16x32_bf16 v[76:79], v[104:107], v[164:167], v[76:79]
  s_waitcnt vmcnt(59)
  buffer_load_dwordx4 v115, s[20:23], s67 offen offset:3072 lds
  v_mfma_f32_16x16x32_bf16 v[80:83], v[104:107], v[168:171], v[80:83]
  ds_read_b64_tr_b16 v[102:103], v122 offset:29184
  s_mov_b32 m0, 71680
  s_xor_b32 s67, s70, 49664
  buffer_load_dwordx4 v112, s[20:23], s67 offen offset:0 lds
  v_mfma_f32_16x16x32_bf16 v[84:87], v[104:107], v[172:175], v[84:87]
  buffer_load_dwordx4 v113, s[20:23], s67 offen offset:1024 lds
  v_mfma_f32_16x16x32_bf16 v[88:91], v[104:107], v[176:179], v[88:91]
  v_mfma_f32_16x16x32_bf16 v[92:95], v[104:107], v[180:183], v[92:95]
  s_waitcnt vmcnt(59)
  buffer_load_dwordx4 v114, s[20:23], s67 offen offset:2048 lds
  s_waitcnt lgkmcnt(4)
  v_mfma_f32_16x16x32_bf16 v[72:75], v[108:111], v[184:187], v[72:75]
  ds_read_b64_tr_b16 v[104:105], v123 offset:24576
  buffer_load_dwordx4 v115, s[20:23], s67 offen offset:3072 lds
  v_mfma_f32_16x16x32_bf16 v[76:79], v[108:111], v[188:191], v[76:79]
  s_xor_b32 s53, s86, s48
  s_mov_b32 m0, 0
  s_nop 0
  buffer_load_dwordx4 v126, s[8:11], s53 offen offset:0 nt lds
  v_mfma_f32_16x16x32_bf16 v[80:83], v[108:111], v[192:195], v[80:83]
  ds_read_b64_tr_b16 v[106:107], v123 offset:25088
  v_mfma_f32_16x16x32_bf16 v[84:87], v[108:111], v[196:199], v[84:87]
  s_mov_b32 m0, 64
  s_waitcnt vmcnt(59)
  buffer_load_dwordx4 v126, s[8:11], s53 offen offset:1024 nt lds
  v_mfma_f32_16x16x32_bf16 v[88:91], v[108:111], v[200:203], v[88:91]
  s_mov_b32 m0, 128
  s_nop 0
  buffer_load_dwordx4 v126, s[8:11], s53 offen offset:2048 nt lds
  v_mfma_f32_16x16x32_bf16 v[92:95], v[108:111], v[204:207], v[92:95]
  s_mov_b32 m0, 192
  s_add_u32 s86, s86, 4096
  buffer_load_dwordx4 v126, s[8:11], s53 offen offset:3072 nt lds
  s_waitcnt lgkmcnt(4)
  v_mfma_f32_16x16x32_bf16 v[0:3], v[96:99], v[208:211], v[0:3]
  ds_read_b64_tr_b16 v[108:109], v123 offset:28672
  v_mfma_f32_16x16x32_bf16 v[4:7], v[96:99], v[212:215], v[4:7]
  s_xor_b32 s53, s86, s48
  s_mov_b32 m0, 4352
  s_waitcnt vmcnt(59)
  buffer_load_dwordx4 v126, s[8:11], s53 offen offset:0 nt lds
  v_mfma_f32_16x16x32_bf16 v[8:11], v[96:99], v[216:219], v[8:11]
  ds_read_b64_tr_b16 v[110:111], v123 offset:29184
  s_mov_b32 m0, 4416
  s_nop 0
  buffer_load_dwordx4 v126, s[8:11], s53 offen offset:1024 nt lds
  v_mfma_f32_16x16x32_bf16 v[12:15], v[96:99], v[220:223], v[12:15]
  s_mov_b32 m0, 4480
  s_nop 0
  buffer_load_dwordx4 v126, s[8:11], s53 offen offset:2048 nt lds
  v_mfma_f32_16x16x32_bf16 v[16:19], v[96:99], v[224:227], v[16:19]
  v_mfma_f32_16x16x32_bf16 v[20:23], v[96:99], v[228:231], v[20:23]
  s_mov_b32 m0, 4544
  s_add_u32 s86, s86, 4096
  s_waitcnt vmcnt(59)
  buffer_load_dwordx4 v126, s[8:11], s53 offen offset:3072 nt lds
  s_waitcnt lgkmcnt(4)
  v_mfma_f32_16x16x32_bf16 v[0:3], v[100:103], v[232:235], v[0:3]
  ds_read_b64_tr_b16 v[96:97], v124 offset:24576
  s_mov_b32 m0, 34816
  s_xor_b32 s53, s87, s48
  buffer_load_dwordx4 v116, s[12:15], s53 offen offset:0 nt lds
  v_mfma_f32_16x16x32_bf16 v[4:7], v[100:103], v[236:239], v[4:7]
  buffer_load_dwordx4 v117, s[12:15], s53 offen offset:1024 nt lds
  v_mfma_f32_16x16x32_bf16 v[8:11], v[100:103], v[240:243], v[8:11]
  ds_read_b64_tr_b16 v[98:99], v124 offset:25088
  v_mfma_f32_16x16x32_bf16 v[12:15], v[100:103], v[244:247], v[12:15]
  s_waitcnt vmcnt(59)
  buffer_load_dwordx4 v116, s[12:15], s53 offen offset:2048 nt lds
  v_mfma_f32_16x16x32_bf16 v[16:19], v[100:103], v[248:251], v[16:19]
  buffer_load_dwordx4 v117, s[12:15], s53 offen offset:3072 nt lds
  v_mfma_f32_16x16x32_bf16 v[20:23], v[100:103], v[252:255], v[20:23]
  s_add_u32 s87, s87, 4096
  s_mov_b32 m0, 38912
  s_xor_b32 s53, s87, s48
  buffer_load_dwordx4 v116, s[12:15], s53 offen offset:0 nt lds
  s_waitcnt lgkmcnt(4)
  v_mfma_f32_16x16x32_bf16 v[24:27], v[104:107], v[208:211], v[24:27]
  ds_read_b64_tr_b16 v[100:101], v124 offset:28672
  v_mfma_f32_16x16x32_bf16 v[28:31], v[104:107], v[212:215], v[28:31]
  s_waitcnt vmcnt(59)
  buffer_load_dwordx4 v117, s[12:15], s53 offen offset:1024 nt lds
  v_mfma_f32_16x16x32_bf16 v[32:35], v[104:107], v[216:219], v[32:35]
  ds_read_b64_tr_b16 v[102:103], v124 offset:29184
  buffer_load_dwordx4 v116, s[12:15], s53 offen offset:2048 nt lds
  v_mfma_f32_16x16x32_bf16 v[36:39], v[104:107], v[220:223], v[36:39]
  buffer_load_dwordx4 v117, s[12:15], s53 offen offset:3072 nt lds
  s_add_u32 s87, s87, 4096
  v_mfma_f32_16x16x32_bf16 v[40:43], v[104:107], v[224:227], v[40:43]
  v_mul_f32 v0, s65, v0
  v_mul_f32 v1, s65, v1
  v_mfma_f32_16x16x32_bf16 v[44:47], v[104:107], v[228:231], v[44:47]
  v_mul_f32 v2, s65, v2
  v_mul_f32 v3, s65, v3
  s_mov_b32 m0, 116736
  s_xor_b32 s67, s89, 1048576
  s_waitcnt vmcnt(59)
  buffer_load_dwordx4 v118, s[16:19], s67 offen offset:0 lds
  s_waitcnt lgkmcnt(4)
  v_mfma_f32_16x16x32_bf16 v[24:27], v[108:111], v[232:235], v[24:27]
  ds_read_b64_tr_b16 v[104:105], v125 offset:24576
  v_mul_f32 v4, s65, v4
  v_mul_f32 v5, s65, v5
  v_mul_f32 v6, s65, v6
  buffer_load_dwordx4 v119, s[16:19], s67 offen offset:1024 lds
  v_mfma_f32_16x16x32_bf16 v[28:31], v[108:111], v[236:239], v[28:31]
  v_mul_f32 v7, s65, v7
  v_cvt_pk_bf16_f32 v0, v0, v1
  buffer_load_dwordx4 v120, s[16:19], s67 offen offset:2048 lds
  v_mfma_f32_16x16x32_bf16 v[32:35], v[108:111], v[240:243], v[32:35]
  ds_read_b64_tr_b16 v[106:107], v125 offset:25088
  v_cvt_pk_bf16_f32 v1, v2, v3
  v_cvt_pk_bf16_f32 v4, v4, v5
  v_cvt_pk_bf16_f32 v5, v6, v7
  v_mfma_f32_16x16x32_bf16 v[36:39], v[108:111], v[244:247], v[36:39]
  ds_write_b64 v127, v[0:1] offset:0
  ds_write_b64 v127, v[4:5] offset:4096
  s_waitcnt vmcnt(59)
  buffer_load_dwordx4 v121, s[16:19], s67 offen offset:3072 lds
  v_mfma_f32_16x16x32_bf16 v[40:43], v[108:111], v[248:251], v[40:43]
  v_mul_f32 v8, s65, v8
  v_mul_f32 v9, s65, v9
  v_mul_f32 v10, s65, v10
  s_mov_b32 m0, 120832
  s_xor_b32 s67, s89, 1310720
  buffer_load_dwordx4 v118, s[16:19], s67 offen offset:0 lds
  v_mfma_f32_16x16x32_bf16 v[44:47], v[108:111], v[252:255], v[44:47]
  v_mul_f32 v11, s65, v11
  v_mul_f32 v12, s65, v12
  buffer_load_dwordx4 v119, s[16:19], s67 offen offset:1024 lds
  s_waitcnt lgkmcnt(6)
  v_mfma_f32_16x16x32_bf16 v[48:51], v[96:99], v[208:211], v[48:51]
  ds_read_b64_tr_b16 v[108:109], v125 offset:28672
  v_mul_f32 v13, s65, v13
  v_mul_f32 v14, s65, v14
  v_mul_f32 v15, s65, v15
  v_mfma_f32_16x16x32_bf16 v[52:55], v[96:99], v[212:215], v[52:55]
  v_cvt_pk_bf16_f32 v8, v8, v9
  v_cvt_pk_bf16_f32 v9, v10, v11
  s_waitcnt vmcnt(59)
  buffer_load_dwordx4 v120, s[16:19], s67 offen offset:2048 lds
  v_mfma_f32_16x16x32_bf16 v[56:59], v[96:99], v[216:219], v[56:59]
  ds_read_b64_tr_b16 v[110:111], v125 offset:29184
  v_cvt_pk_bf16_f32 v12, v12, v13
  v_cvt_pk_bf16_f32 v13, v14, v15
  ds_write_b64 v127, v[8:9] offset:8192
  buffer_load_dwordx4 v121, s[16:19], s67 offen offset:3072 lds
  v_mfma_f32_16x16x32_bf16 v[60:63], v[96:99], v[220:223], v[60:63]
  ds_write_b64 v127, v[12:13] offset:12288
  v_mul_f32 v16, s65, v16
  v_mfma_f32_16x16x32_bf16 v[64:67], v[96:99], v[224:227], v[64:67]
  v_mul_f32 v17, s65, v17
  v_mul_f32 v18, s65, v18
  v_mul_f32 v19, s65, v19
  v_mfma_f32_16x16x32_bf16 v[68:71], v[96:99], v[228:231], v[68:71]
  v_mul_f32 v20, s65, v20
  v_mul_f32 v21, s65, v21
  s_waitcnt lgkmcnt(8)
  v_mfma_f32_16x16x32_bf16 v[48:51], v[100:103], v[232:235], v[48:51]
  ds_read_b64_tr_b16 v[96:97], v122 offset:0
  v_mul_f32 v22, s65, v22
  v_mul_f32 v23, s65, v23
  v_cvt_pk_bf16_f32 v16, v16, v17
  s_barrier
  s_mov_b32 m0, 75776
  s_xor_b32 s67, s70, 33536
  buffer_load_dwordx4 v112, s[20:23], s67 offen offset:0 lds
  v_mfma_f32_16x16x32_bf16 v[52:55], v[100:103], v[236:239], v[52:55]
  v_cvt_pk_bf16_f32 v17, v18, v19
  v_cvt_pk_bf16_f32 v20, v20, v21
  s_waitcnt vmcnt(59)
  buffer_load_dwordx4 v113, s[20:23], s67 offen offset:1024 lds
  v_mfma_f32_16x16x32_bf16 v[56:59], v[100:103], v[240:243], v[56:59]
  ds_read_b64_tr_b16 v[98:99], v122 offset:512
  v_cvt_pk_bf16_f32 v21, v22, v23
  ds_write_b64 v127, v[16:17] offset:16384
  ds_write_b64 v127, v[20:21] offset:20480
  v_mfma_f32_16x16x32_bf16 v[60:63], v[100:103], v[244:247], v[60:63]
  v_mul_f32 v24, s65, v24
  v_mul_f32 v25, s65, v25
  buffer_load_dwordx4 v114, s[20:23], s67 offen offset:2048 lds
  v_mfma_f32_16x16x32_bf16 v[64:67], v[100:103], v[248:251], v[64:67]
  v_mul_f32 v26, s65, v26
  v_mul_f32 v27, s65, v27
  buffer_load_dwordx4 v115, s[20:23], s67 offen offset:3072 lds
  v_mfma_f32_16x16x32_bf16 v[68:71], v[100:103], v[252:255], v[68:71]
  v_mul_f32 v28, s65, v28
  v_mul_f32 v29, s65, v29
  v_mul_f32 v30, s65, v30
  s_mov_b32 m0, 79872
  s_xor_b32 s67, s70, 49920
  s_waitcnt vmcnt(59)
  buffer_load_dwordx4 v112, s[20:23], s67 offen offset:0 lds
  s_waitcnt lgkmcnt(10)
  v_mfma_f32_16x16x32_bf16 v[72:75], v[104:107], v[208:211], v[72:75]
  ds_read_b64_tr_b16 v[100:101], v122 offset:4096
  v_mul_f32 v31, s65, v31
  v_cvt_pk_bf16_f32 v24, v24, v25
  v_mfma_f32_16x16x32_bf16 v[76:79], v[104:107], v[212:215], v[76:79]
  v_cvt_pk_bf16_f32 v25, v26, v27
  v_cvt_pk_bf16_f32 v28, v28, v29
  v_cvt_pk_bf16_f32 v29, v30, v31
  buffer_load_dwordx4 v113, s[20:23], s67 offen offset:1024 lds
  v_mfma_f32_16x16x32_bf16 v[80:83], v[104:107], v[216:219], v[80:83]
  ds_read_b64_tr_b16 v[102:103], v122 offset:4608
  ds_write_b64 v127, v[24:25] offset:256
  ds_write_b64 v127, v[28:29] offset:4352
  buffer_load_dwordx4 v114, s[20:23], s67 offen offset:2048 lds
  v_mfma_f32_16x16x32_bf16 v[84:87], v[104:107], v[220:223], v[84:87]
  v_mul_f32 v32, s65, v32
  v_mul_f32 v33, s65, v33
  v_mul_f32 v34, s65, v34
  s_waitcnt vmcnt(59)
  buffer_load_dwordx4 v115, s[20:23], s67 offen offset:3072 lds
  v_mfma_f32_16x16x32_bf16 v[88:91], v[104:107], v[224:227], v[88:91]
  v_mul_f32 v35, s65, v35
  v_mul_f32 v36, s65, v36
  v_mfma_f32_16x16x32_bf16 v[92:95], v[104:107], v[228:231], v[92:95]
  v_mul_f32 v37, s65, v37
  v_mul_f32 v38, s65, v38
  v_mul_f32 v39, s65, v39
  s_xor_b32 s53, s86, s48
  s_mov_b32 m0, 8704
  s_nop 0
  buffer_load_dwordx4 v126, s[8:11], s53 offen offset:0 nt lds
  s_waitcnt lgkmcnt(10)
  v_mfma_f32_16x16x32_bf16 v[72:75], v[108:111], v[232:235], v[72:75]
  ds_read_b64_tr_b16 v[104:105], v123 offset:0
  v_cvt_pk_bf16_f32 v32, v32, v33
  v_cvt_pk_bf16_f32 v33, v34, v35
  s_mov_b32 m0, 8768
  s_nop 0
  buffer_load_dwordx4 v126, s[8:11], s53 offen offset:1024 nt lds
  v_mfma_f32_16x16x32_bf16 v[76:79], v[108:111], v[236:239], v[76:79]
  v_cvt_pk_bf16_f32 v36, v36, v37
  v_cvt_pk_bf16_f32 v37, v38, v39
  ds_write_b64 v127, v[32:33] offset:8448
  s_mov_b32 m0, 8832
  s_waitcnt vmcnt(59)
  buffer_load_dwordx4 v126, s[8:11], s53 offen offset:2048 nt lds
  v_mfma_f32_16x16x32_bf16 v[80:83], v[108:111], v[240:243], v[80:83]
  ds_read_b64_tr_b16 v[106:107], v123 offset:512
  ds_write_b64 v127, v[36:37] offset:12544
  v_mul_f32 v40, s65, v40
  v_mfma_f32_16x16x32_bf16 v[84:87], v[108:111], v[244:247], v[84:87]
  v_mul_f32 v41, s65, v41
  v_mul_f32 v42, s65, v42
  v_mul_f32 v43, s65, v43
  s_mov_b32 m0, 8896
  s_add_u32 s86, s86, 4096
  buffer_load_dwordx4 v126, s[8:11], s53 offen offset:3072 nt lds
  v_mfma_f32_16x16x32_bf16 v[88:91], v[108:111], v[248:251], v[88:91]
  v_mul_f32 v44, s65, v44
  v_mul_f32 v45, s65, v45
  s_xor_b32 s53, s86, s48
  s_mov_b32 m0, 13056
  s_nop 0
  buffer_load_dwordx4 v126, s[8:11], s53 offen offset:0 nt lds
  v_mfma_f32_16x16x32_bf16 v[92:95], v[108:111], v[252:255], v[92:95]
  v_mul_f32 v46, s65, v46
  v_mul_f32 v47, s65, v47
  v_cvt_pk_bf16_f32 v40, v40, v41
  s_mov_b32 m0, 13120
  s_waitcnt vmcnt(59)
  buffer_load_dwordx4 v126, s[8:11], s53 offen offset:1024 nt lds
  s_waitcnt lgkmcnt(10)
  v_mfma_f32_16x16x32_bf16 v[0:3], v[96:99], a[0:3], 0
  ds_read_b64_tr_b16 v[108:109], v123 offset:4096
  v_cvt_pk_bf16_f32 v41, v42, v43
  v_cvt_pk_bf16_f32 v44, v44, v45
  v_mfma_f32_16x16x32_bf16 v[4:7], v[96:99], a[4:7], 0
  v_cvt_pk_bf16_f32 v45, v46, v47
  ds_write_b64 v127, v[40:41] offset:16640
  ds_write_b64 v127, v[44:45] offset:20736
  s_mov_b32 m0, 13184
  s_nop 0
  buffer_load_dwordx4 v126, s[8:11], s53 offen offset:2048 nt lds
  v_mfma_f32_16x16x32_bf16 v[8:11], v[96:99], a[8:11], 0
  ds_read_b64_tr_b16 v[110:111], v123 offset:4608
  v_mul_f32 v48, s65, v48
  v_mul_f32 v49, s65, v49
  s_mov_b32 m0, 13248
  s_add_u32 s86, s86, 4096
  buffer_load_dwordx4 v126, s[8:11], s53 offen offset:3072 nt lds
  v_mfma_f32_16x16x32_bf16 v[12:15], v[96:99], a[12:15], 0
  v_mul_f32 v50, s65, v50
  v_mul_f32 v51, s65, v51
  s_mov_b32 m0, 43008
  s_xor_b32 s53, s87, s48
  s_waitcnt vmcnt(59)
  buffer_load_dwordx4 v116, s[12:15], s53 offen offset:0 nt lds
  v_mfma_f32_16x16x32_bf16 v[16:19], v[96:99], a[16:19], 0
  v_mul_f32 v52, s65, v52
  v_mul_f32 v53, s65, v53
  v_mul_f32 v54, s65, v54
  v_mfma_f32_16x16x32_bf16 v[20:23], v[96:99], a[20:23], 0
  v_mul_f32 v55, s65, v55
  v_cvt_pk_bf16_f32 v48, v48, v49
  buffer_load_dwordx4 v117, s[12:15], s53 offen offset:1024 nt lds
  s_waitcnt lgkmcnt(10)
  v_mfma_f32_16x16x32_bf16 v[0:3], v[100:103], a[24:27], v[0:3]
  ds_read_b64_tr_b16 v[96:97], v124 offset:0
  v_cvt_pk_bf16_f32 v49, v50, v51
  v_cvt_pk_bf16_f32 v52, v52, v53
  v_cvt_pk_bf16_f32 v53, v54, v55
  buffer_load_dwordx4 v116, s[12:15], s53 offen offset:2048 nt lds
  v_mfma_f32_16x16x32_bf16 v[4:7], v[100:103], a[28:31], v[4:7]
  ds_write_b64 v127, v[48:49] offset:1024
  ds_write_b64 v127, v[52:53] offset:5120
  s_waitcnt vmcnt(59)
  buffer_load_dwordx4 v117, s[12:15], s53 offen offset:3072 nt lds
  v_mfma_f32_16x16x32_bf16 v[8:11], v[100:103], a[32:35], v[8:11]
  ds_read_b64_tr_b16 v[98:99], v124 offset:512
  v_mul_f32 v56, s65, v56
  v_mul_f32 v57, s65, v57
  v_mul_f32 v58, s65, v58
  v_mfma_f32_16x16x32_bf16 v[12:15], v[100:103], a[36:39], v[12:15]
  v_mul_f32 v59, s65, v59
  v_mul_f32 v60, s65, v60
  s_add_u32 s87, s87, 4096
  s_mov_b32 m0, 47104
  s_xor_b32 s53, s87, s48
  buffer_load_dwordx4 v116, s[12:15], s53 offen offset:0 nt lds
  v_mfma_f32_16x16x32_bf16 v[16:19], v[100:103], a[40:43], v[16:19]
  v_mul_f32 v61, s65, v61
  v_mul_f32 v62, s65, v62
  v_mul_f32 v63, s65, v63
  buffer_load_dwordx4 v117, s[12:15], s53 offen offset:1024 nt lds
  s_waitcnt vmcnt(59)
  buffer_load_dwordx4 v116, s[12:15], s53 offen offset:2048 nt lds
  buffer_load_dwordx4 v117, s[12:15], s53 offen offset:3072 nt lds
  s_add_u32 s87, s87, 4096
  s_mov_b32 m0, 124928
  s_xor_b32 s67, s89, 1572864
  buffer_load_dwordx4 v118, s[16:19], s67 offen offset:0 lds
  s_waitcnt vmcnt(59)
  buffer_load_dwordx4 v119, s[16:19], s67 offen offset:1024 lds
  buffer_load_dwordx4 v120, s[16:19], s67 offen offset:2048 lds
  buffer_load_dwordx4 v121, s[16:19], s67 offen offset:3072 lds
  s_mov_b32 m0, 129024
  s_xor_b32 s67, s89, 1835008
  s_waitcnt vmcnt(59)
  buffer_load_dwordx4 v118, s[16:19], s67 offen offset:0 lds
  buffer_load_dwordx4 v119, s[16:19], s67 offen offset:1024 lds
  buffer_load_dwordx4 v120, s[16:19], s67 offen offset:2048 lds
  s_waitcnt vmcnt(59)
  buffer_load_dwordx4 v121, s[16:19], s67 offen offset:3072 lds
  s_barrier
  s_add_u32 s71, s71, 65536
  s_xor_b32 s70, s71, s49
  s_mov_b32 m0, 83968
  s_xor_b32 s67, s70, 0
  buffer_load_dwordx4 v112, s[20:23], s67 offen offset:0 lds
  v_mfma_f32_16x16x32_bf16 v[20:23], v[100:103], a[44:47], v[20:23]
  v_cvt_pk_bf16_f32 v56, v56, v57
  v_cvt_pk_bf16_f32 v57, v58, v59
  buffer_load_dwordx4 v113, s[20:23], s67 offen offset:1024 lds
  s_waitcnt lgkmcnt(9)
  v_mfma_f32_16x16x32_bf16 v[24:27], v[104:107], a[0:3], 0
  ds_read_b64_tr_b16 v[100:101], v124 offset:4096
  v_cvt_pk_bf16_f32 v60, v60, v61
  v_cvt_pk_bf16_f32 v61, v62, v63
  ds_write_b64 v127, v[56:57] offset:9216
  v_mfma_f32_16x16x32_bf16 v[28:31], v[104:107], a[4:7], 0
  ds_write_b64 v127, v[60:61] offset:13312
  v_mul_f32 v64, s65, v64
  s_waitcnt vmcnt(59)
  buffer_load_dwordx4 v114, s[20:23], s67 offen offset:2048 lds
  v_mfma_f32_16x16x32_bf16 v[32:35], v[104:107], a[8:11], 0
  ds_read_b64_tr_b16 v[102:103], v124 offset:4608
  v_mul_f32 v65, s65, v65
  v_mul_f32 v66, s65, v66
  v_mul_f32 v67, s65, v67
  buffer_load_dwordx4 v115, s[20:23], s67 offen offset:3072 lds
  v_mfma_f32_16x16x32_bf16 v[36:39], v[104:107], a[12:15], 0
  v_mul_f32 v68, s65, v68
  v_mul_f32 v69, s65, v69
  s_mov_b32 m0, 88064
  s_xor_b32 s67, s70, 16384
  buffer_load_dwordx4 v112, s[20:23], s67 offen offset:0 lds
  v_mfma_f32_16x16x32_bf16 v[40:43], v[104:107], a[16:19], 0
  v_mul_f32 v70, s65, v70
  v_mul_f32 v71, s65, v71
  v_cvt_pk_bf16_f32 v64, v64, v65
  v_mfma_f32_16x16x32_bf16 v[44:47], v[104:107], a[20:23], 0
  v_cvt_pk_bf16_f32 v65, v66, v67
  v_cvt_pk_bf16_f32 v68, v68, v69
  s_waitcnt vmcnt(59)
  buffer_load_dwordx4 v113, s[20:23], s67 offen offset:1024 lds
  s_waitcnt lgkmcnt(8)
  v_mfma_f32_16x16x32_bf16 v[24:27], v[108:111], a[24:27], v[24:27]
  ds_read_b64_tr_b16 v[104:105], v125 offset:0
  v_cvt_pk_bf16_f32 v69, v70, v71
  ds_write_b64 v127, v[64:65] offset:17408
  ds_write_b64 v127, v[68:69] offset:21504
  buffer_load_dwordx4 v114, s[20:23], s67 offen offset:2048 lds
  v_mfma_f32_16x16x32_bf16 v[28:31], v[108:111], a[28:31], v[28:31]
  v_mul_f32 v72, s65, v72
  v_mul_f32 v73, s65, v73
  buffer_load_dwordx4 v115, s[20:23], s67 offen offset:3072 lds
  v_mfma_f32_16x16x32_bf16 v[32:35], v[108:111], a[32:35], v[32:35]
  ds_read_b64_tr_b16 v[106:107], v125 offset:512
  v_mul_f32 v74, s65, v74
  v_mul_f32 v75, s65, v75
  v_mfma_f32_16x16x32_bf16 v[36:39], v[108:111], a[36:39], v[36:39]
  v_mul_f32 v76, s65, v76
  v_mul_f32 v77, s65, v77
  v_mul_f32 v78, s65, v78
  s_xor_b32 s53, s86, s48
  s_mov_b32 m0, 17408
  s_waitcnt vmcnt(59)
  buffer_load_dwordx4 v126, s[8:11], s53 offen offset:0 nt lds
  v_mfma_f32_16x16x32_bf16 v[40:43], v[108:111], a[40:43], v[40:43]
  v_mul_f32 v79, s65, v79
  v_cvt_pk_bf16_f32 v72, v72, v73
  s_mov_b32 m0, 17472
  s_nop 0
  buffer_load_dwordx4 v126, s[8:11], s53 offen offset:1024 nt lds
  v_mfma_f32_16x16x32_bf16 v[44:47], v[108:111], a[44:47], v[44:47]
  v_cvt_pk_bf16_f32 v73, v74, v75
  v_cvt_pk_bf16_f32 v76, v76, v77
  v_cvt_pk_bf16_f32 v77, v78, v79
  s_mov_b32 m0, 17536
  s_nop 0
  buffer_load_dwordx4 v126, s[8:11], s53 offen offset:2048 nt lds
  s_waitcnt lgkmcnt(8)
  v_mfma_f32_16x16x32_bf16 v[48:51], v[96:99], a[0:3], 0
  ds_read_b64_tr_b16 v[108:109], v125 offset:4096
  ds_write_b64 v127, v[72:73] offset:1280
  ds_write_b64 v127, v[76:77] offset:5376
  v_mfma_f32_16x16x32_bf16 v[52:55], v[96:99], a[4:7], 0
  v_mul_f32 v80, s65, v80
  v_mul_f32 v81, s65, v81
  v_mul_f32 v82, s65, v82
  s_mov_b32 m0, 17600
  s_add_u32 s86, s86, 4096
  s_waitcnt vmcnt(59)
  buffer_load_dwordx4 v126, s[8:11], s53 offen offset:3072 nt lds
  v_mfma_f32_16x16x32_bf16 v[56:59], v[96:99], a[8:11], 0
  ds_read_b64_tr_b16 v[110:111], v125 offset:4608
  v_mul_f32 v83, s65, v83
  v_mul_f32 v84, s65, v84
  s_xor_b32 s53, s86, s48
  s_mov_b32 m0, 21760
  s_nop 0
  buffer_load_dwordx4 v126, s[8:11], s53 offen offset:0 nt lds
  v_mfma_f32_16x16x32_bf16 v[60:63], v[96:99], a[12:15], 0
  v_mul_f32 v85, s65, v85
  v_mul_f32 v86, s65, v86
  v_mul_f32 v87, s65, v87
  s_mov_b32 m0, 21824
  s_nop 0
  buffer_load_dwordx4 v126, s[8:11], s53 offen offset:1024 nt lds
  v_mfma_f32_16x16x32_bf16 v[64:67], v[96:99], a[16:19], 0
  v_cvt_pk_bf16_f32 v80, v80, v81
  v_cvt_pk_bf16_f32 v81, v82, v83
  v_mfma_f32_16x16x32_bf16 v[68:71], v[96:99], a[20:23], 0
  v_cvt_pk_bf16_f32 v84, v84, v85
  v_cvt_pk_bf16_f32 v85, v86, v87
  ds_write_b64 v127, v[80:81] offset:9472
  s_mov_b32 m0, 21888
  s_waitcnt vmcnt(59)
  buffer_load_dwordx4 v126, s[8:11], s53 offen offset:2048 nt lds
  s_waitcnt lgkmcnt(9)
  v_mfma_f32_16x16x32_bf16 v[48:51], v[100:103], a[24:27], v[48:51]
  ds_read_b64_tr_b16 v[96:97], v122 offset:8192
  ds_write_b64 v127, v[84:85] offset:13568
  v_mul_f32 v88, s65, v88
  s_mov_b32 m0, 21952
  s_add_u32 s86, s86, 4096
  buffer_load_dwordx4 v126, s[8:11], s53 offen offset:3072 nt lds
  v_mfma_f32_16x16x32_bf16 v[52:55], v[100:103], a[28:31], v[52:55]
  v_mul_f32 v89, s65, v89
  v_mul_f32 v90, s65, v90
  v_mul_f32 v91, s65, v91
  s_mov_b32 m0, 51200
  s_xor_b32 s53, s87, s48
  buffer_load_dwordx4 v116, s[12:15], s53 offen offset:0 nt lds
  v_mfma_f32_16x16x32_bf16 v[56:59], v[100:103], a[32:35], v[56:59]
  ds_read_b64_tr_b16 v[98:99], v122 offset:8704
  v_mul_f32 v92, s65, v92
  v_mul_f32 v93, s65, v93
  v_mfma_f32_16x16x32_bf16 v[60:63], v[100:103], a[36:39], v[60:63]
  v_mul_f32 v94, s65, v94
  v_mul_f32 v95, s65, v95
  v_cvt_pk_bf16_f32 v88, v88, v89
  s_waitcnt vmcnt(59)
  buffer_load_dwordx4 v117, s[12:15], s53 offen offset:1024 nt lds
  v_mfma_f32_16x16x32_bf16 v[64:67], v[100:103], a[40:43], v[64:67]
  v_cvt_pk_bf16_f32 v89, v90, v91
  v_cvt_pk_bf16_f32 v92, v92, v93
  buffer_load_dwordx4 v116, s[12:15], s53 offen offset:2048 nt lds
  v_mfma_f32_16x16x32_bf16 v[68:71], v[100:103], a[44:47], v[68:71]
  v_cvt_pk_bf16_f32 v93, v94, v95
  ds_write_b64 v127, v[88:89] offset:17664
  ds_write_b64 v127, v[92:93] offset:21760
  buffer_load_dwordx4 v117, s[12:15], s53 offen offset:3072 nt lds
  s_add_u32 s87, s87, 4096
  s_mov_b32 m0, 55296
  s_xor_b32 s53, s87, s48
  s_waitcnt vmcnt(59)
  buffer_load_dwordx4 v116, s[12:15], s53 offen offset:0 nt lds
  buffer_load_dwordx4 v117, s[12:15], s53 offen offset:1024 nt lds
  buffer_load_dwordx4 v116, s[12:15], s53 offen offset:2048 nt lds
  s_waitcnt vmcnt(59)
  buffer_load_dwordx4 v117, s[12:15], s53 offen offset:3072 nt lds
  s_add_u32 s87, s87, 4096
  v_add_u32 v127, s41, v127
  s_sub_u32 s41, 0, s41
  s_mov_b32 s88, s89
  s_add_u32 s69, s69, 128
  s_xor_b32 s89, s69, s50
  s_cmp_lt_u32 s64, 32
  s_cselect_b32 s89, s89, 0x80000000
  s_waitcnt lgkmcnt(0)
  s_barrier
  s_add_u32 s64, s64, 8
  s_cmp_lt_u32 s64, 48
  s_cbranch_scc1 L_lloop
  s_waitcnt lgkmcnt(0)
  s_xor_b32 s70, s93, s49
  v_mov_b32 v102, 157696
  v_mov_b32 v104, 0
  v_mov_b32 v105, 0
  ds_write_b64 v102, v[104:105]
  s_waitcnt lgkmcnt(0)
  s_lshl_b32 s67, s3, 3
  v_mov_b32 v106, s67
  buffer_load_dword v107, v106, s[4:7], 0 offen sc1
  s_mov_b32 m0, 92160
  s_xor_b32 s67, s70, 262400
  buffer_load_dwordx4 v112, s[20:23], s67 offen offset:0 lds
  s_waitcnt vmcnt(59)
  buffer_load_dwordx4 v113, s[20:23], s67 offen offset:1024 lds
  buffer_load_dwordx4 v114, s[20:23], s67 offen offset:2048 lds
  buffer_load_dwordx4 v115, s[20:23], s67 offen offset:3072 lds
  s_mov_b32 m0, 96256
  s_xor_b32 s67, s70, 278784
  s_waitcnt vmcnt(59)
  buffer_load_dwordx4 v112, s[20:23], s67 offen offset:0 lds
  buffer_load_dwordx4 v113, s[20:23], s67 offen offset:1024 lds
  buffer_load_dwordx4 v114, s[20:23], s67 offen offset:2048 lds
  s_waitcnt vmcnt(59)
  buffer_load_dwordx4 v115, s[20:23], s67 offen offset:3072 lds
  s_xor_b32 s53, s86, s48
  s_mov_b32 m0, 26112
  s_nop 0
  buffer_load_dwordx4 v126, s[8:11], s53 offen offset:0 nt lds
  s_mov_b32 m0, 26176
  s_nop 0
  buffer_load_dwordx4 v126, s[8:11], s53 offen offset:1024 nt lds
  s_mov_b32 m0, 26240
  s_waitcnt vmcnt(59)
  buffer_load_dwordx4 v126, s[8:11], s53 offen offset:2048 nt lds
  s_mov_b32 m0, 26304
  s_add_u32 s86, s86, 4096
  buffer_load_dwordx4 v126, s[8:11], s53 offen offset:3072 nt lds
  s_xor_b32 s53, s86, s48
  s_mov_b32 m0, 30464
  s_nop 0
  buffer_load_dwordx4 v126, s[8:11], s53 offen offset:0 nt lds
  s_mov_b32 m0, 30528
  s_waitcnt vmcnt(59)
  buffer_load_dwordx4 v126, s[8:11], s53 offen offset:1024 nt lds
  s_mov_b32 m0, 30592
  s_nop 0
  buffer_load_dwordx4 v126, s[8:11], s53 offen offset:2048 nt lds
  s_mov_b32 m0, 30656
  s_add_u32 s86, s86, 4096
  buffer_load_dwordx4 v126, s[8:11], s53 offen offset:3072 nt lds
  s_mov_b32 m0, 59392
  s_xor_b32 s53, s87, s48
  s_waitcnt vmcnt(59)
  buffer_load_dwordx4 v116, s[12:15], s53 offen offset:0 nt lds
  buffer_load_dwordx4 v117, s[12:15], s53 offen offset:1024 nt lds
  buffer_load_dwordx4 v116, s[12:15], s53 offen offset:2048 nt lds
  s_waitcnt vmcnt(59)
  buffer_load_dwordx4 v117, s[12:15], s53 offen offset:3072 nt lds
  s_add_u32 s87, s87, 4096
  s_mov_b32 m0, 63488
  s_xor_b32 s53, s87, s48
  buffer_load_dwordx4 v116, s[12:15], s53 offen offset:0 nt lds
  buffer_load_dwordx4 v117, s[12:15], s53 offen offset:1024 nt lds
  s_waitcnt vmcnt(59)
  buffer_load_dwordx4 v116, s[12:15], s53 offen offset:2048 nt lds
  buffer_load_dwordx4 v117, s[12:15], s53 offen offset:3072 nt lds
  s_add_u32 s87, s87, 4096
  s_waitcnt vmcnt(57)
  s_barrier
  s_mov_b32 m0, 67584
  s_xor_b32 s67, s70, 262656
  buffer_load_dwordx4 v112, s[20:23], s67 offen offset:0 lds
  buffer_load_dwordx4 v113, s[20:23], s67 offen offset:1024 lds
  buffer_load_dwordx4 v114, s[20:23], s67 offen offset:2048 lds
  buffer_load_dwordx4 v115, s[20:23], s67 offen offset:3072 lds
  s_mov_b32 m0, 71680
  s_xor_b32 s67, s70, 279040
  buffer_load_dwordx4 v112, s[20:23], s67 offen offset:0 lds
  s_waitcnt vmcnt(59)
  buffer_load_dwordx4 v113, s[20:23], s67 offen offset:1024 lds
  buffer_load_dwordx4 v114, s[20:23], s67 offen offset:2048 lds
  buffer_load_dwordx4 v115, s[20:23], s67 offen offset:3072 lds
  s_xor_b32 s53, s86, s48
  s_mov_b32 m0, 0
  s_waitcnt vmcnt(59)
  buffer_load_dwordx4 v126, s[8:11], s53 offen offset:0 nt lds
  s_mov_b32 m0, 64
  s_nop 0
  buffer_load_dwordx4 v126, s[8:11], s53 offen offset:1024 nt lds
  s_mov_b32 m0, 128
  s_nop 0
  buffer_load_dwordx4 v126, s[8:11], s53 offen offset:2048 nt lds
  s_mov_b32 m0, 192
  s_add_u32 s86, s86, 4096
  s_waitcnt vmcnt(59)
  buffer_load_dwordx4 v126, s[8:11], s53 offen offset:3072 nt lds
  s_xor_b32 s53, s86, s48
  s_mov_b32 m0, 4352
  s_nop 0
  buffer_load_dwordx4 v126, s[8:11], s53 offen offset:0 nt lds
  s_mov_b32 m0, 4416
  s_nop 0
  buffer_load_dwordx4 v126, s[8:11], s53 offen offset:1024 nt lds
  s_mov_b32 m0, 4480
  s_waitcnt vmcnt(59)
  buffer_load_dwordx4 v126, s[8:11], s53 offen offset:2048 nt lds
  s_mov_b32 m0, 4544
  s_add_u32 s86, s86, 4096
  buffer_load_dwordx4 v126, s[8:11], s53 offen offset:3072 nt lds
  s_mov_b32 m0, 34816
  s_xor_b32 s53, s87, s48
  buffer_load_dwordx4 v116, s[12:15], s53 offen offset:0 nt lds
  s_waitcnt vmcnt(59)
  buffer_load_dwordx4 v117, s[12:15], s53 offen offset:1024 nt lds
  buffer_load_dwordx4 v116, s[12:15], s53 offen offset:2048 nt lds
  buffer_load_dwordx4 v117, s[12:15], s53 offen offset:3072 nt lds
  s_add_u32 s87, s87, 4096
  s_mov_b32 m0, 38912
  s_xor_b32 s53, s87, s48
  s_waitcnt vmcnt(59)
  buffer_load_dwordx4 v116, s[12:15], s53 offen offset:0 nt lds
  buffer_load_dwordx4 v117, s[12:15], s53 offen offset:1024 nt lds
  buffer_load_dwordx4 v116, s[12:15], s53 offen offset:2048 nt lds
  s_waitcnt vmcnt(59)
  buffer_load_dwordx4 v117, s[12:15], s53 offen offset:3072 nt lds
  s_add_u32 s87, s87, 4096
  s_waitcnt vmcnt(49)
  s_barrier
  s_mov_b32 m0, 75776
  s_xor_b32 s67, s70, 262912
  buffer_load_dwordx4 v112, s[20:23], s67 offen offset:0 lds
  buffer_load_dwordx4 v113, s[20:23], s67 offen offset:1024 lds
  buffer_load_dwordx4 v114, s[20:23], s67 offen offset:2048 lds
  buffer_load_dwordx4 v115, s[20:23], s67 offen offset:3072 lds
  s_mov_b32 m0, 79872
  s_xor_b32 s67, s70, 279296
  buffer_load_dwordx4 v112, s[20:23], s67 offen offset:0 lds
  buffer_load_dwordx4 v113, s[20:23], s67 offen offset:1024 lds
  buffer_load_dwordx4 v114, s[20:23], s67 offen offset:2048 lds
  buffer_load_dwordx4 v115, s[20:23], s67 offen offset:3072 lds
  s_xor_b32 s53, s86, s48
  s_mov_b32 m0, 8704
  s_nop 0
  buffer_load_dwordx4 v126, s[8:11], s53 offen offset:0 nt lds
  s_mov_b32 m0, 8768
  s_nop 0
  buffer_load_dwordx4 v126, s[8:11], s53 offen offset:1024 nt lds
  s_mov_b32 m0, 8832
  s_nop 0
  buffer_load_dwordx4 v126, s[8:11], s53 offen offset:2048 nt lds
  s_mov_b32 m0, 8896
  s_add_u32 s86, s86, 4096
  buffer_load_dwordx4 v126, s[8:11], s53 offen offset:3072 nt lds
  s_xor_b32 s53, s86, s48
  s_mov_b32 m0, 13056
  s_nop 0
  buffer_load_dwordx4 v126, s[8:11], s53 offen offset:0 nt lds
  s_mov_b32 m0, 13120
  s_waitcnt vmcnt(59)
  buffer_load_dwordx4 v126, s[8:11], s53 offen offset:1024 nt lds
  s_mov_b32 m0, 13184
  s_nop 0
  buffer_load_dwordx4 v126, s[8:11], s53 offen offset:2048 nt lds
  s_mov_b32 m0, 13248
  s_add_u32 s86, s86, 4096
  buffer_load_dwordx4 v126, s[8:11], s53 offen offset:3072 nt lds
  s_mov_b32 m0, 43008
  s_xor_b32 s53, s87, s48
  s_waitcnt vmcnt(59)
  buffer_load_dwordx4 v116, s[12:15], s53 offen offset:0 nt lds
  buffer_load_dwordx4 v117, s[12:15], s53 offen offset:1024 nt lds
  buffer_load_dwordx4 v116, s[12:15], s53 offen offset:2048 nt lds
  s_waitcnt vmcnt(59)
  buffer_load_dwordx4 v117, s[12:15], s53 offen offset:3072 nt lds
  s_add_u32 s87, s87, 4096
  s_mov_b32 m0, 47104
  s_xor_b32 s53, s87, s48
  buffer_load_dwordx4 v116, s[12:15], s53 offen offset:0 nt lds
  buffer_load_dwordx4 v117, s[12:15], s53 offen offset:1024 nt lds
  s_waitcnt vmcnt(59)
  buffer_load_dwordx4 v116, s[12:15], s53 offen offset:2048 nt lds
  buffer_load_dwordx4 v117, s[12:15], s53 offen offset:3072 nt lds
  s_add_u32 s87, s87, 4096
  s_waitcnt vmcnt(48)
  s_barrier
  s_mov_b32 m0, 83968
  s_xor_b32 s67, s70, 294912
  buffer_load_dwordx4 v112, s[20:23], s67 offen offset:0 lds
  buffer_load_dwordx4 v113, s[20:23], s67 offen offset:1024 lds
  buffer_load_dwordx4 v114, s[20:23], s67 offen offset:2048 lds
  buffer_load_dwordx4 v115, s[20:23], s67 offen offset:3072 lds
  s_mov_b32 m0, 88064
  s_xor_b32 s67, s70, 311296
  buffer_load_dwordx4 v112, s[20:23], s67 offen offset:0 lds
  buffer_load_dwordx4 v113, s[20:23], s67 offen offset:1024 lds
  buffer_load_dwordx4 v114, s[20:23], s67 offen offset:2048 lds
  buffer_load_dwordx4 v115, s[20:23], s67 offen offset:3072 lds
  s_xor_b32 s53, s86, s48
  s_mov_b32 m0, 17408
  s_nop 0
  buffer_load_dwordx4 v126, s[8:11], s53 offen offset:0 nt lds
  s_mov_b32 m0, 17472
  s_nop 0
  buffer_load_dwordx4 v126, s[8:11], s53 offen offset:1024 nt lds
  s_mov_b32 m0, 17536
  s_nop 0
  buffer_load_dwordx4 v126, s[8:11], s53 offen offset:2048 nt lds
  s_mov_b32 m0, 17600
  s_add_u32 s86, s86, 4096
  buffer_load_dwordx4 v126, s[8:11], s53 offen offset:3072 nt lds
  s_xor_b32 s53, s86, s48
  s_mov_b32 m0, 21760
  s_nop 0
  buffer_load_dwordx4 v126, s[8:11], s53 offen offset:0 nt lds
  s_mov_b32 m0, 21824
  s_nop 0
  buffer_load_dwordx4 v126, s[8:11], s53 offen offset:1024 nt lds
  s_mov_b32 m0, 21888
  s_waitcnt vmcnt(59)
  buffer_load_dwordx4 v126, s[8:11], s53 offen offset:2048 nt lds
  s_mov_b32 m0, 21952
  s_add_u32 s86, s86, 4096
  buffer_load_dwordx4 v126, s[8:11], s53 offen offset:3072 nt lds
  s_mov_b32 m0, 51200
  s_xor_b32 s53, s87, s48
  buffer_load_dwordx4 v116, s[12:15], s53 offen offset:0 nt lds
  s_waitcnt vmcnt(59)
  buffer_load_dwordx4 v117, s[12:15], s53 offen offset:1024 nt lds
  buffer_load_dwordx4 v116, s[12:15], s53 offen offset:2048 nt lds
  buffer_load_dwordx4 v117, s[12:15], s53 offen offset:3072 nt lds
  s_add_u32 s87, s87, 4096
  s_mov_b32 m0, 55296
  s_xor_b32 s53, s87, s48
  s_waitcnt vmcnt(59)
  buffer_load_dwordx4 v116, s[12:15], s53 offen offset:0 nt lds
  buffer_load_dwordx4 v117, s[12:15], s53 offen offset:1024 nt lds
  buffer_load_dwordx4 v116, s[12:15], s53 offen offset:2048 nt lds
  s_waitcnt vmcnt(59)
  buffer_load_dwordx4 v117, s[12:15], s53 offen offset:3072 nt lds
  s_add_u32 s87, s87, 4096
  s_mov_b32 m0, 100352
  s_xor_b32 s67, s70, 425984
  buffer_load_dwordx4 v112, s[20:23], s67 offen offset:0 lds
  buffer_load_dwordx4 v113, s[20:23], s67 offen offset:1024 lds
  s_waitcnt vmcnt(59)
  buffer_load_dwordx4 v114, s[20:23], s67 offen offset:2048 lds
  buffer_load_dwordx4 v115, s[20:23], s67 offen offset:3072 lds
  s_mov_b32 m0, 104448
  s_xor_b32 s67, s70, 442368
  buffer_load_dwordx4 v112, s[20:23], s67 offen offset:0 lds
  s_waitcnt vmcnt(59)
  buffer_load_dwordx4 v113, s[20:23], s67 offen offset:1024 lds
  buffer_load_dwordx4 v114, s[20:23], s67 offen offset:2048 lds
  buffer_load_dwordx4 v115, s[20:23], s67 offen offset:3072 lds
  s_waitcnt vmcnt(56)
  s_barrier
L_rdy:
  v_readfirstlane_b32 s67, v107
  s_nop 2
  s_cmp_lg_u32 s67, 0
  s_cbranch_scc1 L_rdy_ok
  buffer_load_dword v107, v106, s[4:7], 0 offen sc1
  s_waitcnt vmcnt(0)
  s_branch L_rdy
L_rdy_ok:
  s_mov_b32 m0, 92160
  s_xor_b32 s67, s70, 295168
  buffer_load_dwordx4 v112, s[20:23], s67 offen offset:0 lds
  buffer_load_dwordx4 v113, s[20:23], s67 offen offset:1024 lds
  buffer_load_dwordx4 v114, s[20:23], s67 offen offset:2048 lds
  buffer_load_dwordx4 v115, s[20:23], s67 offen offset:3072 lds
  s_mov_b32 m0, 96256
  s_xor_b32 s67, s70, 311552
  buffer_load_dwordx4 v112, s[20:23], s67 offen offset:0 lds
  buffer_load_dwordx4 v113, s[20:23], s67 offen offset:1024 lds
  s_waitcnt vmcnt(59)
  buffer_load_dwordx4 v114, s[20:23], s67 offen offset:2048 lds
  buffer_load_dwordx4 v115, s[20:23], s67 offen offset:3072 lds
  s_xor_b32 s53, s86, s48
  s_mov_b32 m0, 26112
  s_nop 0
  buffer_load_dwordx4 v126, s[8:11], s53 offen offset:0 nt lds
  s_mov_b32 m0, 26176
  s_waitcnt vmcnt(59)
  buffer_load_dwordx4 v126, s[8:11], s53 offen offset:1024 nt lds
  s_mov_b32 m0, 26240
  s_nop 0
  buffer_load_dwordx4 v126, s[8:11], s53 offen offset:2048 nt lds
  s_mov_b32 m0, 26304
  s_add_u32 s86, s86, 4096
  buffer_load_dwordx4 v126, s[8:11], s53 offen offset:3072 nt lds
  s_xor_b32 s53, s86, s48
  s_mov_b32 m0, 30464
  s_waitcnt vmcnt(59)
  buffer_load_dwordx4 v126, s[8:11], s53 offen offset:0 nt lds
  s_mov_b32 m0, 30528
  s_nop 0
  buffer_load_dwordx4 v126, s[8:11], s53 offen offset:1024 nt lds
  s_mov_b32 m0, 30592
  s_nop 0
  buffer_load_dwordx4 v126, s[8:11], s53 offen offset:2048 nt lds
  s_mov_b32 m0, 30656
  s_add_u32 s86, s86, 4096
  s_waitcnt vmcnt(59)
  buffer_load_dwordx4 v126, s[8:11], s53 offen offset:3072 nt lds
  s_mov_b32 m0, 59392
  s_xor_b32 s53, s87, s48
  buffer_load_dwordx4 v116, s[12:15], s53 offen offset:0 nt lds
  buffer_load_dwordx4 v117, s[12:15], s53 offen offset:1024 nt lds
  s_waitcnt vmcnt(59)
  buffer_load_dwordx4 v116, s[12:15], s53 offen offset:2048 nt lds
  buffer_load_dwordx4 v117, s[12:15], s53 offen offset:3072 nt lds
  s_add_u32 s87, s87, 4096
  s_mov_b32 m0, 63488
  s_xor_b32 s53, s87, s48
  buffer_load_dwordx4 v116, s[12:15], s53 offen offset:0 nt lds
  s_waitcnt vmcnt(59)
  buffer_load_dwordx4 v117, s[12:15], s53 offen offset:1024 nt lds
  buffer_load_dwordx4 v116, s[12:15], s53 offen offset:2048 nt lds
  buffer_load_dwordx4 v117, s[12:15], s53 offen offset:3072 nt lds
  s_add_u32 s87, s87, 4096
  s_mov_b32 m0, 108544
  s_xor_b32 s67, s70, 458752
  s_waitcnt vmcnt(59)
  buffer_load_dwordx4 v112, s[20:23], s67 offen offset:0 lds
  buffer_load_dwordx4 v113, s[20:23], s67 offen offset:1024 lds
  buffer_load_dwordx4 v114, s[20:23], s67 offen offset:2048 lds
  s_waitcnt vmcnt(59)
  buffer_load_dwordx4 v115, s[20:23], s67 offen offset:3072 lds
  s_mov_b32 m0, 112640
  s_xor_b32 s67, s70, 475136
  buffer_load_dwordx4 v112, s[20:23], s67 offen offset:0 lds
  buffer_load_dwordx4 v113, s[20:23], s67 offen offset:1024 lds
  s_waitcnt vmcnt(59)
  buffer_load_dwordx4 v114, s[20:23], s67 offen offset:2048 lds
  buffer_load_dwordx4 v115, s[20:23], s67 offen offset:3072 lds
  s_barrier
  s_mov_b32 m0, 67584
  s_xor_b32 s67, s70, 295424
  buffer_load_dwordx4 v112, s[20:23], s67 offen offset:0 lds
  s_waitcnt vmcnt(59)
  buffer_load_dwordx4 v113, s[20:23], s67 offen offset:1024 lds
  buffer_load_dwordx4 v114, s[20:23], s67 offen offset:2048 lds
  buffer_load_dwordx4 v115, s[20:23], s67 offen offset:3072 lds
  s_mov_b32 m0, 71680
  s_xor_b32 s67, s70, 311808
  s_waitcnt vmcnt(59)
  buffer_load_dwordx4 v112, s[20:23], s67 offen offset:0 lds
  buffer_load_dwordx4 v113, s[20:23], s67 offen offset:1024 lds
  buffer_load_dwordx4 v114, s[20:23], s67 offen offset:2048 lds
  s_waitcnt vmcnt(59)
  buffer_load_dwordx4 v115, s[20:23], s67 offen offset:3072 lds
  s_xor_b32 s53, s86, s48
  s_mov_b32 m0, 0
  s_nop 0
  buffer_load_dwordx4 v126, s[8:11], s53 offen offset:0 nt lds
  s_mov_b32 m0, 64
  s_nop 0
  buffer_load_dwordx4 v126, s[8:11], s53 offen offset:1024 nt lds
  s_mov_b32 m0, 128
  s_waitcnt vmcnt(59)
  buffer_load_dwordx4 v126, s[8:11], s53 offen offset:2048 nt lds
  s_mov_b32 m0, 192
  s_add_u32 s86, s86, 4096
  buffer_load_dwordx4 v126, s[8:11], s53 offen offset:3072 nt lds
  s_xor_b32 s53, s86, s48
  s_mov_b32 m0, 4352
  s_nop 0
  buffer_load_dwordx4 v126, s[8:11], s53 offen offset:0 nt lds
  s_mov_b32 m0, 4416
  s_waitcnt vmcnt(59)
  buffer_load_dwordx4 v126, s[8:11], s53 offen offset:1024 nt lds
  s_mov_b32 m0, 4480
  s_nop 0
  buffer_load_dwordx4 v126, s[8:11], s53 offen offset:2048 nt lds
  s_mov_b32 m0, 4544
  s_add_u32 s86, s86, 4096
  buffer_load_dwordx4 v126, s[8:11], s53 offen offset:3072 nt lds
  s_mov_b32 m0, 34816
  s_xor_b32 s53, s87, s48
  s_waitcnt vmcnt(59)
  buffer_load_dwordx4 v116, s[12:15], s53 offen offset:0 nt lds
  buffer_load_dwordx4 v117, s[12:15], s53 offen offset:1024 nt lds
  buffer_load_dwordx4 v116, s[12:15], s53 offen offset:2048 nt lds
  s_waitcnt vmcnt(59)
  buffer_load_dwordx4 v117, s[12:15], s53 offen offset:3072 nt lds
  s_add_u32 s87, s87, 4096
  s_mov_b32 m0, 38912
  s_xor_b32 s53, s87, s48
  buffer_load_dwordx4 v116, s[12:15], s53 offen offset:0 nt lds
  buffer_load_dwordx4 v117, s[12:15], s53 offen offset:1024 nt lds
  s_waitcnt vmcnt(59)
  buffer_load_dwordx4 v116, s[12:15], s53 offen offset:2048 nt lds
  buffer_load_dwordx4 v117, s[12:15], s53 offen offset:3072 nt lds
  s_add_u32 s87, s87, 4096
  s_mov_b32 m0, 116736
  s_xor_b32 s67, s70, 491520
  buffer_load_dwordx4 v112, s[20:23], s67 offen offset:0 lds
  s_waitcnt vmcnt(59)
  buffer_load_dwordx4 v113, s[20:23], s67 offen offset:1024 lds
  buffer_load_dwordx4 v114, s[20:23], s67 offen offset:2048 lds
  buffer_load_dwordx4 v115, s[20:23], s67 offen offset:3072 lds
  s_mov_b32 m0, 120832
  s_xor_b32 s67, s70, 507904
  s_waitcnt vmcnt(59)
  buffer_load_dwordx4 v112, s[20:23], s67 offen offset:0 lds
  buffer_load_dwordx4 v113, s[20:23], s67 offen offset:1024 lds
  buffer_load_dwordx4 v114, s[20:23], s67 offen offset:2048 lds
  s_waitcnt vmcnt(59)
  buffer_load_dwordx4 v115, s[20:23], s67 offen offset:3072 lds
  s_barrier
  s_mov_b32 m0, 75776
  s_xor_b32 s67, s70, 295680
  buffer_load_dwordx4 v112, s[20:23], s67 offen offset:0 lds
  buffer_load_dwordx4 v113, s[20:23], s67 offen offset:1024 lds
  s_waitcnt vmcnt(59)
  buffer_load_dwordx4 v114, s[20:23], s67 offen offset:2048 lds
  buffer_load_dwordx4 v115, s[20:23], s67 offen offset:3072 lds
  s_mov_b32 m0, 79872
  s_xor_b32 s67, s70, 312064
  buffer_load_dwordx4 v112, s[20:23], s67 offen offset:0 lds
  s_waitcnt vmcnt(59)
  buffer_load_dwordx4 v113, s[20:23], s67 offen offset:1024 lds
  buffer_load_dwordx4 v114, s[20:23], s67 offen offset:2048 lds
  buffer_load_dwordx4 v115, s[20:23], s67 offen offset:3072 lds
  s_xor_b32 s53, s86, s48
  s_mov_b32 m0, 8704
  s_waitcnt vmcnt(59)
  buffer_load_dwordx4 v126, s[8:11], s53 offen offset:0 nt lds
  s_mov_b32 m0, 8768
  s_nop 0
  buffer_load_dwordx4 v126, s[8:11], s53 offen offset:1024 nt lds
  s_mov_b32 m0, 8832
  s_nop 0
  buffer_load_dwordx4 v126, s[8:11], s53 offen offset:2048 nt lds
  s_mov_b32 m0, 8896
  s_add_u32 s86, s86, 4096
  s_waitcnt vmcnt(59)
  buffer_load_dwordx4 v126, s[8:11], s53 offen offset:3072 nt lds
  s_xor_b32 s53, s86, s48
  s_mov_b32 m0, 13056
  s_nop 0
  buffer_load_dwordx4 v126, s[8:11], s53 offen offset:0 nt lds
  s_mov_b32 m0, 13120
  s_nop 0
  buffer_load_dwordx4 v126, s[8:11], s53 offen offset:1024 nt lds
  s_mov_b32 m0, 13184
  s_waitcnt vmcnt(59)
  buffer_load_dwordx4 v126, s[8:11], s53 offen offset:2048 nt lds
  s_mov_b32 m0, 13248
  s_add_u32 s86, s86, 4096
  buffer_load_dwordx4 v126, s[8:11], s53 offen offset:3072 nt lds
  s_mov_b32 m0, 43008
  s_xor_b32 s53, s87, s48
  buffer_load_dwordx4 v116, s[12:15], s53 offen offset:0 nt lds
  s_waitcnt vmcnt(59)
  buffer_load_dwordx4 v117, s[12:15], s53 offen offset:1024 nt lds
  buffer_load_dwordx4 v116, s[12:15], s53 offen offset:2048 nt lds
  buffer_load_dwordx4 v117, s[12:15], s53 offen offset:3072 nt lds
  s_add_u32 s87, s87, 4096
  s_mov_b32 m0, 47104
  s_xor_b32 s53, s87, s48
  s_waitcnt vmcnt(59)
  buffer_load_dwordx4 v116, s[12:15], s53 offen offset:0 nt lds
  buffer_load_dwordx4 v117, s[12:15], s53 offen offset:1024 nt lds
  buffer_load_dwordx4 v116, s[12:15], s53 offen offset:2048 nt lds
  s_waitcnt vmcnt(59)
  buffer_load_dwordx4 v117, s[12:15], s53 offen offset:3072 nt lds
  s_add_u32 s87, s87, 4096
  s_mov_b32 m0, 124928
  s_xor_b32 s67, s70, 393472
  buffer_load_dwordx4 v112, s[20:23], s67 offen offset:0 lds
  buffer_load_dwordx4 v113, s[20:23], s67 offen offset:1024 lds
  s_waitcnt vmcnt(59)
  buffer_load_dwordx4 v114, s[20:23], s67 offen offset:2048 lds
  buffer_load_dwordx4 v115, s[20:23], s67 offen offset:3072 lds
  s_mov_b32 m0, 129024
  s_xor_b32 s67, s70, 409856
  buffer_load_dwordx4 v112, s[20:23], s67 offen offset:0 lds
  s_waitcnt vmcnt(59)
  buffer_load_dwordx4 v113, s[20:23], s67 offen offset:1024 lds
  buffer_load_dwordx4 v114, s[20:23], s67 offen offset:2048 lds
  buffer_load_dwordx4 v115, s[20:23], s67 offen offset:3072 lds
  s_barrier
  s_mov_b32 m0, 83968
  s_xor_b32 s67, s70, 327680
  s_waitcnt vmcnt(59)
  buffer_load_dwordx4 v112, s[20:23], s67 offen offset:0 lds
  buffer_load_dwordx4 v113, s[20:23], s67 offen offset:1024 lds
  buffer_load_dwordx4 v114, s[20:23], s67 offen offset:2048 lds
  s_waitcnt vmcnt(59)
  buffer_load_dwordx4 v115, s[20:23], s67 offen offset:3072 lds
  s_mov_b32 m0, 88064
  s_xor_b32 s67, s70, 344064
  buffer_load_dwordx4 v112, s[20:23], s67 offen offset:0 lds
  buffer_load_dwordx4 v113, s[20:23], s67 offen offset:1024 lds
  s_waitcnt vmcnt(59)
  buffer_load_dwordx4 v114, s[20:23], s67 offen offset:2048 lds
  buffer_load_dwordx4 v115, s[20:23], s67 offen offset:3072 lds
  s_xor_b32 s53, s86, s48
  s_mov_b32 m0, 17408
  s_nop 0
  buffer_load_dwordx4 v126, s[8:11], s53 offen offset:0 nt lds
  s_mov_b32 m0, 17472
  s_waitcnt vmcnt(59)
  buffer_load_dwordx4 v126, s[8:11], s53 offen offset:1024 nt lds
  s_mov_b32 m0, 17536
  s_nop 0
  buffer_load_dwordx4 v126, s[8:11], s53 offen offset:2048 nt lds
  s_mov_b32 m0, 17600
  s_add_u32 s86, s86, 4096
  buffer_load_dwordx4 v126, s[8:11], s53 offen offset:3072 nt lds
  s_xor_b32 s53, s86, s48
  s_mov_b32 m0, 21760
  s_waitcnt vmcnt(59)
  buffer_load_dwordx4 v126, s[8:11], s53 offen offset:0 nt lds
  s_mov_b32 m0, 21824
  s_nop 0
  buffer_load_dwordx4 v126, s[8:11], s53 offen offset:1024 nt lds
  s_mov_b32 m0, 21888
  s_nop 0
  buffer_load_dwordx4 v126, s[8:11], s53 offen offset:2048 nt lds
  s_mov_b32 m0, 21952
  s_add_u32 s86, s86, 4096
  s_waitcnt vmcnt(59)
  buffer_load_dwordx4 v126, s[8:11], s53 offen offset:3072 nt lds
  s_mov_b32 m0, 51200
  s_xor_b32 s53, s87, s48
  buffer_load_dwordx4 v116, s[12:15], s53 offen offset:0 nt lds
  buffer_load_dwordx4 v117, s[12:15], s53 offen offset:1024 nt lds
  s_waitcnt vmcnt(59)
  buffer_load_dwordx4 v116, s[12:15], s53 offen offset:2048 nt lds
  buffer_load_dwordx4 v117, s[12:15], s53 offen offset:3072 nt lds
  s_add_u32 s87, s87, 4096
  s_mov_b32 m0, 55296
  s_xor_b32 s53, s87, s48
  buffer_load_dwordx4 v116, s[12:15], s53 offen offset:0 nt lds
  s_waitcnt vmcnt(59)
  buffer_load_dwordx4 v117, s[12:15], s53 offen offset:1024 nt lds
  buffer_load_dwordx4 v116, s[12:15], s53 offen offset:2048 nt lds
  buffer_load_dwordx4 v117, s[12:15], s53 offen offset:3072 nt lds
  s_add_u32 s87, s87, 4096
  s_mov_b32 m0, 133120
  s_xor_b32 s67, s70, 426240
  s_waitcnt vmcnt(59)
  buffer_load_dwordx4 v112, s[20:23], s67 offen offset:0 lds
  buffer_load_dwordx4 v113, s[20:23], s67 offen offset:1024 lds
  buffer_load_dwordx4 v114, s[20:23], s67 offen offset:2048 lds
  s_waitcnt vmcnt(59)
  buffer_load_dwordx4 v115, s[20:23], s67 offen offset:3072 lds
  s_mov_b32 m0, 137216
  s_xor_b32 s67, s70, 442624
  buffer_load_dwordx4 v112, s[20:23], s67 offen offset:0 lds
  buffer_load_dwordx4 v113, s[20:23], s67 offen offset:1024 lds
  s_waitcnt vmcnt(59)
  buffer_load_dwordx4 v114, s[20:23], s67 offen offset:2048 lds
  buffer_load_dwordx4 v115, s[20:23], s67 offen offset:3072 lds
  s_barrier
  s_mov_b32 m0, 92160
  s_xor_b32 s67, s70, 327936
  buffer_load_dwordx4 v112, s[20:23], s67 offen offset:0 lds
  s_waitcnt vmcnt(59)
  buffer_load_dwordx4 v113, s[20:23], s67 offen offset:1024 lds
  buffer_load_dwordx4 v114, s[20:23], s67 offen offset:2048 lds
  buffer_load_dwordx4 v115, s[20:23], s67 offen offset:3072 lds
  s_mov_b32 m0, 96256
  s_xor_b32 s67, s70, 344320
  s_waitcnt vmcnt(59)
  buffer_load_dwordx4 v112, s[20:23], s67 offen offset:0 lds
  buffer_load_dwordx4 v113, s[20:23], s67 offen offset:1024 lds
  buffer_load_dwordx4 v114, s[20:23], s67 offen offset:2048 lds
  s_waitcnt vmcnt(59)
  buffer_load_dwordx4 v115, s[20:23], s67 offen offset:3072 lds
  s_xor_b32 s53, s86, s48
  s_mov_b32 m0, 26112
  s_nop 0
  buffer_load_dwordx4 v126, s[8:11], s53 offen offset:0 nt lds
  s_mov_b32 m0, 26176
  s_nop 0
  buffer_load_dwordx4 v126, s[8:11], s53 offen offset:1024 nt lds
  s_mov_b32 m0, 26240
  s_waitcnt vmcnt(59)
  buffer_load_dwordx4 v126, s[8:11], s53 offen offset:2048 nt lds
  s_mov_b32 m0, 26304
  s_add_u32 s86, s86, 4096
  buffer_load_dwordx4 v126, s[8:11], s53 offen offset:3072 nt lds
  s_xor_b32 s53, s86, s48
  s_mov_b32 m0, 30464
  s_nop 0
  buffer_load_dwordx4 v126, s[8:11], s53 offen offset:0 nt lds
  s_mov_b32 m0, 30528
  s_waitcnt vmcnt(59)
  buffer_load_dwordx4 v126, s[8:11], s53 offen offset:1024 nt lds
  s_mov_b32 m0, 30592
  s_nop 0
  buffer_load_dwordx4 v126, s[8:11], s53 offen offset:2048 nt lds
  s_mov_b32 m0, 30656
  s_add_u32 s86, s86, 4096
  buffer_load_dwordx4 v126, s[8:11], s53 offen offset:3072 nt lds
  s_mov_b32 m0, 59392
  s_xor_b32 s53, s87, s48
  s_waitcnt vmcnt(59)
  buffer_load_dwordx4 v116, s[12:15], s53 offen offset:0 nt lds
  buffer_load_dwordx4 v117, s[12:15], s53 offen offset:1024 nt lds
  buffer_load_dwordx4 v116, s[12:15], s53 offen offset:2048 nt lds
  s_waitcnt vmcnt(59)
  buffer_load_dwordx4 v117, s[12:15], s53 offen offset:3072 nt lds
  s_add_u32 s87, s87, 4096
  s_mov_b32 m0, 63488
  s_xor_b32 s53, s87, s48
  buffer_load_dwordx4 v116, s[12:15], s53 offen offset:0 nt lds
  buffer_load_dwordx4 v117, s[12:15], s53 offen offset:1024 nt lds
  s_waitcnt vmcnt(59)
  buffer_load_dwordx4 v116, s[12:15], s53 offen offset:2048 nt lds
  buffer_load_dwordx4 v117, s[12:15], s53 offen offset:3072 nt lds
  s_add_u32 s87, s87, 4096
  s_mov_b32 m0, 141312
  s_xor_b32 s67, s70, 459008
  buffer_load_dwordx4 v112, s[20:23], s67 offen offset:0 lds
  s_waitcnt vmcnt(59)
  buffer_load_dwordx4 v113, s[20:23], s67 offen offset:1024 lds
  buffer_load_dwordx4 v114, s[20:23], s67 offen offset:2048 lds
  buffer_load_dwordx4 v115, s[20:23], s67 offen offset:3072 lds
  s_mov_b32 m0, 145408
  s_xor_b32 s67, s70, 475392
  s_waitcnt vmcnt(59)
  buffer_load_dwordx4 v112, s[20:23], s67 offen offset:0 lds
  buffer_load_dwordx4 v113, s[20:23], s67 offen offset:1024 lds
  buffer_load_dwordx4 v114, s[20:23], s67 offen offset:2048 lds
  s_waitcnt vmcnt(59)
  buffer_load_dwordx4 v115, s[20:23], s67 offen offset:3072 lds
  s_barrier
  s_mov_b32 m0, 67584
  s_xor_b32 s67, s70, 328192
  buffer_load_dwordx4 v112, s[20:23], s67 offen offset:0 lds
  buffer_load_dwordx4 v113, s[20:23], s67 offen offset:1024 lds
  s_waitcnt vmcnt(59)
  buffer_load_dwordx4 v114, s[20:23], s67 offen offset:2048 lds
  buffer_load_dwordx4 v115, s[20:23], s67 offen offset:3072 lds
  s_mov_b32 m0, 71680
  s_xor_b32 s67, s70, 344576
  buffer_load_dwordx4 v112, s[20:23], s67 offen offset:0 lds
  s_waitcnt vmcnt(59)
  buffer_load_dwordx4 v113, s[20:23], s67 offen offset:1024 lds
  buffer_load_dwordx4 v114, s[20:23], s67 offen offset:2048 lds
  buffer_load_dwordx4 v115, s[20:23], s67 offen offset:3072 lds
  s_xor_b32 s53, s86, s48
  s_mov_b32 m0, 0
  s_waitcnt vmcnt(59)
  buffer_load_dwordx4 v126, s[8:11], s53 offen offset:0 nt lds
  s_mov_b32 m0, 64
  s_nop 0
  buffer_load_dwordx4 v126, s[8:11], s53 offen offset:1024 nt lds
  s_mov_b32 m0, 128
  s_nop 0
  buffer_load_dwordx4 v126, s[8:11], s53 offen offset:2048 nt lds
  s_mov_b32 m0, 192
  s_add_u32 s86, s86, 4096
  s_waitcnt vmcnt(59)
  buffer_load_dwordx4 v126, s[8:11], s53 offen offset:3072 nt lds
  s_xor_b32 s53, s86, s48
  s_mov_b32 m0, 4352
  s_nop 0
  buffer_load_dwordx4 v126, s[8:11], s53 offen offset:0 nt lds
  s_mov_b32 m0, 4416
  s_nop 0
  buffer_load_dwordx4 v126, s[8:11], s53 offen offset:1024 nt lds
  s_mov_b32 m0, 4480
  s_waitcnt vmcnt(59)
  buffer_load_dwordx4 v126, s[8:11], s53 offen offset:2048 nt lds
  s_mov_b32 m0, 4544
  s_add_u32 s86, s86, 4096
  buffer_load_dwordx4 v126, s[8:11], s53 offen offset:3072 nt lds
  s_mov_b32 m0, 34816
  s_xor_b32 s53, s87, s48
  buffer_load_dwordx4 v116, s[12:15], s53 offen offset:0 nt lds
  s_waitcnt vmcnt(59)
  buffer_load_dwordx4 v117, s[12:15], s53 offen offset:1024 nt lds
  buffer_load_dwordx4 v116, s[12:15], s53 offen offset:2048 nt lds
  buffer_load_dwordx4 v117, s[12:15], s53 offen offset:3072 nt lds
  s_add_u32 s87, s87, 4096
  s_mov_b32 m0, 38912
  s_xor_b32 s53, s87, s48
  s_waitcnt vmcnt(59)
  buffer_load_dwordx4 v116, s[12:15], s53 offen offset:0 nt lds
  buffer_load_dwordx4 v117, s[12:15], s53 offen offset:1024 nt lds
  buffer_load_dwordx4 v116, s[12:15], s53 offen offset:2048 nt lds
  s_waitcnt vmcnt(59)
  buffer_load_dwordx4 v117, s[12:15], s53 offen offset:3072 nt lds
  s_add_u32 s87, s87, 4096
  s_mov_b32 m0, 149504
  s_xor_b32 s67, s70, 491776
  buffer_load_dwordx4 v112, s[20:23], s67 offen offset:0 lds
  buffer_load_dwordx4 v113, s[20:23], s67 offen offset:1024 lds
  s_waitcnt vmcnt(59)
  buffer_load_dwordx4 v114, s[20:23], s67 offen offset:2048 lds
  buffer_load_dwordx4 v115, s[20:23], s67 offen offset:3072 lds
  s_mov_b32 m0, 153600
  s_xor_b32 s67, s70, 508160
  buffer_load_dwordx4 v112, s[20:23], s67 offen offset:0 lds
  s_waitcnt vmcnt(59)
  buffer_load_dwordx4 v113, s[20:23], s67 offen offset:1024 lds
  buffer_load_dwordx4 v114, s[20:23], s67 offen offset:2048 lds
  buffer_load_dwordx4 v115, s[20:23], s67 offen offset:3072 lds
  s_barrier
  s_mov_b32 m0, 75776
  s_xor_b32 s67, s70, 328448
  s_waitcnt vmcnt(59)
  buffer_load_dwordx4 v112, s[20:23], s67 offen offset:0 lds
  buffer_load_dwordx4 v113, s[20:23], s67 offen offset:1024 lds
  buffer_load_dwordx4 v114, s[20:23], s67 offen offset:2048 lds
  s_waitcnt vmcnt(59)
  buffer_load_dwordx4 v115, s[20:23], s67 offen offset:3072 lds
  s_mov_b32 m0, 79872
  s_xor_b32 s67, s70, 344832
  buffer_load_dwordx4 v112, s[20:23], s67 offen offset:0 lds
  buffer_load_dwordx4 v113, s[20:23], s67 offen offset:1024 lds
  s_waitcnt vmcnt(59)
  buffer_load_dwordx4 v114, s[20:23], s67 offen offset:2048 lds
  buffer_load_dwordx4 v115, s[20:23], s67 offen offset:3072 lds
  s_xor_b32 s53, s86, s48
  s_mov_b32 m0, 8704
  s_nop 0
  buffer_load_dwordx4 v126, s[8:11], s53 offen offset:0 nt lds
  s_mov_b32 m0, 8768
  s_waitcnt vmcnt(59)
  buffer_load_dwordx4 v126, s[8:11], s53 offen offset:1024 nt lds
  s_mov_b32 m0, 8832
  s_nop 0
  buffer_load_dwordx4 v126, s[8:11], s53 offen offset:2048 nt lds
  s_mov_b32 m0, 8896
  s_add_u32 s86, s86, 4096
  buffer_load_dwordx4 v126, s[8:11], s53 offen offset:3072 nt lds
  s_xor_b32 s53, s86, s48
  s_mov_b32 m0, 13056
  s_waitcnt vmcnt(59)
  buffer_load_dwordx4 v126, s[8:11], s53 offen offset:0 nt lds
  s_mov_b32 m0, 13120
  s_nop 0
  buffer_load_dwordx4 v126, s[8:11], s53 offen offset:1024 nt lds
  s_mov_b32 m0, 13184
  s_nop 0
  buffer_load_dwordx4 v126, s[8:11], s53 offen offset:2048 nt lds
  s_mov_b32 m0, 13248
  s_add_u32 s86, s86, 4096
  s_waitcnt vmcnt(59)
  buffer_load_dwordx4 v126, s[8:11], s53 offen offset:3072 nt lds
  s_mov_b32 m0, 43008
  s_xor_b32 s53, s87, s48
  buffer_load_dwordx4 v116, s[12:15], s53 offen offset:0 nt lds
  buffer_load_dwordx4 v117, s[12:15], s53 offen offset:1024 nt lds
  s_waitcnt vmcnt(59)
  buffer_load_dwordx4 v116, s[12:15], s53 offen offset:2048 nt lds
  buffer_load_dwordx4 v117, s[12:15], s53 offen offset:3072 nt lds
  s_add_u32 s87, s87, 4096
  s_mov_b32 m0, 47104
  s_xor_b32 s53, s87, s48
  buffer_load_dwordx4 v116, s[12:15], s53 offen offset:0 nt lds
  s_waitcnt vmcnt(59)
  buffer_load_dwordx4 v117, s[12:15], s53 offen offset:1024 nt lds
  buffer_load_dwordx4 v116, s[12:15], s53 offen offset:2048 nt lds
  buffer_load_dwordx4 v117, s[12:15], s53 offen offset:3072 nt lds
  s_add_u32 s87, s87, 4096
  s_barrier
  s_mov_b32 m0, 83968
  s_xor_b32 s67, s70, 360448
  s_waitcnt vmcnt(59)
  buffer_load_dwordx4 v112, s[20:23], s67 offen offset:0 lds
  buffer_load_dwordx4 v113, s[20:23], s67 offen offset:1024 lds
  buffer_load_dwordx4 v114, s[20:23], s67 offen offset:2048 lds
  s_waitcnt vmcnt(59)
  buffer_load_dwordx4 v115, s[20:23], s67 offen offset:3072 lds
  s_mov_b32 m0, 88064
  s_xor_b32 s67, s70, 376832
  buffer_load_dwordx4 v112, s[20:23], s67 offen offset:0 lds
  buffer_load_dwordx4 v113, s[20:23], s67 offen offset:1024 lds
  s_waitcnt vmcnt(59)
  buffer_load_dwordx4 v114, s[20:23], s67 offen offset:2048 lds
  buffer_load_dwordx4 v115, s[20:23], s67 offen offset:3072 lds
  s_xor_b32 s53, s86, s48
  s_mov_b32 m0, 17408
  s_nop 0
  buffer_load_dwordx4 v126, s[8:11], s53 offen offset:0 nt lds
  s_mov_b32 m0, 17472
  s_waitcnt vmcnt(59)
  buffer_load_dwordx4 v126, s[8:11], s53 offen offset:1024 nt lds
  s_mov_b32 m0, 17536
  s_nop 0
  buffer_load_dwordx4 v126, s[8:11], s53 offen offset:2048 nt lds
  s_mov_b32 m0, 17600
  s_add_u32 s86, s86, 4096
  buffer_load_dwordx4 v126, s[8:11], s53 offen offset:3072 nt lds
  s_xor_b32 s53, s86, s48
  s_mov_b32 m0, 21760
  s_waitcnt vmcnt(59)
  buffer_load_dwordx4 v126, s[8:11], s53 offen offset:0 nt lds
  s_mov_b32 m0, 21824
  s_nop 0
  buffer_load_dwordx4 v126, s[8:11], s53 offen offset:1024 nt lds
  s_mov_b32 m0, 21888
  s_nop 0
  buffer_load_dwordx4 v126, s[8:11], s53 offen offset:2048 nt lds
  s_mov_b32 m0, 21952
  s_add_u32 s86, s86, 4096
  s_waitcnt vmcnt(59)
  buffer_load_dwordx4 v126, s[8:11], s53 offen offset:3072 nt lds
  s_mov_b32 m0, 51200
  s_xor_b32 s53, s87, s48
  buffer_load_dwordx4 v116, s[12:15], s53 offen offset:0 nt lds
  buffer_load_dwordx4 v117, s[12:15], s53 offen offset:1024 nt lds
  s_waitcnt vmcnt(59)
  buffer_load_dwordx4 v116, s[12:15], s53 offen offset:2048 nt lds
  buffer_load_dwordx4 v117, s[12:15], s53 offen offset:3072 nt lds
  s_add_u32 s87, s87, 4096
  s_mov_b32 m0, 55296
  s_xor_b32 s53, s87, s48
  buffer_load_dwordx4 v116, s[12:15], s53 offen offset:0 nt lds
  s_waitcnt vmcnt(59)
  buffer_load_dwordx4 v117, s[12:15], s53 offen offset:1024 nt lds
  buffer_load_dwordx4 v116, s[12:15], s53 offen offset:2048 nt lds
  buffer_load_dwordx4 v117, s[12:15], s53 offen offset:3072 nt lds
  s_add_u32 s87, s87, 4096
  s_waitcnt vmcnt(56)
  s_barrier
  s_mov_b32 m0, 92160
  s_xor_b32 s67, s70, 360704
  buffer_load_dwordx4 v112, s[20:23], s67 offen offset:0 lds
  buffer_load_dwordx4 v113, s[20:23], s67 offen offset:1024 lds
  buffer_load_dwordx4 v114, s[20:23], s67 offen offset:2048 lds
  buffer_load_dwordx4 v115, s[20:23], s67 offen offset:3072 lds
  s_mov_b32 m0, 96256
  s_xor_b32 s67, s70, 377088
  buffer_load_dwordx4 v112, s[20:23], s67 offen offset:0 lds
  buffer_load_dwordx4 v113, s[20:23], s67 offen offset:1024 lds
  s_waitcnt vmcnt(59)
  buffer_load_dwordx4 v114, s[20:23], s67 offen offset:2048 lds
  buffer_load_dwordx4 v115, s[20:23], s67 offen offset:3072 lds
  s_xor_b32 s53, s86, s48
  s_mov_b32 m0, 26112
  s_nop 0
  buffer_load_dwordx4 v126, s[8:11], s53 offen offset:0 nt lds
  s_mov_b32 m0, 26176
  s_waitcnt vmcnt(59)
  buffer_load_dwordx4 v126, s[8:11], s53 offen offset:1024 nt lds
  s_mov_b32 m0, 26240
  s_nop 0
  buffer_load_dwordx4 v126, s[8:11], s53 offen offset:2048 nt lds
  s_mov_b32 m0, 26304
  s_add_u32 s86, s86, 4096
  buffer_load_dwordx4 v126, s[8:11], s53 offen offset:3072 nt lds
  s_xor_b32 s53, s86, s48
  s_mov_b32 m0, 30464
  s_waitcnt vmcnt(59)
  buffer_load_dwordx4 v126, s[8:11], s53 offen offset:0 nt lds
  s_mov_b32 m0, 30528
  s_nop 0
  buffer_load_dwordx4 v126, s[8:11], s53 offen offset:1024 nt lds
  s_mov_b32 m0, 30592
  s_nop 0
  buffer_load_dwordx4 v126, s[8:11], s53 offen offset:2048 nt lds
  s_mov_b32 m0, 30656
  s_add_u32 s86, s86, 4096
  s_waitcnt vmcnt(59)
  buffer_load_dwordx4 v126, s[8:11], s53 offen offset:3072 nt lds
  s_mov_b32 m0, 59392
  s_xor_b32 s53, s87, s48
  buffer_load_dwordx4 v116, s[12:15], s53 offen offset:0 nt lds
  buffer_load_dwordx4 v117, s[12:15], s53 offen offset:1024 nt lds
  s_waitcnt vmcnt(59)
  buffer_load_dwordx4 v116, s[12:15], s53 offen offset:2048 nt lds
  buffer_load_dwordx4 v117, s[12:15], s53 offen offset:3072 nt lds
  s_add_u32 s87, s87, 4096
  s_mov_b32 m0, 63488
  s_xor_b32 s53, s87, s48
  buffer_load_dwordx4 v116, s[12:15], s53 offen offset:0 nt lds
  s_waitcnt vmcnt(59)
  buffer_load_dwordx4 v117, s[12:15], s53 offen offset:1024 nt lds
  buffer_load_dwordx4 v116, s[12:15], s53 offen offset:2048 nt lds
  buffer_load_dwordx4 v117, s[12:15], s53 offen offset:3072 nt lds
  s_add_u32 s87, s87, 4096
  s_waitcnt vmcnt(48)
  s_barrier
  s_mov_b32 m0, 67584
  s_xor_b32 s67, s70, 360960
  buffer_load_dwordx4 v112, s[20:23], s67 offen offset:0 lds
  buffer_load_dwordx4 v113, s[20:23], s67 offen offset:1024 lds
  buffer_load_dwordx4 v114, s[20:23], s67 offen offset:2048 lds
  buffer_load_dwordx4 v115, s[20:23], s67 offen offset:3072 lds
  s_mov_b32 m0, 71680
  s_xor_b32 s67, s70, 377344
  buffer_load_dwordx4 v112, s[20:23], s67 offen offset:0 lds
  buffer_load_dwordx4 v113, s[20:23], s67 offen offset:1024 lds
  buffer_load_dwordx4 v114, s[20:23], s67 offen offset:2048 lds
  buffer_load_dwordx4 v115, s[20:23], s67 offen offset:3072 lds
  s_mov_b32 m0, 34816
  s_xor_b32 s53, s87, s48
  buffer_load_dwordx4 v116, s[12:15], s53 offen offset:0 nt lds
  buffer_load_dwordx4 v117, s[12:15], s53 offen offset:1024 nt lds
  buffer_load_dwordx4 v116, s[12:15], s53 offen offset:2048 nt lds
  buffer_load_dwordx4 v117, s[12:15], s53 offen offset:3072 nt lds
  s_add_u32 s87, s87, 4096
  s_mov_b32 m0, 38912
  s_xor_b32 s53, s87, s48
  buffer_load_dwordx4 v116, s[12:15], s53 offen offset:0 nt lds
  buffer_load_dwordx4 v117, s[12:15], s53 offen offset:1024 nt lds
  s_waitcnt vmcnt(59)
  buffer_load_dwordx4 v116, s[12:15], s53 offen offset:2048 nt lds
  buffer_load_dwordx4 v117, s[12:15], s53 offen offset:3072 nt lds
  s_add_u32 s87, s87, 4096
  s_mov_b32 m0, 0
  s_xor_b32 s53, s87, s48
  buffer_load_dwordx4 v116, s[12:15], s53 offen offset:0 nt lds
  s_waitcnt vmcnt(59)
  buffer_load_dwordx4 v117, s[12:15], s53 offen offset:1024 nt lds
  buffer_load_dwordx4 v116, s[12:15], s53 offen offset:2048 nt lds
  buffer_load_dwordx4 v117, s[12:15], s53 offen offset:3072 nt lds
  s_add_u32 s87, s87, 4096
  s_mov_b32 m0, 4096
  s_xor_b32 s53, s87, s48
  s_waitcnt vmcnt(59)
  buffer_load_dwordx4 v116, s[12:15], s53 offen offset:0 nt lds
  buffer_load_dwordx4 v117, s[12:15], s53 offen offset:1024 nt lds
  buffer_load_dwordx4 v116, s[12:15], s53 offen offset:2048 nt lds
  s_waitcnt vmcnt(59)
  buffer_load_dwordx4 v117, s[12:15], s53 offen offset:3072 nt lds
  s_add_u32 s87, s87, 4096
  s_waitcnt vmcnt(48)
  s_barrier
  s_mov_b32 m0, 75776
  s_xor_b32 s67, s70, 361216
  buffer_load_dwordx4 v112, s[20:23], s67 offen offset:0 lds
  buffer_load_dwordx4 v113, s[20:23], s67 offen offset:1024 lds
  buffer_load_dwordx4 v114, s[20:23], s67 offen offset:2048 lds
  buffer_load_dwordx4 v115, s[20:23], s67 offen offset:3072 lds
  s_mov_b32 m0, 79872
  s_xor_b32 s67, s70, 377600
  buffer_load_dwordx4 v112, s[20:23], s67 offen offset:0 lds
  buffer_load_dwordx4 v113, s[20:23], s67 offen offset:1024 lds
  buffer_load_dwordx4 v114, s[20:23], s67 offen offset:2048 lds
  buffer_load_dwordx4 v115, s[20:23], s67 offen offset:3072 lds
  s_mov_b32 m0, 8704
  s_xor_b32 s67, s70, 393728
  buffer_load_dwordx4 v112, s[20:23], s67 offen offset:0 lds
  buffer_load_dwordx4 v113, s[20:23], s67 offen offset:1024 lds
  buffer_load_dwordx4 v114, s[20:23], s67 offen offset:2048 lds
  buffer_load_dwordx4 v115, s[20:23], s67 offen offset:3072 lds
  s_mov_b32 m0, 12800
  s_xor_b32 s67, s70, 410112
  buffer_load_dwordx4 v112, s[20:23], s67 offen offset:0 lds
  buffer_load_dwordx4 v113, s[20:23], s67 offen offset:1024 lds
  s_waitcnt vmcnt(59)
  buffer_load_dwordx4 v114, s[20:23], s67 offen offset:2048 lds
  buffer_load_dwordx4 v115, s[20:23], s67 offen offset:3072 lds
  s_mov_b32 m0, 43008
  s_xor_b32 s67, s70, 426496
  buffer_load_dwordx4 v112, s[20:23], s67 offen offset:0 lds
  s_waitcnt vmcnt(59)
  buffer_load_dwordx4 v113, s[20:23], s67 offen offset:1024 lds
  buffer_load_dwordx4 v114, s[20:23], s67 offen offset:2048 lds
  buffer_load_dwordx4 v115, s[20:23], s67 offen offset:3072 lds
  s_mov_b32 m0, 47104
  s_xor_b32 s67, s70, 442880
  s_waitcnt vmcnt(59)
  buffer_load_dwordx4 v112, s[20:23], s67 offen offset:0 lds
  buffer_load_dwordx4 v113, s[20:23], s67 offen offset:1024 lds
  buffer_load_dwordx4 v114, s[20:23], s67 offen offset:2048 lds
  s_waitcnt vmcnt(59)
  buffer_load_dwordx4 v115, s[20:23], s67 offen offset:3072 lds
  s_waitcnt vmcnt(48)
  s_barrier
  s_mov_b32 m0, 83968
  s_xor_b32 s67, s70, 393216
  buffer_load_dwordx4 v112, s[20:23], s67 offen offset:0 lds
  buffer_load_dwordx4 v113, s[20:23], s67 offen offset:1024 lds
  buffer_load_dwordx4 v114, s[20:23], s67 offen offset:2048 lds
  buffer_load_dwordx4 v115, s[20:23], s67 offen offset:3072 lds
  s_mov_b32 m0, 88064
  s_xor_b32 s67, s70, 409600
  buffer_load_dwordx4 v112, s[20:23], s67 offen offset:0 lds
  buffer_load_dwordx4 v113, s[20:23], s67 offen offset:1024 lds
  buffer_load_dwordx4 v114, s[20:23], s67 offen offset:2048 lds
  buffer_load_dwordx4 v115, s[20:23], s67 offen offset:3072 lds
  s_mov_b32 m0, 17408
  s_xor_b32 s67, s70, 459264
  buffer_load_dwordx4 v112, s[20:23], s67 offen offset:0 lds
  buffer_load_dwordx4 v113, s[20:23], s67 offen offset:1024 lds
  buffer_load_dwordx4 v114, s[20:23], s67 offen offset:2048 lds
  buffer_load_dwordx4 v115, s[20:23], s67 offen offset:3072 lds
  s_mov_b32 m0, 21504
  s_xor_b32 s67, s70, 475648
  buffer_load_dwordx4 v112, s[20:23], s67 offen offset:0 lds
  buffer_load_dwordx4 v113, s[20:23], s67 offen offset:1024 lds
  s_waitcnt vmcnt(59)
  buffer_load_dwordx4 v114, s[20:23], s67 offen offset:2048 lds
  buffer_load_dwordx4 v115, s[20:23], s67 offen offset:3072 lds
  s_mov_b32 m0, 51200
  s_xor_b32 s67, s70, 492032
  buffer_load_dwordx4 v112, s[20:23], s67 offen offset:0 lds
  s_waitcnt vmcnt(59)
  buffer_load_dwordx4 v113, s[20:23], s67 offen offset:1024 lds
  buffer_load_dwordx4 v114, s[20:23], s67 offen offset:2048 lds
  buffer_load_dwordx4 v115, s[20:23], s67 offen offset:3072 lds
  s_mov_b32 m0, 55296
  s_xor_b32 s67, s70, 508416
  s_waitcnt vmcnt(59)
  buffer_load_dwordx4 v112, s[20:23], s67 offen offset:0 lds
  buffer_load_dwordx4 v113, s[20:23], s67 offen offset:1024 lds
  buffer_load_dwordx4 v114, s[20:23], s67 offen offset:2048 lds
  s_waitcnt vmcnt(59)
  buffer_load_dwordx4 v115, s[20:23], s67 offen offset:3072 lds
  s_waitcnt vmcnt(48)
  s_barrier
  s_mov_b32 m0, 26112
  s_xor_b32 s67, s70, 393984
  buffer_load_dwordx4 v112, s[20:23], s67 offen offset:0 lds
  buffer_load_dwordx4 v113, s[20:23], s67 offen offset:1024 lds
  buffer_load_dwordx4 v114, s[20:23], s67 offen offset:2048 lds
  buffer_load_dwordx4 v115, s[20:23], s67 offen offset:3072 lds
  s_mov_b32 m0, 30208
  s_xor_b32 s67, s70, 410368
  buffer_load_dwordx4 v112, s[20:23], s67 offen offset:0 lds
  buffer_load_dwordx4 v113, s[20:23], s67 offen offset:1024 lds
  buffer_load_dwordx4 v114, s[20:23], s67 offen offset:2048 lds
  buffer_load_dwordx4 v115, s[20:23], s67 offen offset:3072 lds
  s_mov_b32 m0, 59392
  s_xor_b32 s67, s70, 426752
  buffer_load_dwordx4 v112, s[20:23], s67 offen offset:0 lds
  buffer_load_dwordx4 v113, s[20:23], s67 offen offset:1024 lds
  buffer_load_dwordx4 v114, s[20:23], s67 offen offset:2048 lds
  buffer_load_dwordx4 v115, s[20:23], s67 offen offset:3072 lds
  s_mov_b32 m0, 63488
  s_xor_b32 s67, s70, 443136
  buffer_load_dwordx4 v112, s[20:23], s67 offen offset:0 lds
  buffer_load_dwordx4 v113, s[20:23], s67 offen offset:1024 lds
  s_waitcnt vmcnt(59)
  buffer_load_dwordx4 v114, s[20:23], s67 offen offset:2048 lds
  buffer_load_dwordx4 v115, s[20:23], s67 offen offset:3072 lds
  s_mov_b32 m0, 92160
  s_xor_b32 s67, s70, 459520
  buffer_load_dwordx4 v112, s[20:23], s67 offen offset:0 lds
  s_waitcnt vmcnt(59)
  buffer_load_dwordx4 v113, s[20:23], s67 offen offset:1024 lds
  buffer_load_dwordx4 v114, s[20:23], s67 offen offset:2048 lds
  buffer_load_dwordx4 v115, s[20:23], s67 offen offset:3072 lds
  s_mov_b32 m0, 96256
  s_xor_b32 s67, s70, 475904
  s_waitcnt vmcnt(59)
  buffer_load_dwordx4 v112, s[20:23], s67 offen offset:0 lds
  buffer_load_dwordx4 v113, s[20:23], s67 offen offset:1024 lds
  buffer_load_dwordx4 v114, s[20:23], s67 offen offset:2048 lds
  s_waitcnt vmcnt(59)
  buffer_load_dwordx4 v115, s[20:23], s67 offen offset:3072 lds
  s_barrier
  s_waitcnt vmcnt(40)
  s_barrier
  s_mov_b32 m0, 0
  s_xor_b32 s67, s70, 492288
  buffer_load_dwordx4 v112, s[20:23], s67 offen offset:0 lds
  buffer_load_dwordx4 v113, s[20:23], s67 offen offset:1024 lds
  buffer_load_dwordx4 v114, s[20:23], s67 offen offset:2048 lds
  buffer_load_dwordx4 v115, s[20:23], s67 offen offset:3072 lds
  s_mov_b32 m0, 4096
  s_xor_b32 s67, s70, 508672
  buffer_load_dwordx4 v112, s[20:23], s67 offen offset:0 lds
  buffer_load_dwordx4 v113, s[20:23], s67 offen offset:1024 lds
  buffer_load_dwordx4 v114, s[20:23], s67 offen offset:2048 lds
  buffer_load_dwordx4 v115, s[20:23], s67 offen offset:3072 lds
  s_waitcnt vmcnt(0)
  s_barrier
  v_mbcnt_lo_u32_b32 v128, -1, 0
  v_mbcnt_hi_u32_b32 v128, -1, v128
  v_lshlrev_b32 v129, 4, v128
  v_bfe_u32 v141, v128, 4, 1
  v_lshrrev_b32 v140, 5, v128
  v_lshl_add_u32 v140, v141, 1, v140
  v_and_b32 v130, 15, v128
  v_lshlrev_b32 v130, 11, v130
  v_lshl_add_u32 v130, v140, 4, v130
  s_mul_i32 s74, s3, 786432
  s_lshl_b32 s68, s60, 11
  s_add_u32 s74, s74, s68
  s_mul_i32 s75, s61, 196608
  s_lshl_b32 s68, s62, 10
  s_add_u32 s75, s75, s68
  s_xor_b32 s67, s60, s52
  s_lshl_b32 s68, s67, 6
  s_add_u32 s75, s75, s68
  s_mov_b32 s76, 0xffff0000
  s_mov_b32 s77, 0x00003f80
  s_mov_b32 s78, 0x3f800000
  v_add_u32 v131, 34816, v129
  s_xor_b32 s68, s60, 1
  s_mul_i32 s68, s68, 98304
  s_add_u32 s80, s74, s68
  s_xor_b32 s68, s60, 2
  s_mul_i32 s68, s68, 98304
  s_add_u32 s81, s74, s68
  s_xor_b32 s68, s60, 3
  s_mul_i32 s68, s68, 98304
  s_add_u32 s82, s74, s68
  s_xor_b32 s68, s60, 4
  s_mul_i32 s68, s68, 98304
  s_add_u32 s83, s74, s68
  s_xor_b32 s68, s60, 5
  s_mul_i32 s68, s68, 98304
  s_add_u32 s84, s74, s68
  s_xor_b32 s68, s60, 6
  s_mul_i32 s68, s68, 98304
  s_add_u32 s85, s74, s68
  s_xor_b32 s68, s60, 7
  s_mul_i32 s68, s68, 98304
  s_add_u32 s86, s74, s68
  s_barrier
  s_add_u32 s67, s80, 0
  buffer_load_dwordx4 v[148:151], v129, s[28:31], s67 offen offset:1024 sc1
  s_add_u32 s67, s81, 0
  buffer_load_dwordx4 v[152:155], v129, s[28:31], s67 offen offset:1024 sc1
  s_add_u32 s67, s82, 0
  buffer_load_dwordx4 v[156:159], v129, s[28:31], s67 offen offset:1024 sc1
  s_add_u32 s67, s83, 0
  buffer_load_dwordx4 v[160:163], v129, s[28:31], s67 offen offset:1024 sc1
  s_add_u32 s67, s84, 0
  buffer_load_dwordx4 v[164:167], v129, s[28:31], s67 offen offset:1024 sc1
  s_add_u32 s67, s85, 0
  buffer_load_dwordx4 v[168:171], v129, s[28:31], s67 offen offset:1024 sc1
  s_add_u32 s67, s86, 0
  buffer_load_dwordx4 v[172:175], v129, s[28:31], s67 offen offset:1024 sc1
  s_add_u32 s67, s80, 32768
  buffer_load_dwordx4 v[180:183], v129, s[28:31], s67 offen offset:1024 sc1
  s_add_u32 s67, s81, 32768
  buffer_load_dwordx4 v[184:187], v129, s[28:31], s67 offen offset:1024 sc1
  s_add_u32 s67, s82, 32768
  buffer_load_dwordx4 v[188:191], v129, s[28:31], s67 offen offset:1024 sc1
  s_add_u32 s67, s83, 32768
  buffer_load_dwordx4 v[192:195], v129, s[28:31], s67 offen offset:1024 sc1
  s_add_u32 s67, s84, 32768
  buffer_load_dwordx4 v[196:199], v129, s[28:31], s67 offen offset:1024 sc1
  s_add_u32 s67, s85, 32768
  buffer_load_dwordx4 v[200:203], v129, s[28:31], s67 offen offset:1024 sc1
  s_add_u32 s67, s86, 32768
  buffer_load_dwordx4 v[204:207], v129, s[28:31], s67 offen offset:1024 sc1
  s_add_u32 s67, s80, 65536
  buffer_load_dwordx4 v[212:215], v129, s[28:31], s67 offen offset:1024 sc1
  s_add_u32 s67, s81, 65536
  buffer_load_dwordx4 v[216:219], v129, s[28:31], s67 offen offset:1024 sc1
  s_add_u32 s67, s82, 65536
  buffer_load_dwordx4 v[220:223], v129, s[28:31], s67 offen offset:1024 sc1
  s_add_u32 s67, s83, 65536
  buffer_load_dwordx4 v[224:227], v129, s[28:31], s67 offen offset:1024 sc1
  s_add_u32 s67, s84, 65536
  buffer_load_dwordx4 v[228:231], v129, s[28:31], s67 offen offset:1024 sc1
  s_add_u32 s67, s85, 65536
  buffer_load_dwordx4 v[232:235], v129, s[28:31], s67 offen offset:1024 sc1
  s_add_u32 s67, s86, 65536
  buffer_load_dwordx4 v[236:239], v129, s[28:31], s67 offen offset:1024 sc1
  ds_read_b128 v[144:147], v131 offset:1024
  ds_read_b128 v[176:179], v131 offset:3072
  ds_read_b128 v[208:211], v131 offset:5120
  s_waitcnt lgkmcnt(2)
  v_lshlrev_b32 v132, 16, v144
  v_and_b32 v133, s76, v144
  v_lshlrev_b32 v134, 16, v145
  v_and_b32 v135, s76, v145
  v_lshlrev_b32 v136, 16, v146
  v_and_b32 v137, s76, v146
  v_lshlrev_b32 v138, 16, v147
  v_and_b32 v139, s76, v147
  s_waitcnt vmcnt(20)
  v_dot2_f32_bf16 v132, v148, s77, v132
  v_dot2_f32_bf16 v133, v148, s78, v133
  v_dot2_f32_bf16 v134, v149, s77, v134
  v_dot2_f32_bf16 v135, v149, s78, v135
  v_dot2_f32_bf16 v136, v150, s77, v136
  v_dot2_f32_bf16 v137, v150, s78, v137
  v_dot2_f32_bf16 v138, v151, s77, v138
  v_dot2_f32_bf16 v139, v151, s78, v139
  s_waitcnt vmcnt(19)
  v_dot2_f32_bf16 v132, v152, s77, v132
  v_dot2_f32_bf16 v133, v152, s78, v133
  v_dot2_f32_bf16 v134, v153, s77, v134
  v_dot2_f32_bf16 v135, v153, s78, v135
  v_dot2_f32_bf16 v136, v154, s77, v136
  v_dot2_f32_bf16 v137, v154, s78, v137
  v_dot2_f32_bf16 v138, v155, s77, v138
  v_dot2_f32_bf16 v139, v155, s78, v139
  s_waitcnt vmcnt(18)
  v_dot2_f32_bf16 v132, v156, s77, v132
  v_dot2_f32_bf16 v133, v156, s78, v133
  v_dot2_f32_bf16 v134, v157, s77, v134
  v_dot2_f32_bf16 v135, v157, s78, v135
  v_dot2_f32_bf16 v136, v158, s77, v136
  v_dot2_f32_bf16 v137, v158, s78, v137
  v_dot2_f32_bf16 v138, v159, s77, v138
  v_dot2_f32_bf16 v139, v159, s78, v139
  s_waitcnt vmcnt(17)
  v_dot2_f32_bf16 v132, v160, s77, v132
  v_dot2_f32_bf16 v133, v160, s78, v133
  v_dot2_f32_bf16 v134, v161, s77, v134
  v_dot2_f32_bf16 v135, v161, s78, v135
  v_dot2_f32_bf16 v136, v162, s77, v136
  v_dot2_f32_bf16 v137, v162, s78, v137
  v_dot2_f32_bf16 v138, v163, s77, v138
  v_dot2_f32_bf16 v139, v163, s78, v139
  s_waitcnt vmcnt(16)
  v_dot2_f32_bf16 v132, v164, s77, v132
  v_dot2_f32_bf16 v133, v164, s78, v133
  v_dot2_f32_bf16 v134, v165, s77, v134
  v_dot2_f32_bf16 v135, v165, s78, v135
  v_dot2_f32_bf16 v136, v166, s77, v136
  v_dot2_f32_bf16 v137, v166, s78, v137
  v_dot2_f32_bf16 v138, v167, s77, v138
  v_dot2_f32_bf16 v139, v167, s78, v139
  s_waitcnt vmcnt(15)
  v_dot2_f32_bf16 v132, v168, s77, v132
  v_dot2_f32_bf16 v133, v168, s78, v133
  v_dot2_f32_bf16 v134, v169, s77, v134
  v_dot2_f32_bf16 v135, v169, s78, v135
  v_dot2_f32_bf16 v136, v170, s77, v136
  v_dot2_f32_bf16 v137, v170, s78, v137
  v_dot2_f32_bf16 v138, v171, s77, v138
  v_dot2_f32_bf16 v139, v171, s78, v139
  s_waitcnt vmcnt(14)
  v_dot2_f32_bf16 v132, v172, s77, v132
  v_dot2_f32_bf16 v133, v172, s78, v133
  v_dot2_f32_bf16 v134, v173, s77, v134
  v_dot2_f32_bf16 v135, v173, s78, v135
  v_dot2_f32_bf16 v136, v174, s77, v136
  v_dot2_f32_bf16 v137, v174, s78, v137
  v_dot2_f32_bf16 v138, v175, s77, v138
  v_dot2_f32_bf16 v139, v175, s78, v139
  s_add_u32 s67, s75, 32768
  s_nop 2
  v_cvt_pk_bf16_f32 v144, v132, v133
  v_cvt_pk_bf16_f32 v145, v134, v135
  v_cvt_pk_bf16_f32 v146, v136, v137
  v_cvt_pk_bf16_f32 v147, v138, v139
  s_nop 0
  v_permlane16_swap_b32 v144, v146
  v_permlane16_swap_b32 v145, v147
  buffer_store_dwordx4 v[144:147], v130, s[32:35], s67 offen
  s_waitcnt lgkmcnt(1)
  v_lshlrev_b32 v132, 16, v176
  v_and_b32 v133, s76, v176
  v_lshlrev_b32 v134, 16, v177
  v_and_b32 v135, s76, v177
  v_lshlrev_b32 v136, 16, v178
  v_and_b32 v137, s76, v178
  v_lshlrev_b32 v138, 16, v179
  v_and_b32 v139, s76, v179
  s_waitcnt vmcnt(14)
  v_dot2_f32_bf16 v132, v180, s77, v132
  v_dot2_f32_bf16 v133, v180, s78, v133
  v_dot2_f32_bf16 v134, v181, s77, v134
  v_dot2_f32_bf16 v135, v181, s78, v135
  v_dot2_f32_bf16 v136, v182, s77, v136
  v_dot2_f32_bf16 v137, v182, s78, v137
  v_dot2_f32_bf16 v138, v183, s77, v138
  v_dot2_f32_bf16 v139, v183, s78, v139
  s_waitcnt vmcnt(13)
  v_dot2_f32_bf16 v132, v184, s77, v132
  v_dot2_f32_bf16 v133, v184, s78, v133
  v_dot2_f32_bf16 v134, v185, s77, v134
  v_dot2_f32_bf16 v135, v185, s78, v135
  v_dot2_f32_bf16 v136, v186, s77, v136
  v_dot2_f32_bf16 v137, v186, s78, v137
  v_dot2_f32_bf16 v138, v187, s77, v138
  v_dot2_f32_bf16 v139, v187, s78, v139
  s_waitcnt vmcnt(12)
  v_dot2_f32_bf16 v132, v188, s77, v132
  v_dot2_f32_bf16 v133, v188, s78, v133
  v_dot2_f32_bf16 v134, v189, s77, v134
  v_dot2_f32_bf16 v135, v189, s78, v135
  v_dot2_f32_bf16 v136, v190, s77, v136
  v_dot2_f32_bf16 v137, v190, s78, v137
  v_dot2_f32_bf16 v138, v191, s77, v138
  v_dot2_f32_bf16 v139, v191, s78, v139
  s_waitcnt vmcnt(11)
  v_dot2_f32_bf16 v132, v192, s77, v132
  v_dot2_f32_bf16 v133, v192, s78, v133
  v_dot2_f32_bf16 v134, v193, s77, v134
  v_dot2_f32_bf16 v135, v193, s78, v135
  v_dot2_f32_bf16 v136, v194, s77, v136
  v_dot2_f32_bf16 v137, v194, s78, v137
  v_dot2_f32_bf16 v138, v195, s77, v138
  v_dot2_f32_bf16 v139, v195, s78, v139
  s_waitcnt vmcnt(10)
  v_dot2_f32_bf16 v132, v196, s77, v132
  v_dot2_f32_bf16 v133, v196, s78, v133
  v_dot2_f32_bf16 v134, v197, s77, v134
  v_dot2_f32_bf16 v135, v197, s78, v135
  v_dot2_f32_bf16 v136, v198, s77, v136
  v_dot2_f32_bf16 v137, v198, s78, v137
  v_dot2_f32_bf16 v138, v199, s77, v138
  v_dot2_f32_bf16 v139, v199, s78, v139
  s_waitcnt vmcnt(9)
  v_dot2_f32_bf16 v132, v200, s77, v132
  v_dot2_f32_bf16 v133, v200, s78, v133
  v_dot2_f32_bf16 v134, v201, s77, v134
  v_dot2_f32_bf16 v135, v201, s78, v135
  v_dot2_f32_bf16 v136, v202, s77, v136
  v_dot2_f32_bf16 v137, v202, s78, v137
  v_dot2_f32_bf16 v138, v203, s77, v138
  v_dot2_f32_bf16 v139, v203, s78, v139
  s_waitcnt vmcnt(8)
  v_dot2_f32_bf16 v132, v204, s77, v132
  v_dot2_f32_bf16 v133, v204, s78, v133
  v_dot2_f32_bf16 v134, v205, s77, v134
  v_dot2_f32_bf16 v135, v205, s78, v135
  v_dot2_f32_bf16 v136, v206, s77, v136
  v_dot2_f32_bf16 v137, v206, s78, v137
  v_dot2_f32_bf16 v138, v207, s77, v138
  v_dot2_f32_bf16 v139, v207, s78, v139
  s_add_u32 s67, s75, 98304
  s_nop 2
  v_cvt_pk_bf16_f32 v176, v132, v133
  v_cvt_pk_bf16_f32 v177, v134, v135
  v_cvt_pk_bf16_f32 v178, v136, v137
  v_cvt_pk_bf16_f32 v179, v138, v139
  s_nop 0
  v_permlane16_swap_b32 v176, v178
  v_permlane16_swap_b32 v177, v179
  buffer_store_dwordx4 v[176:179], v130, s[32:35], s67 offen
  s_waitcnt lgkmcnt(0)
  v_lshlrev_b32 v132, 16, v208
  v_and_b32 v133, s76, v208
  v_lshlrev_b32 v134, 16, v209
  v_and_b32 v135, s76, v209
  v_lshlrev_b32 v136, 16, v210
  v_and_b32 v137, s76, v210
  v_lshlrev_b32 v138, 16, v211
  v_and_b32 v139, s76, v211
  s_waitcnt vmcnt(8)
  v_dot2_f32_bf16 v132, v212, s77, v132
  v_dot2_f32_bf16 v133, v212, s78, v133
  v_dot2_f32_bf16 v134, v213, s77, v134
  v_dot2_f32_bf16 v135, v213, s78, v135
  v_dot2_f32_bf16 v136, v214, s77, v136
  v_dot2_f32_bf16 v137, v214, s78, v137
  v_dot2_f32_bf16 v138, v215, s77, v138
  v_dot2_f32_bf16 v139, v215, s78, v139
  s_waitcnt vmcnt(7)
  v_dot2_f32_bf16 v132, v216, s77, v132
  v_dot2_f32_bf16 v133, v216, s78, v133
  v_dot2_f32_bf16 v134, v217, s77, v134
  v_dot2_f32_bf16 v135, v217, s78, v135
  v_dot2_f32_bf16 v136, v218, s77, v136
  v_dot2_f32_bf16 v137, v218, s78, v137
  v_dot2_f32_bf16 v138, v219, s77, v138
  v_dot2_f32_bf16 v139, v219, s78, v139
  s_waitcnt vmcnt(6)
  v_dot2_f32_bf16 v132, v220, s77, v132
  v_dot2_f32_bf16 v133, v220, s78, v133
  v_dot2_f32_bf16 v134, v221, s77, v134
  v_dot2_f32_bf16 v135, v221, s78, v135
  v_dot2_f32_bf16 v136, v222, s77, v136
  v_dot2_f32_bf16 v137, v222, s78, v137
  v_dot2_f32_bf16 v138, v223, s77, v138
  v_dot2_f32_bf16 v139, v223, s78, v139
  s_waitcnt vmcnt(5)
  v_dot2_f32_bf16 v132, v224, s77, v132
  v_dot2_f32_bf16 v133, v224, s78, v133
  v_dot2_f32_bf16 v134, v225, s77, v134
  v_dot2_f32_bf16 v135, v225, s78, v135
  v_dot2_f32_bf16 v136, v226, s77, v136
  v_dot2_f32_bf16 v137, v226, s78, v137
  v_dot2_f32_bf16 v138, v227, s77, v138
  v_dot2_f32_bf16 v139, v227, s78, v139
  s_waitcnt vmcnt(4)
  v_dot2_f32_bf16 v132, v228, s77, v132
  v_dot2_f32_bf16 v133, v228, s78, v133
  v_dot2_f32_bf16 v134, v229, s77, v134
  v_dot2_f32_bf16 v135, v229, s78, v135
  v_dot2_f32_bf16 v136, v230, s77, v136
  v_dot2_f32_bf16 v137, v230, s78, v137
  v_dot2_f32_bf16 v138, v231, s77, v138
  v_dot2_f32_bf16 v139, v231, s78, v139
  s_waitcnt vmcnt(3)
  v_dot2_f32_bf16 v132, v232, s77, v132
  v_dot2_f32_bf16 v133, v232, s78, v133
  v_dot2_f32_bf16 v134, v233, s77, v134
  v_dot2_f32_bf16 v135, v233, s78, v135
  v_dot2_f32_bf16 v136, v234, s77, v136
  v_dot2_f32_bf16 v137, v234, s78, v137
  v_dot2_f32_bf16 v138, v235, s77, v138
  v_dot2_f32_bf16 v139, v235, s78, v139
  s_waitcnt vmcnt(2)
  v_dot2_f32_bf16 v132, v236, s77, v132
  v_dot2_f32_bf16 v133, v236, s78, v133
  v_dot2_f32_bf16 v134, v237, s77, v134
  v_dot2_f32_bf16 v135, v237, s78, v135
  v_dot2_f32_bf16 v136, v238, s77, v136
  v_dot2_f32_bf16 v137, v238, s78, v137
  v_dot2_f32_bf16 v138, v239, s77, v138
  v_dot2_f32_bf16 v139, v239, s78, v139
  s_add_u32 s67, s75, 163840
  s_nop 2
  v_cvt_pk_bf16_f32 v208, v132, v133
  v_cvt_pk_bf16_f32 v209, v134, v135
  v_cvt_pk_bf16_f32 v210, v136, v137
  v_cvt_pk_bf16_f32 v211, v138, v139
  s_nop 0
  v_permlane16_swap_b32 v208, v210
  v_permlane16_swap_b32 v209, v211
  buffer_store_dwordx4 v[208:211], v130, s[32:35], s67 offen
L_done:
  s_endpgm
L_code_end:
.section .rodata,"a"
.p2align 6
.amdhsa_kernel concat_heads__gqa_block_cached__gqa_block_cached__near_ridge_kernel
  .amdhsa_next_free_vgpr 512
  .amdhsa_next_free_sgpr 102
  .amdhsa_accum_offset 256
  .amdhsa_group_segment_fixed_size 0
  .amdhsa_kernarg_size 104
  .amdhsa_user_sgpr_count 2
  .amdhsa_user_sgpr_kernarg_segment_ptr 1
  .amdhsa_system_sgpr_workgroup_id_x 1
.end_amdhsa_kernel
```
